```python
import torch

def _softmax(x, axis=-1):
    return torch.softmax(x, dim=axis)

def _gelu(x):
    return torch.nn.functional.gelu(x, approximate='tanh')

def _silu(x):
    return torch.nn.functional.silu(x)

def _sigmoid(x):
    return torch.sigmoid(x)

def _layernorm(x, axis=-1, eps=1e-05):
    m = x.mean(dim=axis, keepdim=True)
    v = x.var(dim=axis, keepdim=True, unbiased=False)
    return (x - m) / torch.sqrt(v + eps)

def _scatter_add(tgt, idx, src, axis=0):
    return tgt.clone().index_add_(axis, idx, src)

def _segment_sum(src, seg, n):
    out = torch.zeros((n,) + src.shape[1:], dtype=src.dtype)
    return out.index_add_(0, seg, src)

def _pad(x, pw):
    flat = tuple((v for pair in reversed(pw) for v in pair))
    return torch.nn.functional.pad(x, flat)
kernel_name = 'adaLN_cond__compressed_kv_cla__mixer_s_mlp__prompt'

def setup_inputs():

    _w = lambda a: (lambda t: t.to(torch.bfloat16) if t.is_floating_point() else t)(torch.as_tensor(a))

    def _A_setup():
        B, H, Sq, Sk, D, M = (1, 32, 2048, 2048, 128, 640)
        Dc = 4 * D
        return {'x': _w((lambda *s: torch.randn(*s, dtype=torch.bfloat16) * 0.05)(B, Sq, M)), 'c_kv': _w((lambda *s: torch.randn(*s, dtype=torch.bfloat16) * 1.6)(B, Sk, Dc)), 'w_q': _w((lambda *s: torch.randn(*s, dtype=torch.bfloat16) * 0.8)(M, H, D) * M ** (-0.5)), 'w_uk': _w((lambda *s: torch.randn(*s, dtype=torch.bfloat16) * 0.8)(Dc, H, D) * Dc ** (-0.5)), 'w_uv': _w((lambda *s: torch.randn(*s, dtype=torch.bfloat16) * 1.6)(Dc, H, D) * Dc ** (-0.5)), 'w_o': _w((lambda *s: torch.randn(*s, dtype=torch.bfloat16) * 1.6)(H, D, M) * (H * D) ** (-0.5))}
    _A_in = _A_setup()

    def _B_setup():
        B, S, D, F = (1, 2048, 640, 1728)
        return {'x': _w((lambda *s: torch.randn(*s, dtype=torch.bfloat16) * 0.05)(B, S, D)), 'w1': _w((lambda *s: torch.randn(*s, dtype=torch.bfloat16) * 3.2)(D, D) * D ** (-0.5)), 'w2': _w((lambda *s: torch.randn(*s, dtype=torch.bfloat16) * 3.2)(D, D) * D ** (-0.5)), 'w3': _w((lambda *s: torch.randn(*s, dtype=torch.bfloat16) * 3.2)(D, F) * D ** (-0.5)), 'w4': _w((lambda *s: torch.randn(*s, dtype=torch.bfloat16) * 3.2)(F, D) * F ** (-0.5))}
    _B_in = _B_setup()
    return {'A_x': _A_in['x'], 'A_c_kv': _A_in['c_kv'], 'A_w_q': _A_in['w_q'], 'A_w_uk': _A_in['w_uk'], 'A_w_uv': _A_in['w_uv'], 'A_w_o': _A_in['w_o'], 'B_x': _B_in['x'], 'B_w1': _B_in['w1'], 'B_w2': _B_in['w2'], 'B_w3': _B_in['w3'], 'B_w4': _B_in['w4'], 'c': _w((lambda *s: torch.randn(*s, dtype=torch.bfloat16) * 0.1)(1, 640) * 8.0), 'w_mod': _w((lambda *s: torch.randn(*s, dtype=torch.bfloat16) * 0.1)(640, 6 * 640) * 640 ** (-0.5) * 8.0)}

def reference(A_x, A_c_kv, A_w_q, A_w_uk, A_w_uv, A_w_o, B_x, B_w1, B_w2, B_w3, B_w4, c, w_mod):

    def _A_ref(x, c_kv, w_q, w_uk, w_uv, w_o):
        B, Sq, M = (x.shape[0], x.shape[1], x.shape[2])
        Sk = c_kv.shape[1]
        H, D = (w_q.shape[1], w_q.shape[2])
        q = torch.einsum('bqm,mhd->bhqd', x, w_q)
        k = torch.einsum('bkc,chd->bhkd', c_kv, w_uk)
        v = torch.einsum('bkc,chd->bhkd', c_kv, w_uv)
        scores = torch.einsum('bhqd,bhkd->bhqk', q, k) * D ** (-0.5)
        off = Sk - Sq
        qi = torch.arange(Sq)[:, None]
        kj = torch.arange(Sk)[None, :]
        cmask = kj <= qi + off
        scores = torch.where(cmask[None, None], scores, -1000000000.0)
        p = _softmax(scores, axis=-1)
        ctx = torch.einsum('bhqk,bhkd->bhqd', p, v)
        return torch.einsum('bhqd,hdm->bqm', ctx, w_o)

    def _B_ref(x, w1, w2, w3, w4):
        B, S, D = x.shape
        h = _gelu(_layernorm(x, axis=-1) @ w1)
        c = D // 4
        g0 = _pad(h[:, :, 0 * c:1 * c], ((0, 0), (1, 0), (0, 0)))[:, :S, :]
        g1 = _pad(h[:, :, 1 * c:2 * c], ((0, 0), (0, 1), (0, 0)))[:, 1:, :]
        g2 = _pad(h[:, :, 2 * c:3 * c], ((0, 0), (2, 0), (0, 0)))[:, :S, :]
        g3 = _pad(h[:, :, 3 * c:], ((0, 0), (0, 2), (0, 0)))[:, 2:, :]
        hs = torch.concatenate([g0, g1, g2, g3], axis=-1) @ w2
        x1 = x + hs
        h2 = _gelu(_layernorm(x1, axis=-1) @ w3) @ w4
        return x1 + h2
    x = A_x
    mod = (_silu(c) @ w_mod).reshape(c.shape[0], 6, 1, -1)
    sa, ca, ga, sb, cb, gb = (mod[:, 0].clone(), mod[:, 1].clone(), mod[:, 2].clone(), mod[:, 3].clone(), mod[:, 4].clone(), mod[:, 5].clone())
    h = _layernorm(x, axis=-1) * (1 + ca) + sa
    x = x + ga * _A_ref(h, A_c_kv, A_w_q, A_w_uk, A_w_uv, A_w_o)
    h = _layernorm(x, axis=-1) * (1 + cb) + sb
    x = x + gb * _B_ref(h, B_w1, B_w2, B_w3, B_w4)
    return x
```

```asm
; @launch kernel=ka_kernel grid=(256,1,1) block=(512,1,1) lds=163840
; @launch kernel=kb_kernel grid=(256,1,1) block=(512,1,1) lds=163840
.amdgcn_target "amdgcn-amd-amdhsa--gfx950"
.text
.globl ka_kernel
.p2align 8
.type ka_kernel,@function
ka_kernel:
  s_cmp_ge_u32 s2, 256
  s_cbranch_scc1 ka_end
  s_load_dwordx8 s[80:87], s[0:1], 0
  s_load_dwordx2 s[88:89], s[0:1], 32
  s_load_dwordx4 s[92:95], s[0:1], 88
  s_load_dwordx4 s[96:99], s[0:1], 112
  v_lshrrev_b32 v248, 6, v0
  v_and_b32 v247, 63, v0
  v_readfirstlane_b32 s18, v248
  v_lshlrev_b32 v245, 4, v247
  s_and_b32 s21, s2, 7
  s_lshr_b32 s22, s2, 3
  s_and_b32 s16, s22, 3
  s_lshl_b32 s23, s21, 2
  s_add_u32 s16, s16, s23
  s_lshr_b32 s17, s2, 5
  s_lshr_b32 s19, s18, 2
  s_and_b32 s20, s18, 3
  v_lshrrev_b32 v248, 3, v247
  s_lshl_b32 s21, s17, 8
  s_lshl_b32 s22, s18, 5
  s_add_u32 s21, s21, s22
  v_add_u32 v248, s21, v248
  v_lshlrev_b32 v248, 10, v248
  v_lshrrev_b32 v249, 4, v247
  v_xor_b32 v249, v249, v247
  v_and_b32 v249, 7, v249
  v_lshl_add_u32 v232, v249, 4, v248
  v_xor_b32 v233, 64, v232
  v_add_u32 v233, 7168, v233
  v_lshrrev_b32 v248, 4, v247
  s_and_b32 s21, s18, 1
  s_lshl_b32 s21, s21, 3
  v_lshlrev_b32 v249, 1, v248
  v_or_b32 v249, s21, v249
  v_xor_b32 v249, v249, v247
  v_and_b32 v249, 15, v249
  v_lshlrev_b32 v249, 4, v249
  v_lshl_add_u32 v248, v248, 13, v249
  s_lshl_b32 s21, s20, 16
  s_lshl_b32 s22, s16, 8
  s_add_u32 s21, s21, s22
  v_add_u32 v234, s21, v248
  v_add_u32 v235, 31744, v234
  s_lshl_b32 s28, s18, 12
  s_lshl_b32 s34, s18, 11
  s_waitcnt lgkmcnt(0)
  s_mov_b32 s68, s82
  s_and_b32 s69, s83, 0xffff
  s_mov_b32 s70, 0x200000
  s_mov_b32 s71, 0x20000
  s_cmp_lt_u32 s18, 4
  s_cselect_b32 s23, s86, s88
  s_cselect_b32 s24, s87, s89
  s_mov_b32 s72, s23
  s_and_b32 s73, s24, 0xffff
  s_mov_b32 s74, 0x400000
  s_mov_b32 s75, 0x20000
  s_mov_b32 s12, s98
  s_and_b32 s13, s99, 0xffff
  s_mov_b32 s14, 0x10000000
  s_mov_b32 s15, 0x20000
  s_mov_b32 s76, s96
  s_and_b32 s77, s97, 0xffff
  s_mov_b32 s78, 0x100
  s_mov_b32 s79, 0x20000
  s_sub_u32 s21, s2, 192
  s_cmp_lt_u32 s21, 60
  s_cbranch_scc1 ka_mod
  s_add_u32 m0, s34, 98304
  s_mov_b32 s35, 0
  buffer_load_dwordx4 v234, s[72:75], s35 offen lds
  buffer_load_dwordx4 v235, s[72:75], s35 offen offset:1024 lds
  s_add_u32 m0, s28, 32768
  s_mov_b32 s35, 0
  buffer_load_dwordx4 v232, s[68:71], s35 offen lds
  buffer_load_dwordx4 v233, s[68:71], s35 offen offset:1024 lds
  s_add_u32 m0, s28, 34816
  s_mov_b32 s35, 16384
  buffer_load_dwordx4 v232, s[68:71], s35 offen lds
  buffer_load_dwordx4 v233, s[68:71], s35 offen offset:1024 lds
  s_add_u32 m0, s34, 114688
  s_mov_b32 s35, 262144
  buffer_load_dwordx4 v234, s[72:75], s35 offen lds
  buffer_load_dwordx4 v235, s[72:75], s35 offen offset:1024 lds
  s_branch ka_nomod
ka_mod:
  s_mov_b32 s31, s21
  s_mov_b32 s4, s94
  s_and_b32 s5, s95, 0xffff
  s_mov_b32 s6, 0x4b0000
  s_mov_b32 s7, 0x20000
  s_mov_b32 s8, s92
  s_and_b32 s9, s93, 0xffff
  s_mov_b32 s10, 0x500
  s_mov_b32 s11, 0x20000
  v_lshrrev_b32 v60, 3, v0
  v_mul_u32_u24 v61, 7680, v60
  v_and_b32 v62, 7, v0
  v_lshl_add_u32 v61, v62, 4, v61
  s_lshl_b32 s22, s31, 7
  v_add_u32 v61, s22, v61
  v_lshlrev_b32 v60, 1, v60
  buffer_load_ushort v44, v60, s[8:11], 0 offen offset:0
  buffer_load_ushort v45, v60, s[8:11], 0 offen offset:128
  buffer_load_ushort v46, v60, s[8:11], 0 offen offset:256
  buffer_load_ushort v47, v60, s[8:11], 0 offen offset:384
  buffer_load_ushort v48, v60, s[8:11], 0 offen offset:512
  buffer_load_ushort v49, v60, s[8:11], 0 offen offset:640
  buffer_load_ushort v50, v60, s[8:11], 0 offen offset:768
  buffer_load_ushort v51, v60, s[8:11], 0 offen offset:896
  buffer_load_ushort v52, v60, s[8:11], 0 offen offset:1024
  buffer_load_ushort v53, v60, s[8:11], 0 offen offset:1152
  s_mov_b32 s35, 0
  buffer_load_dwordx4 v[4:7], v61, s[4:7], s35 offen
  s_mov_b32 s35, 491520
  buffer_load_dwordx4 v[8:11], v61, s[4:7], s35 offen
  s_mov_b32 s35, 983040
  buffer_load_dwordx4 v[12:15], v61, s[4:7], s35 offen
  s_mov_b32 s35, 1474560
  buffer_load_dwordx4 v[16:19], v61, s[4:7], s35 offen
  s_mov_b32 s35, 1966080
  buffer_load_dwordx4 v[20:23], v61, s[4:7], s35 offen
  s_mov_b32 s35, 2457600
  buffer_load_dwordx4 v[24:27], v61, s[4:7], s35 offen
  s_mov_b32 s35, 2949120
  buffer_load_dwordx4 v[28:31], v61, s[4:7], s35 offen
  s_mov_b32 s35, 3440640
  buffer_load_dwordx4 v[32:35], v61, s[4:7], s35 offen
  s_mov_b32 s35, 3932160
  buffer_load_dwordx4 v[36:39], v61, s[4:7], s35 offen
  s_mov_b32 s35, 4423680
  buffer_load_dwordx4 v[40:43], v61, s[4:7], s35 offen
  s_waitcnt vmcnt(10)
  v_lshlrev_b32 v44, 16, v44
  v_mul_f32 v80, 0xbfb8aa3b, v44
  v_lshlrev_b32 v45, 16, v45
  v_mul_f32 v81, 0xbfb8aa3b, v45
  v_lshlrev_b32 v46, 16, v46
  v_mul_f32 v82, 0xbfb8aa3b, v46
  v_lshlrev_b32 v47, 16, v47
  v_mul_f32 v83, 0xbfb8aa3b, v47
  v_lshlrev_b32 v48, 16, v48
  v_mul_f32 v84, 0xbfb8aa3b, v48
  v_lshlrev_b32 v49, 16, v49
  v_mul_f32 v85, 0xbfb8aa3b, v49
  v_lshlrev_b32 v50, 16, v50
  v_mul_f32 v86, 0xbfb8aa3b, v50
  v_lshlrev_b32 v51, 16, v51
  v_mul_f32 v87, 0xbfb8aa3b, v51
  v_lshlrev_b32 v52, 16, v52
  v_mul_f32 v88, 0xbfb8aa3b, v52
  v_lshlrev_b32 v53, 16, v53
  v_mul_f32 v89, 0xbfb8aa3b, v53
  v_exp_f32 v80, v80
  v_exp_f32 v81, v81
  v_exp_f32 v82, v82
  v_exp_f32 v83, v83
  v_exp_f32 v84, v84
  v_exp_f32 v85, v85
  v_exp_f32 v86, v86
  v_exp_f32 v87, v87
  v_exp_f32 v88, v88
  v_exp_f32 v89, v89
  v_add_f32 v80, 1.0, v80
  v_add_f32 v81, 1.0, v81
  v_add_f32 v82, 1.0, v82
  v_add_f32 v83, 1.0, v83
  v_add_f32 v84, 1.0, v84
  v_add_f32 v85, 1.0, v85
  v_add_f32 v86, 1.0, v86
  v_add_f32 v87, 1.0, v87
  v_add_f32 v88, 1.0, v88
  v_add_f32 v89, 1.0, v89
  v_rcp_f32 v80, v80
  v_rcp_f32 v81, v81
  v_rcp_f32 v82, v82
  v_rcp_f32 v83, v83
  v_rcp_f32 v84, v84
  v_rcp_f32 v85, v85
  v_rcp_f32 v86, v86
  v_rcp_f32 v87, v87
  v_rcp_f32 v88, v88
  v_rcp_f32 v89, v89
  v_mul_f32 v44, v44, v80
  v_mul_f32 v45, v45, v81
  v_mul_f32 v46, v46, v82
  v_mul_f32 v47, v47, v83
  v_mul_f32 v48, v48, v84
  v_mul_f32 v49, v49, v85
  v_mul_f32 v50, v50, v86
  v_mul_f32 v51, v51, v87
  v_mul_f32 v52, v52, v88
  v_mul_f32 v53, v53, v89
  v_cvt_pk_bf16_f32 v44, v44, v44
  v_cvt_pk_bf16_f32 v45, v45, v45
  v_cvt_pk_bf16_f32 v46, v46, v46
  v_cvt_pk_bf16_f32 v47, v47, v47
  v_cvt_pk_bf16_f32 v48, v48, v48
  v_cvt_pk_bf16_f32 v49, v49, v49
  v_cvt_pk_bf16_f32 v50, v50, v50
  v_cvt_pk_bf16_f32 v51, v51, v51
  v_cvt_pk_bf16_f32 v52, v52, v52
  v_cvt_pk_bf16_f32 v53, v53, v53
  v_lshlrev_b32 v44, 16, v44
  v_lshlrev_b32 v45, 16, v45
  v_lshlrev_b32 v46, 16, v46
  v_lshlrev_b32 v47, 16, v47
  v_lshlrev_b32 v48, 16, v48
  v_lshlrev_b32 v49, 16, v49
  v_lshlrev_b32 v50, 16, v50
  v_lshlrev_b32 v51, 16, v51
  v_lshlrev_b32 v52, 16, v52
  v_lshlrev_b32 v53, 16, v53
  s_waitcnt vmcnt(9)
  v_lshlrev_b32 v248, 16, v4
  v_and_b32 v249, 0xffff0000, v4
  v_mul_f32 v64, v248, v44
  v_mul_f32 v65, v249, v44
  v_lshlrev_b32 v248, 16, v5
  v_and_b32 v249, 0xffff0000, v5
  v_mul_f32 v66, v248, v44
  v_mul_f32 v67, v249, v44
  v_lshlrev_b32 v248, 16, v6
  v_and_b32 v249, 0xffff0000, v6
  v_mul_f32 v68, v248, v44
  v_mul_f32 v69, v249, v44
  v_lshlrev_b32 v248, 16, v7
  v_and_b32 v249, 0xffff0000, v7
  v_mul_f32 v70, v248, v44
  v_mul_f32 v71, v249, v44
  s_waitcnt vmcnt(8)
  v_lshlrev_b32 v248, 16, v8
  v_and_b32 v249, 0xffff0000, v8
  v_fmac_f32 v64, v248, v45
  v_fmac_f32 v65, v249, v45
  v_lshlrev_b32 v248, 16, v9
  v_and_b32 v249, 0xffff0000, v9
  v_fmac_f32 v66, v248, v45
  v_fmac_f32 v67, v249, v45
  v_lshlrev_b32 v248, 16, v10
  v_and_b32 v249, 0xffff0000, v10
  v_fmac_f32 v68, v248, v45
  v_fmac_f32 v69, v249, v45
  v_lshlrev_b32 v248, 16, v11
  v_and_b32 v249, 0xffff0000, v11
  v_fmac_f32 v70, v248, v45
  v_fmac_f32 v71, v249, v45
  s_waitcnt vmcnt(7)
  v_lshlrev_b32 v248, 16, v12
  v_and_b32 v249, 0xffff0000, v12
  v_fmac_f32 v64, v248, v46
  v_fmac_f32 v65, v249, v46
  v_lshlrev_b32 v248, 16, v13
  v_and_b32 v249, 0xffff0000, v13
  v_fmac_f32 v66, v248, v46
  v_fmac_f32 v67, v249, v46
  v_lshlrev_b32 v248, 16, v14
  v_and_b32 v249, 0xffff0000, v14
  v_fmac_f32 v68, v248, v46
  v_fmac_f32 v69, v249, v46
  v_lshlrev_b32 v248, 16, v15
  v_and_b32 v249, 0xffff0000, v15
  v_fmac_f32 v70, v248, v46
  v_fmac_f32 v71, v249, v46
  s_waitcnt vmcnt(6)
  v_lshlrev_b32 v248, 16, v16
  v_and_b32 v249, 0xffff0000, v16
  v_fmac_f32 v64, v248, v47
  v_fmac_f32 v65, v249, v47
  v_lshlrev_b32 v248, 16, v17
  v_and_b32 v249, 0xffff0000, v17
  v_fmac_f32 v66, v248, v47
  v_fmac_f32 v67, v249, v47
  v_lshlrev_b32 v248, 16, v18
  v_and_b32 v249, 0xffff0000, v18
  v_fmac_f32 v68, v248, v47
  v_fmac_f32 v69, v249, v47
  v_lshlrev_b32 v248, 16, v19
  v_and_b32 v249, 0xffff0000, v19
  v_fmac_f32 v70, v248, v47
  v_fmac_f32 v71, v249, v47
  s_waitcnt vmcnt(5)
  v_lshlrev_b32 v248, 16, v20
  v_and_b32 v249, 0xffff0000, v20
  v_fmac_f32 v64, v248, v48
  v_fmac_f32 v65, v249, v48
  v_lshlrev_b32 v248, 16, v21
  v_and_b32 v249, 0xffff0000, v21
  v_fmac_f32 v66, v248, v48
  v_fmac_f32 v67, v249, v48
  v_lshlrev_b32 v248, 16, v22
  v_and_b32 v249, 0xffff0000, v22
  v_fmac_f32 v68, v248, v48
  v_fmac_f32 v69, v249, v48
  v_lshlrev_b32 v248, 16, v23
  v_and_b32 v249, 0xffff0000, v23
  v_fmac_f32 v70, v248, v48
  v_fmac_f32 v71, v249, v48
  s_add_u32 m0, s34, 98304
  s_mov_b32 s35, 0
  buffer_load_dwordx4 v234, s[72:75], s35 offen lds
  buffer_load_dwordx4 v235, s[72:75], s35 offen offset:1024 lds
  s_add_u32 m0, s28, 32768
  s_mov_b32 s35, 0
  buffer_load_dwordx4 v232, s[68:71], s35 offen lds
  buffer_load_dwordx4 v233, s[68:71], s35 offen offset:1024 lds
  s_add_u32 m0, s28, 34816
  s_mov_b32 s35, 16384
  buffer_load_dwordx4 v232, s[68:71], s35 offen lds
  buffer_load_dwordx4 v233, s[68:71], s35 offen offset:1024 lds
  s_add_u32 m0, s34, 114688
  s_mov_b32 s35, 262144
  buffer_load_dwordx4 v234, s[72:75], s35 offen lds
  buffer_load_dwordx4 v235, s[72:75], s35 offen offset:1024 lds
  s_waitcnt vmcnt(12)
  v_lshlrev_b32 v248, 16, v24
  v_and_b32 v249, 0xffff0000, v24
  v_fmac_f32 v64, v248, v49
  v_fmac_f32 v65, v249, v49
  v_lshlrev_b32 v248, 16, v25
  v_and_b32 v249, 0xffff0000, v25
  v_fmac_f32 v66, v248, v49
  v_fmac_f32 v67, v249, v49
  v_lshlrev_b32 v248, 16, v26
  v_and_b32 v249, 0xffff0000, v26
  v_fmac_f32 v68, v248, v49
  v_fmac_f32 v69, v249, v49
  v_lshlrev_b32 v248, 16, v27
  v_and_b32 v249, 0xffff0000, v27
  v_fmac_f32 v70, v248, v49
  v_fmac_f32 v71, v249, v49
  s_waitcnt vmcnt(11)
  v_lshlrev_b32 v248, 16, v28
  v_and_b32 v249, 0xffff0000, v28
  v_fmac_f32 v64, v248, v50
  v_fmac_f32 v65, v249, v50
  v_lshlrev_b32 v248, 16, v29
  v_and_b32 v249, 0xffff0000, v29
  v_fmac_f32 v66, v248, v50
  v_fmac_f32 v67, v249, v50
  v_lshlrev_b32 v248, 16, v30
  v_and_b32 v249, 0xffff0000, v30
  v_fmac_f32 v68, v248, v50
  v_fmac_f32 v69, v249, v50
  v_lshlrev_b32 v248, 16, v31
  v_and_b32 v249, 0xffff0000, v31
  v_fmac_f32 v70, v248, v50
  v_fmac_f32 v71, v249, v50
  s_waitcnt vmcnt(10)
  v_lshlrev_b32 v248, 16, v32
  v_and_b32 v249, 0xffff0000, v32
  v_fmac_f32 v64, v248, v51
  v_fmac_f32 v65, v249, v51
  v_lshlrev_b32 v248, 16, v33
  v_and_b32 v249, 0xffff0000, v33
  v_fmac_f32 v66, v248, v51
  v_fmac_f32 v67, v249, v51
  v_lshlrev_b32 v248, 16, v34
  v_and_b32 v249, 0xffff0000, v34
  v_fmac_f32 v68, v248, v51
  v_fmac_f32 v69, v249, v51
  v_lshlrev_b32 v248, 16, v35
  v_and_b32 v249, 0xffff0000, v35
  v_fmac_f32 v70, v248, v51
  v_fmac_f32 v71, v249, v51
  s_waitcnt vmcnt(9)
  v_lshlrev_b32 v248, 16, v36
  v_and_b32 v249, 0xffff0000, v36
  v_fmac_f32 v64, v248, v52
  v_fmac_f32 v65, v249, v52
  v_lshlrev_b32 v248, 16, v37
  v_and_b32 v249, 0xffff0000, v37
  v_fmac_f32 v66, v248, v52
  v_fmac_f32 v67, v249, v52
  v_lshlrev_b32 v248, 16, v38
  v_and_b32 v249, 0xffff0000, v38
  v_fmac_f32 v68, v248, v52
  v_fmac_f32 v69, v249, v52
  v_lshlrev_b32 v248, 16, v39
  v_and_b32 v249, 0xffff0000, v39
  v_fmac_f32 v70, v248, v52
  v_fmac_f32 v71, v249, v52
  s_waitcnt vmcnt(8)
  v_lshlrev_b32 v248, 16, v40
  v_and_b32 v249, 0xffff0000, v40
  v_fmac_f32 v64, v248, v53
  v_fmac_f32 v65, v249, v53
  v_lshlrev_b32 v248, 16, v41
  v_and_b32 v249, 0xffff0000, v41
  v_fmac_f32 v66, v248, v53
  v_fmac_f32 v67, v249, v53
  v_lshlrev_b32 v248, 16, v42
  v_and_b32 v249, 0xffff0000, v42
  v_fmac_f32 v68, v248, v53
  v_fmac_f32 v69, v249, v53
  v_lshlrev_b32 v248, 16, v43
  v_and_b32 v249, 0xffff0000, v43
  v_fmac_f32 v70, v248, v53
  v_fmac_f32 v71, v249, v53
  v_add_f32_dpp v64, v64, v64 row_ror:8 row_mask:0xf bank_mask:0xf
  v_add_f32_dpp v65, v65, v65 row_ror:8 row_mask:0xf bank_mask:0xf
  v_add_f32_dpp v66, v66, v66 row_ror:8 row_mask:0xf bank_mask:0xf
  v_add_f32_dpp v67, v67, v67 row_ror:8 row_mask:0xf bank_mask:0xf
  v_add_f32_dpp v68, v68, v68 row_ror:8 row_mask:0xf bank_mask:0xf
  v_add_f32_dpp v69, v69, v69 row_ror:8 row_mask:0xf bank_mask:0xf
  v_add_f32_dpp v70, v70, v70 row_ror:8 row_mask:0xf bank_mask:0xf
  v_add_f32_dpp v71, v71, v71 row_ror:8 row_mask:0xf bank_mask:0xf
  v_permlane16_swap_b32 v64, v65
  v_permlane16_swap_b32 v66, v67
  v_add_f32 v64, v64, v65
  v_add_f32 v66, v66, v67
  s_nop 1
  v_permlane32_swap_b32 v64, v66
  v_add_f32 v64, v64, v66
  v_permlane16_swap_b32 v68, v69
  v_permlane16_swap_b32 v70, v71
  v_add_f32 v68, v68, v69
  v_add_f32 v70, v70, v71
  s_nop 1
  v_permlane32_swap_b32 v68, v70
  v_add_f32 v68, v68, v70
  v_and_b32 v60, 7, v247
  v_lshrrev_b32 v61, 4, v247
  v_lshl_add_u32 v60, v60, 3, v61
  v_lshlrev_b32 v60, 2, v60
  s_lshl_b32 s21, s18, 8
  s_add_u32 s21, s21, 147456
  v_add_u32 v60, s21, v60
  ds_write_b32 v60, v64
  ds_write_b32 v60, v68 offset:16
  s_waitcnt lgkmcnt(0)
  s_barrier
  s_cmp_lg_u32 s18, 0
  s_cbranch_scc1 ka_nomod
  v_lshlrev_b32 v60, 2, v247
  v_add_u32 v61, 147456, v60
  ds_read_b32 v64, v61 offset:0
  ds_read_b32 v65, v61 offset:256
  ds_read_b32 v66, v61 offset:512
  ds_read_b32 v67, v61 offset:768
  ds_read_b32 v68, v61 offset:1024
  ds_read_b32 v69, v61 offset:1280
  ds_read_b32 v70, v61 offset:1536
  ds_read_b32 v71, v61 offset:1792
  s_waitcnt lgkmcnt(0)
  v_add_f32 v64, v64, v65
  v_add_f32 v64, v64, v66
  v_add_f32 v64, v64, v67
  v_add_f32 v64, v64, v68
  v_add_f32 v64, v64, v69
  v_add_f32 v64, v64, v70
  v_add_f32 v64, v64, v71
  v_cvt_pk_bf16_f32 v64, v64, v64
  v_lshlrev_b32 v64, 16, v64
  s_mul_i32 s32, s31, 6554
  s_lshr_b32 s32, s32, 16
  s_cmp_eq_u32 s32, 1
  s_cselect_b32 s21, 1.0, 0
  s_cmp_eq_u32 s32, 4
  s_cselect_b32 s21, 1.0, s21
  v_add_f32 v64, s21, v64
  v_cvt_pk_bf16_f32 v65, v64, v64
  v_lshlrev_b32 v64, 16, v65
  s_lshl_b32 s21, s31, 8
  buffer_store_dword v64, v60, s[12:15], s21 offen sc1
  s_mul_i32 s22, s32, 10
  s_sub_u32 s22, s31, s22
  s_lshl_b32 s23, s22, 11
  s_add_u32 s23, s23, 0x8000
  v_and_b32 v60, 32, v247
  v_lshlrev_b32 v60, 5, v60
  v_and_b32 v61, 12, v247
  v_lshl_add_u32 v60, v61, 6, v60
  v_and_b32 v61, 16, v247
  v_lshrrev_b32 v61, 1, v61
  v_add_u32 v60, v60, v61
  v_and_b32 v61, 3, v247
  v_lshl_add_u32 v60, v61, 1, v60
  v_add_u32 v60, s23, v60
  s_mov_b32 s22, 0x40000000
  s_cmp_eq_u32 s32, 4
  s_cselect_b32 s21, 0, s22
  s_cmp_eq_u32 s32, 3
  s_cselect_b32 s21, 16, s21
  s_cselect_b32 s22, 32, s22
  v_mov_b32 v67, 0x3f80
  v_add_u32 v61, s21, v60
  v_add_u32 v62, s22, v60
  buffer_store_short v65, v61, s[12:15], 0 offen sc1
  buffer_store_short v67, v62, s[12:15], 0 offen sc1
  s_mul_i32 s21, s31, 5120
  s_add_u32 s21, s21, 0xe0000
  s_cmp_lt_u32 s31, 20
  s_cselect_b32 s21, s21, 0x40000000
  v_add_u32 v60, s21, v245
  v_mov_b32 v4, 0
  v_mov_b32 v5, 0
  v_mov_b32 v6, 0
  v_mov_b32 v7, 0
  buffer_store_dwordx4 v[4:7], v60, s[12:15], 0 offen offset:0 sc1
  buffer_store_dwordx4 v[4:7], v60, s[12:15], 0 offen offset:1024 sc1
  buffer_store_dwordx4 v[4:7], v60, s[12:15], 0 offen offset:2048 sc1
  buffer_store_dwordx4 v[4:7], v60, s[12:15], 0 offen offset:3072 sc1
  v_add_u32 v60, 4096, v60
  buffer_store_dwordx4 v[4:7], v60, s[12:15], 0 offen sc1
  s_waitcnt vmcnt(0)
  s_cmp_lg_u32 s18, 0
  s_cbranch_scc1 ka_kernel_nofl_1
  v_mov_b32 v248, 1
  v_mov_b32 v249, s2
  s_mov_b64 exec, 1
  buffer_store_byte v248, v249, s[76:79], 0 offen sc1
  s_mov_b64 exec, -1
ka_kernel_nofl_1:
ka_nomod:
  s_and_b32 s22, s2, 0x38
  s_add_u32 s22, s22, s18
  s_getpc_b64 s[4:5]
ka_kernel_pc_2:
  s_add_u32 s4, s4, ka_cp0-ka_kernel_pc_2
  s_addc_u32 s5, s5, 0
  s_lshl_b32 s21, s22, 10
  v_add_u32 v248, s21, v245
  v_min_u32 v249, ka_done-ka_cp0-16, v248
  global_load_dwordx4 v[200:203], v249, s[4:5]
  s_mov_b32 s4, s80
  s_and_b32 s5, s81, 0xffff
  s_mov_b32 s6, 0x280000
  s_mov_b32 s7, 0x20000
ka_cp0:
  s_getreg_b32 s100, hwreg(HW_REG_XCC_ID)
  s_and_b32 s100, s100, 15
  s_add_u32 s100, s100, 1
  s_mov_b32 s8, s84
  s_and_b32 s9, s85, 0xffff
  s_mov_b32 s10, 0x500000
  s_mov_b32 s11, 0x20000
  s_sub_u32 s22, 15, s17
  s_bitcmp1_b32 s2, 4
  s_cselect_b32 s21, s22, s17
  s_lshl_b32 s21, s21, 4
  s_and_b32 s23, s2, 15
  s_add_u32 s21, s21, s23
  s_lshl_b32 s21, s21, 3
  s_lshl_b32 s26, s22, 1
  s_add_u32 s26, s26, 2
  s_cmp_eq_u32 s19, 0
  s_cselect_b32 s32, s22, s17
  s_lshl_b32 s31, s32, 2
  s_add_u32 s31, s31, s20
  s_mul_i32 s22, s21, 1280
  s_mul_i32 s23, s18, 10
  v_lshrrev_b32 v255, 3, v247
  v_add_u32 v255, s23, v255
  v_and_b32 v250, 7, v247
  v_mul_u32_u24 v248, 1280, v250
  v_lshl_add_u32 v248, v255, 4, v248
  v_cmp_gt_u32 vcc, 16, v247
  v_mov_b32 v249, 0x40000000
  s_nop 0
  v_cndmask_b32 v251, v249, v248, vcc
  buffer_load_dwordx4 v[192:195], v248, s[4:7], s22 offen
  buffer_load_dwordx4 v[196:199], v251, s[4:7], s22 offen offset:128
  s_lshr_b32 s22, s21, 4
  s_mul_i32 s22, s22, 20480
  s_and_b32 s23, s21, 15
  s_lshl_b32 s23, s23, 4
  s_add_u32 s22, s22, s23
  s_add_u32 s22, s22, 0x100000
  v_lshlrev_b32 v253, 8, v255
  v_lshl_add_u32 v253, v250, 4, v253
  v_add_u32 v253, s22, v253
  v_cndmask_b32 v254, v249, v253, vcc
  v_lshlrev_b32 v255, 5, v255
  v_and_b32 v248, 15, v247
  v_lshrrev_b32 v249, 1, v248
  v_lshrrev_b32 v250, 4, v247
  v_xor_b32 v249, v249, v250
  v_lshlrev_b32 v249, 4, v249
  v_lshl_add_u32 v248, v248, 7, v249
  s_and_b32 s21, s18, 2
  s_lshl_b32 s21, s21, 13
  v_add_u32 v236, s21, v248
  v_add_u32 v237, 65536, v236
  v_xor_b32 v238, 64, v236
  v_xor_b32 v239, 64, v237
  s_and_b32 s21, s18, 1
  s_lshl_b32 s21, s21, 2
  v_lshrrev_b32 v248, 2, v247
  v_and_b32 v248, 3, v248
  v_lshrrev_b32 v250, 4, v247
  v_and_b32 v240, 1, v250
  v_lshl_add_u32 v240, v240, 2, v248
  v_xor_b32 v240, s21, v240
  v_lshlrev_b32 v240, 5, v240
  v_lshl_add_u32 v240, v248, 8, v240
  v_lshl_add_u32 v240, v250, 11, v240
  v_and_b32 v248, 3, v247
  v_lshl_add_u32 v240, v248, 3, v240
  s_lshl_b32 s21, s19, 13
  s_add_u32 s21, s21, 98304
  v_add_u32 v240, s21, v240
  v_xor_b32 v241, 32, v240
  v_xor_b32 v242, 64, v240
  v_xor_b32 v243, 96, v240
  s_lshl_b32 s25, s16, 20
  s_add_u32 s25, s25, 0x400000
  s_lshl_b32 s21, s17, 17
  s_and_b32 s22, s18, 2
  s_lshl_b32 s22, s22, 15
  s_add_u32 s21, s21, s22
  s_add_u32 s21, s21, s25
  s_and_b32 s22, s18, 1
  s_lshl_b32 s23, s22, 11
  s_lshl_b32 s24, s22, 12
  s_add_u32 s24, s24, 8192
  s_cmp_lt_u32 s18, 4
  s_cselect_b32 s23, s23, s24
  s_movk_i32 s24, 2048
  s_cselect_b32 s24, 4096, s24
  s_add_u32 s21, s21, s23
  v_add_u32 v244, s21, v245
  v_add_u32 v246, s24, v244
  s_cmp_ge_u32 s18, 4
  s_cbranch_scc1 ka_vpath
  s_waitcnt vmcnt(5)
  s_barrier
  ds_read_b64_tr_b16 v[160:161], v240 offset:0
  ds_read_b64_tr_b16 v[162:163], v240 offset:1024
  ds_read_b64_tr_b16 v[164:165], v241 offset:0
  ds_read_b64_tr_b16 v[166:167], v241 offset:1024
  ds_read_b64_tr_b16 v[168:169], v242 offset:0
  ds_read_b64_tr_b16 v[170:171], v242 offset:1024
  ds_read_b64_tr_b16 v[172:173], v243 offset:0
  ds_read_b64_tr_b16 v[174:175], v243 offset:1024
  ds_read_b128 v[128:131], v236 offset:32768
  ds_read_b128 v[132:135], v236 offset:34816
  ds_read_b128 v[136:139], v236 offset:36864
  ds_read_b128 v[140:143], v236 offset:38912
  ds_read_b128 v[144:147], v236 offset:40960
  ds_read_b128 v[148:151], v236 offset:43008
  ds_read_b128 v[152:155], v236 offset:45056
  ds_read_b128 v[156:159], v236 offset:47104
  s_add_u32 m0, s28, 65536
  s_mov_b32 s35, 128
  buffer_load_dwordx4 v232, s[68:71], s35 offen lds
  buffer_load_dwordx4 v233, s[68:71], s35 offen offset:1024 lds
  s_add_u32 m0, s28, 67584
  s_mov_b32 s35, 16512
  buffer_load_dwordx4 v232, s[68:71], s35 offen lds
  buffer_load_dwordx4 v233, s[68:71], s35 offen offset:1024 lds
  s_add_u32 m0, s34, 131072
  s_mov_b32 s35, 524288
  buffer_load_dwordx4 v234, s[72:75], s35 offen lds
  buffer_load_dwordx4 v235, s[72:75], s35 offen offset:1024 lds
  s_waitcnt lgkmcnt(7)
  v_mfma_f32_16x16x32_bf16 v[0:3], v[160:163], v[128:131], 0
  v_mfma_f32_16x16x32_bf16 v[4:7], v[164:167], v[128:131], 0
  v_mfma_f32_16x16x32_bf16 v[8:11], v[168:171], v[128:131], 0
  v_mfma_f32_16x16x32_bf16 v[12:15], v[172:175], v[128:131], 0
  s_waitcnt lgkmcnt(0)
  v_mfma_f32_16x16x32_bf16 v[28:31], v[172:175], v[132:135], 0
  v_mfma_f32_16x16x32_bf16 v[24:27], v[168:171], v[132:135], 0
  s_waitcnt vmcnt(9)
  s_barrier
  v_mfma_f32_16x16x32_bf16 v[20:23], v[164:167], v[132:135], 0
  v_mfma_f32_16x16x32_bf16 v[16:19], v[160:163], v[132:135], 0
  v_mfma_f32_16x16x32_bf16 v[32:35], v[160:163], v[136:139], 0
  ds_read_b64_tr_b16 v[176:177], v240 offset:16384
  s_add_u32 m0, s34, 98304
  s_mov_b32 s35, 786432
  buffer_load_dwordx4 v234, s[72:75], s35 offen lds
  v_mfma_f32_16x16x32_bf16 v[36:39], v[164:167], v[136:139], 0
  ds_read_b64_tr_b16 v[178:179], v240 offset:17408
  buffer_load_dwordx4 v235, s[72:75], s35 offen offset:1024 lds
  v_mfma_f32_16x16x32_bf16 v[40:43], v[168:171], v[136:139], 0
  ds_read_b64_tr_b16 v[180:181], v241 offset:16384
  v_mfma_f32_16x16x32_bf16 v[44:47], v[172:175], v[136:139], 0
  ds_read_b64_tr_b16 v[182:183], v241 offset:17408
  s_add_u32 m0, s28, 0
  s_mov_b32 s35, 256
  buffer_load_dwordx4 v232, s[68:71], s35 offen lds
  v_mfma_f32_16x16x32_bf16 v[60:63], v[172:175], v[140:143], 0
  ds_read_b64_tr_b16 v[184:185], v242 offset:16384
  v_mfma_f32_16x16x32_bf16 v[56:59], v[168:171], v[140:143], 0
  ds_read_b64_tr_b16 v[186:187], v242 offset:17408
  buffer_load_dwordx4 v233, s[68:71], s35 offen offset:1024 lds
  v_mfma_f32_16x16x32_bf16 v[52:55], v[164:167], v[140:143], 0
  ds_read_b64_tr_b16 v[188:189], v243 offset:16384
  v_mfma_f32_16x16x32_bf16 v[48:51], v[160:163], v[140:143], 0
  ds_read_b64_tr_b16 v[190:191], v243 offset:17408
  s_add_u32 m0, s28, 2048
  s_mov_b32 s35, 16640
  buffer_load_dwordx4 v232, s[68:71], s35 offen lds
  v_mfma_f32_16x16x32_bf16 v[64:67], v[160:163], v[144:147], 0
  ds_read_b128 v[128:131], v238 offset:32768
  v_mfma_f32_16x16x32_bf16 v[68:71], v[164:167], v[144:147], 0
  ds_read_b128 v[132:135], v238 offset:34816
  buffer_load_dwordx4 v233, s[68:71], s35 offen offset:1024 lds
  v_mfma_f32_16x16x32_bf16 v[72:75], v[168:171], v[144:147], 0
  ds_read_b128 v[136:139], v238 offset:36864
  v_mfma_f32_16x16x32_bf16 v[76:79], v[172:175], v[144:147], 0
  ds_read_b128 v[140:143], v238 offset:38912
  v_mfma_f32_16x16x32_bf16 v[92:95], v[172:175], v[148:151], 0
  ds_read_b128 v[144:147], v238 offset:40960
  v_mfma_f32_16x16x32_bf16 v[88:91], v[168:171], v[148:151], 0
  v_mfma_f32_16x16x32_bf16 v[84:87], v[164:167], v[148:151], 0
  v_mfma_f32_16x16x32_bf16 v[80:83], v[160:163], v[148:151], 0
  v_mfma_f32_16x16x32_bf16 v[96:99], v[160:163], v[152:155], 0
  ds_read_b128 v[148:151], v238 offset:43008
  v_mfma_f32_16x16x32_bf16 v[100:103], v[164:167], v[152:155], 0
  v_mfma_f32_16x16x32_bf16 v[104:107], v[168:171], v[152:155], 0
  v_mfma_f32_16x16x32_bf16 v[108:111], v[172:175], v[152:155], 0
  v_mfma_f32_16x16x32_bf16 v[124:127], v[172:175], v[156:159], 0
  ds_read_b128 v[152:155], v238 offset:45056
  v_mfma_f32_16x16x32_bf16 v[120:123], v[168:171], v[156:159], 0
  v_mfma_f32_16x16x32_bf16 v[116:119], v[164:167], v[156:159], 0
  v_mfma_f32_16x16x32_bf16 v[112:115], v[160:163], v[156:159], 0
  ds_read_b128 v[156:159], v238 offset:47104
  s_waitcnt lgkmcnt(7)
  v_mfma_f32_16x16x32_bf16 v[0:3], v[176:179], v[128:131], v[0:3]
  v_mfma_f32_16x16x32_bf16 v[4:7], v[180:183], v[128:131], v[4:7]
  v_mfma_f32_16x16x32_bf16 v[8:11], v[184:187], v[128:131], v[8:11]
  v_mfma_f32_16x16x32_bf16 v[12:15], v[188:191], v[128:131], v[12:15]
  s_waitcnt lgkmcnt(0)
  v_mfma_f32_16x16x32_bf16 v[28:31], v[188:191], v[132:135], v[28:31]
  v_mfma_f32_16x16x32_bf16 v[24:27], v[184:187], v[132:135], v[24:27]
  s_waitcnt vmcnt(6)
  s_barrier
  v_mfma_f32_16x16x32_bf16 v[20:23], v[180:183], v[132:135], v[20:23]
  v_mfma_f32_16x16x32_bf16 v[16:19], v[176:179], v[132:135], v[16:19]
  v_mfma_f32_16x16x32_bf16 v[32:35], v[176:179], v[136:139], v[32:35]
  ds_read_b64_tr_b16 v[160:161], v240 offset:32768
  s_add_u32 m0, s34, 114688
  s_mov_b32 s35, 1048576
  buffer_load_dwordx4 v234, s[72:75], s35 offen lds
  v_lshlrev_b32 v248, 16, v192
  v_and_b32 v249, 0xffff0000, v192
  v_add_f32 v250, v248, v249
  v_mfma_f32_16x16x32_bf16 v[36:39], v[180:183], v[136:139], v[36:39]
  ds_read_b64_tr_b16 v[162:163], v240 offset:33792
  v_mul_f32 v251, v248, v248
  v_fmac_f32 v251, v249, v249
  v_lshlrev_b32 v248, 16, v193
  v_mfma_f32_16x16x32_bf16 v[40:43], v[184:187], v[136:139], v[40:43]
  ds_read_b64_tr_b16 v[164:165], v241 offset:32768
  buffer_load_dwordx4 v235, s[72:75], s35 offen offset:1024 lds
  v_and_b32 v249, 0xffff0000, v193
  v_add_f32 v250, v250, v248
  v_add_f32 v250, v250, v249
  v_mfma_f32_16x16x32_bf16 v[44:47], v[188:191], v[136:139], v[44:47]
  ds_read_b64_tr_b16 v[166:167], v241 offset:33792
  v_fmac_f32 v251, v248, v248
  v_fmac_f32 v251, v249, v249
  v_lshlrev_b32 v248, 16, v194
  v_mfma_f32_16x16x32_bf16 v[60:63], v[188:191], v[140:143], v[60:63]
  ds_read_b64_tr_b16 v[168:169], v242 offset:32768
  v_and_b32 v249, 0xffff0000, v194
  v_add_f32 v250, v250, v248
  v_add_f32 v250, v250, v249
  v_mfma_f32_16x16x32_bf16 v[56:59], v[184:187], v[140:143], v[56:59]
  ds_read_b64_tr_b16 v[170:171], v242 offset:33792
  s_add_u32 m0, s28, 32768
  s_mov_b32 s35, 384
  buffer_load_dwordx4 v232, s[68:71], s35 offen lds
  v_fmac_f32 v251, v248, v248
  v_fmac_f32 v251, v249, v249
  v_lshlrev_b32 v248, 16, v195
  v_mfma_f32_16x16x32_bf16 v[52:55], v[180:183], v[140:143], v[52:55]
  ds_read_b64_tr_b16 v[172:173], v243 offset:32768
  v_and_b32 v249, 0xffff0000, v195
  v_add_f32 v250, v250, v248
  v_add_f32 v250, v250, v249
  v_mfma_f32_16x16x32_bf16 v[48:51], v[176:179], v[140:143], v[48:51]
  ds_read_b64_tr_b16 v[174:175], v243 offset:33792
  v_fmac_f32 v251, v248, v248
  v_fmac_f32 v251, v249, v249
  v_lshlrev_b32 v248, 16, v196
  v_mfma_f32_16x16x32_bf16 v[64:67], v[176:179], v[144:147], v[64:67]
  ds_read_b128 v[128:131], v237 offset:0
  buffer_load_dwordx4 v233, s[68:71], s35 offen offset:1024 lds
  v_and_b32 v249, 0xffff0000, v196
  v_add_f32 v250, v250, v248
  v_add_f32 v250, v250, v249
  v_mfma_f32_16x16x32_bf16 v[68:71], v[180:183], v[144:147], v[68:71]
  ds_read_b128 v[132:135], v237 offset:2048
  v_fmac_f32 v251, v248, v248
  v_fmac_f32 v251, v249, v249
  v_lshlrev_b32 v248, 16, v197
  v_mfma_f32_16x16x32_bf16 v[72:75], v[184:187], v[144:147], v[72:75]
  ds_read_b128 v[136:139], v237 offset:4096
  v_and_b32 v249, 0xffff0000, v197
  v_add_f32 v250, v250, v248
  v_add_f32 v250, v250, v249
  v_mfma_f32_16x16x32_bf16 v[76:79], v[188:191], v[144:147], v[76:79]
  ds_read_b128 v[140:143], v237 offset:6144
  v_fmac_f32 v251, v248, v248
  v_fmac_f32 v251, v249, v249
  v_lshlrev_b32 v248, 16, v198
  v_mfma_f32_16x16x32_bf16 v[92:95], v[188:191], v[148:151], v[92:95]
  ds_read_b128 v[144:147], v237 offset:8192
  v_and_b32 v249, 0xffff0000, v198
  v_add_f32 v250, v250, v248
  v_add_f32 v250, v250, v249
  v_mfma_f32_16x16x32_bf16 v[88:91], v[184:187], v[148:151], v[88:91]
  v_fmac_f32 v251, v248, v248
  v_fmac_f32 v251, v249, v249
  v_lshlrev_b32 v248, 16, v199
  v_mfma_f32_16x16x32_bf16 v[84:87], v[180:183], v[148:151], v[84:87]
  v_and_b32 v249, 0xffff0000, v199
  v_add_f32 v250, v250, v248
  v_add_f32 v250, v250, v249
  v_mfma_f32_16x16x32_bf16 v[80:83], v[176:179], v[148:151], v[80:83]
  v_fmac_f32 v251, v248, v248
  v_fmac_f32 v251, v249, v249
  v_add_f32_dpp v250, v250, v250 row_ror:8 row_mask:0xf bank_mask:0xf
  v_mfma_f32_16x16x32_bf16 v[96:99], v[176:179], v[152:155], v[96:99]
  ds_read_b128 v[148:151], v237 offset:10240
  v_add_f32_dpp v251, v251, v251 row_ror:8 row_mask:0xf bank_mask:0xf
  v_mov_b32 v248, v250
  v_mov_b32 v249, v251
  v_mfma_f32_16x16x32_bf16 v[100:103], v[180:183], v[152:155], v[100:103]
  v_permlane16_swap_b32 v250, v248
  v_permlane16_swap_b32 v251, v249
  v_add_f32 v250, v250, v248
  v_mfma_f32_16x16x32_bf16 v[104:107], v[184:187], v[152:155], v[104:107]
  v_add_f32 v251, v251, v249
  v_mov_b32 v248, v250
  v_mov_b32 v249, v251
  v_mfma_f32_16x16x32_bf16 v[108:111], v[188:191], v[152:155], v[108:111]
  v_permlane32_swap_b32 v250, v248
  v_permlane32_swap_b32 v251, v249
  v_add_f32 v250, v250, v248
  v_mfma_f32_16x16x32_bf16 v[124:127], v[188:191], v[156:159], v[124:127]
  ds_read_b128 v[152:155], v237 offset:12288
  v_add_f32 v251, v251, v249
  v_and_b32 v248, 7, v247
  v_lshlrev_b32 v248, 6, v248
  v_mfma_f32_16x16x32_bf16 v[120:123], v[184:187], v[156:159], v[120:123]
  v_add_u32 v200, 151552, v248
  s_lshl_b32 s21, s18, 3
  v_add_u32 v248, s21, v200
  v_mfma_f32_16x16x32_bf16 v[116:119], v[180:183], v[156:159], v[116:119]
  v_mfma_f32_16x16x32_bf16 v[112:115], v[176:179], v[156:159], v[112:115]
  ds_read_b128 v[156:159], v237 offset:14336
  s_waitcnt lgkmcnt(7)
  ds_write_b64 v248, v[250:251]
  v_mfma_f32_16x16x32_bf16 v[0:3], v[160:163], v[128:131], v[0:3]
  v_mfma_f32_16x16x32_bf16 v[4:7], v[164:167], v[128:131], v[4:7]
  v_mfma_f32_16x16x32_bf16 v[8:11], v[168:171], v[128:131], v[8:11]
  v_mfma_f32_16x16x32_bf16 v[12:15], v[172:175], v[128:131], v[12:15]
  s_waitcnt lgkmcnt(0)
  v_mfma_f32_16x16x32_bf16 v[28:31], v[172:175], v[132:135], v[28:31]
  v_mfma_f32_16x16x32_bf16 v[24:27], v[168:171], v[132:135], v[24:27]
  s_waitcnt vmcnt(8)
  s_barrier
  v_mfma_f32_16x16x32_bf16 v[20:23], v[164:167], v[132:135], v[20:23]
  v_mfma_f32_16x16x32_bf16 v[16:19], v[160:163], v[132:135], v[16:19]
  v_mfma_f32_16x16x32_bf16 v[32:35], v[160:163], v[136:139], v[32:35]
  ds_read_b64_tr_b16 v[176:177], v240 offset:0
  s_add_u32 m0, s34, 131072
  s_mov_b32 s35, 1310720
  buffer_load_dwordx4 v234, s[72:75], s35 offen lds
  v_mfma_f32_16x16x32_bf16 v[36:39], v[164:167], v[136:139], v[36:39]
  ds_read_b64_tr_b16 v[178:179], v240 offset:1024
  v_mfma_f32_16x16x32_bf16 v[40:43], v[168:171], v[136:139], v[40:43]
  ds_read_b64_tr_b16 v[180:181], v241 offset:0
  buffer_load_dwordx4 v235, s[72:75], s35 offen offset:1024 lds
  v_mfma_f32_16x16x32_bf16 v[44:47], v[172:175], v[136:139], v[44:47]
  ds_read_b64_tr_b16 v[182:183], v241 offset:1024
  v_mfma_f32_16x16x32_bf16 v[60:63], v[172:175], v[140:143], v[60:63]
  ds_read_b64_tr_b16 v[184:185], v242 offset:0
  v_mfma_f32_16x16x32_bf16 v[56:59], v[168:171], v[140:143], v[56:59]
  ds_read_b64_tr_b16 v[186:187], v242 offset:1024
  s_add_u32 m0, s28, 34816
  s_mov_b32 s35, 16768
  buffer_load_dwordx4 v232, s[68:71], s35 offen lds
  v_mfma_f32_16x16x32_bf16 v[52:55], v[164:167], v[140:143], v[52:55]
  ds_read_b64_tr_b16 v[188:189], v243 offset:0
  v_mfma_f32_16x16x32_bf16 v[48:51], v[160:163], v[140:143], v[48:51]
  ds_read_b64_tr_b16 v[190:191], v243 offset:1024
  v_mfma_f32_16x16x32_bf16 v[64:67], v[160:163], v[144:147], v[64:67]
  ds_read_b128 v[128:131], v239 offset:0
  buffer_load_dwordx4 v233, s[68:71], s35 offen offset:1024 lds
  v_mfma_f32_16x16x32_bf16 v[68:71], v[164:167], v[144:147], v[68:71]
  ds_read_b128 v[132:135], v239 offset:2048
  v_mfma_f32_16x16x32_bf16 v[72:75], v[168:171], v[144:147], v[72:75]
  ds_read_b128 v[136:139], v239 offset:4096
  v_mfma_f32_16x16x32_bf16 v[76:79], v[172:175], v[144:147], v[76:79]
  ds_read_b128 v[140:143], v239 offset:6144
  v_mfma_f32_16x16x32_bf16 v[92:95], v[172:175], v[148:151], v[92:95]
  ds_read_b128 v[144:147], v239 offset:8192
  v_mfma_f32_16x16x32_bf16 v[88:91], v[168:171], v[148:151], v[88:91]
  v_mfma_f32_16x16x32_bf16 v[84:87], v[164:167], v[148:151], v[84:87]
  v_mfma_f32_16x16x32_bf16 v[80:83], v[160:163], v[148:151], v[80:83]
  v_mfma_f32_16x16x32_bf16 v[96:99], v[160:163], v[152:155], v[96:99]
  ds_read_b128 v[148:151], v239 offset:10240
  v_mfma_f32_16x16x32_bf16 v[100:103], v[164:167], v[152:155], v[100:103]
  v_mfma_f32_16x16x32_bf16 v[104:107], v[168:171], v[152:155], v[104:107]
  v_mfma_f32_16x16x32_bf16 v[108:111], v[172:175], v[152:155], v[108:111]
  v_mfma_f32_16x16x32_bf16 v[124:127], v[172:175], v[156:159], v[124:127]
  ds_read_b128 v[152:155], v239 offset:12288
  v_mfma_f32_16x16x32_bf16 v[120:123], v[168:171], v[156:159], v[120:123]
  v_mfma_f32_16x16x32_bf16 v[116:119], v[164:167], v[156:159], v[116:119]
  v_mfma_f32_16x16x32_bf16 v[112:115], v[160:163], v[156:159], v[112:115]
  ds_read_b128 v[156:159], v239 offset:14336
  s_waitcnt lgkmcnt(7)
  ds_read_b128 v[216:219], v200 offset:0
  ds_read_b128 v[220:223], v200 offset:16
  ds_read_b128 v[224:227], v200 offset:32
  ds_read_b128 v[228:231], v200 offset:48
  v_mfma_f32_16x16x32_bf16 v[0:3], v[176:179], v[128:131], v[0:3]
  v_mfma_f32_16x16x32_bf16 v[4:7], v[180:183], v[128:131], v[4:7]
  v_mfma_f32_16x16x32_bf16 v[8:11], v[184:187], v[128:131], v[8:11]
  v_mfma_f32_16x16x32_bf16 v[12:15], v[188:191], v[128:131], v[12:15]
  s_waitcnt lgkmcnt(0)
  v_mfma_f32_16x16x32_bf16 v[28:31], v[188:191], v[132:135], v[28:31]
  v_mfma_f32_16x16x32_bf16 v[24:27], v[184:187], v[132:135], v[24:27]
  s_waitcnt vmcnt(6)
  s_barrier
  v_mfma_f32_16x16x32_bf16 v[20:23], v[180:183], v[132:135], v[20:23]
  v_mfma_f32_16x16x32_bf16 v[16:19], v[176:179], v[132:135], v[16:19]
  v_mfma_f32_16x16x32_bf16 v[32:35], v[176:179], v[136:139], v[32:35]
  ds_read_b64_tr_b16 v[160:161], v240 offset:16384
  s_add_u32 m0, s34, 98304
  s_mov_b32 s35, 1572864
  buffer_load_dwordx4 v234, s[72:75], s35 offen lds
  v_add_f32 v216, v216, v218
  v_add_f32 v217, v217, v219
  v_add_f32 v216, v216, v220
  v_mfma_f32_16x16x32_bf16 v[36:39], v[180:183], v[136:139], v[36:39]
  ds_read_b64_tr_b16 v[162:163], v240 offset:17408
  v_add_f32 v217, v217, v221
  v_add_f32 v216, v216, v222
  v_add_f32 v217, v217, v223
  v_mfma_f32_16x16x32_bf16 v[40:43], v[184:187], v[136:139], v[40:43]
  ds_read_b64_tr_b16 v[164:165], v241 offset:16384
  buffer_load_dwordx4 v235, s[72:75], s35 offen offset:1024 lds
  v_add_f32 v216, v216, v224
  v_add_f32 v217, v217, v225
  v_add_f32 v216, v216, v226
  v_mfma_f32_16x16x32_bf16 v[44:47], v[188:191], v[136:139], v[44:47]
  ds_read_b64_tr_b16 v[166:167], v241 offset:17408
  v_add_f32 v217, v217, v227
  v_add_f32 v216, v216, v228
  v_add_f32 v217, v217, v229
  v_mfma_f32_16x16x32_bf16 v[60:63], v[188:191], v[140:143], v[60:63]
  ds_read_b64_tr_b16 v[168:169], v242 offset:16384
  v_add_f32 v216, v216, v230
  v_add_f32 v217, v217, v231
  v_mul_f32 v250, 0x3acccccd, v216
  v_mfma_f32_16x16x32_bf16 v[56:59], v[184:187], v[140:143], v[56:59]
  ds_read_b64_tr_b16 v[170:171], v242 offset:17408
  s_add_u32 m0, s28, 65536
  s_mov_b32 s35, 512
  buffer_load_dwordx4 v232, s[68:71], s35 offen lds
  v_mul_f32 v251, 0x3acccccd, v217
  v_fma_f32 v251, -v250, v250, v251
  v_max_f32 v251, 0, v251
  v_mfma_f32_16x16x32_bf16 v[52:55], v[180:183], v[140:143], v[52:55]
  ds_read_b64_tr_b16 v[172:173], v243 offset:16384
  v_add_f32 v251, 0x3727c5ac, v251
  v_rsq_f32 v251, v251
  s_nop 0
  v_mul_f32 v251, 0x3e0293ee, v251
  v_mfma_f32_16x16x32_bf16 v[48:51], v[176:179], v[140:143], v[48:51]
  ds_read_b64_tr_b16 v[174:175], v243 offset:17408
  v_mfma_f32_16x16x32_bf16 v[64:67], v[176:179], v[144:147], v[64:67]
  ds_read_b128 v[128:131], v236 offset:0
  buffer_load_dwordx4 v233, s[68:71], s35 offen offset:1024 lds
  v_mfma_f32_16x16x32_bf16 v[68:71], v[180:183], v[144:147], v[68:71]
  ds_read_b128 v[132:135], v236 offset:2048
  v_mfma_f32_16x16x32_bf16 v[72:75], v[184:187], v[144:147], v[72:75]
  ds_read_b128 v[136:139], v236 offset:4096
  v_mfma_f32_16x16x32_bf16 v[76:79], v[188:191], v[144:147], v[76:79]
  ds_read_b128 v[140:143], v236 offset:6144
  v_mfma_f32_16x16x32_bf16 v[92:95], v[188:191], v[148:151], v[92:95]
  ds_read_b128 v[144:147], v236 offset:8192
  v_mfma_f32_16x16x32_bf16 v[88:91], v[184:187], v[148:151], v[88:91]
  v_mfma_f32_16x16x32_bf16 v[84:87], v[180:183], v[148:151], v[84:87]
  v_mfma_f32_16x16x32_bf16 v[80:83], v[176:179], v[148:151], v[80:83]
  v_mfma_f32_16x16x32_bf16 v[96:99], v[176:179], v[152:155], v[96:99]
  ds_read_b128 v[148:151], v236 offset:10240
  v_mfma_f32_16x16x32_bf16 v[100:103], v[180:183], v[152:155], v[100:103]
  v_mfma_f32_16x16x32_bf16 v[104:107], v[184:187], v[152:155], v[104:107]
  v_mfma_f32_16x16x32_bf16 v[108:111], v[188:191], v[152:155], v[108:111]
  v_mfma_f32_16x16x32_bf16 v[124:127], v[188:191], v[156:159], v[124:127]
  ds_read_b128 v[152:155], v236 offset:12288
  v_mfma_f32_16x16x32_bf16 v[120:123], v[184:187], v[156:159], v[120:123]
  v_mfma_f32_16x16x32_bf16 v[116:119], v[180:183], v[156:159], v[116:119]
  v_mfma_f32_16x16x32_bf16 v[112:115], v[176:179], v[156:159], v[112:115]
  ds_read_b128 v[156:159], v236 offset:14336
  s_waitcnt lgkmcnt(7)
  v_mfma_f32_16x16x32_bf16 v[0:3], v[160:163], v[128:131], v[0:3]
  v_mfma_f32_16x16x32_bf16 v[4:7], v[164:167], v[128:131], v[4:7]
  v_mfma_f32_16x16x32_bf16 v[8:11], v[168:171], v[128:131], v[8:11]
  v_mfma_f32_16x16x32_bf16 v[12:15], v[172:175], v[128:131], v[12:15]
  s_waitcnt lgkmcnt(0)
  v_mfma_f32_16x16x32_bf16 v[28:31], v[172:175], v[132:135], v[28:31]
  v_mfma_f32_16x16x32_bf16 v[24:27], v[168:171], v[132:135], v[24:27]
  s_waitcnt vmcnt(6)
  s_barrier
  v_mfma_f32_16x16x32_bf16 v[20:23], v[164:167], v[132:135], v[20:23]
  v_mfma_f32_16x16x32_bf16 v[16:19], v[160:163], v[132:135], v[16:19]
  v_mfma_f32_16x16x32_bf16 v[32:35], v[160:163], v[136:139], v[32:35]
  ds_read_b64_tr_b16 v[176:177], v240 offset:32768
  s_add_u32 m0, s34, 114688
  s_mov_b32 s35, 1835008
  buffer_load_dwordx4 v234, s[72:75], s35 offen lds
  v_mfma_f32_16x16x32_bf16 v[36:39], v[164:167], v[136:139], v[36:39]
  ds_read_b64_tr_b16 v[178:179], v240 offset:33792
  v_mfma_f32_16x16x32_bf16 v[40:43], v[168:171], v[136:139], v[40:43]
  ds_read_b64_tr_b16 v[180:181], v241 offset:32768
  buffer_load_dwordx4 v235, s[72:75], s35 offen offset:1024 lds
  v_mfma_f32_16x16x32_bf16 v[44:47], v[172:175], v[136:139], v[44:47]
  ds_read_b64_tr_b16 v[182:183], v241 offset:33792
  v_mfma_f32_16x16x32_bf16 v[60:63], v[172:175], v[140:143], v[60:63]
  ds_read_b64_tr_b16 v[184:185], v242 offset:32768
  s_add_u32 m0, s28, 67584
  s_mov_b32 s35, 16896
  buffer_load_dwordx4 v232, s[68:71], s35 offen lds
  v_mfma_f32_16x16x32_bf16 v[56:59], v[168:171], v[140:143], v[56:59]
  ds_read_b64_tr_b16 v[186:187], v242 offset:33792
  v_mfma_f32_16x16x32_bf16 v[52:55], v[164:167], v[140:143], v[52:55]
  ds_read_b64_tr_b16 v[188:189], v243 offset:32768
  buffer_load_dwordx4 v233, s[68:71], s35 offen offset:1024 lds
  v_mfma_f32_16x16x32_bf16 v[48:51], v[160:163], v[140:143], v[48:51]
  ds_read_b64_tr_b16 v[190:191], v243 offset:33792
  v_mfma_f32_16x16x32_bf16 v[64:67], v[160:163], v[144:147], v[64:67]
  ds_read_b128 v[128:131], v238 offset:0
  v_lshrrev_b32 v248, 1, v247
  s_mul_i32 s21, s17, 80
  s_mul_i32 s22, s18, 10
  s_add_u32 s21, s21, s22
  v_add_u32 v248, s21, v248
  v_lshlrev_b32 v248, 13, v248
  v_and_b32 v249, 1, v247
  v_lshl_add_u32 v248, v249, 7, v248
  s_lshl_b32 s21, s16, 8
  v_add_u32 v248, s21, v248
  v_cmp_gt_u32 vcc, 20, v247
  v_mov_b32 v249, 0x40000000
  s_nop 0
  v_cndmask_b32 v248, v249, v248, vcc
  buffer_load_dword v252, v248, s[8:11], 0 offen
  v_mfma_f32_16x16x32_bf16 v[68:71], v[164:167], v[144:147], v[68:71]
  ds_read_b128 v[132:135], v238 offset:2048
  v_mfma_f32_16x16x32_bf16 v[72:75], v[168:171], v[144:147], v[72:75]
  ds_read_b128 v[136:139], v238 offset:4096
  v_mfma_f32_16x16x32_bf16 v[76:79], v[172:175], v[144:147], v[76:79]
  ds_read_b128 v[140:143], v238 offset:6144
  v_mfma_f32_16x16x32_bf16 v[92:95], v[172:175], v[148:151], v[92:95]
  ds_read_b128 v[144:147], v238 offset:8192
  v_mfma_f32_16x16x32_bf16 v[88:91], v[168:171], v[148:151], v[88:91]
  v_mfma_f32_16x16x32_bf16 v[84:87], v[164:167], v[148:151], v[84:87]
  v_mfma_f32_16x16x32_bf16 v[80:83], v[160:163], v[148:151], v[80:83]
  v_mfma_f32_16x16x32_bf16 v[96:99], v[160:163], v[152:155], v[96:99]
  ds_read_b128 v[148:151], v238 offset:10240
  v_mfma_f32_16x16x32_bf16 v[100:103], v[164:167], v[152:155], v[100:103]
  v_mfma_f32_16x16x32_bf16 v[104:107], v[168:171], v[152:155], v[104:107]
  v_mfma_f32_16x16x32_bf16 v[108:111], v[172:175], v[152:155], v[108:111]
  v_mfma_f32_16x16x32_bf16 v[124:127], v[172:175], v[156:159], v[124:127]
  ds_read_b128 v[152:155], v238 offset:12288
  v_mfma_f32_16x16x32_bf16 v[120:123], v[168:171], v[156:159], v[120:123]
  v_mfma_f32_16x16x32_bf16 v[116:119], v[164:167], v[156:159], v[116:119]
  v_mfma_f32_16x16x32_bf16 v[112:115], v[160:163], v[156:159], v[112:115]
  ds_read_b128 v[156:159], v238 offset:14336
  s_waitcnt lgkmcnt(7)
  v_mfma_f32_16x16x32_bf16 v[0:3], v[176:179], v[128:131], v[0:3]
  v_mfma_f32_16x16x32_bf16 v[4:7], v[180:183], v[128:131], v[4:7]
  v_mfma_f32_16x16x32_bf16 v[8:11], v[184:187], v[128:131], v[8:11]
  v_mfma_f32_16x16x32_bf16 v[12:15], v[188:191], v[128:131], v[12:15]
  s_waitcnt lgkmcnt(0)
  v_mfma_f32_16x16x32_bf16 v[28:31], v[188:191], v[132:135], v[28:31]
  v_mfma_f32_16x16x32_bf16 v[24:27], v[184:187], v[132:135], v[24:27]
  s_waitcnt vmcnt(7)
  s_barrier
  v_mfma_f32_16x16x32_bf16 v[20:23], v[180:183], v[132:135], v[20:23]
  v_mfma_f32_16x16x32_bf16 v[16:19], v[176:179], v[132:135], v[16:19]
  v_mfma_f32_16x16x32_bf16 v[32:35], v[176:179], v[136:139], v[32:35]
  ds_read_b64_tr_b16 v[160:161], v240 offset:0
  s_add_u32 m0, s34, 131072
  s_mov_b32 s35, 2097152
  buffer_load_dwordx4 v234, s[72:75], s35 offen lds
  v_mfma_f32_16x16x32_bf16 v[36:39], v[180:183], v[136:139], v[36:39]
  ds_read_b64_tr_b16 v[162:163], v240 offset:1024
  v_mfma_f32_16x16x32_bf16 v[40:43], v[184:187], v[136:139], v[40:43]
  ds_read_b64_tr_b16 v[164:165], v241 offset:0
  buffer_load_dwordx4 v235, s[72:75], s35 offen offset:1024 lds
  v_mfma_f32_16x16x32_bf16 v[44:47], v[188:191], v[136:139], v[44:47]
  ds_read_b64_tr_b16 v[166:167], v241 offset:1024
  v_mfma_f32_16x16x32_bf16 v[60:63], v[188:191], v[140:143], v[60:63]
  ds_read_b64_tr_b16 v[168:169], v242 offset:0
  v_mfma_f32_16x16x32_bf16 v[56:59], v[184:187], v[140:143], v[56:59]
  ds_read_b64_tr_b16 v[170:171], v242 offset:1024
  s_add_u32 m0, s28, 0
  s_mov_b32 s35, 640
  buffer_load_dwordx4 v232, s[68:71], s35 offen lds
  v_mfma_f32_16x16x32_bf16 v[52:55], v[180:183], v[140:143], v[52:55]
  ds_read_b64_tr_b16 v[172:173], v243 offset:0
  v_mfma_f32_16x16x32_bf16 v[48:51], v[176:179], v[140:143], v[48:51]
  ds_read_b64_tr_b16 v[174:175], v243 offset:1024
  v_mfma_f32_16x16x32_bf16 v[64:67], v[176:179], v[144:147], v[64:67]
  ds_read_b128 v[128:131], v236 offset:32768
  buffer_load_dwordx4 v233, s[68:71], s35 offen offset:1024 lds
  v_mfma_f32_16x16x32_bf16 v[68:71], v[180:183], v[144:147], v[68:71]
  ds_read_b128 v[132:135], v236 offset:34816
  v_mfma_f32_16x16x32_bf16 v[72:75], v[184:187], v[144:147], v[72:75]
  ds_read_b128 v[136:139], v236 offset:36864
  v_mfma_f32_16x16x32_bf16 v[76:79], v[188:191], v[144:147], v[76:79]
  ds_read_b128 v[140:143], v236 offset:38912
  v_mfma_f32_16x16x32_bf16 v[92:95], v[188:191], v[148:151], v[92:95]
  ds_read_b128 v[144:147], v236 offset:40960
  v_mfma_f32_16x16x32_bf16 v[88:91], v[184:187], v[148:151], v[88:91]
  v_mfma_f32_16x16x32_bf16 v[84:87], v[180:183], v[148:151], v[84:87]
  v_mfma_f32_16x16x32_bf16 v[80:83], v[176:179], v[148:151], v[80:83]
  v_mfma_f32_16x16x32_bf16 v[96:99], v[176:179], v[152:155], v[96:99]
  ds_read_b128 v[148:151], v236 offset:43008
  v_mfma_f32_16x16x32_bf16 v[100:103], v[180:183], v[152:155], v[100:103]
  v_mfma_f32_16x16x32_bf16 v[104:107], v[184:187], v[152:155], v[104:107]
  v_mfma_f32_16x16x32_bf16 v[108:111], v[188:191], v[152:155], v[108:111]
  v_mfma_f32_16x16x32_bf16 v[124:127], v[188:191], v[156:159], v[124:127]
  ds_read_b128 v[152:155], v236 offset:45056
  v_mfma_f32_16x16x32_bf16 v[120:123], v[184:187], v[156:159], v[120:123]
  v_mfma_f32_16x16x32_bf16 v[116:119], v[180:183], v[156:159], v[116:119]
  v_mfma_f32_16x16x32_bf16 v[112:115], v[176:179], v[156:159], v[112:115]
  ds_read_b128 v[156:159], v236 offset:47104
  s_waitcnt lgkmcnt(7)
  v_mfma_f32_16x16x32_bf16 v[0:3], v[160:163], v[128:131], v[0:3]
  v_mfma_f32_16x16x32_bf16 v[4:7], v[164:167], v[128:131], v[4:7]
  v_mfma_f32_16x16x32_bf16 v[8:11], v[168:171], v[128:131], v[8:11]
  v_mfma_f32_16x16x32_bf16 v[12:15], v[172:175], v[128:131], v[12:15]
  s_waitcnt lgkmcnt(0)
  v_mfma_f32_16x16x32_bf16 v[28:31], v[172:175], v[132:135], v[28:31]
  v_mfma_f32_16x16x32_bf16 v[24:27], v[168:171], v[132:135], v[24:27]
  s_waitcnt vmcnt(7)
  s_barrier
  v_mfma_f32_16x16x32_bf16 v[20:23], v[164:167], v[132:135], v[20:23]
  v_mfma_f32_16x16x32_bf16 v[16:19], v[160:163], v[132:135], v[16:19]
  s_cmp_lg_u32 s18, 0
  s_cbranch_scc1 ka_kernel_nopi_3
  v_lshrrev_b32 v248, 4, v245
  v_min_u32 v248, 4, v248
  v_lshlrev_b32 v248, 2, v248
  v_add_u32 v248, 192, v248
  buffer_load_dword v252, v248, s[76:79], 0 offen sc1
ka_kernel_nopi_3:
  v_mfma_f32_16x16x32_bf16 v[32:35], v[160:163], v[136:139], v[32:35]
  ds_read_b64_tr_b16 v[176:177], v240 offset:16384
  s_add_u32 m0, s34, 98304
  s_mov_b32 s35, 2359296
  buffer_load_dwordx4 v234, s[72:75], s35 offen lds
  v_mfma_f32_16x16x32_bf16 v[36:39], v[164:167], v[136:139], v[36:39]
  ds_read_b64_tr_b16 v[178:179], v240 offset:17408
  v_mfma_f32_16x16x32_bf16 v[40:43], v[168:171], v[136:139], v[40:43]
  ds_read_b64_tr_b16 v[180:181], v241 offset:16384
  buffer_load_dwordx4 v235, s[72:75], s35 offen offset:1024 lds
  v_mfma_f32_16x16x32_bf16 v[44:47], v[172:175], v[136:139], v[44:47]
  ds_read_b64_tr_b16 v[182:183], v241 offset:17408
  v_mfma_f32_16x16x32_bf16 v[60:63], v[172:175], v[140:143], v[60:63]
  ds_read_b64_tr_b16 v[184:185], v242 offset:16384
  v_mfma_f32_16x16x32_bf16 v[56:59], v[168:171], v[140:143], v[56:59]
  ds_read_b64_tr_b16 v[186:187], v242 offset:17408
  s_add_u32 m0, s28, 2048
  s_mov_b32 s35, 17024
  buffer_load_dwordx4 v232, s[68:71], s35 offen lds
  v_mfma_f32_16x16x32_bf16 v[52:55], v[164:167], v[140:143], v[52:55]
  ds_read_b64_tr_b16 v[188:189], v243 offset:16384
  v_mfma_f32_16x16x32_bf16 v[48:51], v[160:163], v[140:143], v[48:51]
  ds_read_b64_tr_b16 v[190:191], v243 offset:17408
  v_mfma_f32_16x16x32_bf16 v[64:67], v[160:163], v[144:147], v[64:67]
  ds_read_b128 v[128:131], v238 offset:32768
  buffer_load_dwordx4 v233, s[68:71], s35 offen offset:1024 lds
  v_mfma_f32_16x16x32_bf16 v[68:71], v[164:167], v[144:147], v[68:71]
  ds_read_b128 v[132:135], v238 offset:34816
  v_mfma_f32_16x16x32_bf16 v[72:75], v[168:171], v[144:147], v[72:75]
  ds_read_b128 v[136:139], v238 offset:36864
  v_mfma_f32_16x16x32_bf16 v[76:79], v[172:175], v[144:147], v[76:79]
  ds_read_b128 v[140:143], v238 offset:38912
  v_mfma_f32_16x16x32_bf16 v[92:95], v[172:175], v[148:151], v[92:95]
  ds_read_b128 v[144:147], v238 offset:40960
  v_mfma_f32_16x16x32_bf16 v[88:91], v[168:171], v[148:151], v[88:91]
  v_mfma_f32_16x16x32_bf16 v[84:87], v[164:167], v[148:151], v[84:87]
  v_mfma_f32_16x16x32_bf16 v[80:83], v[160:163], v[148:151], v[80:83]
  v_mfma_f32_16x16x32_bf16 v[96:99], v[160:163], v[152:155], v[96:99]
  ds_read_b128 v[148:151], v238 offset:43008
  v_mfma_f32_16x16x32_bf16 v[100:103], v[164:167], v[152:155], v[100:103]
  v_mfma_f32_16x16x32_bf16 v[104:107], v[168:171], v[152:155], v[104:107]
  v_mfma_f32_16x16x32_bf16 v[108:111], v[172:175], v[152:155], v[108:111]
  v_mfma_f32_16x16x32_bf16 v[124:127], v[172:175], v[156:159], v[124:127]
  ds_read_b128 v[152:155], v238 offset:45056
  v_mfma_f32_16x16x32_bf16 v[120:123], v[168:171], v[156:159], v[120:123]
  v_mfma_f32_16x16x32_bf16 v[116:119], v[164:167], v[156:159], v[116:119]
  v_mfma_f32_16x16x32_bf16 v[112:115], v[160:163], v[156:159], v[112:115]
  ds_read_b128 v[156:159], v238 offset:47104
  s_waitcnt lgkmcnt(7)
  v_mfma_f32_16x16x32_bf16 v[0:3], v[176:179], v[128:131], v[0:3]
  v_mfma_f32_16x16x32_bf16 v[4:7], v[180:183], v[128:131], v[4:7]
  v_mfma_f32_16x16x32_bf16 v[8:11], v[184:187], v[128:131], v[8:11]
  v_mfma_f32_16x16x32_bf16 v[12:15], v[188:191], v[128:131], v[12:15]
  s_waitcnt lgkmcnt(0)
  v_mfma_f32_16x16x32_bf16 v[28:31], v[188:191], v[132:135], v[28:31]
  v_mfma_f32_16x16x32_bf16 v[24:27], v[184:187], v[132:135], v[24:27]
  s_waitcnt vmcnt(6)
  s_cmp_lg_u32 s18, 0
  s_cbranch_scc1 ka_kernel_nopc_4
  s_waitcnt vmcnt(4)
  v_lshrrev_b32 v248, 4, v245
  v_min_u32 v248, 4, v248
  v_lshlrev_b32 v248, 2, v248
  v_add_u32 v248, 192, v248
  s_mov_b32 s24, 0x40000
ka_kernel_spin_6:
  v_cmp_ne_u32 vcc, 0x1010101, v252
  s_cbranch_vccz ka_kernel_pok_5
  s_sleep 2
  buffer_load_dword v252, v248, s[76:79], 0 offen sc1
  s_waitcnt vmcnt(0)
  s_sub_u32 s24, s24, 1
  s_cmp_lg_u32 s24, 0
  s_cbranch_scc1 ka_kernel_spin_6
ka_kernel_pok_5:
ka_kernel_nopc_4:
  s_barrier
  v_mfma_f32_16x16x32_bf16 v[20:23], v[180:183], v[132:135], v[20:23]
  v_mfma_f32_16x16x32_bf16 v[16:19], v[176:179], v[132:135], v[16:19]
  s_cmp_lg_u32 s18, 0
  s_cbranch_scc1 ka_kernel_nofl_7
  v_mov_b32 v248, s100
  s_lshl_b32 s21, s16, 7
  s_lshl_b32 s22, s17, 2
  s_add_u32 s21, s21, s22
  s_add_u32 s21, s21, 0xf0420
  v_mov_b32 v249, s21
  s_mov_b64 exec, 1
  buffer_store_dword v248, v249, s[12:15], 0 offen sc1
  s_mov_b64 exec, -1
ka_kernel_nofl_7:
  v_mfma_f32_16x16x32_bf16 v[32:35], v[176:179], v[136:139], v[32:35]
  ds_read_b64_tr_b16 v[160:161], v240 offset:32768
  v_cmp_gt_u32 vcc, 16, v247
  v_mov_b32 v248, 0x40000000
  s_nop 0
  v_cndmask_b32 v248, v248, v255, vcc
  buffer_load_dwordx4 v[200:203], v255, s[12:15], 0 offen offset:0 sc1
  buffer_load_dwordx4 v[204:207], v255, s[12:15], 0 offen offset:16 sc1
  v_mfma_f32_16x16x32_bf16 v[36:39], v[180:183], v[136:139], v[36:39]
  ds_read_b64_tr_b16 v[162:163], v240 offset:33792
  buffer_load_dwordx4 v[208:211], v248, s[12:15], 0 offen offset:256 sc1
  v_mfma_f32_16x16x32_bf16 v[40:43], v[184:187], v[136:139], v[40:43]
  ds_read_b64_tr_b16 v[164:165], v241 offset:32768
  buffer_load_dwordx4 v[212:215], v248, s[12:15], 0 offen offset:272 sc1
  v_mfma_f32_16x16x32_bf16 v[44:47], v[188:191], v[136:139], v[44:47]
  ds_read_b64_tr_b16 v[166:167], v241 offset:33792
  buffer_load_dwordx4 v[216:219], v255, s[12:15], 0 offen offset:2560 sc1
  v_mfma_f32_16x16x32_bf16 v[60:63], v[188:191], v[140:143], v[60:63]
  ds_read_b64_tr_b16 v[168:169], v242 offset:32768
  buffer_load_dwordx4 v[220:223], v255, s[12:15], 0 offen offset:2576 sc1
  v_mfma_f32_16x16x32_bf16 v[56:59], v[184:187], v[140:143], v[56:59]
  ds_read_b64_tr_b16 v[170:171], v242 offset:33792
  buffer_load_dwordx4 v[224:227], v248, s[12:15], 0 offen offset:2816 sc1
  v_mfma_f32_16x16x32_bf16 v[52:55], v[180:183], v[140:143], v[52:55]
  ds_read_b64_tr_b16 v[172:173], v243 offset:32768
  buffer_load_dwordx4 v[228:231], v248, s[12:15], 0 offen offset:2832 sc1
  v_mfma_f32_16x16x32_bf16 v[48:51], v[176:179], v[140:143], v[48:51]
  ds_read_b64_tr_b16 v[174:175], v243 offset:33792
  s_add_u32 m0, s34, 114688
  s_mov_b32 s35, 2621440
  buffer_load_dwordx4 v234, s[72:75], s35 offen lds
  v_mfma_f32_16x16x32_bf16 v[64:67], v[176:179], v[144:147], v[64:67]
  ds_read_b128 v[128:131], v237 offset:0
  buffer_load_dwordx4 v235, s[72:75], s35 offen offset:1024 lds
  v_mfma_f32_16x16x32_bf16 v[68:71], v[180:183], v[144:147], v[68:71]
  ds_read_b128 v[132:135], v237 offset:2048
  s_add_u32 m0, s28, 32768
  s_mov_b32 s35, 768
  buffer_load_dwordx4 v232, s[68:71], s35 offen lds
  v_mfma_f32_16x16x32_bf16 v[72:75], v[184:187], v[144:147], v[72:75]
  ds_read_b128 v[136:139], v237 offset:4096
  buffer_load_dwordx4 v233, s[68:71], s35 offen offset:1024 lds
  v_mfma_f32_16x16x32_bf16 v[76:79], v[188:191], v[144:147], v[76:79]
  ds_read_b128 v[140:143], v237 offset:6144
  v_mfma_f32_16x16x32_bf16 v[92:95], v[188:191], v[148:151], v[92:95]
  ds_read_b128 v[144:147], v237 offset:8192
  v_mfma_f32_16x16x32_bf16 v[88:91], v[184:187], v[148:151], v[88:91]
  v_mfma_f32_16x16x32_bf16 v[84:87], v[180:183], v[148:151], v[84:87]
  v_mfma_f32_16x16x32_bf16 v[80:83], v[176:179], v[148:151], v[80:83]
  v_mfma_f32_16x16x32_bf16 v[96:99], v[176:179], v[152:155], v[96:99]
  ds_read_b128 v[148:151], v237 offset:10240
  v_mfma_f32_16x16x32_bf16 v[100:103], v[180:183], v[152:155], v[100:103]
  v_mfma_f32_16x16x32_bf16 v[104:107], v[184:187], v[152:155], v[104:107]
  v_mfma_f32_16x16x32_bf16 v[108:111], v[188:191], v[152:155], v[108:111]
  v_mfma_f32_16x16x32_bf16 v[124:127], v[188:191], v[156:159], v[124:127]
  ds_read_b128 v[152:155], v237 offset:12288
  v_mfma_f32_16x16x32_bf16 v[120:123], v[184:187], v[156:159], v[120:123]
  v_mfma_f32_16x16x32_bf16 v[116:119], v[180:183], v[156:159], v[116:119]
  v_mfma_f32_16x16x32_bf16 v[112:115], v[176:179], v[156:159], v[112:115]
  ds_read_b128 v[156:159], v237 offset:14336
  s_waitcnt lgkmcnt(7)
  v_mfma_f32_16x16x32_bf16 v[0:3], v[160:163], v[128:131], v[0:3]
  v_mfma_f32_16x16x32_bf16 v[4:7], v[164:167], v[128:131], v[4:7]
  v_mfma_f32_16x16x32_bf16 v[8:11], v[168:171], v[128:131], v[8:11]
  v_mfma_f32_16x16x32_bf16 v[12:15], v[172:175], v[128:131], v[12:15]
  s_waitcnt lgkmcnt(0)
  v_mfma_f32_16x16x32_bf16 v[28:31], v[172:175], v[132:135], v[28:31]
  v_mfma_f32_16x16x32_bf16 v[24:27], v[168:171], v[132:135], v[24:27]
  s_waitcnt vmcnt(14)
  s_barrier
  v_mfma_f32_16x16x32_bf16 v[20:23], v[164:167], v[132:135], v[20:23]
  v_mfma_f32_16x16x32_bf16 v[16:19], v[160:163], v[132:135], v[16:19]
  v_mfma_f32_16x16x32_bf16 v[32:35], v[160:163], v[136:139], v[32:35]
  ds_read_b64_tr_b16 v[176:177], v240 offset:0
  s_add_u32 m0, s34, 131072
  s_mov_b32 s35, 2883584
  buffer_load_dwordx4 v234, s[72:75], s35 offen lds
  v_mfma_f32_16x16x32_bf16 v[36:39], v[164:167], v[136:139], v[36:39]
  ds_read_b64_tr_b16 v[178:179], v240 offset:1024
  v_mfma_f32_16x16x32_bf16 v[40:43], v[168:171], v[136:139], v[40:43]
  ds_read_b64_tr_b16 v[180:181], v241 offset:0
  buffer_load_dwordx4 v235, s[72:75], s35 offen offset:1024 lds
  v_mfma_f32_16x16x32_bf16 v[44:47], v[172:175], v[136:139], v[44:47]
  ds_read_b64_tr_b16 v[182:183], v241 offset:1024
  v_mfma_f32_16x16x32_bf16 v[60:63], v[172:175], v[140:143], v[60:63]
  ds_read_b64_tr_b16 v[184:185], v242 offset:0
  v_mfma_f32_16x16x32_bf16 v[56:59], v[168:171], v[140:143], v[56:59]
  ds_read_b64_tr_b16 v[186:187], v242 offset:1024
  s_add_u32 m0, s28, 34816
  s_mov_b32 s35, 17152
  buffer_load_dwordx4 v232, s[68:71], s35 offen lds
  v_mfma_f32_16x16x32_bf16 v[52:55], v[164:167], v[140:143], v[52:55]
  ds_read_b64_tr_b16 v[188:189], v243 offset:0
  v_mfma_f32_16x16x32_bf16 v[48:51], v[160:163], v[140:143], v[48:51]
  ds_read_b64_tr_b16 v[190:191], v243 offset:1024
  v_mfma_f32_16x16x32_bf16 v[64:67], v[160:163], v[144:147], v[64:67]
  ds_read_b128 v[128:131], v239 offset:0
  buffer_load_dwordx4 v233, s[68:71], s35 offen offset:1024 lds
  v_mfma_f32_16x16x32_bf16 v[68:71], v[164:167], v[144:147], v[68:71]
  ds_read_b128 v[132:135], v239 offset:2048
  v_mfma_f32_16x16x32_bf16 v[72:75], v[168:171], v[144:147], v[72:75]
  ds_read_b128 v[136:139], v239 offset:4096
  v_mfma_f32_16x16x32_bf16 v[76:79], v[172:175], v[144:147], v[76:79]
  ds_read_b128 v[140:143], v239 offset:6144
  v_mfma_f32_16x16x32_bf16 v[92:95], v[172:175], v[148:151], v[92:95]
  ds_read_b128 v[144:147], v239 offset:8192
  v_mfma_f32_16x16x32_bf16 v[88:91], v[168:171], v[148:151], v[88:91]
  v_mfma_f32_16x16x32_bf16 v[84:87], v[164:167], v[148:151], v[84:87]
  v_mfma_f32_16x16x32_bf16 v[80:83], v[160:163], v[148:151], v[80:83]
  v_mfma_f32_16x16x32_bf16 v[96:99], v[160:163], v[152:155], v[96:99]
  ds_read_b128 v[148:151], v239 offset:10240
  v_mfma_f32_16x16x32_bf16 v[100:103], v[164:167], v[152:155], v[100:103]
  v_mfma_f32_16x16x32_bf16 v[104:107], v[168:171], v[152:155], v[104:107]
  v_mfma_f32_16x16x32_bf16 v[108:111], v[172:175], v[152:155], v[108:111]
  v_mfma_f32_16x16x32_bf16 v[124:127], v[172:175], v[156:159], v[124:127]
  ds_read_b128 v[152:155], v239 offset:12288
  v_mfma_f32_16x16x32_bf16 v[120:123], v[168:171], v[156:159], v[120:123]
  v_mfma_f32_16x16x32_bf16 v[116:119], v[164:167], v[156:159], v[116:119]
  v_mfma_f32_16x16x32_bf16 v[112:115], v[160:163], v[156:159], v[112:115]
  ds_read_b128 v[156:159], v239 offset:14336
  s_waitcnt lgkmcnt(7)
  v_mfma_f32_16x16x32_bf16 v[0:3], v[176:179], v[128:131], v[0:3]
  v_mfma_f32_16x16x32_bf16 v[4:7], v[180:183], v[128:131], v[4:7]
  v_mfma_f32_16x16x32_bf16 v[8:11], v[184:187], v[128:131], v[8:11]
  v_mfma_f32_16x16x32_bf16 v[12:15], v[188:191], v[128:131], v[12:15]
  s_waitcnt lgkmcnt(0)
  v_mfma_f32_16x16x32_bf16 v[28:31], v[188:191], v[132:135], v[28:31]
  v_mfma_f32_16x16x32_bf16 v[24:27], v[184:187], v[132:135], v[24:27]
  s_waitcnt vmcnt(6)
  s_barrier
  v_mfma_f32_16x16x32_bf16 v[20:23], v[180:183], v[132:135], v[20:23]
  v_mfma_f32_16x16x32_bf16 v[16:19], v[176:179], v[132:135], v[16:19]
  v_mfma_f32_16x16x32_bf16 v[32:35], v[176:179], v[136:139], v[32:35]
  ds_read_b64_tr_b16 v[160:161], v240 offset:16384
  s_add_u32 m0, s34, 98304
  s_mov_b32 s35, 3145728
  buffer_load_dwordx4 v234, s[72:75], s35 offen lds
  s_mov_b32 s21, 0x3e0293ee
  v_lshlrev_b32 v248, 16, v192
  v_and_b32 v249, 0xffff0000, v192
  v_sub_f32 v248, v248, v250
  v_mfma_f32_16x16x32_bf16 v[36:39], v[180:183], v[136:139], v[36:39]
  ds_read_b64_tr_b16 v[162:163], v240 offset:17408
  v_sub_f32 v249, v249, v250
  v_mul_f32 v248, v251, v248
  v_mul_f32 v249, v251, v249
  v_mul_f32 v200, s21, v200
  v_mfma_f32_16x16x32_bf16 v[40:43], v[184:187], v[136:139], v[40:43]
  ds_read_b64_tr_b16 v[164:165], v241 offset:16384
  buffer_load_dwordx4 v235, s[72:75], s35 offen offset:1024 lds
  v_mul_f32 v201, s21, v201
  v_fma_f32 v248, v248, v216, v200
  v_fma_f32 v249, v249, v217, v201
  v_cvt_pk_bf16_f32 v192, v248, v249
  v_mfma_f32_16x16x32_bf16 v[44:47], v[188:191], v[136:139], v[44:47]
  ds_read_b64_tr_b16 v[166:167], v241 offset:17408
  v_lshlrev_b32 v248, 16, v193
  v_and_b32 v249, 0xffff0000, v193
  v_sub_f32 v248, v248, v250
  v_sub_f32 v249, v249, v250
  v_mfma_f32_16x16x32_bf16 v[60:63], v[188:191], v[140:143], v[60:63]
  ds_read_b64_tr_b16 v[168:169], v242 offset:16384
  v_mul_f32 v248, v251, v248
  v_mul_f32 v249, v251, v249
  v_mul_f32 v202, s21, v202
  v_mul_f32 v203, s21, v203
  v_mfma_f32_16x16x32_bf16 v[56:59], v[184:187], v[140:143], v[56:59]
  ds_read_b64_tr_b16 v[170:171], v242 offset:17408
  s_add_u32 m0, s28, 65536
  s_mov_b32 s35, 896
  buffer_load_dwordx4 v232, s[68:71], s35 offen lds
  v_fma_f32 v248, v248, v218, v202
  v_fma_f32 v249, v249, v219, v203
  v_cvt_pk_bf16_f32 v193, v248, v249
  v_lshlrev_b32 v248, 16, v194
  v_mfma_f32_16x16x32_bf16 v[52:55], v[180:183], v[140:143], v[52:55]
  ds_read_b64_tr_b16 v[172:173], v243 offset:16384
  v_and_b32 v249, 0xffff0000, v194
  v_sub_f32 v248, v248, v250
  v_sub_f32 v249, v249, v250
  v_mul_f32 v248, v251, v248
  v_mfma_f32_16x16x32_bf16 v[48:51], v[176:179], v[140:143], v[48:51]
  ds_read_b64_tr_b16 v[174:175], v243 offset:17408
  v_mul_f32 v249, v251, v249
  v_mul_f32 v204, s21, v204
  v_mul_f32 v205, s21, v205
  v_fma_f32 v248, v248, v220, v204
  v_mfma_f32_16x16x32_bf16 v[64:67], v[176:179], v[144:147], v[64:67]
  ds_read_b128 v[128:131], v236 offset:0
  buffer_load_dwordx4 v233, s[68:71], s35 offen offset:1024 lds
  v_fma_f32 v249, v249, v221, v205
  v_cvt_pk_bf16_f32 v194, v248, v249
  v_lshlrev_b32 v248, 16, v195
  v_and_b32 v249, 0xffff0000, v195
  v_mfma_f32_16x16x32_bf16 v[68:71], v[180:183], v[144:147], v[68:71]
  ds_read_b128 v[132:135], v236 offset:2048
  v_sub_f32 v248, v248, v250
  v_sub_f32 v249, v249, v250
  v_mul_f32 v248, v251, v248
  v_mul_f32 v249, v251, v249
  v_mfma_f32_16x16x32_bf16 v[72:75], v[184:187], v[144:147], v[72:75]
  ds_read_b128 v[136:139], v236 offset:4096
  v_mul_f32 v206, s21, v206
  v_mul_f32 v207, s21, v207
  v_fma_f32 v248, v248, v222, v206
  v_fma_f32 v249, v249, v223, v207
  v_mfma_f32_16x16x32_bf16 v[76:79], v[188:191], v[144:147], v[76:79]
  ds_read_b128 v[140:143], v236 offset:6144
  v_cvt_pk_bf16_f32 v195, v248, v249
  v_lshlrev_b32 v248, 16, v196
  v_and_b32 v249, 0xffff0000, v196
  v_sub_f32 v248, v248, v250
  v_mfma_f32_16x16x32_bf16 v[92:95], v[188:191], v[148:151], v[92:95]
  ds_read_b128 v[144:147], v236 offset:8192
  v_sub_f32 v249, v249, v250
  v_mul_f32 v248, v251, v248
  v_mul_f32 v249, v251, v249
  v_mul_f32 v208, s21, v208
  v_mfma_f32_16x16x32_bf16 v[88:91], v[184:187], v[148:151], v[88:91]
  v_mul_f32 v209, s21, v209
  v_fma_f32 v248, v248, v224, v208
  v_fma_f32 v249, v249, v225, v209
  v_cvt_pk_bf16_f32 v196, v248, v249
  v_mfma_f32_16x16x32_bf16 v[84:87], v[180:183], v[148:151], v[84:87]
  v_lshlrev_b32 v248, 16, v197
  v_and_b32 v249, 0xffff0000, v197
  v_sub_f32 v248, v248, v250
  v_sub_f32 v249, v249, v250
  v_mfma_f32_16x16x32_bf16 v[80:83], v[176:179], v[148:151], v[80:83]
  v_mul_f32 v248, v251, v248
  v_mul_f32 v249, v251, v249
  v_mul_f32 v210, s21, v210
  v_mul_f32 v211, s21, v211
  v_mfma_f32_16x16x32_bf16 v[96:99], v[176:179], v[152:155], v[96:99]
  ds_read_b128 v[148:151], v236 offset:10240
  v_fma_f32 v248, v248, v226, v210
  v_fma_f32 v249, v249, v227, v211
  v_cvt_pk_bf16_f32 v197, v248, v249
  v_lshlrev_b32 v248, 16, v198
  v_mfma_f32_16x16x32_bf16 v[100:103], v[180:183], v[152:155], v[100:103]
  v_and_b32 v249, 0xffff0000, v198
  v_sub_f32 v248, v248, v250
  v_sub_f32 v249, v249, v250
  v_mul_f32 v248, v251, v248
  v_mfma_f32_16x16x32_bf16 v[104:107], v[184:187], v[152:155], v[104:107]
  v_mul_f32 v249, v251, v249
  v_mul_f32 v212, s21, v212
  v_mul_f32 v213, s21, v213
  v_fma_f32 v248, v248, v228, v212
  v_mfma_f32_16x16x32_bf16 v[108:111], v[188:191], v[152:155], v[108:111]
  v_fma_f32 v249, v249, v229, v213
  v_cvt_pk_bf16_f32 v198, v248, v249
  v_lshlrev_b32 v248, 16, v199
  v_and_b32 v249, 0xffff0000, v199
  v_mfma_f32_16x16x32_bf16 v[124:127], v[188:191], v[156:159], v[124:127]
  ds_read_b128 v[152:155], v236 offset:12288
  v_sub_f32 v248, v248, v250
  v_sub_f32 v249, v249, v250
  v_mul_f32 v248, v251, v248
  v_mul_f32 v249, v251, v249
  v_mfma_f32_16x16x32_bf16 v[120:123], v[184:187], v[156:159], v[120:123]
  v_mul_f32 v214, s21, v214
  v_mul_f32 v215, s21, v215
  v_fma_f32 v248, v248, v230, v214
  v_fma_f32 v249, v249, v231, v215
  v_mfma_f32_16x16x32_bf16 v[116:119], v[180:183], v[156:159], v[116:119]
  v_cvt_pk_bf16_f32 v199, v248, v249
  v_mfma_f32_16x16x32_bf16 v[112:115], v[176:179], v[156:159], v[112:115]
  ds_read_b128 v[156:159], v236 offset:14336
  buffer_store_dwordx4 v[192:195], v253, s[12:15], 0 offen sc1
  buffer_store_dwordx4 v[196:199], v254, s[12:15], 0 offen offset:2048 sc1
  s_waitcnt lgkmcnt(7)
  v_mfma_f32_16x16x32_bf16 v[0:3], v[160:163], v[128:131], v[0:3]
  v_mfma_f32_16x16x32_bf16 v[4:7], v[164:167], v[128:131], v[4:7]
  v_mfma_f32_16x16x32_bf16 v[8:11], v[168:171], v[128:131], v[8:11]
  v_mfma_f32_16x16x32_bf16 v[12:15], v[172:175], v[128:131], v[12:15]
  s_waitcnt lgkmcnt(0)
  v_mfma_f32_16x16x32_bf16 v[28:31], v[172:175], v[132:135], v[28:31]
  v_mfma_f32_16x16x32_bf16 v[24:27], v[168:171], v[132:135], v[24:27]
  s_waitcnt vmcnt(8)
  s_barrier
  v_mfma_f32_16x16x32_bf16 v[20:23], v[164:167], v[132:135], v[20:23]
  v_mfma_f32_16x16x32_bf16 v[16:19], v[160:163], v[132:135], v[16:19]
  v_mfma_f32_16x16x32_bf16 v[32:35], v[160:163], v[136:139], v[32:35]
  ds_read_b64_tr_b16 v[176:177], v240 offset:32768
  s_add_u32 m0, s34, 114688
  s_mov_b32 s35, 3407872
  buffer_load_dwordx4 v234, s[72:75], s35 offen lds
  v_lshrrev_b32 v248, 4, v247
  v_lshlrev_b32 v249, 1, v248
  v_xor_b32 v249, v249, v247
  v_mfma_f32_16x16x32_bf16 v[36:39], v[164:167], v[136:139], v[36:39]
  ds_read_b64_tr_b16 v[178:179], v240 offset:33792
  v_and_b32 v249, 15, v249
  v_lshlrev_b32 v249, 4, v249
  v_lshl_add_u32 v249, v248, 13, v249
  v_mfma_f32_16x16x32_bf16 v[40:43], v[168:171], v[136:139], v[40:43]
  ds_read_b64_tr_b16 v[180:181], v241 offset:32768
  buffer_load_dwordx4 v235, s[72:75], s35 offen offset:1024 lds
  s_lshl_b32 s21, s18, 17
  s_lshl_b32 s22, s16, 8
  s_add_u32 s21, s21, s22
  v_mfma_f32_16x16x32_bf16 v[44:47], v[172:175], v[136:139], v[44:47]
  ds_read_b64_tr_b16 v[182:183], v241 offset:33792
  v_add_u32 v253, s21, v249
  v_xor_b32 v254, 128, v253
  s_mul_i32 s21, s31, 40960
  v_mfma_f32_16x16x32_bf16 v[60:63], v[172:175], v[140:143], v[60:63]
  ds_read_b64_tr_b16 v[184:185], v242 offset:32768
  s_add_u32 s21, s21, 0x100000
  v_add_u32 v255, s21, v245
  v_lshrrev_b32 v248, 2, v247
  v_mfma_f32_16x16x32_bf16 v[56:59], v[168:171], v[140:143], v[56:59]
  ds_read_b64_tr_b16 v[186:187], v242 offset:33792
  s_add_u32 m0, s28, 67584
  s_mov_b32 s35, 17280
  buffer_load_dwordx4 v232, s[68:71], s35 offen lds
  v_and_b32 v248, 3, v248
  v_lshrrev_b32 v250, 4, v247
  v_and_b32 v192, 1, v250
  v_mfma_f32_16x16x32_bf16 v[52:55], v[164:167], v[140:143], v[52:55]
  ds_read_b64_tr_b16 v[188:189], v243 offset:32768
  v_lshl_add_u32 v192, v192, 2, v248
  v_lshlrev_b32 v192, 5, v192
  v_lshl_add_u32 v192, v248, 8, v192
  v_mfma_f32_16x16x32_bf16 v[48:51], v[160:163], v[140:143], v[48:51]
  ds_read_b64_tr_b16 v[190:191], v243 offset:33792
  v_lshl_add_u32 v192, v250, 11, v192
  v_and_b32 v248, 3, v247
  v_lshl_add_u32 v192, v248, 3, v192
  v_mfma_f32_16x16x32_bf16 v[64:67], v[160:163], v[144:147], v[64:67]
  ds_read_b128 v[128:131], v238 offset:0
  buffer_load_dwordx4 v233, s[68:71], s35 offen offset:1024 lds
  v_xor_b32 v193, 32, v192
  v_xor_b32 v194, 64, v192
  v_xor_b32 v195, 96, v192
  v_mfma_f32_16x16x32_bf16 v[68:71], v[164:167], v[144:147], v[68:71]
  ds_read_b128 v[132:135], v238 offset:2048
  v_xor_b32 v196, 128, v192
  v_xor_b32 v197, 160, v192
  v_xor_b32 v198, 192, v192
  v_mfma_f32_16x16x32_bf16 v[72:75], v[168:171], v[144:147], v[72:75]
  ds_read_b128 v[136:139], v238 offset:4096
  v_xor_b32 v199, 224, v192
  v_mfma_f32_16x16x32_bf16 v[76:79], v[172:175], v[144:147], v[76:79]
  ds_read_b128 v[140:143], v238 offset:6144
  v_mfma_f32_16x16x32_bf16 v[92:95], v[172:175], v[148:151], v[92:95]
  ds_read_b128 v[144:147], v238 offset:8192
  v_mfma_f32_16x16x32_bf16 v[88:91], v[168:171], v[148:151], v[88:91]
  v_mfma_f32_16x16x32_bf16 v[84:87], v[164:167], v[148:151], v[84:87]
  v_mfma_f32_16x16x32_bf16 v[80:83], v[160:163], v[148:151], v[80:83]
  v_mfma_f32_16x16x32_bf16 v[96:99], v[160:163], v[152:155], v[96:99]
  ds_read_b128 v[148:151], v238 offset:10240
  v_mfma_f32_16x16x32_bf16 v[100:103], v[164:167], v[152:155], v[100:103]
  v_mfma_f32_16x16x32_bf16 v[104:107], v[168:171], v[152:155], v[104:107]
  v_mfma_f32_16x16x32_bf16 v[108:111], v[172:175], v[152:155], v[108:111]
  v_mfma_f32_16x16x32_bf16 v[124:127], v[172:175], v[156:159], v[124:127]
  ds_read_b128 v[152:155], v238 offset:12288
  v_mfma_f32_16x16x32_bf16 v[120:123], v[168:171], v[156:159], v[120:123]
  v_mfma_f32_16x16x32_bf16 v[116:119], v[164:167], v[156:159], v[116:119]
  v_mfma_f32_16x16x32_bf16 v[112:115], v[160:163], v[156:159], v[112:115]
  ds_read_b128 v[156:159], v238 offset:14336
  s_waitcnt lgkmcnt(7)
  v_mfma_f32_16x16x32_bf16 v[0:3], v[176:179], v[128:131], v[0:3]
  v_mfma_f32_16x16x32_bf16 v[4:7], v[180:183], v[128:131], v[4:7]
  v_mfma_f32_16x16x32_bf16 v[8:11], v[184:187], v[128:131], v[8:11]
  v_mfma_f32_16x16x32_bf16 v[12:15], v[188:191], v[128:131], v[12:15]
  s_waitcnt lgkmcnt(0)
  v_mfma_f32_16x16x32_bf16 v[28:31], v[188:191], v[132:135], v[28:31]
  v_mfma_f32_16x16x32_bf16 v[24:27], v[184:187], v[132:135], v[24:27]
  s_waitcnt vmcnt(8)
  s_waitcnt vmcnt(4)
  s_barrier
  v_mfma_f32_16x16x32_bf16 v[20:23], v[180:183], v[132:135], v[20:23]
  v_mfma_f32_16x16x32_bf16 v[16:19], v[176:179], v[132:135], v[16:19]
  s_cmp_lg_u32 s18, 0
  s_cbranch_scc1 ka_kernel_nofl_8
  v_mov_b32 v248, 1
  s_lshl_b32 s21, s2, 2
  s_add_u32 s21, s21, 0xf0000
  v_mov_b32 v249, s21
  s_mov_b64 exec, 1
  buffer_store_dword v248, v249, s[12:15], 0 offen sc1
  s_mov_b64 exec, -1
ka_kernel_nofl_8:
  v_mfma_f32_16x16x32_bf16 v[32:35], v[176:179], v[136:139], v[32:35]
  ds_read_b64_tr_b16 v[160:161], v240 offset:0
  s_add_u32 m0, s34, 131072
  s_mov_b32 s35, 3670016
  buffer_load_dwordx4 v234, s[72:75], s35 offen lds
  v_mfma_f32_16x16x32_bf16 v[36:39], v[180:183], v[136:139], v[36:39]
  ds_read_b64_tr_b16 v[162:163], v240 offset:1024
  buffer_load_dwordx4 v235, s[72:75], s35 offen offset:1024 lds
  v_mfma_f32_16x16x32_bf16 v[40:43], v[184:187], v[136:139], v[40:43]
  ds_read_b64_tr_b16 v[164:165], v241 offset:0
  v_mfma_f32_16x16x32_bf16 v[44:47], v[188:191], v[136:139], v[44:47]
  ds_read_b64_tr_b16 v[166:167], v241 offset:1024
  s_add_u32 m0, s28, 0
  s_mov_b32 s35, 0
  buffer_load_dwordx4 v253, s[8:11], s35 offen offset:0 lds
  v_mfma_f32_16x16x32_bf16 v[60:63], v[188:191], v[140:143], v[60:63]
  ds_read_b64_tr_b16 v[168:169], v242 offset:0
  v_mfma_f32_16x16x32_bf16 v[56:59], v[184:187], v[140:143], v[56:59]
  ds_read_b64_tr_b16 v[170:171], v242 offset:1024
  s_mov_b32 s35, 31744
  buffer_load_dwordx4 v253, s[8:11], s35 offen offset:1024 lds
  v_mfma_f32_16x16x32_bf16 v[52:55], v[180:183], v[140:143], v[52:55]
  ds_read_b64_tr_b16 v[172:173], v243 offset:0
  v_mfma_f32_16x16x32_bf16 v[48:51], v[176:179], v[140:143], v[48:51]
  ds_read_b64_tr_b16 v[174:175], v243 offset:1024
  s_mov_b32 s35, 63488
  buffer_load_dwordx4 v254, s[8:11], s35 offen offset:2048 lds
  v_mfma_f32_16x16x32_bf16 v[64:67], v[176:179], v[144:147], v[64:67]
  ds_read_b128 v[128:131], v236 offset:32768
  v_mfma_f32_16x16x32_bf16 v[68:71], v[180:183], v[144:147], v[68:71]
  ds_read_b128 v[132:135], v236 offset:34816
  s_mov_b32 s35, 95232
  buffer_load_dwordx4 v254, s[8:11], s35 offen offset:3072 lds
  v_mfma_f32_16x16x32_bf16 v[72:75], v[184:187], v[144:147], v[72:75]
  ds_read_b128 v[136:139], v236 offset:36864
  v_mfma_f32_16x16x32_bf16 v[76:79], v[188:191], v[144:147], v[76:79]
  ds_read_b128 v[140:143], v236 offset:38912
  v_mfma_f32_16x16x32_bf16 v[92:95], v[188:191], v[148:151], v[92:95]
  ds_read_b128 v[144:147], v236 offset:40960
  v_mfma_f32_16x16x32_bf16 v[88:91], v[184:187], v[148:151], v[88:91]
  v_mfma_f32_16x16x32_bf16 v[84:87], v[180:183], v[148:151], v[84:87]
  v_mfma_f32_16x16x32_bf16 v[80:83], v[176:179], v[148:151], v[80:83]
  v_mfma_f32_16x16x32_bf16 v[96:99], v[176:179], v[152:155], v[96:99]
  ds_read_b128 v[148:151], v236 offset:43008
  v_mfma_f32_16x16x32_bf16 v[100:103], v[180:183], v[152:155], v[100:103]
  v_mfma_f32_16x16x32_bf16 v[104:107], v[184:187], v[152:155], v[104:107]
  v_mfma_f32_16x16x32_bf16 v[108:111], v[188:191], v[152:155], v[108:111]
  v_mfma_f32_16x16x32_bf16 v[124:127], v[188:191], v[156:159], v[124:127]
  ds_read_b128 v[152:155], v236 offset:45056
  v_mfma_f32_16x16x32_bf16 v[120:123], v[184:187], v[156:159], v[120:123]
  v_mfma_f32_16x16x32_bf16 v[116:119], v[180:183], v[156:159], v[116:119]
  v_mfma_f32_16x16x32_bf16 v[112:115], v[176:179], v[156:159], v[112:115]
  ds_read_b128 v[156:159], v236 offset:47104
  s_waitcnt lgkmcnt(7)
  v_mfma_f32_16x16x32_bf16 v[0:3], v[160:163], v[128:131], v[0:3]
  v_mfma_f32_16x16x32_bf16 v[4:7], v[164:167], v[128:131], v[4:7]
  v_mfma_f32_16x16x32_bf16 v[8:11], v[168:171], v[128:131], v[8:11]
  v_mfma_f32_16x16x32_bf16 v[12:15], v[172:175], v[128:131], v[12:15]
  s_waitcnt lgkmcnt(0)
  v_mfma_f32_16x16x32_bf16 v[28:31], v[172:175], v[132:135], v[28:31]
  v_mfma_f32_16x16x32_bf16 v[24:27], v[168:171], v[132:135], v[24:27]
  s_waitcnt vmcnt(8)
  s_barrier
  v_mfma_f32_16x16x32_bf16 v[20:23], v[164:167], v[132:135], v[20:23]
  v_mfma_f32_16x16x32_bf16 v[16:19], v[160:163], v[132:135], v[16:19]
  v_mfma_f32_16x16x32_bf16 v[32:35], v[160:163], v[136:139], v[32:35]
  ds_read_b64_tr_b16 v[176:177], v240 offset:16384
  s_add_u32 m0, s34, 98304
  s_mov_b32 s35, 3932160
  buffer_load_dwordx4 v234, s[72:75], s35 offen lds
  v_mfma_f32_16x16x32_bf16 v[36:39], v[164:167], v[136:139], v[36:39]
  ds_read_b64_tr_b16 v[178:179], v240 offset:17408
  v_mfma_f32_16x16x32_bf16 v[40:43], v[168:171], v[136:139], v[40:43]
  ds_read_b64_tr_b16 v[180:181], v241 offset:16384
  buffer_load_dwordx4 v235, s[72:75], s35 offen offset:1024 lds
  v_mfma_f32_16x16x32_bf16 v[44:47], v[172:175], v[136:139], v[44:47]
  ds_read_b64_tr_b16 v[182:183], v241 offset:17408
  v_mfma_f32_16x16x32_bf16 v[60:63], v[172:175], v[140:143], v[60:63]
  ds_read_b64_tr_b16 v[184:185], v242 offset:16384
  v_mfma_f32_16x16x32_bf16 v[56:59], v[168:171], v[140:143], v[56:59]
  ds_read_b64_tr_b16 v[186:187], v242 offset:17408
  v_mfma_f32_16x16x32_bf16 v[52:55], v[164:167], v[140:143], v[52:55]
  ds_read_b64_tr_b16 v[188:189], v243 offset:16384
  v_mfma_f32_16x16x32_bf16 v[48:51], v[160:163], v[140:143], v[48:51]
  ds_read_b64_tr_b16 v[190:191], v243 offset:17408
  v_mfma_f32_16x16x32_bf16 v[64:67], v[160:163], v[144:147], v[64:67]
  ds_read_b128 v[128:131], v238 offset:32768
  v_mfma_f32_16x16x32_bf16 v[68:71], v[164:167], v[144:147], v[68:71]
  ds_read_b128 v[132:135], v238 offset:34816
  v_mfma_f32_16x16x32_bf16 v[72:75], v[168:171], v[144:147], v[72:75]
  ds_read_b128 v[136:139], v238 offset:36864
  v_mfma_f32_16x16x32_bf16 v[76:79], v[172:175], v[144:147], v[76:79]
  ds_read_b128 v[140:143], v238 offset:38912
  v_mfma_f32_16x16x32_bf16 v[92:95], v[172:175], v[148:151], v[92:95]
  ds_read_b128 v[144:147], v238 offset:40960
  v_mfma_f32_16x16x32_bf16 v[88:91], v[168:171], v[148:151], v[88:91]
  v_mfma_f32_16x16x32_bf16 v[84:87], v[164:167], v[148:151], v[84:87]
  v_mfma_f32_16x16x32_bf16 v[80:83], v[160:163], v[148:151], v[80:83]
  v_mfma_f32_16x16x32_bf16 v[96:99], v[160:163], v[152:155], v[96:99]
  ds_read_b128 v[148:151], v238 offset:43008
  v_mfma_f32_16x16x32_bf16 v[100:103], v[164:167], v[152:155], v[100:103]
  v_mfma_f32_16x16x32_bf16 v[104:107], v[168:171], v[152:155], v[104:107]
  v_mfma_f32_16x16x32_bf16 v[108:111], v[172:175], v[152:155], v[108:111]
  v_mfma_f32_16x16x32_bf16 v[124:127], v[172:175], v[156:159], v[124:127]
  ds_read_b128 v[152:155], v238 offset:45056
  v_mfma_f32_16x16x32_bf16 v[120:123], v[168:171], v[156:159], v[120:123]
  v_mfma_f32_16x16x32_bf16 v[116:119], v[164:167], v[156:159], v[116:119]
  v_mfma_f32_16x16x32_bf16 v[112:115], v[160:163], v[156:159], v[112:115]
  ds_read_b128 v[156:159], v238 offset:47104
  s_waitcnt lgkmcnt(7)
  v_mfma_f32_16x16x32_bf16 v[0:3], v[176:179], v[128:131], v[0:3]
  v_mfma_f32_16x16x32_bf16 v[4:7], v[180:183], v[128:131], v[4:7]
  v_mfma_f32_16x16x32_bf16 v[8:11], v[184:187], v[128:131], v[8:11]
  v_mfma_f32_16x16x32_bf16 v[12:15], v[188:191], v[128:131], v[12:15]
  s_waitcnt lgkmcnt(0)
  v_mfma_f32_16x16x32_bf16 v[28:31], v[188:191], v[132:135], v[28:31]
  v_mfma_f32_16x16x32_bf16 v[24:27], v[184:187], v[132:135], v[24:27]
  s_waitcnt vmcnt(6)
  s_barrier
  v_mfma_f32_16x16x32_bf16 v[20:23], v[180:183], v[132:135], v[20:23]
  v_mfma_f32_16x16x32_bf16 v[16:19], v[176:179], v[132:135], v[16:19]
  v_mfma_f32_16x16x32_bf16 v[32:35], v[176:179], v[136:139], v[32:35]
  ds_read_b64_tr_b16 v[160:161], v240 offset:32768
  v_lshrrev_b32 v248, 4, v245
  v_min_u32 v248, 7, v248
  v_lshlrev_b32 v248, 2, v248
  s_lshl_b32 s21, s16, 7
  s_add_u32 s21, s21, 0xf0400
  v_add_u32 v248, s21, v248
  buffer_load_dword v250, v248, s[12:15], 0 offen offset:32 sc1
  v_mfma_f32_16x16x32_bf16 v[36:39], v[180:183], v[136:139], v[36:39]
  ds_read_b64_tr_b16 v[162:163], v240 offset:33792
  v_mfma_f32_16x16x32_bf16 v[40:43], v[184:187], v[136:139], v[40:43]
  ds_read_b64_tr_b16 v[164:165], v241 offset:32768
  s_add_u32 m0, s28, 32768
  s_mov_b32 s35, 1048576
  buffer_load_dwordx4 v253, s[8:11], s35 offen offset:0 lds
  v_mfma_f32_16x16x32_bf16 v[44:47], v[188:191], v[136:139], v[44:47]
  ds_read_b64_tr_b16 v[166:167], v241 offset:33792
  v_mfma_f32_16x16x32_bf16 v[60:63], v[188:191], v[140:143], v[60:63]
  ds_read_b64_tr_b16 v[168:169], v242 offset:32768
  s_mov_b32 s35, 1080320
  buffer_load_dwordx4 v253, s[8:11], s35 offen offset:1024 lds
  v_mfma_f32_16x16x32_bf16 v[56:59], v[184:187], v[140:143], v[56:59]
  ds_read_b64_tr_b16 v[170:171], v242 offset:33792
  v_mfma_f32_16x16x32_bf16 v[52:55], v[180:183], v[140:143], v[52:55]
  ds_read_b64_tr_b16 v[172:173], v243 offset:32768
  s_mov_b32 s35, 1112064
  buffer_load_dwordx4 v254, s[8:11], s35 offen offset:2048 lds
  v_mfma_f32_16x16x32_bf16 v[48:51], v[176:179], v[140:143], v[48:51]
  ds_read_b64_tr_b16 v[174:175], v243 offset:33792
  v_mfma_f32_16x16x32_bf16 v[64:67], v[176:179], v[144:147], v[64:67]
  ds_read_b128 v[128:131], v237 offset:0
  s_mov_b32 s35, 1143808
  buffer_load_dwordx4 v254, s[8:11], s35 offen offset:3072 lds
  v_mfma_f32_16x16x32_bf16 v[68:71], v[180:183], v[144:147], v[68:71]
  ds_read_b128 v[132:135], v237 offset:2048
  v_mfma_f32_16x16x32_bf16 v[72:75], v[184:187], v[144:147], v[72:75]
  ds_read_b128 v[136:139], v237 offset:4096
  v_mfma_f32_16x16x32_bf16 v[76:79], v[188:191], v[144:147], v[76:79]
  ds_read_b128 v[140:143], v237 offset:6144
  v_mfma_f32_16x16x32_bf16 v[92:95], v[188:191], v[148:151], v[92:95]
  ds_read_b128 v[144:147], v237 offset:8192
  v_mfma_f32_16x16x32_bf16 v[88:91], v[184:187], v[148:151], v[88:91]
  v_mfma_f32_16x16x32_bf16 v[84:87], v[180:183], v[148:151], v[84:87]
  v_mfma_f32_16x16x32_bf16 v[80:83], v[176:179], v[148:151], v[80:83]
  v_mfma_f32_16x16x32_bf16 v[96:99], v[176:179], v[152:155], v[96:99]
  ds_read_b128 v[148:151], v237 offset:10240
  v_mfma_f32_16x16x32_bf16 v[100:103], v[180:183], v[152:155], v[100:103]
  v_mfma_f32_16x16x32_bf16 v[104:107], v[184:187], v[152:155], v[104:107]
  v_mfma_f32_16x16x32_bf16 v[108:111], v[188:191], v[152:155], v[108:111]
  v_mfma_f32_16x16x32_bf16 v[124:127], v[188:191], v[156:159], v[124:127]
  ds_read_b128 v[152:155], v237 offset:12288
  v_mfma_f32_16x16x32_bf16 v[120:123], v[184:187], v[156:159], v[120:123]
  v_mfma_f32_16x16x32_bf16 v[116:119], v[180:183], v[156:159], v[116:119]
  v_mfma_f32_16x16x32_bf16 v[112:115], v[176:179], v[156:159], v[112:115]
  ds_read_b128 v[156:159], v237 offset:14336
  s_waitcnt lgkmcnt(7)
  v_mfma_f32_16x16x32_bf16 v[0:3], v[160:163], v[128:131], v[0:3]
  v_mfma_f32_16x16x32_bf16 v[4:7], v[164:167], v[128:131], v[4:7]
  v_mfma_f32_16x16x32_bf16 v[8:11], v[168:171], v[128:131], v[8:11]
  v_mfma_f32_16x16x32_bf16 v[12:15], v[172:175], v[128:131], v[12:15]
  s_waitcnt lgkmcnt(0)
  v_mfma_f32_16x16x32_bf16 v[28:31], v[172:175], v[132:135], v[28:31]
  v_mfma_f32_16x16x32_bf16 v[24:27], v[168:171], v[132:135], v[24:27]
  s_waitcnt vmcnt(5)
  s_barrier
  v_mfma_f32_16x16x32_bf16 v[20:23], v[164:167], v[132:135], v[20:23]
  v_mfma_f32_16x16x32_bf16 v[16:19], v[160:163], v[132:135], v[16:19]
  s_cmp_lg_u32 s18, 0
  s_cbranch_scc1 ka_kernel_nopi_9
  v_lshrrev_b32 v248, 4, v245
  v_min_u32 v248, 31, v248
  v_lshlrev_b32 v248, 2, v248
  s_lshl_b32 s21, s17, 7
  s_add_u32 s21, s21, 0xf0000
  v_add_u32 v248, s21, v248
  buffer_load_dword v252, v248, s[12:15], 0 offen sc1
ka_kernel_nopi_9:
  v_mfma_f32_16x16x32_bf16 v[32:35], v[160:163], v[136:139], v[32:35]
  ds_read_b64_tr_b16 v[176:177], v240 offset:0
  v_mfma_f32_16x16x32_bf16 v[36:39], v[164:167], v[136:139], v[36:39]
  ds_read_b64_tr_b16 v[178:179], v240 offset:1024
  v_mfma_f32_16x16x32_bf16 v[40:43], v[168:171], v[136:139], v[40:43]
  ds_read_b64_tr_b16 v[180:181], v241 offset:0
  v_mfma_f32_16x16x32_bf16 v[44:47], v[172:175], v[136:139], v[44:47]
  ds_read_b64_tr_b16 v[182:183], v241 offset:1024
  v_mfma_f32_16x16x32_bf16 v[60:63], v[172:175], v[140:143], v[60:63]
  ds_read_b64_tr_b16 v[184:185], v242 offset:0
  v_mfma_f32_16x16x32_bf16 v[56:59], v[168:171], v[140:143], v[56:59]
  ds_read_b64_tr_b16 v[186:187], v242 offset:1024
  v_mfma_f32_16x16x32_bf16 v[52:55], v[164:167], v[140:143], v[52:55]
  ds_read_b64_tr_b16 v[188:189], v243 offset:0
  v_mfma_f32_16x16x32_bf16 v[48:51], v[160:163], v[140:143], v[48:51]
  ds_read_b64_tr_b16 v[190:191], v243 offset:1024
  v_mfma_f32_16x16x32_bf16 v[64:67], v[160:163], v[144:147], v[64:67]
  ds_read_b128 v[128:131], v239 offset:0
  v_mfma_f32_16x16x32_bf16 v[68:71], v[164:167], v[144:147], v[68:71]
  ds_read_b128 v[132:135], v239 offset:2048
  v_mfma_f32_16x16x32_bf16 v[72:75], v[168:171], v[144:147], v[72:75]
  ds_read_b128 v[136:139], v239 offset:4096
  v_mfma_f32_16x16x32_bf16 v[76:79], v[172:175], v[144:147], v[76:79]
  ds_read_b128 v[140:143], v239 offset:6144
  v_mfma_f32_16x16x32_bf16 v[92:95], v[172:175], v[148:151], v[92:95]
  ds_read_b128 v[144:147], v239 offset:8192
  v_mfma_f32_16x16x32_bf16 v[88:91], v[168:171], v[148:151], v[88:91]
  v_mfma_f32_16x16x32_bf16 v[84:87], v[164:167], v[148:151], v[84:87]
  v_mfma_f32_16x16x32_bf16 v[80:83], v[160:163], v[148:151], v[80:83]
  v_mfma_f32_16x16x32_bf16 v[96:99], v[160:163], v[152:155], v[96:99]
  ds_read_b128 v[148:151], v239 offset:10240
  v_mfma_f32_16x16x32_bf16 v[100:103], v[164:167], v[152:155], v[100:103]
  v_mfma_f32_16x16x32_bf16 v[104:107], v[168:171], v[152:155], v[104:107]
  v_mfma_f32_16x16x32_bf16 v[108:111], v[172:175], v[152:155], v[108:111]
  v_mfma_f32_16x16x32_bf16 v[124:127], v[172:175], v[156:159], v[124:127]
  ds_read_b128 v[152:155], v239 offset:12288
  v_mfma_f32_16x16x32_bf16 v[120:123], v[168:171], v[156:159], v[120:123]
  v_mfma_f32_16x16x32_bf16 v[116:119], v[164:167], v[156:159], v[116:119]
  v_mfma_f32_16x16x32_bf16 v[112:115], v[160:163], v[156:159], v[112:115]
  ds_read_b128 v[156:159], v239 offset:14336
  s_waitcnt lgkmcnt(7)
  v_mfma_f32_16x16x32_bf16 v[0:3], v[176:179], v[128:131], v[0:3]
  v_mfma_f32_16x16x32_bf16 v[4:7], v[180:183], v[128:131], v[4:7]
  v_mfma_f32_16x16x32_bf16 v[8:11], v[184:187], v[128:131], v[8:11]
  v_mfma_f32_16x16x32_bf16 v[12:15], v[188:191], v[128:131], v[12:15]
  s_waitcnt lgkmcnt(0)
  v_mfma_f32_16x16x32_bf16 v[28:31], v[188:191], v[132:135], v[28:31]
  v_mfma_f32_16x16x32_bf16 v[24:27], v[184:187], v[132:135], v[24:27]
  s_cmp_lg_u32 s18, 0
  s_cbranch_scc1 ka_kernel_nopc_10
  s_waitcnt vmcnt(0)
  v_lshrrev_b32 v248, 4, v245
  v_min_u32 v248, 31, v248
  v_lshlrev_b32 v248, 2, v248
  s_lshl_b32 s21, s17, 7
  s_add_u32 s21, s21, 0xf0000
  v_add_u32 v248, s21, v248
  s_mov_b32 s24, 0x40000
ka_kernel_spin_12:
  v_cmp_ne_u32 vcc, 0x1, v252
  s_cbranch_vccz ka_kernel_pok_11
  s_sleep 2
  buffer_load_dword v252, v248, s[12:15], 0 offen sc1
  s_waitcnt vmcnt(0)
  s_sub_u32 s24, s24, 1
  s_cmp_lg_u32 s24, 0
  s_cbranch_scc1 ka_kernel_spin_12
ka_kernel_pok_11:
ka_kernel_nopc_10:
  s_barrier
  v_mfma_f32_16x16x32_bf16 v[20:23], v[180:183], v[132:135], v[20:23]
  v_mfma_f32_16x16x32_bf16 v[16:19], v[176:179], v[132:135], v[16:19]
  v_mfma_f32_16x16x32_bf16 v[32:35], v[176:179], v[136:139], v[32:35]
  v_add_u32 v232, 20480, v255
  s_mov_b32 s35, 0
  buffer_load_dwordx4 v[200:203], v255, s[12:15], s35 offen sc1
  buffer_load_dwordx4 v[204:207], v232, s[12:15], s35 offen sc1
  v_mfma_f32_16x16x32_bf16 v[36:39], v[180:183], v[136:139], v[36:39]
  s_mov_b32 s35, 1024
  buffer_load_dwordx4 v[208:211], v255, s[12:15], s35 offen sc1
  v_mfma_f32_16x16x32_bf16 v[40:43], v[184:187], v[136:139], v[40:43]
  buffer_load_dwordx4 v[212:215], v232, s[12:15], s35 offen sc1
  v_mfma_f32_16x16x32_bf16 v[44:47], v[188:191], v[136:139], v[44:47]
  s_mov_b32 s35, 2048
  buffer_load_dwordx4 v[216:219], v255, s[12:15], s35 offen sc1
  v_mfma_f32_16x16x32_bf16 v[60:63], v[188:191], v[140:143], v[60:63]
  buffer_load_dwordx4 v[220:223], v232, s[12:15], s35 offen sc1
  v_mfma_f32_16x16x32_bf16 v[56:59], v[184:187], v[140:143], v[56:59]
  s_mov_b32 s35, 3072
  buffer_load_dwordx4 v[224:227], v255, s[12:15], s35 offen sc1
  v_mfma_f32_16x16x32_bf16 v[52:55], v[180:183], v[140:143], v[52:55]
  buffer_load_dwordx4 v[228:231], v232, s[12:15], s35 offen sc1
  v_mfma_f32_16x16x32_bf16 v[48:51], v[176:179], v[140:143], v[48:51]
  s_add_u32 m0, s28, 65536
  s_mov_b32 s35, 2097152
  buffer_load_dwordx4 v253, s[8:11], s35 offen offset:0 lds
  v_mfma_f32_16x16x32_bf16 v[64:67], v[176:179], v[144:147], v[64:67]
  s_mov_b32 s35, 2128896
  buffer_load_dwordx4 v253, s[8:11], s35 offen offset:1024 lds
  v_mfma_f32_16x16x32_bf16 v[68:71], v[180:183], v[144:147], v[68:71]
  s_mov_b32 s35, 2160640
  buffer_load_dwordx4 v254, s[8:11], s35 offen offset:2048 lds
  v_mfma_f32_16x16x32_bf16 v[72:75], v[184:187], v[144:147], v[72:75]
  s_mov_b32 s35, 2192384
  buffer_load_dwordx4 v254, s[8:11], s35 offen offset:3072 lds
  v_mfma_f32_16x16x32_bf16 v[76:79], v[188:191], v[144:147], v[76:79]
  v_mfma_f32_16x16x32_bf16 v[92:95], v[188:191], v[148:151], v[92:95]
  v_mfma_f32_16x16x32_bf16 v[88:91], v[184:187], v[148:151], v[88:91]
  v_mfma_f32_16x16x32_bf16 v[84:87], v[180:183], v[148:151], v[84:87]
  v_mfma_f32_16x16x32_bf16 v[80:83], v[176:179], v[148:151], v[80:83]
  v_mfma_f32_16x16x32_bf16 v[96:99], v[176:179], v[152:155], v[96:99]
  v_mfma_f32_16x16x32_bf16 v[100:103], v[180:183], v[152:155], v[100:103]
  v_mfma_f32_16x16x32_bf16 v[104:107], v[184:187], v[152:155], v[104:107]
  v_mfma_f32_16x16x32_bf16 v[108:111], v[188:191], v[152:155], v[108:111]
  v_mfma_f32_16x16x32_bf16 v[124:127], v[188:191], v[156:159], v[124:127]
  v_mfma_f32_16x16x32_bf16 v[120:123], v[184:187], v[156:159], v[120:123]
  v_mfma_f32_16x16x32_bf16 v[116:119], v[180:183], v[156:159], v[116:119]
  v_mfma_f32_16x16x32_bf16 v[112:115], v[176:179], v[156:159], v[112:115]
  v_cvt_pk_bf16_f32 v128, v0, v1
  v_cvt_pk_bf16_f32 v129, v2, v3
  v_cvt_pk_bf16_f32 v130, v4, v5
  v_cvt_pk_bf16_f32 v131, v6, v7
  v_cvt_pk_bf16_f32 v132, v8, v9
  v_cvt_pk_bf16_f32 v133, v10, v11
  v_cvt_pk_bf16_f32 v134, v12, v13
  v_cvt_pk_bf16_f32 v135, v14, v15
  v_cvt_pk_bf16_f32 v136, v16, v17
  v_cvt_pk_bf16_f32 v137, v18, v19
  v_cvt_pk_bf16_f32 v138, v20, v21
  v_cvt_pk_bf16_f32 v139, v22, v23
  v_cvt_pk_bf16_f32 v140, v24, v25
  v_cvt_pk_bf16_f32 v141, v26, v27
  v_cvt_pk_bf16_f32 v142, v28, v29
  v_cvt_pk_bf16_f32 v143, v30, v31
  v_cvt_pk_bf16_f32 v144, v32, v33
  v_cvt_pk_bf16_f32 v145, v34, v35
  v_cvt_pk_bf16_f32 v146, v36, v37
  v_cvt_pk_bf16_f32 v147, v38, v39
  v_cvt_pk_bf16_f32 v148, v40, v41
  v_cvt_pk_bf16_f32 v149, v42, v43
  v_cvt_pk_bf16_f32 v150, v44, v45
  v_cvt_pk_bf16_f32 v151, v46, v47
  v_cvt_pk_bf16_f32 v152, v48, v49
  v_cvt_pk_bf16_f32 v153, v50, v51
  v_cvt_pk_bf16_f32 v154, v52, v53
  v_cvt_pk_bf16_f32 v155, v54, v55
  v_cvt_pk_bf16_f32 v156, v56, v57
  v_cvt_pk_bf16_f32 v157, v58, v59
  v_cvt_pk_bf16_f32 v158, v60, v61
  v_cvt_pk_bf16_f32 v159, v62, v63
  v_cvt_pk_bf16_f32 v160, v64, v65
  v_cvt_pk_bf16_f32 v161, v66, v67
  v_cvt_pk_bf16_f32 v162, v68, v69
  v_cvt_pk_bf16_f32 v163, v70, v71
  v_cvt_pk_bf16_f32 v164, v72, v73
  v_cvt_pk_bf16_f32 v165, v74, v75
  v_cvt_pk_bf16_f32 v166, v76, v77
  v_cvt_pk_bf16_f32 v167, v78, v79
  v_cvt_pk_bf16_f32 v168, v80, v81
  v_cvt_pk_bf16_f32 v169, v82, v83
  v_cvt_pk_bf16_f32 v170, v84, v85
  v_cvt_pk_bf16_f32 v171, v86, v87
  v_cvt_pk_bf16_f32 v172, v88, v89
  v_cvt_pk_bf16_f32 v173, v90, v91
  v_cvt_pk_bf16_f32 v174, v92, v93
  v_cvt_pk_bf16_f32 v175, v94, v95
  v_cvt_pk_bf16_f32 v176, v96, v97
  v_cvt_pk_bf16_f32 v177, v98, v99
  v_cvt_pk_bf16_f32 v178, v100, v101
  v_cvt_pk_bf16_f32 v179, v102, v103
  v_cvt_pk_bf16_f32 v180, v104, v105
  v_cvt_pk_bf16_f32 v181, v106, v107
  v_cvt_pk_bf16_f32 v182, v108, v109
  v_cvt_pk_bf16_f32 v183, v110, v111
  v_cvt_pk_bf16_f32 v184, v112, v113
  v_cvt_pk_bf16_f32 v185, v114, v115
  v_cvt_pk_bf16_f32 v186, v116, v117
  v_cvt_pk_bf16_f32 v187, v118, v119
  v_cvt_pk_bf16_f32 v188, v120, v121
  v_cvt_pk_bf16_f32 v189, v122, v123
  v_cvt_pk_bf16_f32 v190, v124, v125
  v_cvt_pk_bf16_f32 v191, v126, v127
  s_branch ka_phase2
ka_vpath:
  s_waitcnt vmcnt(5)
  s_barrier
  ds_read_b64_tr_b16 v[160:161], v240 offset:0
  ds_read_b64_tr_b16 v[162:163], v240 offset:1024
  ds_read_b64_tr_b16 v[164:165], v241 offset:0
  ds_read_b64_tr_b16 v[166:167], v241 offset:1024
  ds_read_b64_tr_b16 v[168:169], v242 offset:0
  ds_read_b64_tr_b16 v[170:171], v242 offset:1024
  ds_read_b64_tr_b16 v[172:173], v243 offset:0
  ds_read_b64_tr_b16 v[174:175], v243 offset:1024
  ds_read_b128 v[128:131], v236 offset:32768
  ds_read_b128 v[132:135], v236 offset:34816
  ds_read_b128 v[136:139], v236 offset:36864
  ds_read_b128 v[140:143], v236 offset:38912
  ds_read_b128 v[144:147], v236 offset:40960
  ds_read_b128 v[148:151], v236 offset:43008
  ds_read_b128 v[152:155], v236 offset:45056
  ds_read_b128 v[156:159], v236 offset:47104
  s_add_u32 m0, s28, 65536
  s_mov_b32 s35, 128
  buffer_load_dwordx4 v232, s[68:71], s35 offen lds
  buffer_load_dwordx4 v233, s[68:71], s35 offen offset:1024 lds
  s_add_u32 m0, s28, 67584
  s_mov_b32 s35, 16512
  buffer_load_dwordx4 v232, s[68:71], s35 offen lds
  buffer_load_dwordx4 v233, s[68:71], s35 offen offset:1024 lds
  s_add_u32 m0, s34, 131072
  s_mov_b32 s35, 524288
  buffer_load_dwordx4 v234, s[72:75], s35 offen lds
  buffer_load_dwordx4 v235, s[72:75], s35 offen offset:1024 lds
  s_waitcnt lgkmcnt(7)
  v_mfma_f32_16x16x32_bf16 v[0:3], v[128:131], v[160:163], 0
  v_mfma_f32_16x16x32_bf16 v[4:7], v[128:131], v[164:167], 0
  v_mfma_f32_16x16x32_bf16 v[8:11], v[128:131], v[168:171], 0
  v_mfma_f32_16x16x32_bf16 v[12:15], v[128:131], v[172:175], 0
  s_waitcnt lgkmcnt(0)
  v_mfma_f32_16x16x32_bf16 v[28:31], v[132:135], v[172:175], 0
  v_mfma_f32_16x16x32_bf16 v[24:27], v[132:135], v[168:171], 0
  s_waitcnt vmcnt(9)
  s_barrier
  v_mfma_f32_16x16x32_bf16 v[20:23], v[132:135], v[164:167], 0
  v_mfma_f32_16x16x32_bf16 v[16:19], v[132:135], v[160:163], 0
  v_mfma_f32_16x16x32_bf16 v[32:35], v[136:139], v[160:163], 0
  ds_read_b64_tr_b16 v[176:177], v240 offset:16384
  v_mfma_f32_16x16x32_bf16 v[36:39], v[136:139], v[164:167], 0
  ds_read_b64_tr_b16 v[178:179], v240 offset:17408
  v_mfma_f32_16x16x32_bf16 v[40:43], v[136:139], v[168:171], 0
  ds_read_b64_tr_b16 v[180:181], v241 offset:16384
  v_mfma_f32_16x16x32_bf16 v[44:47], v[136:139], v[172:175], 0
  ds_read_b64_tr_b16 v[182:183], v241 offset:17408
  v_mfma_f32_16x16x32_bf16 v[60:63], v[140:143], v[172:175], 0
  ds_read_b64_tr_b16 v[184:185], v242 offset:16384
  v_mfma_f32_16x16x32_bf16 v[56:59], v[140:143], v[168:171], 0
  ds_read_b64_tr_b16 v[186:187], v242 offset:17408
  v_mfma_f32_16x16x32_bf16 v[52:55], v[140:143], v[164:167], 0
  ds_read_b64_tr_b16 v[188:189], v243 offset:16384
  v_mfma_f32_16x16x32_bf16 v[48:51], v[140:143], v[160:163], 0
  ds_read_b64_tr_b16 v[190:191], v243 offset:17408
  v_mfma_f32_16x16x32_bf16 v[64:67], v[144:147], v[160:163], 0
  ds_read_b128 v[128:131], v238 offset:32768
  v_mfma_f32_16x16x32_bf16 v[68:71], v[144:147], v[164:167], 0
  ds_read_b128 v[132:135], v238 offset:34816
  v_mfma_f32_16x16x32_bf16 v[72:75], v[144:147], v[168:171], 0
  ds_read_b128 v[136:139], v238 offset:36864
  v_mfma_f32_16x16x32_bf16 v[76:79], v[144:147], v[172:175], 0
  ds_read_b128 v[140:143], v238 offset:38912
  s_add_u32 m0, s34, 98304
  s_mov_b32 s35, 786432
  buffer_load_dwordx4 v234, s[72:75], s35 offen lds
  v_mfma_f32_16x16x32_bf16 v[92:95], v[148:151], v[172:175], 0
  ds_read_b128 v[144:147], v238 offset:40960
  buffer_load_dwordx4 v235, s[72:75], s35 offen offset:1024 lds
  v_mfma_f32_16x16x32_bf16 v[88:91], v[148:151], v[168:171], 0
  v_mfma_f32_16x16x32_bf16 v[84:87], v[148:151], v[164:167], 0
  s_add_u32 m0, s28, 0
  s_mov_b32 s35, 256
  buffer_load_dwordx4 v232, s[68:71], s35 offen lds
  v_mfma_f32_16x16x32_bf16 v[80:83], v[148:151], v[160:163], 0
  v_mfma_f32_16x16x32_bf16 v[96:99], v[152:155], v[160:163], 0
  ds_read_b128 v[148:151], v238 offset:43008
  buffer_load_dwordx4 v233, s[68:71], s35 offen offset:1024 lds
  v_mfma_f32_16x16x32_bf16 v[100:103], v[152:155], v[164:167], 0
  v_mfma_f32_16x16x32_bf16 v[104:107], v[152:155], v[168:171], 0
  s_add_u32 m0, s28, 2048
  s_mov_b32 s35, 16640
  buffer_load_dwordx4 v232, s[68:71], s35 offen lds
  v_mfma_f32_16x16x32_bf16 v[108:111], v[152:155], v[172:175], 0
  v_mfma_f32_16x16x32_bf16 v[124:127], v[156:159], v[172:175], 0
  ds_read_b128 v[152:155], v238 offset:45056
  buffer_load_dwordx4 v233, s[68:71], s35 offen offset:1024 lds
  v_mfma_f32_16x16x32_bf16 v[120:123], v[156:159], v[168:171], 0
  v_mfma_f32_16x16x32_bf16 v[116:119], v[156:159], v[164:167], 0
  v_mfma_f32_16x16x32_bf16 v[112:115], v[156:159], v[160:163], 0
  ds_read_b128 v[156:159], v238 offset:47104
  s_waitcnt lgkmcnt(7)
  v_mfma_f32_16x16x32_bf16 v[0:3], v[128:131], v[176:179], v[0:3]
  v_mfma_f32_16x16x32_bf16 v[4:7], v[128:131], v[180:183], v[4:7]
  v_mfma_f32_16x16x32_bf16 v[8:11], v[128:131], v[184:187], v[8:11]
  v_mfma_f32_16x16x32_bf16 v[12:15], v[128:131], v[188:191], v[12:15]
  s_waitcnt lgkmcnt(0)
  v_mfma_f32_16x16x32_bf16 v[28:31], v[132:135], v[188:191], v[28:31]
  v_mfma_f32_16x16x32_bf16 v[24:27], v[132:135], v[184:187], v[24:27]
  s_waitcnt vmcnt(6)
  s_barrier
  v_mfma_f32_16x16x32_bf16 v[20:23], v[132:135], v[180:183], v[20:23]
  v_mfma_f32_16x16x32_bf16 v[16:19], v[132:135], v[176:179], v[16:19]
  v_mfma_f32_16x16x32_bf16 v[32:35], v[136:139], v[176:179], v[32:35]
  ds_read_b64_tr_b16 v[160:161], v240 offset:32768
  v_lshlrev_b32 v248, 16, v192
  v_and_b32 v249, 0xffff0000, v192
  v_add_f32 v250, v248, v249
  v_mfma_f32_16x16x32_bf16 v[36:39], v[136:139], v[180:183], v[36:39]
  ds_read_b64_tr_b16 v[162:163], v240 offset:33792
  v_mul_f32 v251, v248, v248
  v_fmac_f32 v251, v249, v249
  v_lshlrev_b32 v248, 16, v193
  v_mfma_f32_16x16x32_bf16 v[40:43], v[136:139], v[184:187], v[40:43]
  ds_read_b64_tr_b16 v[164:165], v241 offset:32768
  v_and_b32 v249, 0xffff0000, v193
  v_add_f32 v250, v250, v248
  v_add_f32 v250, v250, v249
  v_mfma_f32_16x16x32_bf16 v[44:47], v[136:139], v[188:191], v[44:47]
  ds_read_b64_tr_b16 v[166:167], v241 offset:33792
  v_fmac_f32 v251, v248, v248
  v_fmac_f32 v251, v249, v249
  v_lshlrev_b32 v248, 16, v194
  v_mfma_f32_16x16x32_bf16 v[60:63], v[140:143], v[188:191], v[60:63]
  ds_read_b64_tr_b16 v[168:169], v242 offset:32768
  v_and_b32 v249, 0xffff0000, v194
  v_add_f32 v250, v250, v248
  v_add_f32 v250, v250, v249
  v_mfma_f32_16x16x32_bf16 v[56:59], v[140:143], v[184:187], v[56:59]
  ds_read_b64_tr_b16 v[170:171], v242 offset:33792
  v_fmac_f32 v251, v248, v248
  v_fmac_f32 v251, v249, v249
  v_lshlrev_b32 v248, 16, v195
  v_mfma_f32_16x16x32_bf16 v[52:55], v[140:143], v[180:183], v[52:55]
  ds_read_b64_tr_b16 v[172:173], v243 offset:32768
  v_and_b32 v249, 0xffff0000, v195
  v_add_f32 v250, v250, v248
  v_add_f32 v250, v250, v249
  v_mfma_f32_16x16x32_bf16 v[48:51], v[140:143], v[176:179], v[48:51]
  ds_read_b64_tr_b16 v[174:175], v243 offset:33792
  v_fmac_f32 v251, v248, v248
  v_fmac_f32 v251, v249, v249
  v_lshlrev_b32 v248, 16, v196
  v_mfma_f32_16x16x32_bf16 v[64:67], v[144:147], v[176:179], v[64:67]
  ds_read_b128 v[128:131], v237 offset:0
  v_and_b32 v249, 0xffff0000, v196
  v_add_f32 v250, v250, v248
  v_add_f32 v250, v250, v249
  v_mfma_f32_16x16x32_bf16 v[68:71], v[144:147], v[180:183], v[68:71]
  ds_read_b128 v[132:135], v237 offset:2048
  v_fmac_f32 v251, v248, v248
  v_fmac_f32 v251, v249, v249
  v_lshlrev_b32 v248, 16, v197
  v_mfma_f32_16x16x32_bf16 v[72:75], v[144:147], v[184:187], v[72:75]
  ds_read_b128 v[136:139], v237 offset:4096
  v_and_b32 v249, 0xffff0000, v197
  v_add_f32 v250, v250, v248
  v_add_f32 v250, v250, v249
  v_mfma_f32_16x16x32_bf16 v[76:79], v[144:147], v[188:191], v[76:79]
  ds_read_b128 v[140:143], v237 offset:6144
  s_add_u32 m0, s34, 114688
  s_mov_b32 s35, 1048576
  buffer_load_dwordx4 v234, s[72:75], s35 offen lds
  v_fmac_f32 v251, v248, v248
  v_fmac_f32 v251, v249, v249
  v_lshlrev_b32 v248, 16, v198
  v_mfma_f32_16x16x32_bf16 v[92:95], v[148:151], v[188:191], v[92:95]
  ds_read_b128 v[144:147], v237 offset:8192
  v_and_b32 v249, 0xffff0000, v198
  v_add_f32 v250, v250, v248
  v_add_f32 v250, v250, v249
  v_mfma_f32_16x16x32_bf16 v[88:91], v[148:151], v[184:187], v[88:91]
  buffer_load_dwordx4 v235, s[72:75], s35 offen offset:1024 lds
  v_fmac_f32 v251, v248, v248
  v_fmac_f32 v251, v249, v249
  v_lshlrev_b32 v248, 16, v199
  v_mfma_f32_16x16x32_bf16 v[84:87], v[148:151], v[180:183], v[84:87]
  v_and_b32 v249, 0xffff0000, v199
  v_add_f32 v250, v250, v248
  v_add_f32 v250, v250, v249
  v_mfma_f32_16x16x32_bf16 v[80:83], v[148:151], v[176:179], v[80:83]
  v_fmac_f32 v251, v248, v248
  v_fmac_f32 v251, v249, v249
  v_add_f32_dpp v250, v250, v250 row_ror:8 row_mask:0xf bank_mask:0xf
  v_mfma_f32_16x16x32_bf16 v[96:99], v[152:155], v[176:179], v[96:99]
  ds_read_b128 v[148:151], v237 offset:10240
  s_add_u32 m0, s28, 32768
  s_mov_b32 s35, 384
  buffer_load_dwordx4 v232, s[68:71], s35 offen lds
  v_add_f32_dpp v251, v251, v251 row_ror:8 row_mask:0xf bank_mask:0xf
  v_mov_b32 v248, v250
  v_mov_b32 v249, v251
  v_mfma_f32_16x16x32_bf16 v[100:103], v[152:155], v[180:183], v[100:103]
  v_permlane16_swap_b32 v250, v248
  v_permlane16_swap_b32 v251, v249
  v_add_f32 v250, v250, v248
  v_mfma_f32_16x16x32_bf16 v[104:107], v[152:155], v[184:187], v[104:107]
  v_add_f32 v251, v251, v249
  v_mov_b32 v248, v250
  v_mov_b32 v249, v251
  v_mfma_f32_16x16x32_bf16 v[108:111], v[152:155], v[188:191], v[108:111]
  buffer_load_dwordx4 v233, s[68:71], s35 offen offset:1024 lds
  v_permlane32_swap_b32 v250, v248
  v_permlane32_swap_b32 v251, v249
  v_add_f32 v250, v250, v248
  v_mfma_f32_16x16x32_bf16 v[124:127], v[156:159], v[188:191], v[124:127]
  ds_read_b128 v[152:155], v237 offset:12288
  v_add_f32 v251, v251, v249
  v_and_b32 v248, 7, v247
  v_lshlrev_b32 v248, 6, v248
  v_mfma_f32_16x16x32_bf16 v[120:123], v[156:159], v[184:187], v[120:123]
  v_add_u32 v200, 151552, v248
  s_lshl_b32 s21, s18, 3
  v_add_u32 v248, s21, v200
  v_mfma_f32_16x16x32_bf16 v[116:119], v[156:159], v[180:183], v[116:119]
  v_mfma_f32_16x16x32_bf16 v[112:115], v[156:159], v[176:179], v[112:115]
  ds_read_b128 v[156:159], v237 offset:14336
  s_waitcnt lgkmcnt(7)
  ds_write_b64 v248, v[250:251]
  v_mfma_f32_16x16x32_bf16 v[0:3], v[128:131], v[160:163], v[0:3]
  v_mfma_f32_16x16x32_bf16 v[4:7], v[128:131], v[164:167], v[4:7]
  v_mfma_f32_16x16x32_bf16 v[8:11], v[128:131], v[168:171], v[8:11]
  v_mfma_f32_16x16x32_bf16 v[12:15], v[128:131], v[172:175], v[12:15]
  s_waitcnt lgkmcnt(0)
  v_mfma_f32_16x16x32_bf16 v[28:31], v[132:135], v[172:175], v[28:31]
  v_mfma_f32_16x16x32_bf16 v[24:27], v[132:135], v[168:171], v[24:27]
  s_waitcnt vmcnt(8)
  s_barrier
  v_mfma_f32_16x16x32_bf16 v[20:23], v[132:135], v[164:167], v[20:23]
  v_mfma_f32_16x16x32_bf16 v[16:19], v[132:135], v[160:163], v[16:19]
  v_mfma_f32_16x16x32_bf16 v[32:35], v[136:139], v[160:163], v[32:35]
  ds_read_b64_tr_b16 v[176:177], v240 offset:0
  v_mfma_f32_16x16x32_bf16 v[36:39], v[136:139], v[164:167], v[36:39]
  ds_read_b64_tr_b16 v[178:179], v240 offset:1024
  v_mfma_f32_16x16x32_bf16 v[40:43], v[136:139], v[168:171], v[40:43]
  ds_read_b64_tr_b16 v[180:181], v241 offset:0
  v_mfma_f32_16x16x32_bf16 v[44:47], v[136:139], v[172:175], v[44:47]
  ds_read_b64_tr_b16 v[182:183], v241 offset:1024
  v_mfma_f32_16x16x32_bf16 v[60:63], v[140:143], v[172:175], v[60:63]
  ds_read_b64_tr_b16 v[184:185], v242 offset:0
  v_mfma_f32_16x16x32_bf16 v[56:59], v[140:143], v[168:171], v[56:59]
  ds_read_b64_tr_b16 v[186:187], v242 offset:1024
  v_mfma_f32_16x16x32_bf16 v[52:55], v[140:143], v[164:167], v[52:55]
  ds_read_b64_tr_b16 v[188:189], v243 offset:0
  v_mfma_f32_16x16x32_bf16 v[48:51], v[140:143], v[160:163], v[48:51]
  ds_read_b64_tr_b16 v[190:191], v243 offset:1024
  v_mfma_f32_16x16x32_bf16 v[64:67], v[144:147], v[160:163], v[64:67]
  ds_read_b128 v[128:131], v239 offset:0
  v_mfma_f32_16x16x32_bf16 v[68:71], v[144:147], v[164:167], v[68:71]
  ds_read_b128 v[132:135], v239 offset:2048
  v_mfma_f32_16x16x32_bf16 v[72:75], v[144:147], v[168:171], v[72:75]
  ds_read_b128 v[136:139], v239 offset:4096
  v_mfma_f32_16x16x32_bf16 v[76:79], v[144:147], v[172:175], v[76:79]
  ds_read_b128 v[140:143], v239 offset:6144
  s_add_u32 m0, s34, 131072
  s_mov_b32 s35, 1310720
  buffer_load_dwordx4 v234, s[72:75], s35 offen lds
  v_mfma_f32_16x16x32_bf16 v[92:95], v[148:151], v[172:175], v[92:95]
  ds_read_b128 v[144:147], v239 offset:8192
  v_mfma_f32_16x16x32_bf16 v[88:91], v[148:151], v[168:171], v[88:91]
  buffer_load_dwordx4 v235, s[72:75], s35 offen offset:1024 lds
  v_mfma_f32_16x16x32_bf16 v[84:87], v[148:151], v[164:167], v[84:87]
  v_mfma_f32_16x16x32_bf16 v[80:83], v[148:151], v[160:163], v[80:83]
  v_mfma_f32_16x16x32_bf16 v[96:99], v[152:155], v[160:163], v[96:99]
  ds_read_b128 v[148:151], v239 offset:10240
  s_add_u32 m0, s28, 34816
  s_mov_b32 s35, 16768
  buffer_load_dwordx4 v232, s[68:71], s35 offen lds
  v_mfma_f32_16x16x32_bf16 v[100:103], v[152:155], v[164:167], v[100:103]
  v_mfma_f32_16x16x32_bf16 v[104:107], v[152:155], v[168:171], v[104:107]
  v_mfma_f32_16x16x32_bf16 v[108:111], v[152:155], v[172:175], v[108:111]
  buffer_load_dwordx4 v233, s[68:71], s35 offen offset:1024 lds
  v_mfma_f32_16x16x32_bf16 v[124:127], v[156:159], v[172:175], v[124:127]
  ds_read_b128 v[152:155], v239 offset:12288
  v_mfma_f32_16x16x32_bf16 v[120:123], v[156:159], v[168:171], v[120:123]
  v_mfma_f32_16x16x32_bf16 v[116:119], v[156:159], v[164:167], v[116:119]
  v_mfma_f32_16x16x32_bf16 v[112:115], v[156:159], v[160:163], v[112:115]
  ds_read_b128 v[156:159], v239 offset:14336
  s_waitcnt lgkmcnt(7)
  ds_read_b128 v[216:219], v200 offset:0
  ds_read_b128 v[220:223], v200 offset:16
  ds_read_b128 v[224:227], v200 offset:32
  ds_read_b128 v[228:231], v200 offset:48
  v_mfma_f32_16x16x32_bf16 v[0:3], v[128:131], v[176:179], v[0:3]
  v_mfma_f32_16x16x32_bf16 v[4:7], v[128:131], v[180:183], v[4:7]
  v_mfma_f32_16x16x32_bf16 v[8:11], v[128:131], v[184:187], v[8:11]
  v_mfma_f32_16x16x32_bf16 v[12:15], v[128:131], v[188:191], v[12:15]
  s_waitcnt lgkmcnt(0)
  v_mfma_f32_16x16x32_bf16 v[28:31], v[132:135], v[188:191], v[28:31]
  v_mfma_f32_16x16x32_bf16 v[24:27], v[132:135], v[184:187], v[24:27]
  s_waitcnt vmcnt(6)
  s_barrier
  v_mfma_f32_16x16x32_bf16 v[20:23], v[132:135], v[180:183], v[20:23]
  v_mfma_f32_16x16x32_bf16 v[16:19], v[132:135], v[176:179], v[16:19]
  v_mfma_f32_16x16x32_bf16 v[32:35], v[136:139], v[176:179], v[32:35]
  ds_read_b64_tr_b16 v[160:161], v240 offset:16384
  v_add_f32 v216, v216, v218
  v_add_f32 v217, v217, v219
  v_add_f32 v216, v216, v220
  v_mfma_f32_16x16x32_bf16 v[36:39], v[136:139], v[180:183], v[36:39]
  ds_read_b64_tr_b16 v[162:163], v240 offset:17408
  v_add_f32 v217, v217, v221
  v_add_f32 v216, v216, v222
  v_add_f32 v217, v217, v223
  v_mfma_f32_16x16x32_bf16 v[40:43], v[136:139], v[184:187], v[40:43]
  ds_read_b64_tr_b16 v[164:165], v241 offset:16384
  v_add_f32 v216, v216, v224
  v_add_f32 v217, v217, v225
  v_add_f32 v216, v216, v226
  v_mfma_f32_16x16x32_bf16 v[44:47], v[136:139], v[188:191], v[44:47]
  ds_read_b64_tr_b16 v[166:167], v241 offset:17408
  v_add_f32 v217, v217, v227
  v_add_f32 v216, v216, v228
  v_add_f32 v217, v217, v229
  v_mfma_f32_16x16x32_bf16 v[60:63], v[140:143], v[188:191], v[60:63]
  ds_read_b64_tr_b16 v[168:169], v242 offset:16384
  v_add_f32 v216, v216, v230
  v_add_f32 v217, v217, v231
  v_mul_f32 v250, 0x3acccccd, v216
  v_mfma_f32_16x16x32_bf16 v[56:59], v[140:143], v[184:187], v[56:59]
  ds_read_b64_tr_b16 v[170:171], v242 offset:17408
  v_mul_f32 v251, 0x3acccccd, v217
  v_fma_f32 v251, -v250, v250, v251
  v_max_f32 v251, 0, v251
  v_mfma_f32_16x16x32_bf16 v[52:55], v[140:143], v[180:183], v[52:55]
  ds_read_b64_tr_b16 v[172:173], v243 offset:16384
  v_add_f32 v251, 0x3727c5ac, v251
  v_rsq_f32 v251, v251
  s_nop 0
  v_mul_f32 v251, 0x3e0293ee, v251
  v_mfma_f32_16x16x32_bf16 v[48:51], v[140:143], v[176:179], v[48:51]
  ds_read_b64_tr_b16 v[174:175], v243 offset:17408
  v_mfma_f32_16x16x32_bf16 v[64:67], v[144:147], v[176:179], v[64:67]
  ds_read_b128 v[128:131], v236 offset:0
  v_mfma_f32_16x16x32_bf16 v[68:71], v[144:147], v[180:183], v[68:71]
  ds_read_b128 v[132:135], v236 offset:2048
  v_mfma_f32_16x16x32_bf16 v[72:75], v[144:147], v[184:187], v[72:75]
  ds_read_b128 v[136:139], v236 offset:4096
  v_mfma_f32_16x16x32_bf16 v[76:79], v[144:147], v[188:191], v[76:79]
  ds_read_b128 v[140:143], v236 offset:6144
  s_add_u32 m0, s34, 98304
  s_mov_b32 s35, 1572864
  buffer_load_dwordx4 v234, s[72:75], s35 offen lds
  v_mfma_f32_16x16x32_bf16 v[92:95], v[148:151], v[188:191], v[92:95]
  ds_read_b128 v[144:147], v236 offset:8192
  v_mfma_f32_16x16x32_bf16 v[88:91], v[148:151], v[184:187], v[88:91]
  buffer_load_dwordx4 v235, s[72:75], s35 offen offset:1024 lds
  v_mfma_f32_16x16x32_bf16 v[84:87], v[148:151], v[180:183], v[84:87]
  v_mfma_f32_16x16x32_bf16 v[80:83], v[148:151], v[176:179], v[80:83]
  v_mfma_f32_16x16x32_bf16 v[96:99], v[152:155], v[176:179], v[96:99]
  ds_read_b128 v[148:151], v236 offset:10240
  s_add_u32 m0, s28, 65536
  s_mov_b32 s35, 512
  buffer_load_dwordx4 v232, s[68:71], s35 offen lds
  v_mfma_f32_16x16x32_bf16 v[100:103], v[152:155], v[180:183], v[100:103]
  v_mfma_f32_16x16x32_bf16 v[104:107], v[152:155], v[184:187], v[104:107]
  v_mfma_f32_16x16x32_bf16 v[108:111], v[152:155], v[188:191], v[108:111]
  buffer_load_dwordx4 v233, s[68:71], s35 offen offset:1024 lds
  v_mfma_f32_16x16x32_bf16 v[124:127], v[156:159], v[188:191], v[124:127]
  ds_read_b128 v[152:155], v236 offset:12288
  v_mfma_f32_16x16x32_bf16 v[120:123], v[156:159], v[184:187], v[120:123]
  v_mfma_f32_16x16x32_bf16 v[116:119], v[156:159], v[180:183], v[116:119]
  v_mfma_f32_16x16x32_bf16 v[112:115], v[156:159], v[176:179], v[112:115]
  ds_read_b128 v[156:159], v236 offset:14336
  s_waitcnt lgkmcnt(7)
  v_mfma_f32_16x16x32_bf16 v[0:3], v[128:131], v[160:163], v[0:3]
  v_mfma_f32_16x16x32_bf16 v[4:7], v[128:131], v[164:167], v[4:7]
  v_mfma_f32_16x16x32_bf16 v[8:11], v[128:131], v[168:171], v[8:11]
  v_mfma_f32_16x16x32_bf16 v[12:15], v[128:131], v[172:175], v[12:15]
  s_waitcnt lgkmcnt(0)
  v_mfma_f32_16x16x32_bf16 v[28:31], v[132:135], v[172:175], v[28:31]
  v_mfma_f32_16x16x32_bf16 v[24:27], v[132:135], v[168:171], v[24:27]
  s_waitcnt vmcnt(6)
  s_barrier
  v_mfma_f32_16x16x32_bf16 v[20:23], v[132:135], v[164:167], v[20:23]
  v_mfma_f32_16x16x32_bf16 v[16:19], v[132:135], v[160:163], v[16:19]
  v_mfma_f32_16x16x32_bf16 v[32:35], v[136:139], v[160:163], v[32:35]
  ds_read_b64_tr_b16 v[176:177], v240 offset:32768
  v_mfma_f32_16x16x32_bf16 v[36:39], v[136:139], v[164:167], v[36:39]
  ds_read_b64_tr_b16 v[178:179], v240 offset:33792
  v_mfma_f32_16x16x32_bf16 v[40:43], v[136:139], v[168:171], v[40:43]
  ds_read_b64_tr_b16 v[180:181], v241 offset:32768
  v_mfma_f32_16x16x32_bf16 v[44:47], v[136:139], v[172:175], v[44:47]
  ds_read_b64_tr_b16 v[182:183], v241 offset:33792
  v_mfma_f32_16x16x32_bf16 v[60:63], v[140:143], v[172:175], v[60:63]
  ds_read_b64_tr_b16 v[184:185], v242 offset:32768
  v_mfma_f32_16x16x32_bf16 v[56:59], v[140:143], v[168:171], v[56:59]
  ds_read_b64_tr_b16 v[186:187], v242 offset:33792
  v_mfma_f32_16x16x32_bf16 v[52:55], v[140:143], v[164:167], v[52:55]
  ds_read_b64_tr_b16 v[188:189], v243 offset:32768
  v_mfma_f32_16x16x32_bf16 v[48:51], v[140:143], v[160:163], v[48:51]
  ds_read_b64_tr_b16 v[190:191], v243 offset:33792
  v_mfma_f32_16x16x32_bf16 v[64:67], v[144:147], v[160:163], v[64:67]
  ds_read_b128 v[128:131], v238 offset:0
  v_mfma_f32_16x16x32_bf16 v[68:71], v[144:147], v[164:167], v[68:71]
  ds_read_b128 v[132:135], v238 offset:2048
  v_mfma_f32_16x16x32_bf16 v[72:75], v[144:147], v[168:171], v[72:75]
  ds_read_b128 v[136:139], v238 offset:4096
  v_mfma_f32_16x16x32_bf16 v[76:79], v[144:147], v[172:175], v[76:79]
  ds_read_b128 v[140:143], v238 offset:6144
  s_add_u32 m0, s34, 114688
  s_mov_b32 s35, 1835008
  buffer_load_dwordx4 v234, s[72:75], s35 offen lds
  v_mfma_f32_16x16x32_bf16 v[92:95], v[148:151], v[172:175], v[92:95]
  ds_read_b128 v[144:147], v238 offset:8192
  v_mfma_f32_16x16x32_bf16 v[88:91], v[148:151], v[168:171], v[88:91]
  buffer_load_dwordx4 v235, s[72:75], s35 offen offset:1024 lds
  v_mfma_f32_16x16x32_bf16 v[84:87], v[148:151], v[164:167], v[84:87]
  v_mfma_f32_16x16x32_bf16 v[80:83], v[148:151], v[160:163], v[80:83]
  s_add_u32 m0, s28, 67584
  s_mov_b32 s35, 16896
  buffer_load_dwordx4 v232, s[68:71], s35 offen lds
  v_mfma_f32_16x16x32_bf16 v[96:99], v[152:155], v[160:163], v[96:99]
  ds_read_b128 v[148:151], v238 offset:10240
  v_mfma_f32_16x16x32_bf16 v[100:103], v[152:155], v[164:167], v[100:103]
  buffer_load_dwordx4 v233, s[68:71], s35 offen offset:1024 lds
  v_mfma_f32_16x16x32_bf16 v[104:107], v[152:155], v[168:171], v[104:107]
  v_mfma_f32_16x16x32_bf16 v[108:111], v[152:155], v[172:175], v[108:111]
  v_lshrrev_b32 v248, 1, v247
  s_mul_i32 s21, s17, 80
  s_mul_i32 s22, s18, 10
  s_add_u32 s21, s21, s22
  v_add_u32 v248, s21, v248
  v_lshlrev_b32 v248, 13, v248
  v_and_b32 v249, 1, v247
  v_lshl_add_u32 v248, v249, 7, v248
  s_lshl_b32 s21, s16, 8
  v_add_u32 v248, s21, v248
  v_cmp_gt_u32 vcc, 20, v247
  v_mov_b32 v249, 0x40000000
  s_nop 0
  v_cndmask_b32 v248, v249, v248, vcc
  buffer_load_dword v252, v248, s[8:11], 0 offen
  v_mfma_f32_16x16x32_bf16 v[124:127], v[156:159], v[172:175], v[124:127]
  ds_read_b128 v[152:155], v238 offset:12288
  v_mfma_f32_16x16x32_bf16 v[120:123], v[156:159], v[168:171], v[120:123]
  v_mfma_f32_16x16x32_bf16 v[116:119], v[156:159], v[164:167], v[116:119]
  v_mfma_f32_16x16x32_bf16 v[112:115], v[156:159], v[160:163], v[112:115]
  ds_read_b128 v[156:159], v238 offset:14336
  s_waitcnt lgkmcnt(7)
  v_mfma_f32_16x16x32_bf16 v[0:3], v[128:131], v[176:179], v[0:3]
  v_mfma_f32_16x16x32_bf16 v[4:7], v[128:131], v[180:183], v[4:7]
  v_mfma_f32_16x16x32_bf16 v[8:11], v[128:131], v[184:187], v[8:11]
  v_mfma_f32_16x16x32_bf16 v[12:15], v[128:131], v[188:191], v[12:15]
  s_waitcnt lgkmcnt(0)
  v_mfma_f32_16x16x32_bf16 v[28:31], v[132:135], v[188:191], v[28:31]
  v_mfma_f32_16x16x32_bf16 v[24:27], v[132:135], v[184:187], v[24:27]
  s_waitcnt vmcnt(7)
  s_barrier
  v_mfma_f32_16x16x32_bf16 v[20:23], v[132:135], v[180:183], v[20:23]
  v_mfma_f32_16x16x32_bf16 v[16:19], v[132:135], v[176:179], v[16:19]
  v_mfma_f32_16x16x32_bf16 v[32:35], v[136:139], v[176:179], v[32:35]
  ds_read_b64_tr_b16 v[160:161], v240 offset:0
  v_mfma_f32_16x16x32_bf16 v[36:39], v[136:139], v[180:183], v[36:39]
  ds_read_b64_tr_b16 v[162:163], v240 offset:1024
  v_mfma_f32_16x16x32_bf16 v[40:43], v[136:139], v[184:187], v[40:43]
  ds_read_b64_tr_b16 v[164:165], v241 offset:0
  v_mfma_f32_16x16x32_bf16 v[44:47], v[136:139], v[188:191], v[44:47]
  ds_read_b64_tr_b16 v[166:167], v241 offset:1024
  v_mfma_f32_16x16x32_bf16 v[60:63], v[140:143], v[188:191], v[60:63]
  ds_read_b64_tr_b16 v[168:169], v242 offset:0
  v_mfma_f32_16x16x32_bf16 v[56:59], v[140:143], v[184:187], v[56:59]
  ds_read_b64_tr_b16 v[170:171], v242 offset:1024
  v_mfma_f32_16x16x32_bf16 v[52:55], v[140:143], v[180:183], v[52:55]
  ds_read_b64_tr_b16 v[172:173], v243 offset:0
  v_mfma_f32_16x16x32_bf16 v[48:51], v[140:143], v[176:179], v[48:51]
  ds_read_b64_tr_b16 v[174:175], v243 offset:1024
  v_mfma_f32_16x16x32_bf16 v[64:67], v[144:147], v[176:179], v[64:67]
  ds_read_b128 v[128:131], v236 offset:32768
  v_mfma_f32_16x16x32_bf16 v[68:71], v[144:147], v[180:183], v[68:71]
  ds_read_b128 v[132:135], v236 offset:34816
  v_mfma_f32_16x16x32_bf16 v[72:75], v[144:147], v[184:187], v[72:75]
  ds_read_b128 v[136:139], v236 offset:36864
  v_mfma_f32_16x16x32_bf16 v[76:79], v[144:147], v[188:191], v[76:79]
  ds_read_b128 v[140:143], v236 offset:38912
  s_add_u32 m0, s34, 131072
  s_mov_b32 s35, 2097152
  buffer_load_dwordx4 v234, s[72:75], s35 offen lds
  v_mfma_f32_16x16x32_bf16 v[92:95], v[148:151], v[188:191], v[92:95]
  ds_read_b128 v[144:147], v236 offset:40960
  v_mfma_f32_16x16x32_bf16 v[88:91], v[148:151], v[184:187], v[88:91]
  buffer_load_dwordx4 v235, s[72:75], s35 offen offset:1024 lds
  v_mfma_f32_16x16x32_bf16 v[84:87], v[148:151], v[180:183], v[84:87]
  v_mfma_f32_16x16x32_bf16 v[80:83], v[148:151], v[176:179], v[80:83]
  v_mfma_f32_16x16x32_bf16 v[96:99], v[152:155], v[176:179], v[96:99]
  ds_read_b128 v[148:151], v236 offset:43008
  s_add_u32 m0, s28, 0
  s_mov_b32 s35, 640
  buffer_load_dwordx4 v232, s[68:71], s35 offen lds
  v_mfma_f32_16x16x32_bf16 v[100:103], v[152:155], v[180:183], v[100:103]
  v_mfma_f32_16x16x32_bf16 v[104:107], v[152:155], v[184:187], v[104:107]
  v_mfma_f32_16x16x32_bf16 v[108:111], v[152:155], v[188:191], v[108:111]
  buffer_load_dwordx4 v233, s[68:71], s35 offen offset:1024 lds
  v_mfma_f32_16x16x32_bf16 v[124:127], v[156:159], v[188:191], v[124:127]
  ds_read_b128 v[152:155], v236 offset:45056
  v_mfma_f32_16x16x32_bf16 v[120:123], v[156:159], v[184:187], v[120:123]
  v_mfma_f32_16x16x32_bf16 v[116:119], v[156:159], v[180:183], v[116:119]
  v_mfma_f32_16x16x32_bf16 v[112:115], v[156:159], v[176:179], v[112:115]
  ds_read_b128 v[156:159], v236 offset:47104
  s_waitcnt lgkmcnt(7)
  v_mfma_f32_16x16x32_bf16 v[0:3], v[128:131], v[160:163], v[0:3]
  v_mfma_f32_16x16x32_bf16 v[4:7], v[128:131], v[164:167], v[4:7]
  v_mfma_f32_16x16x32_bf16 v[8:11], v[128:131], v[168:171], v[8:11]
  v_mfma_f32_16x16x32_bf16 v[12:15], v[128:131], v[172:175], v[12:15]
  s_waitcnt lgkmcnt(0)
  v_mfma_f32_16x16x32_bf16 v[28:31], v[132:135], v[172:175], v[28:31]
  v_mfma_f32_16x16x32_bf16 v[24:27], v[132:135], v[168:171], v[24:27]
  s_waitcnt vmcnt(7)
  s_barrier
  v_mfma_f32_16x16x32_bf16 v[20:23], v[132:135], v[164:167], v[20:23]
  v_mfma_f32_16x16x32_bf16 v[16:19], v[132:135], v[160:163], v[16:19]
  v_mfma_f32_16x16x32_bf16 v[32:35], v[136:139], v[160:163], v[32:35]
  ds_read_b64_tr_b16 v[176:177], v240 offset:16384
  v_mfma_f32_16x16x32_bf16 v[36:39], v[136:139], v[164:167], v[36:39]
  ds_read_b64_tr_b16 v[178:179], v240 offset:17408
  v_mfma_f32_16x16x32_bf16 v[40:43], v[136:139], v[168:171], v[40:43]
  ds_read_b64_tr_b16 v[180:181], v241 offset:16384
  v_mfma_f32_16x16x32_bf16 v[44:47], v[136:139], v[172:175], v[44:47]
  ds_read_b64_tr_b16 v[182:183], v241 offset:17408
  v_mfma_f32_16x16x32_bf16 v[60:63], v[140:143], v[172:175], v[60:63]
  ds_read_b64_tr_b16 v[184:185], v242 offset:16384
  v_mfma_f32_16x16x32_bf16 v[56:59], v[140:143], v[168:171], v[56:59]
  ds_read_b64_tr_b16 v[186:187], v242 offset:17408
  v_mfma_f32_16x16x32_bf16 v[52:55], v[140:143], v[164:167], v[52:55]
  ds_read_b64_tr_b16 v[188:189], v243 offset:16384
  v_mfma_f32_16x16x32_bf16 v[48:51], v[140:143], v[160:163], v[48:51]
  ds_read_b64_tr_b16 v[190:191], v243 offset:17408
  v_mfma_f32_16x16x32_bf16 v[64:67], v[144:147], v[160:163], v[64:67]
  ds_read_b128 v[128:131], v238 offset:32768
  v_mfma_f32_16x16x32_bf16 v[68:71], v[144:147], v[164:167], v[68:71]
  ds_read_b128 v[132:135], v238 offset:34816
  v_mfma_f32_16x16x32_bf16 v[72:75], v[144:147], v[168:171], v[72:75]
  ds_read_b128 v[136:139], v238 offset:36864
  v_mfma_f32_16x16x32_bf16 v[76:79], v[144:147], v[172:175], v[76:79]
  ds_read_b128 v[140:143], v238 offset:38912
  s_add_u32 m0, s34, 98304
  s_mov_b32 s35, 2359296
  buffer_load_dwordx4 v234, s[72:75], s35 offen lds
  v_mfma_f32_16x16x32_bf16 v[92:95], v[148:151], v[172:175], v[92:95]
  ds_read_b128 v[144:147], v238 offset:40960
  v_mfma_f32_16x16x32_bf16 v[88:91], v[148:151], v[168:171], v[88:91]
  buffer_load_dwordx4 v235, s[72:75], s35 offen offset:1024 lds
  v_mfma_f32_16x16x32_bf16 v[84:87], v[148:151], v[164:167], v[84:87]
  v_mfma_f32_16x16x32_bf16 v[80:83], v[148:151], v[160:163], v[80:83]
  v_mfma_f32_16x16x32_bf16 v[96:99], v[152:155], v[160:163], v[96:99]
  ds_read_b128 v[148:151], v238 offset:43008
  s_add_u32 m0, s28, 2048
  s_mov_b32 s35, 17024
  buffer_load_dwordx4 v232, s[68:71], s35 offen lds
  v_mfma_f32_16x16x32_bf16 v[100:103], v[152:155], v[164:167], v[100:103]
  v_mfma_f32_16x16x32_bf16 v[104:107], v[152:155], v[168:171], v[104:107]
  v_mfma_f32_16x16x32_bf16 v[108:111], v[152:155], v[172:175], v[108:111]
  buffer_load_dwordx4 v233, s[68:71], s35 offen offset:1024 lds
  v_mfma_f32_16x16x32_bf16 v[124:127], v[156:159], v[172:175], v[124:127]
  ds_read_b128 v[152:155], v238 offset:45056
  v_mfma_f32_16x16x32_bf16 v[120:123], v[156:159], v[168:171], v[120:123]
  v_mfma_f32_16x16x32_bf16 v[116:119], v[156:159], v[164:167], v[116:119]
  v_mfma_f32_16x16x32_bf16 v[112:115], v[156:159], v[160:163], v[112:115]
  ds_read_b128 v[156:159], v238 offset:47104
  s_waitcnt lgkmcnt(7)
  v_mfma_f32_16x16x32_bf16 v[0:3], v[128:131], v[176:179], v[0:3]
  v_mfma_f32_16x16x32_bf16 v[4:7], v[128:131], v[180:183], v[4:7]
  v_mfma_f32_16x16x32_bf16 v[8:11], v[128:131], v[184:187], v[8:11]
  v_mfma_f32_16x16x32_bf16 v[12:15], v[128:131], v[188:191], v[12:15]
  s_waitcnt lgkmcnt(0)
  v_mfma_f32_16x16x32_bf16 v[28:31], v[132:135], v[188:191], v[28:31]
  v_mfma_f32_16x16x32_bf16 v[24:27], v[132:135], v[184:187], v[24:27]
  s_waitcnt vmcnt(6)
  s_barrier
  v_mfma_f32_16x16x32_bf16 v[20:23], v[132:135], v[180:183], v[20:23]
  v_mfma_f32_16x16x32_bf16 v[16:19], v[132:135], v[176:179], v[16:19]
  v_mfma_f32_16x16x32_bf16 v[32:35], v[136:139], v[176:179], v[32:35]
  ds_read_b64_tr_b16 v[160:161], v240 offset:32768
  v_mfma_f32_16x16x32_bf16 v[36:39], v[136:139], v[180:183], v[36:39]
  ds_read_b64_tr_b16 v[162:163], v240 offset:33792
  v_mfma_f32_16x16x32_bf16 v[40:43], v[136:139], v[184:187], v[40:43]
  ds_read_b64_tr_b16 v[164:165], v241 offset:32768
  v_mfma_f32_16x16x32_bf16 v[44:47], v[136:139], v[188:191], v[44:47]
  ds_read_b64_tr_b16 v[166:167], v241 offset:33792
  v_mfma_f32_16x16x32_bf16 v[60:63], v[140:143], v[188:191], v[60:63]
  ds_read_b64_tr_b16 v[168:169], v242 offset:32768
  v_mfma_f32_16x16x32_bf16 v[56:59], v[140:143], v[184:187], v[56:59]
  ds_read_b64_tr_b16 v[170:171], v242 offset:33792
  v_mfma_f32_16x16x32_bf16 v[52:55], v[140:143], v[180:183], v[52:55]
  ds_read_b64_tr_b16 v[172:173], v243 offset:32768
  v_mfma_f32_16x16x32_bf16 v[48:51], v[140:143], v[176:179], v[48:51]
  ds_read_b64_tr_b16 v[174:175], v243 offset:33792
  v_mfma_f32_16x16x32_bf16 v[64:67], v[144:147], v[176:179], v[64:67]
  ds_read_b128 v[128:131], v237 offset:0
  v_mfma_f32_16x16x32_bf16 v[68:71], v[144:147], v[180:183], v[68:71]
  ds_read_b128 v[132:135], v237 offset:2048
  v_mfma_f32_16x16x32_bf16 v[72:75], v[144:147], v[184:187], v[72:75]
  ds_read_b128 v[136:139], v237 offset:4096
  v_mfma_f32_16x16x32_bf16 v[76:79], v[144:147], v[188:191], v[76:79]
  ds_read_b128 v[140:143], v237 offset:6144
  v_cmp_gt_u32 vcc, 16, v247
  v_mov_b32 v248, 0x40000000
  s_nop 0
  v_cndmask_b32 v248, v248, v255, vcc
  buffer_load_dwordx4 v[200:203], v255, s[12:15], 0 offen offset:0 sc1
  buffer_load_dwordx4 v[204:207], v255, s[12:15], 0 offen offset:16 sc1
  v_mfma_f32_16x16x32_bf16 v[92:95], v[148:151], v[188:191], v[92:95]
  ds_read_b128 v[144:147], v237 offset:8192
  buffer_load_dwordx4 v[208:211], v248, s[12:15], 0 offen offset:256 sc1
  v_mfma_f32_16x16x32_bf16 v[88:91], v[148:151], v[184:187], v[88:91]
  buffer_load_dwordx4 v[212:215], v248, s[12:15], 0 offen offset:272 sc1
  v_mfma_f32_16x16x32_bf16 v[84:87], v[148:151], v[180:183], v[84:87]
  buffer_load_dwordx4 v[216:219], v255, s[12:15], 0 offen offset:2560 sc1
  v_mfma_f32_16x16x32_bf16 v[80:83], v[148:151], v[176:179], v[80:83]
  buffer_load_dwordx4 v[220:223], v255, s[12:15], 0 offen offset:2576 sc1
  v_mfma_f32_16x16x32_bf16 v[96:99], v[152:155], v[176:179], v[96:99]
  ds_read_b128 v[148:151], v237 offset:10240
  buffer_load_dwordx4 v[224:227], v248, s[12:15], 0 offen offset:2816 sc1
  v_mfma_f32_16x16x32_bf16 v[100:103], v[152:155], v[180:183], v[100:103]
  buffer_load_dwordx4 v[228:231], v248, s[12:15], 0 offen offset:2832 sc1
  v_mfma_f32_16x16x32_bf16 v[104:107], v[152:155], v[184:187], v[104:107]
  s_add_u32 m0, s34, 114688
  s_mov_b32 s35, 2621440
  buffer_load_dwordx4 v234, s[72:75], s35 offen lds
  v_mfma_f32_16x16x32_bf16 v[108:111], v[152:155], v[188:191], v[108:111]
  buffer_load_dwordx4 v235, s[72:75], s35 offen offset:1024 lds
  v_mfma_f32_16x16x32_bf16 v[124:127], v[156:159], v[188:191], v[124:127]
  ds_read_b128 v[152:155], v237 offset:12288
  s_add_u32 m0, s28, 32768
  s_mov_b32 s35, 768
  buffer_load_dwordx4 v232, s[68:71], s35 offen lds
  v_mfma_f32_16x16x32_bf16 v[120:123], v[156:159], v[184:187], v[120:123]
  buffer_load_dwordx4 v233, s[68:71], s35 offen offset:1024 lds
  v_mfma_f32_16x16x32_bf16 v[116:119], v[156:159], v[180:183], v[116:119]
  v_mfma_f32_16x16x32_bf16 v[112:115], v[156:159], v[176:179], v[112:115]
  ds_read_b128 v[156:159], v237 offset:14336
  s_waitcnt lgkmcnt(7)
  v_mfma_f32_16x16x32_bf16 v[0:3], v[128:131], v[160:163], v[0:3]
  v_mfma_f32_16x16x32_bf16 v[4:7], v[128:131], v[164:167], v[4:7]
  v_mfma_f32_16x16x32_bf16 v[8:11], v[128:131], v[168:171], v[8:11]
  v_mfma_f32_16x16x32_bf16 v[12:15], v[128:131], v[172:175], v[12:15]
  s_waitcnt lgkmcnt(0)
  v_mfma_f32_16x16x32_bf16 v[28:31], v[132:135], v[172:175], v[28:31]
  v_mfma_f32_16x16x32_bf16 v[24:27], v[132:135], v[168:171], v[24:27]
  s_waitcnt vmcnt(14)
  s_barrier
  v_mfma_f32_16x16x32_bf16 v[20:23], v[132:135], v[164:167], v[20:23]
  v_mfma_f32_16x16x32_bf16 v[16:19], v[132:135], v[160:163], v[16:19]
  v_mfma_f32_16x16x32_bf16 v[32:35], v[136:139], v[160:163], v[32:35]
  ds_read_b64_tr_b16 v[176:177], v240 offset:0
  v_mfma_f32_16x16x32_bf16 v[36:39], v[136:139], v[164:167], v[36:39]
  ds_read_b64_tr_b16 v[178:179], v240 offset:1024
  v_mfma_f32_16x16x32_bf16 v[40:43], v[136:139], v[168:171], v[40:43]
  ds_read_b64_tr_b16 v[180:181], v241 offset:0
  v_mfma_f32_16x16x32_bf16 v[44:47], v[136:139], v[172:175], v[44:47]
  ds_read_b64_tr_b16 v[182:183], v241 offset:1024
  v_mfma_f32_16x16x32_bf16 v[60:63], v[140:143], v[172:175], v[60:63]
  ds_read_b64_tr_b16 v[184:185], v242 offset:0
  v_mfma_f32_16x16x32_bf16 v[56:59], v[140:143], v[168:171], v[56:59]
  ds_read_b64_tr_b16 v[186:187], v242 offset:1024
  v_mfma_f32_16x16x32_bf16 v[52:55], v[140:143], v[164:167], v[52:55]
  ds_read_b64_tr_b16 v[188:189], v243 offset:0
  v_mfma_f32_16x16x32_bf16 v[48:51], v[140:143], v[160:163], v[48:51]
  ds_read_b64_tr_b16 v[190:191], v243 offset:1024
  v_mfma_f32_16x16x32_bf16 v[64:67], v[144:147], v[160:163], v[64:67]
  ds_read_b128 v[128:131], v239 offset:0
  v_mfma_f32_16x16x32_bf16 v[68:71], v[144:147], v[164:167], v[68:71]
  ds_read_b128 v[132:135], v239 offset:2048
  v_mfma_f32_16x16x32_bf16 v[72:75], v[144:147], v[168:171], v[72:75]
  ds_read_b128 v[136:139], v239 offset:4096
  v_mfma_f32_16x16x32_bf16 v[76:79], v[144:147], v[172:175], v[76:79]
  ds_read_b128 v[140:143], v239 offset:6144
  s_add_u32 m0, s34, 131072
  s_mov_b32 s35, 2883584
  buffer_load_dwordx4 v234, s[72:75], s35 offen lds
  v_mfma_f32_16x16x32_bf16 v[92:95], v[148:151], v[172:175], v[92:95]
  ds_read_b128 v[144:147], v239 offset:8192
  v_mfma_f32_16x16x32_bf16 v[88:91], v[148:151], v[168:171], v[88:91]
  buffer_load_dwordx4 v235, s[72:75], s35 offen offset:1024 lds
  v_mfma_f32_16x16x32_bf16 v[84:87], v[148:151], v[164:167], v[84:87]
  v_mfma_f32_16x16x32_bf16 v[80:83], v[148:151], v[160:163], v[80:83]
  v_mfma_f32_16x16x32_bf16 v[96:99], v[152:155], v[160:163], v[96:99]
  ds_read_b128 v[148:151], v239 offset:10240
  s_add_u32 m0, s28, 34816
  s_mov_b32 s35, 17152
  buffer_load_dwordx4 v232, s[68:71], s35 offen lds
  v_mfma_f32_16x16x32_bf16 v[100:103], v[152:155], v[164:167], v[100:103]
  v_mfma_f32_16x16x32_bf16 v[104:107], v[152:155], v[168:171], v[104:107]
  v_mfma_f32_16x16x32_bf16 v[108:111], v[152:155], v[172:175], v[108:111]
  buffer_load_dwordx4 v233, s[68:71], s35 offen offset:1024 lds
  v_mfma_f32_16x16x32_bf16 v[124:127], v[156:159], v[172:175], v[124:127]
  ds_read_b128 v[152:155], v239 offset:12288
  v_mfma_f32_16x16x32_bf16 v[120:123], v[156:159], v[168:171], v[120:123]
  v_mfma_f32_16x16x32_bf16 v[116:119], v[156:159], v[164:167], v[116:119]
  v_mfma_f32_16x16x32_bf16 v[112:115], v[156:159], v[160:163], v[112:115]
  ds_read_b128 v[156:159], v239 offset:14336
  s_waitcnt lgkmcnt(7)
  v_mfma_f32_16x16x32_bf16 v[0:3], v[128:131], v[176:179], v[0:3]
  v_mfma_f32_16x16x32_bf16 v[4:7], v[128:131], v[180:183], v[4:7]
  v_mfma_f32_16x16x32_bf16 v[8:11], v[128:131], v[184:187], v[8:11]
  v_mfma_f32_16x16x32_bf16 v[12:15], v[128:131], v[188:191], v[12:15]
  s_waitcnt lgkmcnt(0)
  v_mfma_f32_16x16x32_bf16 v[28:31], v[132:135], v[188:191], v[28:31]
  v_mfma_f32_16x16x32_bf16 v[24:27], v[132:135], v[184:187], v[24:27]
  s_waitcnt vmcnt(6)
  s_barrier
  v_mfma_f32_16x16x32_bf16 v[20:23], v[132:135], v[180:183], v[20:23]
  v_mfma_f32_16x16x32_bf16 v[16:19], v[132:135], v[176:179], v[16:19]
  v_mfma_f32_16x16x32_bf16 v[32:35], v[136:139], v[176:179], v[32:35]
  ds_read_b64_tr_b16 v[160:161], v240 offset:16384
  s_mov_b32 s21, 0x3e0293ee
  v_lshlrev_b32 v248, 16, v192
  v_and_b32 v249, 0xffff0000, v192
  v_sub_f32 v248, v248, v250
  v_mfma_f32_16x16x32_bf16 v[36:39], v[136:139], v[180:183], v[36:39]
  ds_read_b64_tr_b16 v[162:163], v240 offset:17408
  v_sub_f32 v249, v249, v250
  v_mul_f32 v248, v251, v248
  v_mul_f32 v249, v251, v249
  v_mul_f32 v200, s21, v200
  v_mfma_f32_16x16x32_bf16 v[40:43], v[136:139], v[184:187], v[40:43]
  ds_read_b64_tr_b16 v[164:165], v241 offset:16384
  v_mul_f32 v201, s21, v201
  v_fma_f32 v248, v248, v216, v200
  v_fma_f32 v249, v249, v217, v201
  v_cvt_pk_bf16_f32 v192, v248, v249
  v_mfma_f32_16x16x32_bf16 v[44:47], v[136:139], v[188:191], v[44:47]
  ds_read_b64_tr_b16 v[166:167], v241 offset:17408
  v_lshlrev_b32 v248, 16, v193
  v_and_b32 v249, 0xffff0000, v193
  v_sub_f32 v248, v248, v250
  v_sub_f32 v249, v249, v250
  v_mfma_f32_16x16x32_bf16 v[60:63], v[140:143], v[188:191], v[60:63]
  ds_read_b64_tr_b16 v[168:169], v242 offset:16384
  v_mul_f32 v248, v251, v248
  v_mul_f32 v249, v251, v249
  v_mul_f32 v202, s21, v202
  v_mul_f32 v203, s21, v203
  v_mfma_f32_16x16x32_bf16 v[56:59], v[140:143], v[184:187], v[56:59]
  ds_read_b64_tr_b16 v[170:171], v242 offset:17408
  v_fma_f32 v248, v248, v218, v202
  v_fma_f32 v249, v249, v219, v203
  v_cvt_pk_bf16_f32 v193, v248, v249
  v_lshlrev_b32 v248, 16, v194
  v_mfma_f32_16x16x32_bf16 v[52:55], v[140:143], v[180:183], v[52:55]
  ds_read_b64_tr_b16 v[172:173], v243 offset:16384
  v_and_b32 v249, 0xffff0000, v194
  v_sub_f32 v248, v248, v250
  v_sub_f32 v249, v249, v250
  v_mul_f32 v248, v251, v248
  v_mfma_f32_16x16x32_bf16 v[48:51], v[140:143], v[176:179], v[48:51]
  ds_read_b64_tr_b16 v[174:175], v243 offset:17408
  v_mul_f32 v249, v251, v249
  v_mul_f32 v204, s21, v204
  v_mul_f32 v205, s21, v205
  v_fma_f32 v248, v248, v220, v204
  v_mfma_f32_16x16x32_bf16 v[64:67], v[144:147], v[176:179], v[64:67]
  ds_read_b128 v[128:131], v236 offset:0
  v_fma_f32 v249, v249, v221, v205
  v_cvt_pk_bf16_f32 v194, v248, v249
  v_lshlrev_b32 v248, 16, v195
  v_and_b32 v249, 0xffff0000, v195
  v_mfma_f32_16x16x32_bf16 v[68:71], v[144:147], v[180:183], v[68:71]
  ds_read_b128 v[132:135], v236 offset:2048
  v_sub_f32 v248, v248, v250
  v_sub_f32 v249, v249, v250
  v_mul_f32 v248, v251, v248
  v_mul_f32 v249, v251, v249
  v_mfma_f32_16x16x32_bf16 v[72:75], v[144:147], v[184:187], v[72:75]
  ds_read_b128 v[136:139], v236 offset:4096
  v_mul_f32 v206, s21, v206
  v_mul_f32 v207, s21, v207
  v_fma_f32 v248, v248, v222, v206
  v_fma_f32 v249, v249, v223, v207
  v_mfma_f32_16x16x32_bf16 v[76:79], v[144:147], v[188:191], v[76:79]
  ds_read_b128 v[140:143], v236 offset:6144
  s_add_u32 m0, s34, 98304
  s_mov_b32 s35, 3145728
  buffer_load_dwordx4 v234, s[72:75], s35 offen lds
  v_cvt_pk_bf16_f32 v195, v248, v249
  v_lshlrev_b32 v248, 16, v196
  v_and_b32 v249, 0xffff0000, v196
  v_sub_f32 v248, v248, v250
  v_mfma_f32_16x16x32_bf16 v[92:95], v[148:151], v[188:191], v[92:95]
  ds_read_b128 v[144:147], v236 offset:8192
  v_sub_f32 v249, v249, v250
  v_mul_f32 v248, v251, v248
  v_mul_f32 v249, v251, v249
  v_mul_f32 v208, s21, v208
  v_mfma_f32_16x16x32_bf16 v[88:91], v[148:151], v[184:187], v[88:91]
  buffer_load_dwordx4 v235, s[72:75], s35 offen offset:1024 lds
  v_mul_f32 v209, s21, v209
  v_fma_f32 v248, v248, v224, v208
  v_fma_f32 v249, v249, v225, v209
  v_cvt_pk_bf16_f32 v196, v248, v249
  v_mfma_f32_16x16x32_bf16 v[84:87], v[148:151], v[180:183], v[84:87]
  v_lshlrev_b32 v248, 16, v197
  v_and_b32 v249, 0xffff0000, v197
  v_sub_f32 v248, v248, v250
  v_sub_f32 v249, v249, v250
  v_mfma_f32_16x16x32_bf16 v[80:83], v[148:151], v[176:179], v[80:83]
  v_mul_f32 v248, v251, v248
  v_mul_f32 v249, v251, v249
  v_mul_f32 v210, s21, v210
  v_mul_f32 v211, s21, v211
  v_mfma_f32_16x16x32_bf16 v[96:99], v[152:155], v[176:179], v[96:99]
  ds_read_b128 v[148:151], v236 offset:10240
  s_add_u32 m0, s28, 65536
  s_mov_b32 s35, 896
  buffer_load_dwordx4 v232, s[68:71], s35 offen lds
  v_fma_f32 v248, v248, v226, v210
  v_fma_f32 v249, v249, v227, v211
  v_cvt_pk_bf16_f32 v197, v248, v249
  v_lshlrev_b32 v248, 16, v198
  v_mfma_f32_16x16x32_bf16 v[100:103], v[152:155], v[180:183], v[100:103]
  v_and_b32 v249, 0xffff0000, v198
  v_sub_f32 v248, v248, v250
  v_sub_f32 v249, v249, v250
  v_mul_f32 v248, v251, v248
  v_mfma_f32_16x16x32_bf16 v[104:107], v[152:155], v[184:187], v[104:107]
  v_mul_f32 v249, v251, v249
  v_mul_f32 v212, s21, v212
  v_mul_f32 v213, s21, v213
  v_fma_f32 v248, v248, v228, v212
  v_mfma_f32_16x16x32_bf16 v[108:111], v[152:155], v[188:191], v[108:111]
  buffer_load_dwordx4 v233, s[68:71], s35 offen offset:1024 lds
  v_fma_f32 v249, v249, v229, v213
  v_cvt_pk_bf16_f32 v198, v248, v249
  v_lshlrev_b32 v248, 16, v199
  v_and_b32 v249, 0xffff0000, v199
  v_mfma_f32_16x16x32_bf16 v[124:127], v[156:159], v[188:191], v[124:127]
  ds_read_b128 v[152:155], v236 offset:12288
  v_sub_f32 v248, v248, v250
  v_sub_f32 v249, v249, v250
  v_mul_f32 v248, v251, v248
  v_mul_f32 v249, v251, v249
  v_mfma_f32_16x16x32_bf16 v[120:123], v[156:159], v[184:187], v[120:123]
  v_mul_f32 v214, s21, v214
  v_mul_f32 v215, s21, v215
  v_fma_f32 v248, v248, v230, v214
  v_fma_f32 v249, v249, v231, v215
  v_mfma_f32_16x16x32_bf16 v[116:119], v[156:159], v[180:183], v[116:119]
  v_cvt_pk_bf16_f32 v199, v248, v249
  v_mfma_f32_16x16x32_bf16 v[112:115], v[156:159], v[176:179], v[112:115]
  ds_read_b128 v[156:159], v236 offset:14336
  buffer_store_dwordx4 v[192:195], v253, s[12:15], 0 offen sc1
  buffer_store_dwordx4 v[196:199], v254, s[12:15], 0 offen offset:2048 sc1
  s_waitcnt lgkmcnt(7)
  v_mfma_f32_16x16x32_bf16 v[0:3], v[128:131], v[160:163], v[0:3]
  v_mfma_f32_16x16x32_bf16 v[4:7], v[128:131], v[164:167], v[4:7]
  v_mfma_f32_16x16x32_bf16 v[8:11], v[128:131], v[168:171], v[8:11]
  v_mfma_f32_16x16x32_bf16 v[12:15], v[128:131], v[172:175], v[12:15]
  s_waitcnt lgkmcnt(0)
  v_mfma_f32_16x16x32_bf16 v[28:31], v[132:135], v[172:175], v[28:31]
  v_mfma_f32_16x16x32_bf16 v[24:27], v[132:135], v[168:171], v[24:27]
  s_waitcnt vmcnt(8)
  s_barrier
  v_mfma_f32_16x16x32_bf16 v[20:23], v[132:135], v[164:167], v[20:23]
  v_mfma_f32_16x16x32_bf16 v[16:19], v[132:135], v[160:163], v[16:19]
  v_mfma_f32_16x16x32_bf16 v[32:35], v[136:139], v[160:163], v[32:35]
  ds_read_b64_tr_b16 v[176:177], v240 offset:32768
  v_lshrrev_b32 v248, 4, v247
  v_lshlrev_b32 v249, 1, v248
  v_xor_b32 v249, v249, v247
  v_mfma_f32_16x16x32_bf16 v[36:39], v[136:139], v[164:167], v[36:39]
  ds_read_b64_tr_b16 v[178:179], v240 offset:33792
  v_and_b32 v249, 15, v249
  v_lshlrev_b32 v249, 4, v249
  v_lshl_add_u32 v249, v248, 13, v249
  v_mfma_f32_16x16x32_bf16 v[40:43], v[136:139], v[168:171], v[40:43]
  ds_read_b64_tr_b16 v[180:181], v241 offset:32768
  s_lshl_b32 s21, s18, 17
  s_lshl_b32 s22, s16, 8
  s_add_u32 s21, s21, s22
  v_mfma_f32_16x16x32_bf16 v[44:47], v[136:139], v[172:175], v[44:47]
  ds_read_b64_tr_b16 v[182:183], v241 offset:33792
  v_add_u32 v253, s21, v249
  v_xor_b32 v254, 128, v253
  s_mul_i32 s21, s31, 40960
  v_mfma_f32_16x16x32_bf16 v[60:63], v[140:143], v[172:175], v[60:63]
  ds_read_b64_tr_b16 v[184:185], v242 offset:32768
  s_add_u32 s21, s21, 0x100000
  v_add_u32 v255, s21, v245
  v_lshrrev_b32 v248, 2, v247
  v_mfma_f32_16x16x32_bf16 v[56:59], v[140:143], v[168:171], v[56:59]
  ds_read_b64_tr_b16 v[186:187], v242 offset:33792
  v_and_b32 v248, 3, v248
  v_lshrrev_b32 v250, 4, v247
  v_and_b32 v192, 1, v250
  v_mfma_f32_16x16x32_bf16 v[52:55], v[140:143], v[164:167], v[52:55]
  ds_read_b64_tr_b16 v[188:189], v243 offset:32768
  v_lshl_add_u32 v192, v192, 2, v248
  v_lshlrev_b32 v192, 5, v192
  v_lshl_add_u32 v192, v248, 8, v192
  v_mfma_f32_16x16x32_bf16 v[48:51], v[140:143], v[160:163], v[48:51]
  ds_read_b64_tr_b16 v[190:191], v243 offset:33792
  v_lshl_add_u32 v192, v250, 11, v192
  v_and_b32 v248, 3, v247
  v_lshl_add_u32 v192, v248, 3, v192
  v_mfma_f32_16x16x32_bf16 v[64:67], v[144:147], v[160:163], v[64:67]
  ds_read_b128 v[128:131], v238 offset:0
  v_xor_b32 v193, 32, v192
  v_xor_b32 v194, 64, v192
  v_xor_b32 v195, 96, v192
  v_mfma_f32_16x16x32_bf16 v[68:71], v[144:147], v[164:167], v[68:71]
  ds_read_b128 v[132:135], v238 offset:2048
  v_xor_b32 v196, 128, v192
  v_xor_b32 v197, 160, v192
  v_xor_b32 v198, 192, v192
  v_mfma_f32_16x16x32_bf16 v[72:75], v[144:147], v[168:171], v[72:75]
  ds_read_b128 v[136:139], v238 offset:4096
  v_xor_b32 v199, 224, v192
  v_mfma_f32_16x16x32_bf16 v[76:79], v[144:147], v[172:175], v[76:79]
  ds_read_b128 v[140:143], v238 offset:6144
  s_add_u32 m0, s34, 114688
  s_mov_b32 s35, 3407872
  buffer_load_dwordx4 v234, s[72:75], s35 offen lds
  v_mfma_f32_16x16x32_bf16 v[92:95], v[148:151], v[172:175], v[92:95]
  ds_read_b128 v[144:147], v238 offset:8192
  v_mfma_f32_16x16x32_bf16 v[88:91], v[148:151], v[168:171], v[88:91]
  buffer_load_dwordx4 v235, s[72:75], s35 offen offset:1024 lds
  v_mfma_f32_16x16x32_bf16 v[84:87], v[148:151], v[164:167], v[84:87]
  v_mfma_f32_16x16x32_bf16 v[80:83], v[148:151], v[160:163], v[80:83]
  v_mfma_f32_16x16x32_bf16 v[96:99], v[152:155], v[160:163], v[96:99]
  ds_read_b128 v[148:151], v238 offset:10240
  s_add_u32 m0, s28, 67584
  s_mov_b32 s35, 17280
  buffer_load_dwordx4 v232, s[68:71], s35 offen lds
  v_mfma_f32_16x16x32_bf16 v[100:103], v[152:155], v[164:167], v[100:103]
  v_mfma_f32_16x16x32_bf16 v[104:107], v[152:155], v[168:171], v[104:107]
  v_mfma_f32_16x16x32_bf16 v[108:111], v[152:155], v[172:175], v[108:111]
  buffer_load_dwordx4 v233, s[68:71], s35 offen offset:1024 lds
  v_mfma_f32_16x16x32_bf16 v[124:127], v[156:159], v[172:175], v[124:127]
  ds_read_b128 v[152:155], v238 offset:12288
  v_mfma_f32_16x16x32_bf16 v[120:123], v[156:159], v[168:171], v[120:123]
  v_mfma_f32_16x16x32_bf16 v[116:119], v[156:159], v[164:167], v[116:119]
  v_mfma_f32_16x16x32_bf16 v[112:115], v[156:159], v[160:163], v[112:115]
  ds_read_b128 v[156:159], v238 offset:14336
  s_waitcnt lgkmcnt(7)
  v_mfma_f32_16x16x32_bf16 v[0:3], v[128:131], v[176:179], v[0:3]
  v_mfma_f32_16x16x32_bf16 v[4:7], v[128:131], v[180:183], v[4:7]
  v_mfma_f32_16x16x32_bf16 v[8:11], v[128:131], v[184:187], v[8:11]
  v_mfma_f32_16x16x32_bf16 v[12:15], v[128:131], v[188:191], v[12:15]
  s_waitcnt lgkmcnt(0)
  v_mfma_f32_16x16x32_bf16 v[28:31], v[132:135], v[188:191], v[28:31]
  v_mfma_f32_16x16x32_bf16 v[24:27], v[132:135], v[184:187], v[24:27]
  s_waitcnt vmcnt(8)
  s_waitcnt vmcnt(4)
  s_barrier
  v_mfma_f32_16x16x32_bf16 v[20:23], v[132:135], v[180:183], v[20:23]
  v_mfma_f32_16x16x32_bf16 v[16:19], v[132:135], v[176:179], v[16:19]
  v_mfma_f32_16x16x32_bf16 v[32:35], v[136:139], v[176:179], v[32:35]
  ds_read_b64_tr_b16 v[160:161], v240 offset:0
  v_mfma_f32_16x16x32_bf16 v[36:39], v[136:139], v[180:183], v[36:39]
  ds_read_b64_tr_b16 v[162:163], v240 offset:1024
  v_mfma_f32_16x16x32_bf16 v[40:43], v[136:139], v[184:187], v[40:43]
  ds_read_b64_tr_b16 v[164:165], v241 offset:0
  v_mfma_f32_16x16x32_bf16 v[44:47], v[136:139], v[188:191], v[44:47]
  ds_read_b64_tr_b16 v[166:167], v241 offset:1024
  v_mfma_f32_16x16x32_bf16 v[60:63], v[140:143], v[188:191], v[60:63]
  ds_read_b64_tr_b16 v[168:169], v242 offset:0
  v_mfma_f32_16x16x32_bf16 v[56:59], v[140:143], v[184:187], v[56:59]
  ds_read_b64_tr_b16 v[170:171], v242 offset:1024
  v_mfma_f32_16x16x32_bf16 v[52:55], v[140:143], v[180:183], v[52:55]
  ds_read_b64_tr_b16 v[172:173], v243 offset:0
  v_mfma_f32_16x16x32_bf16 v[48:51], v[140:143], v[176:179], v[48:51]
  ds_read_b64_tr_b16 v[174:175], v243 offset:1024
  v_mfma_f32_16x16x32_bf16 v[64:67], v[144:147], v[176:179], v[64:67]
  ds_read_b128 v[128:131], v236 offset:32768
  v_mfma_f32_16x16x32_bf16 v[68:71], v[144:147], v[180:183], v[68:71]
  ds_read_b128 v[132:135], v236 offset:34816
  v_mfma_f32_16x16x32_bf16 v[72:75], v[144:147], v[184:187], v[72:75]
  ds_read_b128 v[136:139], v236 offset:36864
  v_mfma_f32_16x16x32_bf16 v[76:79], v[144:147], v[188:191], v[76:79]
  ds_read_b128 v[140:143], v236 offset:38912
  s_add_u32 m0, s34, 131072
  s_mov_b32 s35, 3670016
  buffer_load_dwordx4 v234, s[72:75], s35 offen lds
  v_mfma_f32_16x16x32_bf16 v[92:95], v[148:151], v[188:191], v[92:95]
  ds_read_b128 v[144:147], v236 offset:40960
  buffer_load_dwordx4 v235, s[72:75], s35 offen offset:1024 lds
  v_mfma_f32_16x16x32_bf16 v[88:91], v[148:151], v[184:187], v[88:91]
  v_mfma_f32_16x16x32_bf16 v[84:87], v[148:151], v[180:183], v[84:87]
  s_add_u32 m0, s28, 0
  s_mov_b32 s35, 0
  buffer_load_dwordx4 v253, s[8:11], s35 offen offset:0 lds
  v_mfma_f32_16x16x32_bf16 v[80:83], v[148:151], v[176:179], v[80:83]
  v_mfma_f32_16x16x32_bf16 v[96:99], v[152:155], v[176:179], v[96:99]
  ds_read_b128 v[148:151], v236 offset:43008
  s_mov_b32 s35, 31744
  buffer_load_dwordx4 v253, s[8:11], s35 offen offset:1024 lds
  v_mfma_f32_16x16x32_bf16 v[100:103], v[152:155], v[180:183], v[100:103]
  v_mfma_f32_16x16x32_bf16 v[104:107], v[152:155], v[184:187], v[104:107]
  s_mov_b32 s35, 63488
  buffer_load_dwordx4 v254, s[8:11], s35 offen offset:2048 lds
  v_mfma_f32_16x16x32_bf16 v[108:111], v[152:155], v[188:191], v[108:111]
  v_mfma_f32_16x16x32_bf16 v[124:127], v[156:159], v[188:191], v[124:127]
  ds_read_b128 v[152:155], v236 offset:45056
  s_mov_b32 s35, 95232
  buffer_load_dwordx4 v254, s[8:11], s35 offen offset:3072 lds
  v_mfma_f32_16x16x32_bf16 v[120:123], v[156:159], v[184:187], v[120:123]
  v_mfma_f32_16x16x32_bf16 v[116:119], v[156:159], v[180:183], v[116:119]
  v_mfma_f32_16x16x32_bf16 v[112:115], v[156:159], v[176:179], v[112:115]
  ds_read_b128 v[156:159], v236 offset:47104
  s_waitcnt lgkmcnt(7)
  v_mfma_f32_16x16x32_bf16 v[0:3], v[128:131], v[160:163], v[0:3]
  v_mfma_f32_16x16x32_bf16 v[4:7], v[128:131], v[164:167], v[4:7]
  v_mfma_f32_16x16x32_bf16 v[8:11], v[128:131], v[168:171], v[8:11]
  v_mfma_f32_16x16x32_bf16 v[12:15], v[128:131], v[172:175], v[12:15]
  s_waitcnt lgkmcnt(0)
  v_mfma_f32_16x16x32_bf16 v[28:31], v[132:135], v[172:175], v[28:31]
  v_mfma_f32_16x16x32_bf16 v[24:27], v[132:135], v[168:171], v[24:27]
  s_waitcnt vmcnt(8)
  s_barrier
  v_mfma_f32_16x16x32_bf16 v[20:23], v[132:135], v[164:167], v[20:23]
  v_mfma_f32_16x16x32_bf16 v[16:19], v[132:135], v[160:163], v[16:19]
  v_mfma_f32_16x16x32_bf16 v[32:35], v[136:139], v[160:163], v[32:35]
  ds_read_b64_tr_b16 v[176:177], v240 offset:16384
  v_mfma_f32_16x16x32_bf16 v[36:39], v[136:139], v[164:167], v[36:39]
  ds_read_b64_tr_b16 v[178:179], v240 offset:17408
  v_mfma_f32_16x16x32_bf16 v[40:43], v[136:139], v[168:171], v[40:43]
  ds_read_b64_tr_b16 v[180:181], v241 offset:16384
  v_mfma_f32_16x16x32_bf16 v[44:47], v[136:139], v[172:175], v[44:47]
  ds_read_b64_tr_b16 v[182:183], v241 offset:17408
  v_mfma_f32_16x16x32_bf16 v[60:63], v[140:143], v[172:175], v[60:63]
  ds_read_b64_tr_b16 v[184:185], v242 offset:16384
  v_mfma_f32_16x16x32_bf16 v[56:59], v[140:143], v[168:171], v[56:59]
  ds_read_b64_tr_b16 v[186:187], v242 offset:17408
  v_mfma_f32_16x16x32_bf16 v[52:55], v[140:143], v[164:167], v[52:55]
  ds_read_b64_tr_b16 v[188:189], v243 offset:16384
  v_mfma_f32_16x16x32_bf16 v[48:51], v[140:143], v[160:163], v[48:51]
  ds_read_b64_tr_b16 v[190:191], v243 offset:17408
  v_mfma_f32_16x16x32_bf16 v[64:67], v[144:147], v[160:163], v[64:67]
  ds_read_b128 v[128:131], v238 offset:32768
  v_mfma_f32_16x16x32_bf16 v[68:71], v[144:147], v[164:167], v[68:71]
  ds_read_b128 v[132:135], v238 offset:34816
  v_mfma_f32_16x16x32_bf16 v[72:75], v[144:147], v[168:171], v[72:75]
  ds_read_b128 v[136:139], v238 offset:36864
  v_mfma_f32_16x16x32_bf16 v[76:79], v[144:147], v[172:175], v[76:79]
  ds_read_b128 v[140:143], v238 offset:38912
  s_add_u32 m0, s34, 98304
  s_mov_b32 s35, 3932160
  buffer_load_dwordx4 v234, s[72:75], s35 offen lds
  v_mfma_f32_16x16x32_bf16 v[92:95], v[148:151], v[172:175], v[92:95]
  ds_read_b128 v[144:147], v238 offset:40960
  v_mfma_f32_16x16x32_bf16 v[88:91], v[148:151], v[168:171], v[88:91]
  buffer_load_dwordx4 v235, s[72:75], s35 offen offset:1024 lds
  v_mfma_f32_16x16x32_bf16 v[84:87], v[148:151], v[164:167], v[84:87]
  v_mfma_f32_16x16x32_bf16 v[80:83], v[148:151], v[160:163], v[80:83]
  v_mfma_f32_16x16x32_bf16 v[96:99], v[152:155], v[160:163], v[96:99]
  ds_read_b128 v[148:151], v238 offset:43008
  v_mfma_f32_16x16x32_bf16 v[100:103], v[152:155], v[164:167], v[100:103]
  v_mfma_f32_16x16x32_bf16 v[104:107], v[152:155], v[168:171], v[104:107]
  v_mfma_f32_16x16x32_bf16 v[108:111], v[152:155], v[172:175], v[108:111]
  v_mfma_f32_16x16x32_bf16 v[124:127], v[156:159], v[172:175], v[124:127]
  ds_read_b128 v[152:155], v238 offset:45056
  v_mfma_f32_16x16x32_bf16 v[120:123], v[156:159], v[168:171], v[120:123]
  v_mfma_f32_16x16x32_bf16 v[116:119], v[156:159], v[164:167], v[116:119]
  v_mfma_f32_16x16x32_bf16 v[112:115], v[156:159], v[160:163], v[112:115]
  ds_read_b128 v[156:159], v238 offset:47104
  s_waitcnt lgkmcnt(7)
  v_mfma_f32_16x16x32_bf16 v[0:3], v[128:131], v[176:179], v[0:3]
  v_mfma_f32_16x16x32_bf16 v[4:7], v[128:131], v[180:183], v[4:7]
  v_mfma_f32_16x16x32_bf16 v[8:11], v[128:131], v[184:187], v[8:11]
  v_mfma_f32_16x16x32_bf16 v[12:15], v[128:131], v[188:191], v[12:15]
  s_waitcnt lgkmcnt(0)
  v_mfma_f32_16x16x32_bf16 v[28:31], v[132:135], v[188:191], v[28:31]
  v_mfma_f32_16x16x32_bf16 v[24:27], v[132:135], v[184:187], v[24:27]
  s_waitcnt vmcnt(6)
  s_barrier
  v_mfma_f32_16x16x32_bf16 v[20:23], v[132:135], v[180:183], v[20:23]
  v_mfma_f32_16x16x32_bf16 v[16:19], v[132:135], v[176:179], v[16:19]
  v_mfma_f32_16x16x32_bf16 v[32:35], v[136:139], v[176:179], v[32:35]
  ds_read_b64_tr_b16 v[160:161], v240 offset:32768
  v_mfma_f32_16x16x32_bf16 v[36:39], v[136:139], v[180:183], v[36:39]
  ds_read_b64_tr_b16 v[162:163], v240 offset:33792
  v_mfma_f32_16x16x32_bf16 v[40:43], v[136:139], v[184:187], v[40:43]
  ds_read_b64_tr_b16 v[164:165], v241 offset:32768
  v_mfma_f32_16x16x32_bf16 v[44:47], v[136:139], v[188:191], v[44:47]
  ds_read_b64_tr_b16 v[166:167], v241 offset:33792
  v_mfma_f32_16x16x32_bf16 v[60:63], v[140:143], v[188:191], v[60:63]
  ds_read_b64_tr_b16 v[168:169], v242 offset:32768
  v_mfma_f32_16x16x32_bf16 v[56:59], v[140:143], v[184:187], v[56:59]
  ds_read_b64_tr_b16 v[170:171], v242 offset:33792
  v_mfma_f32_16x16x32_bf16 v[52:55], v[140:143], v[180:183], v[52:55]
  ds_read_b64_tr_b16 v[172:173], v243 offset:32768
  v_mfma_f32_16x16x32_bf16 v[48:51], v[140:143], v[176:179], v[48:51]
  ds_read_b64_tr_b16 v[174:175], v243 offset:33792
  v_mfma_f32_16x16x32_bf16 v[64:67], v[144:147], v[176:179], v[64:67]
  ds_read_b128 v[128:131], v237 offset:0
  v_mfma_f32_16x16x32_bf16 v[68:71], v[144:147], v[180:183], v[68:71]
  ds_read_b128 v[132:135], v237 offset:2048
  v_mfma_f32_16x16x32_bf16 v[72:75], v[144:147], v[184:187], v[72:75]
  ds_read_b128 v[136:139], v237 offset:4096
  v_mfma_f32_16x16x32_bf16 v[76:79], v[144:147], v[188:191], v[76:79]
  ds_read_b128 v[140:143], v237 offset:6144
  v_lshrrev_b32 v248, 4, v245
  v_min_u32 v248, 7, v248
  v_lshlrev_b32 v248, 2, v248
  s_lshl_b32 s21, s16, 7
  s_add_u32 s21, s21, 0xf0400
  v_add_u32 v248, s21, v248
  buffer_load_dword v250, v248, s[12:15], 0 offen offset:32 sc1
  v_mfma_f32_16x16x32_bf16 v[92:95], v[148:151], v[188:191], v[92:95]
  ds_read_b128 v[144:147], v237 offset:8192
  v_mfma_f32_16x16x32_bf16 v[88:91], v[148:151], v[184:187], v[88:91]
  s_add_u32 m0, s28, 32768
  s_mov_b32 s35, 1048576
  buffer_load_dwordx4 v253, s[8:11], s35 offen offset:0 lds
  v_mfma_f32_16x16x32_bf16 v[84:87], v[148:151], v[180:183], v[84:87]
  v_mfma_f32_16x16x32_bf16 v[80:83], v[148:151], v[176:179], v[80:83]
  s_mov_b32 s35, 1080320
  buffer_load_dwordx4 v253, s[8:11], s35 offen offset:1024 lds
  v_mfma_f32_16x16x32_bf16 v[96:99], v[152:155], v[176:179], v[96:99]
  ds_read_b128 v[148:151], v237 offset:10240
  v_mfma_f32_16x16x32_bf16 v[100:103], v[152:155], v[180:183], v[100:103]
  s_mov_b32 s35, 1112064
  buffer_load_dwordx4 v254, s[8:11], s35 offen offset:2048 lds
  v_mfma_f32_16x16x32_bf16 v[104:107], v[152:155], v[184:187], v[104:107]
  v_mfma_f32_16x16x32_bf16 v[108:111], v[152:155], v[188:191], v[108:111]
  s_mov_b32 s35, 1143808
  buffer_load_dwordx4 v254, s[8:11], s35 offen offset:3072 lds
  v_mfma_f32_16x16x32_bf16 v[124:127], v[156:159], v[188:191], v[124:127]
  ds_read_b128 v[152:155], v237 offset:12288
  v_mfma_f32_16x16x32_bf16 v[120:123], v[156:159], v[184:187], v[120:123]
  v_mfma_f32_16x16x32_bf16 v[116:119], v[156:159], v[180:183], v[116:119]
  v_mfma_f32_16x16x32_bf16 v[112:115], v[156:159], v[176:179], v[112:115]
  ds_read_b128 v[156:159], v237 offset:14336
  s_waitcnt lgkmcnt(7)
  v_mfma_f32_16x16x32_bf16 v[0:3], v[128:131], v[160:163], v[0:3]
  v_mfma_f32_16x16x32_bf16 v[4:7], v[128:131], v[164:167], v[4:7]
  v_mfma_f32_16x16x32_bf16 v[8:11], v[128:131], v[168:171], v[8:11]
  v_mfma_f32_16x16x32_bf16 v[12:15], v[128:131], v[172:175], v[12:15]
  s_waitcnt lgkmcnt(0)
  v_mfma_f32_16x16x32_bf16 v[28:31], v[132:135], v[172:175], v[28:31]
  v_mfma_f32_16x16x32_bf16 v[24:27], v[132:135], v[168:171], v[24:27]
  s_waitcnt vmcnt(5)
  s_barrier
  v_mfma_f32_16x16x32_bf16 v[20:23], v[132:135], v[164:167], v[20:23]
  v_mfma_f32_16x16x32_bf16 v[16:19], v[132:135], v[160:163], v[16:19]
  v_mfma_f32_16x16x32_bf16 v[32:35], v[136:139], v[160:163], v[32:35]
  ds_read_b64_tr_b16 v[176:177], v240 offset:0
  v_mfma_f32_16x16x32_bf16 v[36:39], v[136:139], v[164:167], v[36:39]
  ds_read_b64_tr_b16 v[178:179], v240 offset:1024
  v_mfma_f32_16x16x32_bf16 v[40:43], v[136:139], v[168:171], v[40:43]
  ds_read_b64_tr_b16 v[180:181], v241 offset:0
  v_mfma_f32_16x16x32_bf16 v[44:47], v[136:139], v[172:175], v[44:47]
  ds_read_b64_tr_b16 v[182:183], v241 offset:1024
  v_mfma_f32_16x16x32_bf16 v[60:63], v[140:143], v[172:175], v[60:63]
  ds_read_b64_tr_b16 v[184:185], v242 offset:0
  v_mfma_f32_16x16x32_bf16 v[56:59], v[140:143], v[168:171], v[56:59]
  ds_read_b64_tr_b16 v[186:187], v242 offset:1024
  v_mfma_f32_16x16x32_bf16 v[52:55], v[140:143], v[164:167], v[52:55]
  ds_read_b64_tr_b16 v[188:189], v243 offset:0
  v_mfma_f32_16x16x32_bf16 v[48:51], v[140:143], v[160:163], v[48:51]
  ds_read_b64_tr_b16 v[190:191], v243 offset:1024
  v_mfma_f32_16x16x32_bf16 v[64:67], v[144:147], v[160:163], v[64:67]
  ds_read_b128 v[128:131], v239 offset:0
  v_mfma_f32_16x16x32_bf16 v[68:71], v[144:147], v[164:167], v[68:71]
  ds_read_b128 v[132:135], v239 offset:2048
  v_mfma_f32_16x16x32_bf16 v[72:75], v[144:147], v[168:171], v[72:75]
  ds_read_b128 v[136:139], v239 offset:4096
  v_mfma_f32_16x16x32_bf16 v[76:79], v[144:147], v[172:175], v[76:79]
  ds_read_b128 v[140:143], v239 offset:6144
  v_mfma_f32_16x16x32_bf16 v[92:95], v[148:151], v[172:175], v[92:95]
  ds_read_b128 v[144:147], v239 offset:8192
  v_mfma_f32_16x16x32_bf16 v[88:91], v[148:151], v[168:171], v[88:91]
  v_mfma_f32_16x16x32_bf16 v[84:87], v[148:151], v[164:167], v[84:87]
  v_mfma_f32_16x16x32_bf16 v[80:83], v[148:151], v[160:163], v[80:83]
  v_mfma_f32_16x16x32_bf16 v[96:99], v[152:155], v[160:163], v[96:99]
  ds_read_b128 v[148:151], v239 offset:10240
  v_mfma_f32_16x16x32_bf16 v[100:103], v[152:155], v[164:167], v[100:103]
  v_mfma_f32_16x16x32_bf16 v[104:107], v[152:155], v[168:171], v[104:107]
  v_mfma_f32_16x16x32_bf16 v[108:111], v[152:155], v[172:175], v[108:111]
  v_mfma_f32_16x16x32_bf16 v[124:127], v[156:159], v[172:175], v[124:127]
  ds_read_b128 v[152:155], v239 offset:12288
  v_mfma_f32_16x16x32_bf16 v[120:123], v[156:159], v[168:171], v[120:123]
  v_mfma_f32_16x16x32_bf16 v[116:119], v[156:159], v[164:167], v[116:119]
  v_mfma_f32_16x16x32_bf16 v[112:115], v[156:159], v[160:163], v[112:115]
  ds_read_b128 v[156:159], v239 offset:14336
  s_waitcnt lgkmcnt(7)
  v_mfma_f32_16x16x32_bf16 v[0:3], v[128:131], v[176:179], v[0:3]
  v_mfma_f32_16x16x32_bf16 v[4:7], v[128:131], v[180:183], v[4:7]
  v_mfma_f32_16x16x32_bf16 v[8:11], v[128:131], v[184:187], v[8:11]
  v_mfma_f32_16x16x32_bf16 v[12:15], v[128:131], v[188:191], v[12:15]
  s_waitcnt lgkmcnt(0)
  v_mfma_f32_16x16x32_bf16 v[28:31], v[132:135], v[188:191], v[28:31]
  v_mfma_f32_16x16x32_bf16 v[24:27], v[132:135], v[184:187], v[24:27]
  s_barrier
  v_mfma_f32_16x16x32_bf16 v[20:23], v[132:135], v[180:183], v[20:23]
  v_mfma_f32_16x16x32_bf16 v[16:19], v[132:135], v[176:179], v[16:19]
  v_mfma_f32_16x16x32_bf16 v[32:35], v[136:139], v[176:179], v[32:35]
  v_mfma_f32_16x16x32_bf16 v[36:39], v[136:139], v[180:183], v[36:39]
  v_mfma_f32_16x16x32_bf16 v[40:43], v[136:139], v[184:187], v[40:43]
  v_mfma_f32_16x16x32_bf16 v[44:47], v[136:139], v[188:191], v[44:47]
  v_mfma_f32_16x16x32_bf16 v[60:63], v[140:143], v[188:191], v[60:63]
  v_mfma_f32_16x16x32_bf16 v[56:59], v[140:143], v[184:187], v[56:59]
  v_mfma_f32_16x16x32_bf16 v[52:55], v[140:143], v[180:183], v[52:55]
  v_mfma_f32_16x16x32_bf16 v[48:51], v[140:143], v[176:179], v[48:51]
  v_mfma_f32_16x16x32_bf16 v[64:67], v[144:147], v[176:179], v[64:67]
  v_mfma_f32_16x16x32_bf16 v[68:71], v[144:147], v[180:183], v[68:71]
  v_mfma_f32_16x16x32_bf16 v[72:75], v[144:147], v[184:187], v[72:75]
  v_mfma_f32_16x16x32_bf16 v[76:79], v[144:147], v[188:191], v[76:79]
  v_add_u32 v232, 20480, v255
  s_mov_b32 s35, 0
  buffer_load_dwordx4 v[200:203], v255, s[12:15], s35 offen sc1
  buffer_load_dwordx4 v[204:207], v232, s[12:15], s35 offen sc1
  v_mfma_f32_16x16x32_bf16 v[92:95], v[148:151], v[188:191], v[92:95]
  s_mov_b32 s35, 1024
  buffer_load_dwordx4 v[208:211], v255, s[12:15], s35 offen sc1
  v_mfma_f32_16x16x32_bf16 v[88:91], v[148:151], v[184:187], v[88:91]
  buffer_load_dwordx4 v[212:215], v232, s[12:15], s35 offen sc1
  v_mfma_f32_16x16x32_bf16 v[84:87], v[148:151], v[180:183], v[84:87]
  s_mov_b32 s35, 2048
  buffer_load_dwordx4 v[216:219], v255, s[12:15], s35 offen sc1
  v_mfma_f32_16x16x32_bf16 v[80:83], v[148:151], v[176:179], v[80:83]
  buffer_load_dwordx4 v[220:223], v232, s[12:15], s35 offen sc1
  v_mfma_f32_16x16x32_bf16 v[96:99], v[152:155], v[176:179], v[96:99]
  s_mov_b32 s35, 3072
  buffer_load_dwordx4 v[224:227], v255, s[12:15], s35 offen sc1
  v_mfma_f32_16x16x32_bf16 v[100:103], v[152:155], v[180:183], v[100:103]
  buffer_load_dwordx4 v[228:231], v232, s[12:15], s35 offen sc1
  v_mfma_f32_16x16x32_bf16 v[104:107], v[152:155], v[184:187], v[104:107]
  s_add_u32 m0, s28, 65536
  s_mov_b32 s35, 2097152
  buffer_load_dwordx4 v253, s[8:11], s35 offen offset:0 lds
  v_mfma_f32_16x16x32_bf16 v[108:111], v[152:155], v[188:191], v[108:111]
  s_mov_b32 s35, 2128896
  buffer_load_dwordx4 v253, s[8:11], s35 offen offset:1024 lds
  v_mfma_f32_16x16x32_bf16 v[124:127], v[156:159], v[188:191], v[124:127]
  s_mov_b32 s35, 2160640
  buffer_load_dwordx4 v254, s[8:11], s35 offen offset:2048 lds
  v_mfma_f32_16x16x32_bf16 v[120:123], v[156:159], v[184:187], v[120:123]
  s_mov_b32 s35, 2192384
  buffer_load_dwordx4 v254, s[8:11], s35 offen offset:3072 lds
  v_mfma_f32_16x16x32_bf16 v[116:119], v[156:159], v[180:183], v[116:119]
  v_mfma_f32_16x16x32_bf16 v[112:115], v[156:159], v[176:179], v[112:115]
  v_cvt_pk_bf16_f32 v128, v0, v1
  v_cvt_pk_bf16_f32 v129, v2, v3
  v_cvt_pk_bf16_f32 v130, v16, v17
  v_cvt_pk_bf16_f32 v131, v18, v19
  v_cvt_pk_bf16_f32 v132, v4, v5
  v_cvt_pk_bf16_f32 v133, v6, v7
  v_cvt_pk_bf16_f32 v134, v20, v21
  v_cvt_pk_bf16_f32 v135, v22, v23
  v_cvt_pk_bf16_f32 v136, v8, v9
  v_cvt_pk_bf16_f32 v137, v10, v11
  v_cvt_pk_bf16_f32 v138, v24, v25
  v_cvt_pk_bf16_f32 v139, v26, v27
  v_cvt_pk_bf16_f32 v140, v12, v13
  v_cvt_pk_bf16_f32 v141, v14, v15
  v_cvt_pk_bf16_f32 v142, v28, v29
  v_cvt_pk_bf16_f32 v143, v30, v31
  v_cvt_pk_bf16_f32 v144, v32, v33
  v_cvt_pk_bf16_f32 v145, v34, v35
  v_cvt_pk_bf16_f32 v146, v48, v49
  v_cvt_pk_bf16_f32 v147, v50, v51
  v_cvt_pk_bf16_f32 v148, v36, v37
  v_cvt_pk_bf16_f32 v149, v38, v39
  v_cvt_pk_bf16_f32 v150, v52, v53
  v_cvt_pk_bf16_f32 v151, v54, v55
  v_cvt_pk_bf16_f32 v152, v40, v41
  v_cvt_pk_bf16_f32 v153, v42, v43
  v_cvt_pk_bf16_f32 v154, v56, v57
  v_cvt_pk_bf16_f32 v155, v58, v59
  v_cvt_pk_bf16_f32 v156, v44, v45
  v_cvt_pk_bf16_f32 v157, v46, v47
  v_cvt_pk_bf16_f32 v158, v60, v61
  v_cvt_pk_bf16_f32 v159, v62, v63
  v_cvt_pk_bf16_f32 v160, v64, v65
  v_cvt_pk_bf16_f32 v161, v66, v67
  v_cvt_pk_bf16_f32 v162, v80, v81
  v_cvt_pk_bf16_f32 v163, v82, v83
  v_cvt_pk_bf16_f32 v164, v68, v69
  v_cvt_pk_bf16_f32 v165, v70, v71
  v_cvt_pk_bf16_f32 v166, v84, v85
  v_cvt_pk_bf16_f32 v167, v86, v87
  v_cvt_pk_bf16_f32 v168, v72, v73
  v_cvt_pk_bf16_f32 v169, v74, v75
  v_cvt_pk_bf16_f32 v170, v88, v89
  v_cvt_pk_bf16_f32 v171, v90, v91
  v_cvt_pk_bf16_f32 v172, v76, v77
  v_cvt_pk_bf16_f32 v173, v78, v79
  v_cvt_pk_bf16_f32 v174, v92, v93
  v_cvt_pk_bf16_f32 v175, v94, v95
  v_cvt_pk_bf16_f32 v176, v96, v97
  v_cvt_pk_bf16_f32 v177, v98, v99
  v_cvt_pk_bf16_f32 v178, v112, v113
  v_cvt_pk_bf16_f32 v179, v114, v115
  v_cvt_pk_bf16_f32 v180, v100, v101
  v_cvt_pk_bf16_f32 v181, v102, v103
  v_cvt_pk_bf16_f32 v182, v116, v117
  v_cvt_pk_bf16_f32 v183, v118, v119
  v_cvt_pk_bf16_f32 v184, v104, v105
  v_cvt_pk_bf16_f32 v185, v106, v107
  v_cvt_pk_bf16_f32 v186, v120, v121
  v_cvt_pk_bf16_f32 v187, v122, v123
  v_cvt_pk_bf16_f32 v188, v108, v109
  v_cvt_pk_bf16_f32 v189, v110, v111
  v_cvt_pk_bf16_f32 v190, v124, v125
  v_cvt_pk_bf16_f32 v191, v126, v127
ka_phase2:
  s_waitcnt vmcnt(16)
  v_cmp_ne_u32 vcc, s100, v250
  s_nop 0
  s_cmp_eq_u64 vcc, 0
  s_cselect_b32 s101, 1, 0
  ds_read_b64_tr_b16 v[64:65], v192 offset:0
  ds_read_b64_tr_b16 v[66:67], v192 offset:1024
  ds_read_b64_tr_b16 v[68:69], v193 offset:0
  ds_read_b64_tr_b16 v[70:71], v193 offset:1024
  ds_read_b64_tr_b16 v[72:73], v194 offset:0
  ds_read_b64_tr_b16 v[74:75], v194 offset:1024
  ds_read_b64_tr_b16 v[76:77], v195 offset:0
  ds_read_b64_tr_b16 v[78:79], v195 offset:1024
  ds_read_b64_tr_b16 v[80:81], v196 offset:0
  ds_read_b64_tr_b16 v[82:83], v196 offset:1024
  ds_read_b64_tr_b16 v[84:85], v197 offset:0
  ds_read_b64_tr_b16 v[86:87], v197 offset:1024
  ds_read_b64_tr_b16 v[88:89], v198 offset:0
  ds_read_b64_tr_b16 v[90:91], v198 offset:1024
  ds_read_b64_tr_b16 v[92:93], v199 offset:0
  ds_read_b64_tr_b16 v[94:95], v199 offset:1024
  s_mov_b32 s35, 4096
  buffer_load_dwordx4 v[96:99], v255, s[12:15], s35 offen sc1
  buffer_load_dwordx4 v[100:103], v232, s[12:15], s35 offen sc1
  s_mov_b32 s35, 5120
  buffer_load_dwordx4 v[104:107], v255, s[12:15], s35 offen sc1
  buffer_load_dwordx4 v[108:111], v232, s[12:15], s35 offen sc1
  s_mov_b32 s35, 6144
  buffer_load_dwordx4 v[112:115], v255, s[12:15], s35 offen sc1
  buffer_load_dwordx4 v[116:119], v232, s[12:15], s35 offen sc1
  s_waitcnt vmcnt(16)
  s_waitcnt lgkmcnt(12)
  v_mfma_f32_16x16x32_bf16 v[0:3], v[64:67], v[200:203], 0
  v_mfma_f32_16x16x32_bf16 v[4:7], v[64:67], v[204:207], 0
  ds_read_b64_tr_b16 v[64:65], v192 offset:8192
  ds_read_b64_tr_b16 v[66:67], v192 offset:9216
  v_mfma_f32_16x16x32_bf16 v[12:15], v[68:71], v[204:207], 0
  v_mfma_f32_16x16x32_bf16 v[8:11], v[68:71], v[200:203], 0
  ds_read_b64_tr_b16 v[68:69], v193 offset:8192
  ds_read_b64_tr_b16 v[70:71], v193 offset:9216
  s_mov_b32 s35, 7168
  buffer_load_dwordx4 v[120:123], v255, s[12:15], s35 offen sc1
  buffer_load_dwordx4 v[124:127], v232, s[12:15], s35 offen sc1
  s_waitcnt lgkmcnt(12)
  v_mfma_f32_16x16x32_bf16 v[16:19], v[72:75], v[200:203], 0
  v_mfma_f32_16x16x32_bf16 v[20:23], v[72:75], v[204:207], 0
  ds_read_b64_tr_b16 v[72:73], v194 offset:8192
  ds_read_b64_tr_b16 v[74:75], v194 offset:9216
  v_mfma_f32_16x16x32_bf16 v[28:31], v[76:79], v[204:207], 0
  v_mfma_f32_16x16x32_bf16 v[24:27], v[76:79], v[200:203], 0
  ds_read_b64_tr_b16 v[76:77], v195 offset:8192
  ds_read_b64_tr_b16 v[78:79], v195 offset:9216
  s_waitcnt lgkmcnt(12)
  v_mfma_f32_16x16x32_bf16 v[32:35], v[80:83], v[200:203], 0
  v_mfma_f32_16x16x32_bf16 v[36:39], v[80:83], v[204:207], 0
  ds_read_b64_tr_b16 v[80:81], v196 offset:8192
  ds_read_b64_tr_b16 v[82:83], v196 offset:9216
  v_mfma_f32_16x16x32_bf16 v[44:47], v[84:87], v[204:207], 0
  v_mfma_f32_16x16x32_bf16 v[40:43], v[84:87], v[200:203], 0
  ds_read_b64_tr_b16 v[84:85], v197 offset:8192
  ds_read_b64_tr_b16 v[86:87], v197 offset:9216
  s_waitcnt lgkmcnt(12)
  v_mfma_f32_16x16x32_bf16 v[48:51], v[88:91], v[200:203], 0
  v_mfma_f32_16x16x32_bf16 v[52:55], v[88:91], v[204:207], 0
  ds_read_b64_tr_b16 v[88:89], v198 offset:8192
  ds_read_b64_tr_b16 v[90:91], v198 offset:9216
  s_mov_b32 s35, 0
  s_cmp_eq_u32 s101, 0
  s_cbranch_scc1 ka_kernel_kf_13
  buffer_store_dwordx4 v[128:131], v244, s[12:15], s35 offen offset:0
ka_kernel_kj_14:
  v_mfma_f32_16x16x32_bf16 v[60:63], v[92:95], v[204:207], 0
  v_mfma_f32_16x16x32_bf16 v[56:59], v[92:95], v[200:203], 0
  ds_read_b64_tr_b16 v[92:93], v199 offset:8192
  ds_read_b64_tr_b16 v[94:95], v199 offset:9216
  s_mov_b32 s35, 0
  s_cmp_eq_u32 s101, 0
  s_cbranch_scc1 ka_kernel_kf_15
  buffer_store_dwordx4 v[132:135], v244, s[12:15], s35 offen offset:1024
ka_kernel_kj_16:
  s_waitcnt vmcnt(18)
  s_waitcnt lgkmcnt(12)
  v_mfma_f32_16x16x32_bf16 v[0:3], v[64:67], v[208:211], v[0:3]
  v_mfma_f32_16x16x32_bf16 v[4:7], v[64:67], v[212:215], v[4:7]
  ds_read_b64_tr_b16 v[64:65], v192 offset:16384
  ds_read_b64_tr_b16 v[66:67], v192 offset:17408
  v_mfma_f32_16x16x32_bf16 v[12:15], v[68:71], v[212:215], v[12:15]
  v_mfma_f32_16x16x32_bf16 v[8:11], v[68:71], v[208:211], v[8:11]
  ds_read_b64_tr_b16 v[68:69], v193 offset:16384
  ds_read_b64_tr_b16 v[70:71], v193 offset:17408
  s_mov_b32 s35, 8192
  buffer_load_dwordx4 v[200:203], v255, s[12:15], s35 offen sc1
  buffer_load_dwordx4 v[204:207], v232, s[12:15], s35 offen sc1
  s_waitcnt lgkmcnt(12)
  v_mfma_f32_16x16x32_bf16 v[16:19], v[72:75], v[208:211], v[16:19]
  v_mfma_f32_16x16x32_bf16 v[20:23], v[72:75], v[212:215], v[20:23]
  ds_read_b64_tr_b16 v[72:73], v194 offset:16384
  ds_read_b64_tr_b16 v[74:75], v194 offset:17408
  v_mfma_f32_16x16x32_bf16 v[28:31], v[76:79], v[212:215], v[28:31]
  v_mfma_f32_16x16x32_bf16 v[24:27], v[76:79], v[208:211], v[24:27]
  ds_read_b64_tr_b16 v[76:77], v195 offset:16384
  ds_read_b64_tr_b16 v[78:79], v195 offset:17408
  s_add_u32 m0, s28, 98304
  s_mov_b32 s35, 3145728
  buffer_load_dwordx4 v253, s[8:11], s35 offen offset:0 lds
  s_mov_b32 s35, 3177472
  buffer_load_dwordx4 v253, s[8:11], s35 offen offset:1024 lds
  s_mov_b32 s35, 3209216
  buffer_load_dwordx4 v254, s[8:11], s35 offen offset:2048 lds
  s_mov_b32 s35, 3240960
  buffer_load_dwordx4 v254, s[8:11], s35 offen offset:3072 lds
  s_waitcnt lgkmcnt(12)
  v_mfma_f32_16x16x32_bf16 v[32:35], v[80:83], v[208:211], v[32:35]
  v_mfma_f32_16x16x32_bf16 v[36:39], v[80:83], v[212:215], v[36:39]
  ds_read_b64_tr_b16 v[80:81], v196 offset:16384
  ds_read_b64_tr_b16 v[82:83], v196 offset:17408
  v_mfma_f32_16x16x32_bf16 v[44:47], v[84:87], v[212:215], v[44:47]
  v_mfma_f32_16x16x32_bf16 v[40:43], v[84:87], v[208:211], v[40:43]
  ds_read_b64_tr_b16 v[84:85], v197 offset:16384
  ds_read_b64_tr_b16 v[86:87], v197 offset:17408
  s_waitcnt lgkmcnt(12)
  v_mfma_f32_16x16x32_bf16 v[48:51], v[88:91], v[208:211], v[48:51]
  v_mfma_f32_16x16x32_bf16 v[52:55], v[88:91], v[212:215], v[52:55]
  ds_read_b64_tr_b16 v[88:89], v198 offset:16384
  ds_read_b64_tr_b16 v[90:91], v198 offset:17408
  s_mov_b32 s35, 0
  s_cmp_eq_u32 s101, 0
  s_cbranch_scc1 ka_kernel_kf_17
  buffer_store_dwordx4 v[136:139], v246, s[12:15], s35 offen offset:0
ka_kernel_kj_18:
  v_mfma_f32_16x16x32_bf16 v[60:63], v[92:95], v[212:215], v[60:63]
  v_mfma_f32_16x16x32_bf16 v[56:59], v[92:95], v[208:211], v[56:59]
  ds_read_b64_tr_b16 v[92:93], v199 offset:16384
  ds_read_b64_tr_b16 v[94:95], v199 offset:17408
  s_mov_b32 s35, 0
  s_cmp_eq_u32 s101, 0
  s_cbranch_scc1 ka_kernel_kf_19
  buffer_store_dwordx4 v[140:143], v246, s[12:15], s35 offen offset:1024
ka_kernel_kj_20:
  s_waitcnt vmcnt(24)
  s_waitcnt lgkmcnt(12)
  v_mfma_f32_16x16x32_bf16 v[0:3], v[64:67], v[216:219], v[0:3]
  v_mfma_f32_16x16x32_bf16 v[4:7], v[64:67], v[220:223], v[4:7]
  ds_read_b64_tr_b16 v[64:65], v192 offset:24576
  ds_read_b64_tr_b16 v[66:67], v192 offset:25600
  v_mfma_f32_16x16x32_bf16 v[12:15], v[68:71], v[220:223], v[12:15]
  v_mfma_f32_16x16x32_bf16 v[8:11], v[68:71], v[216:219], v[8:11]
  ds_read_b64_tr_b16 v[68:69], v193 offset:24576
  ds_read_b64_tr_b16 v[70:71], v193 offset:25600
  s_mov_b32 s35, 9216
  buffer_load_dwordx4 v[208:211], v255, s[12:15], s35 offen sc1
  buffer_load_dwordx4 v[212:215], v232, s[12:15], s35 offen sc1
  s_waitcnt lgkmcnt(12)
  v_mfma_f32_16x16x32_bf16 v[16:19], v[72:75], v[216:219], v[16:19]
  v_mfma_f32_16x16x32_bf16 v[20:23], v[72:75], v[220:223], v[20:23]
  ds_read_b64_tr_b16 v[72:73], v194 offset:24576
  ds_read_b64_tr_b16 v[74:75], v194 offset:25600
  v_mfma_f32_16x16x32_bf16 v[28:31], v[76:79], v[220:223], v[28:31]
  v_mfma_f32_16x16x32_bf16 v[24:27], v[76:79], v[216:219], v[24:27]
  ds_read_b64_tr_b16 v[76:77], v195 offset:24576
  ds_read_b64_tr_b16 v[78:79], v195 offset:25600
  s_waitcnt lgkmcnt(12)
  v_mfma_f32_16x16x32_bf16 v[32:35], v[80:83], v[216:219], v[32:35]
  v_mfma_f32_16x16x32_bf16 v[36:39], v[80:83], v[220:223], v[36:39]
  ds_read_b64_tr_b16 v[80:81], v196 offset:24576
  ds_read_b64_tr_b16 v[82:83], v196 offset:25600
  v_mfma_f32_16x16x32_bf16 v[44:47], v[84:87], v[220:223], v[44:47]
  v_mfma_f32_16x16x32_bf16 v[40:43], v[84:87], v[216:219], v[40:43]
  ds_read_b64_tr_b16 v[84:85], v197 offset:24576
  ds_read_b64_tr_b16 v[86:87], v197 offset:25600
  s_waitcnt lgkmcnt(12)
  v_mfma_f32_16x16x32_bf16 v[48:51], v[88:91], v[216:219], v[48:51]
  v_mfma_f32_16x16x32_bf16 v[52:55], v[88:91], v[220:223], v[52:55]
  ds_read_b64_tr_b16 v[88:89], v198 offset:24576
  ds_read_b64_tr_b16 v[90:91], v198 offset:25600
  s_mov_b32 s35, 16384
  s_cmp_eq_u32 s101, 0
  s_cbranch_scc1 ka_kernel_kf_21
  buffer_store_dwordx4 v[144:147], v244, s[12:15], s35 offen offset:0
ka_kernel_kj_22:
  v_mfma_f32_16x16x32_bf16 v[60:63], v[92:95], v[220:223], v[60:63]
  v_mfma_f32_16x16x32_bf16 v[56:59], v[92:95], v[216:219], v[56:59]
  ds_read_b64_tr_b16 v[92:93], v199 offset:24576
  ds_read_b64_tr_b16 v[94:95], v199 offset:25600
  s_mov_b32 s35, 16384
  s_cmp_eq_u32 s101, 0
  s_cbranch_scc1 ka_kernel_kf_23
  buffer_store_dwordx4 v[148:151], v244, s[12:15], s35 offen offset:1024
ka_kernel_kj_24:
  s_waitcnt vmcnt(26)
  s_waitcnt lgkmcnt(12)
  v_mfma_f32_16x16x32_bf16 v[0:3], v[64:67], v[224:227], v[0:3]
  v_mfma_f32_16x16x32_bf16 v[4:7], v[64:67], v[228:231], v[4:7]
  v_mfma_f32_16x16x32_bf16 v[12:15], v[68:71], v[228:231], v[12:15]
  v_mfma_f32_16x16x32_bf16 v[8:11], v[68:71], v[224:227], v[8:11]
  s_mov_b32 s35, 10240
  buffer_load_dwordx4 v[216:219], v255, s[12:15], s35 offen sc1
  buffer_load_dwordx4 v[220:223], v232, s[12:15], s35 offen sc1
  s_waitcnt lgkmcnt(0)
  v_mfma_f32_16x16x32_bf16 v[16:19], v[72:75], v[224:227], v[16:19]
  v_mfma_f32_16x16x32_bf16 v[20:23], v[72:75], v[228:231], v[20:23]
  s_barrier
  ds_read_b64_tr_b16 v[64:65], v192 offset:32768
  ds_read_b64_tr_b16 v[66:67], v192 offset:33792
  ds_read_b64_tr_b16 v[68:69], v193 offset:32768
  ds_read_b64_tr_b16 v[70:71], v193 offset:33792
  v_mfma_f32_16x16x32_bf16 v[28:31], v[76:79], v[228:231], v[28:31]
  v_mfma_f32_16x16x32_bf16 v[24:27], v[76:79], v[224:227], v[24:27]
  ds_read_b64_tr_b16 v[72:73], v194 offset:32768
  ds_read_b64_tr_b16 v[74:75], v194 offset:33792
  ds_read_b64_tr_b16 v[76:77], v195 offset:32768
  ds_read_b64_tr_b16 v[78:79], v195 offset:33792
  v_mfma_f32_16x16x32_bf16 v[32:35], v[80:83], v[224:227], v[32:35]
  v_mfma_f32_16x16x32_bf16 v[36:39], v[80:83], v[228:231], v[36:39]
  ds_read_b64_tr_b16 v[80:81], v196 offset:32768
  ds_read_b64_tr_b16 v[82:83], v196 offset:33792
  v_mfma_f32_16x16x32_bf16 v[44:47], v[84:87], v[228:231], v[44:47]
  v_mfma_f32_16x16x32_bf16 v[40:43], v[84:87], v[224:227], v[40:43]
  s_add_u32 m0, s28, 0
  s_mov_b32 s35, 4194304
  buffer_load_dwordx4 v253, s[8:11], s35 offen offset:0 lds
  s_mov_b32 s35, 4226048
  buffer_load_dwordx4 v253, s[8:11], s35 offen offset:1024 lds
  s_mov_b32 s35, 4257792
  buffer_load_dwordx4 v254, s[8:11], s35 offen offset:2048 lds
  s_mov_b32 s35, 4289536
  buffer_load_dwordx4 v254, s[8:11], s35 offen offset:3072 lds
  ds_read_b64_tr_b16 v[84:85], v197 offset:32768
  ds_read_b64_tr_b16 v[86:87], v197 offset:33792
  v_mfma_f32_16x16x32_bf16 v[48:51], v[88:91], v[224:227], v[48:51]
  v_mfma_f32_16x16x32_bf16 v[52:55], v[88:91], v[228:231], v[52:55]
  ds_read_b64_tr_b16 v[88:89], v198 offset:32768
  ds_read_b64_tr_b16 v[90:91], v198 offset:33792
  s_mov_b32 s35, 16384
  s_cmp_eq_u32 s101, 0
  s_cbranch_scc1 ka_kernel_kf_25
  buffer_store_dwordx4 v[152:155], v246, s[12:15], s35 offen offset:0
ka_kernel_kj_26:
  v_mfma_f32_16x16x32_bf16 v[60:63], v[92:95], v[228:231], v[60:63]
  v_mfma_f32_16x16x32_bf16 v[56:59], v[92:95], v[224:227], v[56:59]
  ds_read_b64_tr_b16 v[92:93], v199 offset:32768
  ds_read_b64_tr_b16 v[94:95], v199 offset:33792
  s_mov_b32 s35, 16384
  s_cmp_eq_u32 s101, 0
  s_cbranch_scc1 ka_kernel_kf_27
  buffer_store_dwordx4 v[156:159], v246, s[12:15], s35 offen offset:1024
ka_kernel_kj_28:
  s_waitcnt vmcnt(28)
  s_waitcnt lgkmcnt(12)
  v_mfma_f32_16x16x32_bf16 v[0:3], v[64:67], v[96:99], v[0:3]
  v_mfma_f32_16x16x32_bf16 v[4:7], v[64:67], v[100:103], v[4:7]
  ds_read_b64_tr_b16 v[64:65], v192 offset:40960
  ds_read_b64_tr_b16 v[66:67], v192 offset:41984
  v_mfma_f32_16x16x32_bf16 v[12:15], v[68:71], v[100:103], v[12:15]
  v_mfma_f32_16x16x32_bf16 v[8:11], v[68:71], v[96:99], v[8:11]
  ds_read_b64_tr_b16 v[68:69], v193 offset:40960
  ds_read_b64_tr_b16 v[70:71], v193 offset:41984
  s_mov_b32 s35, 11264
  buffer_load_dwordx4 v[224:227], v255, s[12:15], s35 offen sc1
  buffer_load_dwordx4 v[228:231], v232, s[12:15], s35 offen sc1
  s_waitcnt lgkmcnt(12)
  v_mfma_f32_16x16x32_bf16 v[16:19], v[72:75], v[96:99], v[16:19]
  v_mfma_f32_16x16x32_bf16 v[20:23], v[72:75], v[100:103], v[20:23]
  ds_read_b64_tr_b16 v[72:73], v194 offset:40960
  ds_read_b64_tr_b16 v[74:75], v194 offset:41984
  v_mfma_f32_16x16x32_bf16 v[28:31], v[76:79], v[100:103], v[28:31]
  v_mfma_f32_16x16x32_bf16 v[24:27], v[76:79], v[96:99], v[24:27]
  ds_read_b64_tr_b16 v[76:77], v195 offset:40960
  ds_read_b64_tr_b16 v[78:79], v195 offset:41984
  s_waitcnt lgkmcnt(12)
  v_mfma_f32_16x16x32_bf16 v[32:35], v[80:83], v[96:99], v[32:35]
  v_mfma_f32_16x16x32_bf16 v[36:39], v[80:83], v[100:103], v[36:39]
  ds_read_b64_tr_b16 v[80:81], v196 offset:40960
  ds_read_b64_tr_b16 v[82:83], v196 offset:41984
  v_mfma_f32_16x16x32_bf16 v[44:47], v[84:87], v[100:103], v[44:47]
  v_mfma_f32_16x16x32_bf16 v[40:43], v[84:87], v[96:99], v[40:43]
  ds_read_b64_tr_b16 v[84:85], v197 offset:40960
  ds_read_b64_tr_b16 v[86:87], v197 offset:41984
  s_waitcnt lgkmcnt(12)
  v_mfma_f32_16x16x32_bf16 v[48:51], v[88:91], v[96:99], v[48:51]
  v_mfma_f32_16x16x32_bf16 v[52:55], v[88:91], v[100:103], v[52:55]
  ds_read_b64_tr_b16 v[88:89], v198 offset:40960
  ds_read_b64_tr_b16 v[90:91], v198 offset:41984
  s_mov_b32 s35, 32768
  s_cmp_eq_u32 s101, 0
  s_cbranch_scc1 ka_kernel_kf_29
  buffer_store_dwordx4 v[160:163], v244, s[12:15], s35 offen offset:0
ka_kernel_kj_30:
  v_mfma_f32_16x16x32_bf16 v[60:63], v[92:95], v[100:103], v[60:63]
  v_mfma_f32_16x16x32_bf16 v[56:59], v[92:95], v[96:99], v[56:59]
  ds_read_b64_tr_b16 v[92:93], v199 offset:40960
  ds_read_b64_tr_b16 v[94:95], v199 offset:41984
  s_mov_b32 s35, 32768
  s_cmp_eq_u32 s101, 0
  s_cbranch_scc1 ka_kernel_kf_31
  buffer_store_dwordx4 v[164:167], v244, s[12:15], s35 offen offset:1024
ka_kernel_kj_32:
  s_waitcnt vmcnt(30)
  s_waitcnt lgkmcnt(12)
  v_mfma_f32_16x16x32_bf16 v[0:3], v[64:67], v[104:107], v[0:3]
  v_mfma_f32_16x16x32_bf16 v[4:7], v[64:67], v[108:111], v[4:7]
  ds_read_b64_tr_b16 v[64:65], v192 offset:49152
  ds_read_b64_tr_b16 v[66:67], v192 offset:50176
  v_mfma_f32_16x16x32_bf16 v[12:15], v[68:71], v[108:111], v[12:15]
  v_mfma_f32_16x16x32_bf16 v[8:11], v[68:71], v[104:107], v[8:11]
  ds_read_b64_tr_b16 v[68:69], v193 offset:49152
  ds_read_b64_tr_b16 v[70:71], v193 offset:50176
  s_mov_b32 s35, 12288
  buffer_load_dwordx4 v[96:99], v255, s[12:15], s35 offen sc1
  buffer_load_dwordx4 v[100:103], v232, s[12:15], s35 offen sc1
  s_waitcnt lgkmcnt(12)
  v_mfma_f32_16x16x32_bf16 v[16:19], v[72:75], v[104:107], v[16:19]
  v_mfma_f32_16x16x32_bf16 v[20:23], v[72:75], v[108:111], v[20:23]
  ds_read_b64_tr_b16 v[72:73], v194 offset:49152
  ds_read_b64_tr_b16 v[74:75], v194 offset:50176
  v_mfma_f32_16x16x32_bf16 v[28:31], v[76:79], v[108:111], v[28:31]
  v_mfma_f32_16x16x32_bf16 v[24:27], v[76:79], v[104:107], v[24:27]
  ds_read_b64_tr_b16 v[76:77], v195 offset:49152
  ds_read_b64_tr_b16 v[78:79], v195 offset:50176
  s_waitcnt lgkmcnt(12)
  v_mfma_f32_16x16x32_bf16 v[32:35], v[80:83], v[104:107], v[32:35]
  v_mfma_f32_16x16x32_bf16 v[36:39], v[80:83], v[108:111], v[36:39]
  ds_read_b64_tr_b16 v[80:81], v196 offset:49152
  ds_read_b64_tr_b16 v[82:83], v196 offset:50176
  v_mfma_f32_16x16x32_bf16 v[44:47], v[84:87], v[108:111], v[44:47]
  v_mfma_f32_16x16x32_bf16 v[40:43], v[84:87], v[104:107], v[40:43]
  ds_read_b64_tr_b16 v[84:85], v197 offset:49152
  ds_read_b64_tr_b16 v[86:87], v197 offset:50176
  s_waitcnt lgkmcnt(12)
  v_mfma_f32_16x16x32_bf16 v[48:51], v[88:91], v[104:107], v[48:51]
  v_mfma_f32_16x16x32_bf16 v[52:55], v[88:91], v[108:111], v[52:55]
  ds_read_b64_tr_b16 v[88:89], v198 offset:49152
  ds_read_b64_tr_b16 v[90:91], v198 offset:50176
  s_mov_b32 s35, 32768
  s_cmp_eq_u32 s101, 0
  s_cbranch_scc1 ka_kernel_kf_33
  buffer_store_dwordx4 v[168:171], v246, s[12:15], s35 offen offset:0
ka_kernel_kj_34:
  v_mfma_f32_16x16x32_bf16 v[60:63], v[92:95], v[108:111], v[60:63]
  v_mfma_f32_16x16x32_bf16 v[56:59], v[92:95], v[104:107], v[56:59]
  ds_read_b64_tr_b16 v[92:93], v199 offset:49152
  ds_read_b64_tr_b16 v[94:95], v199 offset:50176
  s_mov_b32 s35, 32768
  s_cmp_eq_u32 s101, 0
  s_cbranch_scc1 ka_kernel_kf_35
  buffer_store_dwordx4 v[172:175], v246, s[12:15], s35 offen offset:1024
ka_kernel_kj_36:
  s_waitcnt vmcnt(32)
  s_waitcnt lgkmcnt(12)
  v_mfma_f32_16x16x32_bf16 v[0:3], v[64:67], v[112:115], v[0:3]
  v_mfma_f32_16x16x32_bf16 v[4:7], v[64:67], v[116:119], v[4:7]
  ds_read_b64_tr_b16 v[64:65], v192 offset:57344
  ds_read_b64_tr_b16 v[66:67], v192 offset:58368
  v_mfma_f32_16x16x32_bf16 v[12:15], v[68:71], v[116:119], v[12:15]
  v_mfma_f32_16x16x32_bf16 v[8:11], v[68:71], v[112:115], v[8:11]
  ds_read_b64_tr_b16 v[68:69], v193 offset:57344
  ds_read_b64_tr_b16 v[70:71], v193 offset:58368
  s_mov_b32 s35, 13312
  buffer_load_dwordx4 v[104:107], v255, s[12:15], s35 offen sc1
  buffer_load_dwordx4 v[108:111], v232, s[12:15], s35 offen sc1
  s_waitcnt lgkmcnt(12)
  v_mfma_f32_16x16x32_bf16 v[16:19], v[72:75], v[112:115], v[16:19]
  v_mfma_f32_16x16x32_bf16 v[20:23], v[72:75], v[116:119], v[20:23]
  ds_read_b64_tr_b16 v[72:73], v194 offset:57344
  ds_read_b64_tr_b16 v[74:75], v194 offset:58368
  v_mfma_f32_16x16x32_bf16 v[28:31], v[76:79], v[116:119], v[28:31]
  v_mfma_f32_16x16x32_bf16 v[24:27], v[76:79], v[112:115], v[24:27]
  ds_read_b64_tr_b16 v[76:77], v195 offset:57344
  ds_read_b64_tr_b16 v[78:79], v195 offset:58368
  s_waitcnt lgkmcnt(12)
  v_mfma_f32_16x16x32_bf16 v[32:35], v[80:83], v[112:115], v[32:35]
  v_mfma_f32_16x16x32_bf16 v[36:39], v[80:83], v[116:119], v[36:39]
  ds_read_b64_tr_b16 v[80:81], v196 offset:57344
  ds_read_b64_tr_b16 v[82:83], v196 offset:58368
  v_mfma_f32_16x16x32_bf16 v[44:47], v[84:87], v[116:119], v[44:47]
  v_mfma_f32_16x16x32_bf16 v[40:43], v[84:87], v[112:115], v[40:43]
  ds_read_b64_tr_b16 v[84:85], v197 offset:57344
  ds_read_b64_tr_b16 v[86:87], v197 offset:58368
  s_waitcnt lgkmcnt(12)
  v_mfma_f32_16x16x32_bf16 v[48:51], v[88:91], v[112:115], v[48:51]
  v_mfma_f32_16x16x32_bf16 v[52:55], v[88:91], v[116:119], v[52:55]
  ds_read_b64_tr_b16 v[88:89], v198 offset:57344
  ds_read_b64_tr_b16 v[90:91], v198 offset:58368
  s_mov_b32 s35, 49152
  s_cmp_eq_u32 s101, 0
  s_cbranch_scc1 ka_kernel_kf_37
  buffer_store_dwordx4 v[176:179], v244, s[12:15], s35 offen offset:0
ka_kernel_kj_38:
  v_mfma_f32_16x16x32_bf16 v[60:63], v[92:95], v[116:119], v[60:63]
  v_mfma_f32_16x16x32_bf16 v[56:59], v[92:95], v[112:115], v[56:59]
  ds_read_b64_tr_b16 v[92:93], v199 offset:57344
  ds_read_b64_tr_b16 v[94:95], v199 offset:58368
  s_mov_b32 s35, 49152
  s_cmp_eq_u32 s101, 0
  s_cbranch_scc1 ka_kernel_kf_39
  buffer_store_dwordx4 v[180:183], v244, s[12:15], s35 offen offset:1024
ka_kernel_kj_40:
  s_waitcnt vmcnt(34)
  s_waitcnt lgkmcnt(12)
  v_mfma_f32_16x16x32_bf16 v[0:3], v[64:67], v[120:123], v[0:3]
  v_mfma_f32_16x16x32_bf16 v[4:7], v[64:67], v[124:127], v[4:7]
  v_mfma_f32_16x16x32_bf16 v[12:15], v[68:71], v[124:127], v[12:15]
  v_mfma_f32_16x16x32_bf16 v[8:11], v[68:71], v[120:123], v[8:11]
  s_mov_b32 s35, 14336
  buffer_load_dwordx4 v[112:115], v255, s[12:15], s35 offen sc1
  buffer_load_dwordx4 v[116:119], v232, s[12:15], s35 offen sc1
  s_waitcnt lgkmcnt(0)
  v_mfma_f32_16x16x32_bf16 v[16:19], v[72:75], v[120:123], v[16:19]
  v_mfma_f32_16x16x32_bf16 v[20:23], v[72:75], v[124:127], v[20:23]
  s_barrier
  v_add_u32 v192, 65536, v192
  v_add_u32 v193, 65536, v193
  v_add_u32 v194, 65536, v194
  v_add_u32 v195, 65536, v195
  v_add_u32 v196, 65536, v196
  v_add_u32 v197, 65536, v197
  v_add_u32 v198, 65536, v198
  v_add_u32 v199, 65536, v199
  ds_read_b64_tr_b16 v[64:65], v192 offset:0
  ds_read_b64_tr_b16 v[66:67], v192 offset:1024
  ds_read_b64_tr_b16 v[68:69], v193 offset:0
  ds_read_b64_tr_b16 v[70:71], v193 offset:1024
  v_mfma_f32_16x16x32_bf16 v[28:31], v[76:79], v[124:127], v[28:31]
  v_mfma_f32_16x16x32_bf16 v[24:27], v[76:79], v[120:123], v[24:27]
  ds_read_b64_tr_b16 v[72:73], v194 offset:0
  ds_read_b64_tr_b16 v[74:75], v194 offset:1024
  ds_read_b64_tr_b16 v[76:77], v195 offset:0
  ds_read_b64_tr_b16 v[78:79], v195 offset:1024
  v_mfma_f32_16x16x32_bf16 v[32:35], v[80:83], v[120:123], v[32:35]
  v_mfma_f32_16x16x32_bf16 v[36:39], v[80:83], v[124:127], v[36:39]
  ds_read_b64_tr_b16 v[80:81], v196 offset:0
  ds_read_b64_tr_b16 v[82:83], v196 offset:1024
  v_mfma_f32_16x16x32_bf16 v[44:47], v[84:87], v[124:127], v[44:47]
  v_mfma_f32_16x16x32_bf16 v[40:43], v[84:87], v[120:123], v[40:43]
  ds_read_b64_tr_b16 v[84:85], v197 offset:0
  ds_read_b64_tr_b16 v[86:87], v197 offset:1024
  v_mfma_f32_16x16x32_bf16 v[48:51], v[88:91], v[120:123], v[48:51]
  v_mfma_f32_16x16x32_bf16 v[52:55], v[88:91], v[124:127], v[52:55]
  ds_read_b64_tr_b16 v[88:89], v198 offset:0
  ds_read_b64_tr_b16 v[90:91], v198 offset:1024
  s_mov_b32 s35, 49152
  s_cmp_eq_u32 s101, 0
  s_cbranch_scc1 ka_kernel_kf_41
  buffer_store_dwordx4 v[184:187], v246, s[12:15], s35 offen offset:0
ka_kernel_kj_42:
  v_mfma_f32_16x16x32_bf16 v[60:63], v[92:95], v[124:127], v[60:63]
  v_mfma_f32_16x16x32_bf16 v[56:59], v[92:95], v[120:123], v[56:59]
  ds_read_b64_tr_b16 v[92:93], v199 offset:0
  ds_read_b64_tr_b16 v[94:95], v199 offset:1024
  s_mov_b32 s35, 49152
  s_cmp_eq_u32 s101, 0
  s_cbranch_scc1 ka_kernel_kf_43
  buffer_store_dwordx4 v[188:191], v246, s[12:15], s35 offen offset:1024
ka_kernel_kj_44:
  s_waitcnt vmcnt(34)
  s_waitcnt lgkmcnt(12)
  v_mfma_f32_16x16x32_bf16 v[0:3], v[64:67], v[200:203], v[0:3]
  v_mfma_f32_16x16x32_bf16 v[4:7], v[64:67], v[204:207], v[4:7]
  ds_read_b64_tr_b16 v[64:65], v192 offset:8192
  ds_read_b64_tr_b16 v[66:67], v192 offset:9216
  v_mfma_f32_16x16x32_bf16 v[12:15], v[68:71], v[204:207], v[12:15]
  v_mfma_f32_16x16x32_bf16 v[8:11], v[68:71], v[200:203], v[8:11]
  ds_read_b64_tr_b16 v[68:69], v193 offset:8192
  ds_read_b64_tr_b16 v[70:71], v193 offset:9216
  s_mov_b32 s35, 15360
  buffer_load_dwordx4 v[120:123], v255, s[12:15], s35 offen sc1
  buffer_load_dwordx4 v[124:127], v232, s[12:15], s35 offen sc1
  s_waitcnt lgkmcnt(12)
  v_mfma_f32_16x16x32_bf16 v[16:19], v[72:75], v[200:203], v[16:19]
  v_mfma_f32_16x16x32_bf16 v[20:23], v[72:75], v[204:207], v[20:23]
  ds_read_b64_tr_b16 v[72:73], v194 offset:8192
  ds_read_b64_tr_b16 v[74:75], v194 offset:9216
  v_mfma_f32_16x16x32_bf16 v[28:31], v[76:79], v[204:207], v[28:31]
  v_mfma_f32_16x16x32_bf16 v[24:27], v[76:79], v[200:203], v[24:27]
  ds_read_b64_tr_b16 v[76:77], v195 offset:8192
  ds_read_b64_tr_b16 v[78:79], v195 offset:9216
  s_waitcnt lgkmcnt(12)
  v_mfma_f32_16x16x32_bf16 v[32:35], v[80:83], v[200:203], v[32:35]
  v_mfma_f32_16x16x32_bf16 v[36:39], v[80:83], v[204:207], v[36:39]
  ds_read_b64_tr_b16 v[80:81], v196 offset:8192
  ds_read_b64_tr_b16 v[82:83], v196 offset:9216
  v_mfma_f32_16x16x32_bf16 v[44:47], v[84:87], v[204:207], v[44:47]
  v_mfma_f32_16x16x32_bf16 v[40:43], v[84:87], v[200:203], v[40:43]
  ds_read_b64_tr_b16 v[84:85], v197 offset:8192
  ds_read_b64_tr_b16 v[86:87], v197 offset:9216
  s_waitcnt lgkmcnt(12)
  v_mfma_f32_16x16x32_bf16 v[48:51], v[88:91], v[200:203], v[48:51]
  v_mfma_f32_16x16x32_bf16 v[52:55], v[88:91], v[204:207], v[52:55]
  ds_read_b64_tr_b16 v[88:89], v198 offset:8192
  ds_read_b64_tr_b16 v[90:91], v198 offset:9216
  v_mfma_f32_16x16x32_bf16 v[60:63], v[92:95], v[204:207], v[60:63]
  v_mfma_f32_16x16x32_bf16 v[56:59], v[92:95], v[200:203], v[56:59]
  ds_read_b64_tr_b16 v[92:93], v199 offset:8192
  ds_read_b64_tr_b16 v[94:95], v199 offset:9216
  s_waitcnt vmcnt(28)
  s_waitcnt lgkmcnt(12)
  v_mfma_f32_16x16x32_bf16 v[0:3], v[64:67], v[208:211], v[0:3]
  v_mfma_f32_16x16x32_bf16 v[4:7], v[64:67], v[212:215], v[4:7]
  ds_read_b64_tr_b16 v[64:65], v192 offset:16384
  ds_read_b64_tr_b16 v[66:67], v192 offset:17408
  v_mfma_f32_16x16x32_bf16 v[12:15], v[68:71], v[212:215], v[12:15]
  v_mfma_f32_16x16x32_bf16 v[8:11], v[68:71], v[208:211], v[8:11]
  ds_read_b64_tr_b16 v[68:69], v193 offset:16384
  ds_read_b64_tr_b16 v[70:71], v193 offset:17408
  s_mov_b32 s35, 16384
  buffer_load_dwordx4 v[200:203], v255, s[12:15], s35 offen sc1
  buffer_load_dwordx4 v[204:207], v232, s[12:15], s35 offen sc1
  s_waitcnt lgkmcnt(12)
  v_mfma_f32_16x16x32_bf16 v[16:19], v[72:75], v[208:211], v[16:19]
  v_mfma_f32_16x16x32_bf16 v[20:23], v[72:75], v[212:215], v[20:23]
  s_waitcnt vmcnt(4)
  s_barrier
  s_cmp_lg_u32 s18, 0
  s_cbranch_scc1 ka_kernel_nofl_45
  v_mov_b32 v248, 1
  s_lshl_b32 s21, s16, 7
  s_lshl_b32 s22, s17, 2
  s_add_u32 s21, s21, s22
  s_add_u32 s21, s21, 0xf0400
  v_mov_b32 v249, s21
  s_mov_b64 exec, 1
  buffer_store_dword v248, v249, s[12:15], 0 offen sc1
  s_mov_b64 exec, -1
ka_kernel_nofl_45:
  ds_read_b64_tr_b16 v[72:73], v194 offset:16384
  ds_read_b64_tr_b16 v[74:75], v194 offset:17408
  v_mfma_f32_16x16x32_bf16 v[28:31], v[76:79], v[212:215], v[28:31]
  v_mfma_f32_16x16x32_bf16 v[24:27], v[76:79], v[208:211], v[24:27]
  ds_read_b64_tr_b16 v[76:77], v195 offset:16384
  ds_read_b64_tr_b16 v[78:79], v195 offset:17408
  s_waitcnt lgkmcnt(12)
  v_mfma_f32_16x16x32_bf16 v[32:35], v[80:83], v[208:211], v[32:35]
  v_mfma_f32_16x16x32_bf16 v[36:39], v[80:83], v[212:215], v[36:39]
  ds_read_b64_tr_b16 v[80:81], v196 offset:16384
  ds_read_b64_tr_b16 v[82:83], v196 offset:17408
  v_mfma_f32_16x16x32_bf16 v[44:47], v[84:87], v[212:215], v[44:47]
  v_mfma_f32_16x16x32_bf16 v[40:43], v[84:87], v[208:211], v[40:43]
  ds_read_b64_tr_b16 v[84:85], v197 offset:16384
  ds_read_b64_tr_b16 v[86:87], v197 offset:17408
  s_waitcnt lgkmcnt(12)
  v_mfma_f32_16x16x32_bf16 v[48:51], v[88:91], v[208:211], v[48:51]
  v_mfma_f32_16x16x32_bf16 v[52:55], v[88:91], v[212:215], v[52:55]
  ds_read_b64_tr_b16 v[88:89], v198 offset:16384
  ds_read_b64_tr_b16 v[90:91], v198 offset:17408
  v_mfma_f32_16x16x32_bf16 v[60:63], v[92:95], v[212:215], v[60:63]
  v_mfma_f32_16x16x32_bf16 v[56:59], v[92:95], v[208:211], v[56:59]
  ds_read_b64_tr_b16 v[92:93], v199 offset:16384
  ds_read_b64_tr_b16 v[94:95], v199 offset:17408
  s_waitcnt lgkmcnt(12)
  v_mfma_f32_16x16x32_bf16 v[0:3], v[64:67], v[216:219], v[0:3]
  v_mfma_f32_16x16x32_bf16 v[4:7], v[64:67], v[220:223], v[4:7]
  ds_read_b64_tr_b16 v[64:65], v192 offset:24576
  ds_read_b64_tr_b16 v[66:67], v192 offset:25600
  v_mfma_f32_16x16x32_bf16 v[12:15], v[68:71], v[220:223], v[12:15]
  v_mfma_f32_16x16x32_bf16 v[8:11], v[68:71], v[216:219], v[8:11]
  ds_read_b64_tr_b16 v[68:69], v193 offset:24576
  ds_read_b64_tr_b16 v[70:71], v193 offset:25600
  s_mov_b32 s35, 17408
  buffer_load_dwordx4 v[208:211], v255, s[12:15], s35 offen sc1
  buffer_load_dwordx4 v[212:215], v232, s[12:15], s35 offen sc1
  s_waitcnt lgkmcnt(12)
  v_mfma_f32_16x16x32_bf16 v[16:19], v[72:75], v[216:219], v[16:19]
  v_mfma_f32_16x16x32_bf16 v[20:23], v[72:75], v[220:223], v[20:23]
  ds_read_b64_tr_b16 v[72:73], v194 offset:24576
  ds_read_b64_tr_b16 v[74:75], v194 offset:25600
  v_mfma_f32_16x16x32_bf16 v[28:31], v[76:79], v[220:223], v[28:31]
  v_mfma_f32_16x16x32_bf16 v[24:27], v[76:79], v[216:219], v[24:27]
  ds_read_b64_tr_b16 v[76:77], v195 offset:24576
  ds_read_b64_tr_b16 v[78:79], v195 offset:25600
  s_waitcnt lgkmcnt(12)
  v_mfma_f32_16x16x32_bf16 v[32:35], v[80:83], v[216:219], v[32:35]
  v_mfma_f32_16x16x32_bf16 v[36:39], v[80:83], v[220:223], v[36:39]
  ds_read_b64_tr_b16 v[80:81], v196 offset:24576
  ds_read_b64_tr_b16 v[82:83], v196 offset:25600
  v_mfma_f32_16x16x32_bf16 v[44:47], v[84:87], v[220:223], v[44:47]
  v_mfma_f32_16x16x32_bf16 v[40:43], v[84:87], v[216:219], v[40:43]
  ds_read_b64_tr_b16 v[84:85], v197 offset:24576
  ds_read_b64_tr_b16 v[86:87], v197 offset:25600
  s_waitcnt lgkmcnt(12)
  v_mfma_f32_16x16x32_bf16 v[48:51], v[88:91], v[216:219], v[48:51]
  v_mfma_f32_16x16x32_bf16 v[52:55], v[88:91], v[220:223], v[52:55]
  ds_read_b64_tr_b16 v[88:89], v198 offset:24576
  ds_read_b64_tr_b16 v[90:91], v198 offset:25600
  v_mfma_f32_16x16x32_bf16 v[60:63], v[92:95], v[220:223], v[60:63]
  v_mfma_f32_16x16x32_bf16 v[56:59], v[92:95], v[216:219], v[56:59]
  ds_read_b64_tr_b16 v[92:93], v199 offset:24576
  ds_read_b64_tr_b16 v[94:95], v199 offset:25600
  s_waitcnt lgkmcnt(12)
  v_mfma_f32_16x16x32_bf16 v[0:3], v[64:67], v[224:227], v[0:3]
  v_mfma_f32_16x16x32_bf16 v[4:7], v[64:67], v[228:231], v[4:7]
  s_cmp_lg_u32 s18, 0
  s_cbranch_scc1 ka_kernel_nopi_46
  v_lshrrev_b32 v248, 4, v245
  v_min_u32 v248, 5, v248
  v_lshlrev_b32 v248, 2, v248
  s_lshl_b32 s21, s16, 7
  s_add_u32 s21, s21, 0xf0400
  v_add_u32 v248, s21, v248
  buffer_load_dword v252, v248, s[12:15], 0 offen sc1
ka_kernel_nopi_46:
  v_mfma_f32_16x16x32_bf16 v[12:15], v[68:71], v[228:231], v[12:15]
  v_mfma_f32_16x16x32_bf16 v[8:11], v[68:71], v[224:227], v[8:11]
  s_mov_b32 s35, 18432
  buffer_load_dwordx4 v[216:219], v255, s[12:15], s35 offen sc1
  buffer_load_dwordx4 v[220:223], v232, s[12:15], s35 offen sc1
  s_waitcnt lgkmcnt(0)
  v_mfma_f32_16x16x32_bf16 v[16:19], v[72:75], v[224:227], v[16:19]
  v_mfma_f32_16x16x32_bf16 v[20:23], v[72:75], v[228:231], v[20:23]
  s_barrier
  ds_read_b64_tr_b16 v[64:65], v192 offset:32768
  ds_read_b64_tr_b16 v[66:67], v192 offset:33792
  ds_read_b64_tr_b16 v[68:69], v193 offset:32768
  ds_read_b64_tr_b16 v[70:71], v193 offset:33792
  v_mfma_f32_16x16x32_bf16 v[28:31], v[76:79], v[228:231], v[28:31]
  v_mfma_f32_16x16x32_bf16 v[24:27], v[76:79], v[224:227], v[24:27]
  ds_read_b64_tr_b16 v[72:73], v194 offset:32768
  ds_read_b64_tr_b16 v[74:75], v194 offset:33792
  ds_read_b64_tr_b16 v[76:77], v195 offset:32768
  ds_read_b64_tr_b16 v[78:79], v195 offset:33792
  v_mfma_f32_16x16x32_bf16 v[32:35], v[80:83], v[224:227], v[32:35]
  v_mfma_f32_16x16x32_bf16 v[36:39], v[80:83], v[228:231], v[36:39]
  ds_read_b64_tr_b16 v[80:81], v196 offset:32768
  ds_read_b64_tr_b16 v[82:83], v196 offset:33792
  v_mfma_f32_16x16x32_bf16 v[44:47], v[84:87], v[228:231], v[44:47]
  v_mfma_f32_16x16x32_bf16 v[40:43], v[84:87], v[224:227], v[40:43]
  ds_read_b64_tr_b16 v[84:85], v197 offset:32768
  ds_read_b64_tr_b16 v[86:87], v197 offset:33792
  v_mfma_f32_16x16x32_bf16 v[48:51], v[88:91], v[224:227], v[48:51]
  v_mfma_f32_16x16x32_bf16 v[52:55], v[88:91], v[228:231], v[52:55]
  ds_read_b64_tr_b16 v[88:89], v198 offset:32768
  ds_read_b64_tr_b16 v[90:91], v198 offset:33792
  v_mfma_f32_16x16x32_bf16 v[60:63], v[92:95], v[228:231], v[60:63]
  v_mfma_f32_16x16x32_bf16 v[56:59], v[92:95], v[224:227], v[56:59]
  ds_read_b64_tr_b16 v[92:93], v199 offset:32768
  ds_read_b64_tr_b16 v[94:95], v199 offset:33792
  s_waitcnt lgkmcnt(12)
  v_mfma_f32_16x16x32_bf16 v[0:3], v[64:67], v[96:99], v[0:3]
  v_mfma_f32_16x16x32_bf16 v[4:7], v[64:67], v[100:103], v[4:7]
  ds_read_b64_tr_b16 v[64:65], v192 offset:40960
  ds_read_b64_tr_b16 v[66:67], v192 offset:41984
  v_mfma_f32_16x16x32_bf16 v[12:15], v[68:71], v[100:103], v[12:15]
  v_mfma_f32_16x16x32_bf16 v[8:11], v[68:71], v[96:99], v[8:11]
  ds_read_b64_tr_b16 v[68:69], v193 offset:40960
  ds_read_b64_tr_b16 v[70:71], v193 offset:41984
  s_mov_b32 s35, 19456
  buffer_load_dwordx4 v[224:227], v255, s[12:15], s35 offen sc1
  buffer_load_dwordx4 v[228:231], v232, s[12:15], s35 offen sc1
  s_waitcnt lgkmcnt(12)
  v_mfma_f32_16x16x32_bf16 v[16:19], v[72:75], v[96:99], v[16:19]
  v_mfma_f32_16x16x32_bf16 v[20:23], v[72:75], v[100:103], v[20:23]
  s_cmp_lg_u32 s18, 0
  s_cbranch_scc1 ka_kernel_nopc_47
  s_waitcnt vmcnt(4)
  v_lshrrev_b32 v248, 4, v245
  v_min_u32 v248, 5, v248
  v_lshlrev_b32 v248, 2, v248
  s_lshl_b32 s21, s16, 7
  s_add_u32 s21, s21, 0xf0400
  v_add_u32 v248, s21, v248
  s_mov_b32 s24, 0x40000
ka_kernel_spin_49:
  v_cmp_ne_u32 vcc, 0x1, v252
  s_cbranch_vccz ka_kernel_pok_48
  s_sleep 2
  buffer_load_dword v252, v248, s[12:15], 0 offen sc1
  s_waitcnt vmcnt(0)
  s_sub_u32 s24, s24, 1
  s_cmp_lg_u32 s24, 0
  s_cbranch_scc1 ka_kernel_spin_49
ka_kernel_pok_48:
ka_kernel_nopc_47:
  s_barrier
  ds_read_b64_tr_b16 v[72:73], v194 offset:40960
  ds_read_b64_tr_b16 v[74:75], v194 offset:41984
  v_mfma_f32_16x16x32_bf16 v[28:31], v[76:79], v[100:103], v[28:31]
  v_mfma_f32_16x16x32_bf16 v[24:27], v[76:79], v[96:99], v[24:27]
  ds_read_b64_tr_b16 v[76:77], v195 offset:40960
  ds_read_b64_tr_b16 v[78:79], v195 offset:41984
  s_waitcnt lgkmcnt(12)
  v_mfma_f32_16x16x32_bf16 v[32:35], v[80:83], v[96:99], v[32:35]
  v_mfma_f32_16x16x32_bf16 v[36:39], v[80:83], v[100:103], v[36:39]
  ds_read_b64_tr_b16 v[80:81], v196 offset:40960
  ds_read_b64_tr_b16 v[82:83], v196 offset:41984
  s_mul_i32 s21, s18, 3072
  s_add_u32 s35, s21, s25
  s_add_u32 m0, s21, 131072
  s_nop 0
  buffer_load_dwordx4 v245, s[12:15], s35 offen offset:0 sc1 lds
  buffer_load_dwordx4 v245, s[12:15], s35 offen offset:1024 sc1 lds
  buffer_load_dwordx4 v245, s[12:15], s35 offen offset:2048 sc1 lds
  s_add_u32 s27, s25, 1040384
  s_add_u32 s88, s25, s28
  s_add_u32 s25, s25, 98304
  s_lshl_b32 s29, s20, 13
  s_add_u32 s25, s25, s29
  s_add_u32 s25, s25, 24576
  s_mov_b32 s30, 32768
  v_mfma_f32_16x16x32_bf16 v[44:47], v[84:87], v[100:103], v[44:47]
  v_mfma_f32_16x16x32_bf16 v[40:43], v[84:87], v[96:99], v[40:43]
  ds_read_b64_tr_b16 v[84:85], v197 offset:40960
  ds_read_b64_tr_b16 v[86:87], v197 offset:41984
  s_waitcnt lgkmcnt(12)
  v_mfma_f32_16x16x32_bf16 v[48:51], v[88:91], v[96:99], v[48:51]
  v_mfma_f32_16x16x32_bf16 v[52:55], v[88:91], v[100:103], v[52:55]
  ds_read_b64_tr_b16 v[88:89], v198 offset:40960
  ds_read_b64_tr_b16 v[90:91], v198 offset:41984
  v_mfma_f32_16x16x32_bf16 v[60:63], v[92:95], v[100:103], v[60:63]
  v_mfma_f32_16x16x32_bf16 v[56:59], v[92:95], v[96:99], v[56:59]
  ds_read_b64_tr_b16 v[92:93], v199 offset:40960
  ds_read_b64_tr_b16 v[94:95], v199 offset:41984
  s_waitcnt lgkmcnt(12)
  v_mfma_f32_16x16x32_bf16 v[0:3], v[64:67], v[104:107], v[0:3]
  v_mfma_f32_16x16x32_bf16 v[4:7], v[64:67], v[108:111], v[4:7]
  ds_read_b64_tr_b16 v[64:65], v192 offset:49152
  ds_read_b64_tr_b16 v[66:67], v192 offset:50176
  v_mfma_f32_16x16x32_bf16 v[12:15], v[68:71], v[108:111], v[12:15]
  v_mfma_f32_16x16x32_bf16 v[8:11], v[68:71], v[104:107], v[8:11]
  ds_read_b64_tr_b16 v[68:69], v193 offset:49152
  ds_read_b64_tr_b16 v[70:71], v193 offset:50176
  s_waitcnt lgkmcnt(12)
  v_mfma_f32_16x16x32_bf16 v[16:19], v[72:75], v[104:107], v[16:19]
  v_mfma_f32_16x16x32_bf16 v[20:23], v[72:75], v[108:111], v[20:23]
  ds_read_b64_tr_b16 v[72:73], v194 offset:49152
  ds_read_b64_tr_b16 v[74:75], v194 offset:50176
  v_mfma_f32_16x16x32_bf16 v[28:31], v[76:79], v[108:111], v[28:31]
  v_mfma_f32_16x16x32_bf16 v[24:27], v[76:79], v[104:107], v[24:27]
  ds_read_b64_tr_b16 v[76:77], v195 offset:49152
  ds_read_b64_tr_b16 v[78:79], v195 offset:50176
  s_waitcnt lgkmcnt(12)
  v_mfma_f32_16x16x32_bf16 v[32:35], v[80:83], v[104:107], v[32:35]
  v_mfma_f32_16x16x32_bf16 v[36:39], v[80:83], v[108:111], v[36:39]
  ds_read_b64_tr_b16 v[80:81], v196 offset:49152
  ds_read_b64_tr_b16 v[82:83], v196 offset:50176
  s_add_u32 m0, s28, 32768
  s_add_u32 s35, s88, 24576
  buffer_load_dwordx4 v245, s[12:15], s35 offen offset:0 sc1 lds
  buffer_load_dwordx4 v245, s[12:15], s35 offen offset:1024 sc1 lds
  buffer_load_dwordx4 v245, s[12:15], s35 offen offset:2048 sc1 lds
  buffer_load_dwordx4 v245, s[12:15], s35 offen offset:3072 sc1 lds
  v_mfma_f32_16x16x32_bf16 v[44:47], v[84:87], v[108:111], v[44:47]
  v_mfma_f32_16x16x32_bf16 v[40:43], v[84:87], v[104:107], v[40:43]
  ds_read_b64_tr_b16 v[84:85], v197 offset:49152
  ds_read_b64_tr_b16 v[86:87], v197 offset:50176
  s_waitcnt lgkmcnt(12)
  v_mfma_f32_16x16x32_bf16 v[48:51], v[88:91], v[104:107], v[48:51]
  v_mfma_f32_16x16x32_bf16 v[52:55], v[88:91], v[108:111], v[52:55]
  ds_read_b64_tr_b16 v[88:89], v198 offset:49152
  ds_read_b64_tr_b16 v[90:91], v198 offset:50176
  v_mfma_f32_16x16x32_bf16 v[60:63], v[92:95], v[108:111], v[60:63]
  v_mfma_f32_16x16x32_bf16 v[56:59], v[92:95], v[104:107], v[56:59]
  ds_read_b64_tr_b16 v[92:93], v199 offset:49152
  ds_read_b64_tr_b16 v[94:95], v199 offset:50176
  s_waitcnt lgkmcnt(12)
  v_mfma_f32_16x16x32_bf16 v[0:3], v[64:67], v[112:115], v[0:3]
  v_mfma_f32_16x16x32_bf16 v[4:7], v[64:67], v[116:119], v[4:7]
  ds_read_b64_tr_b16 v[64:65], v192 offset:57344
  ds_read_b64_tr_b16 v[66:67], v192 offset:58368
  v_mfma_f32_16x16x32_bf16 v[12:15], v[68:71], v[116:119], v[12:15]
  v_mfma_f32_16x16x32_bf16 v[8:11], v[68:71], v[112:115], v[8:11]
  ds_read_b64_tr_b16 v[68:69], v193 offset:57344
  ds_read_b64_tr_b16 v[70:71], v193 offset:58368
  s_waitcnt lgkmcnt(12)
  v_mfma_f32_16x16x32_bf16 v[16:19], v[72:75], v[112:115], v[16:19]
  v_mfma_f32_16x16x32_bf16 v[20:23], v[72:75], v[116:119], v[20:23]
  ds_read_b64_tr_b16 v[72:73], v194 offset:57344
  ds_read_b64_tr_b16 v[74:75], v194 offset:58368
  v_mfma_f32_16x16x32_bf16 v[28:31], v[76:79], v[116:119], v[28:31]
  v_mfma_f32_16x16x32_bf16 v[24:27], v[76:79], v[112:115], v[24:27]
  ds_read_b64_tr_b16 v[76:77], v195 offset:57344
  ds_read_b64_tr_b16 v[78:79], v195 offset:58368
  s_waitcnt lgkmcnt(12)
  v_mfma_f32_16x16x32_bf16 v[32:35], v[80:83], v[112:115], v[32:35]
  v_mfma_f32_16x16x32_bf16 v[36:39], v[80:83], v[116:119], v[36:39]
  ds_read_b64_tr_b16 v[80:81], v196 offset:57344
  ds_read_b64_tr_b16 v[82:83], v196 offset:58368
  s_add_u32 m0, s28, 65536
  s_add_u32 s35, s88, 57344
  buffer_load_dwordx4 v245, s[12:15], s35 offen offset:0 sc1 lds
  buffer_load_dwordx4 v245, s[12:15], s35 offen offset:1024 sc1 lds
  buffer_load_dwordx4 v245, s[12:15], s35 offen offset:2048 sc1 lds
  buffer_load_dwordx4 v245, s[12:15], s35 offen offset:3072 sc1 lds
  v_mfma_f32_16x16x32_bf16 v[44:47], v[84:87], v[116:119], v[44:47]
  v_mfma_f32_16x16x32_bf16 v[40:43], v[84:87], v[112:115], v[40:43]
  ds_read_b64_tr_b16 v[84:85], v197 offset:57344
  ds_read_b64_tr_b16 v[86:87], v197 offset:58368
  s_waitcnt lgkmcnt(12)
  v_mfma_f32_16x16x32_bf16 v[48:51], v[88:91], v[112:115], v[48:51]
  v_mfma_f32_16x16x32_bf16 v[52:55], v[88:91], v[116:119], v[52:55]
  ds_read_b64_tr_b16 v[88:89], v198 offset:57344
  ds_read_b64_tr_b16 v[90:91], v198 offset:58368
  v_mfma_f32_16x16x32_bf16 v[60:63], v[92:95], v[116:119], v[60:63]
  v_mfma_f32_16x16x32_bf16 v[56:59], v[92:95], v[112:115], v[56:59]
  ds_read_b64_tr_b16 v[92:93], v199 offset:57344
  ds_read_b64_tr_b16 v[94:95], v199 offset:58368
  s_waitcnt vmcnt(19)
  s_waitcnt lgkmcnt(12)
  v_mfma_f32_16x16x32_bf16 v[0:3], v[64:67], v[120:123], v[0:3]
  v_mfma_f32_16x16x32_bf16 v[4:7], v[64:67], v[124:127], v[4:7]
  v_mfma_f32_16x16x32_bf16 v[12:15], v[68:71], v[124:127], v[12:15]
  v_mfma_f32_16x16x32_bf16 v[8:11], v[68:71], v[120:123], v[8:11]
  s_waitcnt lgkmcnt(0)
  v_mfma_f32_16x16x32_bf16 v[16:19], v[72:75], v[120:123], v[16:19]
  v_mfma_f32_16x16x32_bf16 v[20:23], v[72:75], v[124:127], v[20:23]
  s_barrier
  v_add_u32 v192, 4294901760, v192
  v_add_u32 v193, 4294901760, v193
  v_add_u32 v194, 4294901760, v194
  v_add_u32 v195, 4294901760, v195
  v_add_u32 v196, 4294901760, v196
  v_add_u32 v197, 4294901760, v197
  v_add_u32 v198, 4294901760, v198
  v_add_u32 v199, 4294901760, v199
  ds_read_b64_tr_b16 v[64:65], v192 offset:0
  ds_read_b64_tr_b16 v[66:67], v192 offset:1024
  ds_read_b64_tr_b16 v[68:69], v193 offset:0
  ds_read_b64_tr_b16 v[70:71], v193 offset:1024
  v_mfma_f32_16x16x32_bf16 v[28:31], v[76:79], v[124:127], v[28:31]
  v_mfma_f32_16x16x32_bf16 v[24:27], v[76:79], v[120:123], v[24:27]
  ds_read_b64_tr_b16 v[72:73], v194 offset:0
  ds_read_b64_tr_b16 v[74:75], v194 offset:1024
  ds_read_b64_tr_b16 v[76:77], v195 offset:0
  ds_read_b64_tr_b16 v[78:79], v195 offset:1024
  v_mfma_f32_16x16x32_bf16 v[32:35], v[80:83], v[120:123], v[32:35]
  v_mfma_f32_16x16x32_bf16 v[36:39], v[80:83], v[124:127], v[36:39]
  ds_read_b64_tr_b16 v[80:81], v196 offset:0
  ds_read_b64_tr_b16 v[82:83], v196 offset:1024
  v_mfma_f32_16x16x32_bf16 v[44:47], v[84:87], v[124:127], v[44:47]
  v_mfma_f32_16x16x32_bf16 v[40:43], v[84:87], v[120:123], v[40:43]
  ds_read_b64_tr_b16 v[84:85], v197 offset:0
  ds_read_b64_tr_b16 v[86:87], v197 offset:1024
  v_mfma_f32_16x16x32_bf16 v[48:51], v[88:91], v[120:123], v[48:51]
  v_mfma_f32_16x16x32_bf16 v[52:55], v[88:91], v[124:127], v[52:55]
  ds_read_b64_tr_b16 v[88:89], v198 offset:0
  ds_read_b64_tr_b16 v[90:91], v198 offset:1024
  s_add_u32 m0, s28, 98304
  s_add_u32 s35, s88, 90112
  buffer_load_dwordx4 v245, s[12:15], s35 offen offset:0 sc1 lds
  buffer_load_dwordx4 v245, s[12:15], s35 offen offset:1024 sc1 lds
  buffer_load_dwordx4 v245, s[12:15], s35 offen offset:2048 sc1 lds
  buffer_load_dwordx4 v245, s[12:15], s35 offen offset:3072 sc1 lds
  v_mfma_f32_16x16x32_bf16 v[60:63], v[92:95], v[124:127], v[60:63]
  v_mfma_f32_16x16x32_bf16 v[56:59], v[92:95], v[120:123], v[56:59]
  ds_read_b64_tr_b16 v[92:93], v199 offset:0
  ds_read_b64_tr_b16 v[94:95], v199 offset:1024
  s_waitcnt vmcnt(21)
  s_waitcnt lgkmcnt(12)
  v_mfma_f32_16x16x32_bf16 v[0:3], v[64:67], v[200:203], v[0:3]
  v_mfma_f32_16x16x32_bf16 v[4:7], v[64:67], v[204:207], v[4:7]
  ds_read_b64_tr_b16 v[64:65], v192 offset:8192
  ds_read_b64_tr_b16 v[66:67], v192 offset:9216
  v_mfma_f32_16x16x32_bf16 v[12:15], v[68:71], v[204:207], v[12:15]
  v_mfma_f32_16x16x32_bf16 v[8:11], v[68:71], v[200:203], v[8:11]
  ds_read_b64_tr_b16 v[68:69], v193 offset:8192
  ds_read_b64_tr_b16 v[70:71], v193 offset:9216
  s_waitcnt lgkmcnt(12)
  v_mfma_f32_16x16x32_bf16 v[16:19], v[72:75], v[200:203], v[16:19]
  v_mfma_f32_16x16x32_bf16 v[20:23], v[72:75], v[204:207], v[20:23]
  ds_read_b64_tr_b16 v[72:73], v194 offset:8192
  ds_read_b64_tr_b16 v[74:75], v194 offset:9216
  v_mfma_f32_16x16x32_bf16 v[28:31], v[76:79], v[204:207], v[28:31]
  v_mfma_f32_16x16x32_bf16 v[24:27], v[76:79], v[200:203], v[24:27]
  ds_read_b64_tr_b16 v[76:77], v195 offset:8192
  ds_read_b64_tr_b16 v[78:79], v195 offset:9216
  s_waitcnt lgkmcnt(12)
  v_mfma_f32_16x16x32_bf16 v[32:35], v[80:83], v[200:203], v[32:35]
  v_mfma_f32_16x16x32_bf16 v[36:39], v[80:83], v[204:207], v[36:39]
  ds_read_b64_tr_b16 v[80:81], v196 offset:8192
  ds_read_b64_tr_b16 v[82:83], v196 offset:9216
  v_mfma_f32_16x16x32_bf16 v[44:47], v[84:87], v[204:207], v[44:47]
  v_mfma_f32_16x16x32_bf16 v[40:43], v[84:87], v[200:203], v[40:43]
  ds_read_b64_tr_b16 v[84:85], v197 offset:8192
  ds_read_b64_tr_b16 v[86:87], v197 offset:9216
  s_waitcnt lgkmcnt(12)
  v_mfma_f32_16x16x32_bf16 v[48:51], v[88:91], v[200:203], v[48:51]
  v_mfma_f32_16x16x32_bf16 v[52:55], v[88:91], v[204:207], v[52:55]
  ds_read_b64_tr_b16 v[88:89], v198 offset:8192
  ds_read_b64_tr_b16 v[90:91], v198 offset:9216
  v_mfma_f32_16x16x32_bf16 v[60:63], v[92:95], v[204:207], v[60:63]
  v_mfma_f32_16x16x32_bf16 v[56:59], v[92:95], v[200:203], v[56:59]
  ds_read_b64_tr_b16 v[92:93], v199 offset:8192
  ds_read_b64_tr_b16 v[94:95], v199 offset:9216
  s_waitcnt vmcnt(19)
  s_waitcnt lgkmcnt(12)
  v_mfma_f32_16x16x32_bf16 v[0:3], v[64:67], v[208:211], v[0:3]
  v_mfma_f32_16x16x32_bf16 v[4:7], v[64:67], v[212:215], v[4:7]
  ds_read_b64_tr_b16 v[64:65], v192 offset:16384
  ds_read_b64_tr_b16 v[66:67], v192 offset:17408
  v_lshrrev_b32 v251, 4, v245
  v_mov_b32 v244, 0xf149f2ca
  s_mov_b32 s33, 0x49800000
  v_mfma_f32_16x16x32_bf16 v[12:15], v[68:71], v[212:215], v[12:15]
  v_mfma_f32_16x16x32_bf16 v[8:11], v[68:71], v[208:211], v[8:11]
  ds_read_b64_tr_b16 v[68:69], v193 offset:16384
  ds_read_b64_tr_b16 v[70:71], v193 offset:17408
  v_mov_b32 v240, 0x3f803f80
  v_mov_b32 v241, 0x3f803f80
  v_mov_b32 v242, 0x3f803f80
  s_waitcnt lgkmcnt(12)
  v_mfma_f32_16x16x32_bf16 v[16:19], v[72:75], v[208:211], v[16:19]
  v_mfma_f32_16x16x32_bf16 v[20:23], v[72:75], v[212:215], v[20:23]
  ds_read_b64_tr_b16 v[72:73], v194 offset:16384
  ds_read_b64_tr_b16 v[74:75], v194 offset:17408
  v_mov_b32 v243, 0x3f803f80
  v_and_b32 v248, 15, v251
  v_lshrrev_b32 v250, 4, v251
  v_mfma_f32_16x16x32_bf16 v[28:31], v[76:79], v[212:215], v[28:31]
  v_mfma_f32_16x16x32_bf16 v[24:27], v[76:79], v[208:211], v[24:27]
  ds_read_b64_tr_b16 v[76:77], v195 offset:16384
  ds_read_b64_tr_b16 v[78:79], v195 offset:17408
  v_lshlrev_b32 v250, 2, v250
  v_sub_u32 v248, v248, v250
  v_cmp_le_i32 s[80:81], 0, v248
  s_waitcnt lgkmcnt(12)
  v_mfma_f32_16x16x32_bf16 v[32:35], v[80:83], v[208:211], v[32:35]
  v_mfma_f32_16x16x32_bf16 v[36:39], v[80:83], v[212:215], v[36:39]
  ds_read_b64_tr_b16 v[80:81], v196 offset:16384
  ds_read_b64_tr_b16 v[82:83], v196 offset:17408
  v_cmp_le_i32 s[82:83], 1, v248
  v_cmp_le_i32 s[84:85], 2, v248
  v_cmp_le_i32 s[86:87], 3, v248
  v_mfma_f32_16x16x32_bf16 v[44:47], v[84:87], v[212:215], v[44:47]
  v_mfma_f32_16x16x32_bf16 v[40:43], v[84:87], v[208:211], v[40:43]
  ds_read_b64_tr_b16 v[84:85], v197 offset:16384
  ds_read_b64_tr_b16 v[86:87], v197 offset:17408
  s_lshl_b32 s21, s31, 18
  s_lshl_b32 s22, s16, 12
  s_add_u32 s21, s21, s22
  s_waitcnt lgkmcnt(12)
  v_mfma_f32_16x16x32_bf16 v[48:51], v[88:91], v[208:211], v[48:51]
  v_mfma_f32_16x16x32_bf16 v[52:55], v[88:91], v[212:215], v[52:55]
  ds_read_b64_tr_b16 v[88:89], v198 offset:16384
  ds_read_b64_tr_b16 v[90:91], v198 offset:17408
  s_add_u32 s21, s21, 0x2400000
  v_add_u32 v247, s21, v245
  s_load_dwordx2 s[98:99], s[0:1], 40
  v_mfma_f32_16x16x32_bf16 v[60:63], v[92:95], v[212:215], v[60:63]
  v_mfma_f32_16x16x32_bf16 v[56:59], v[92:95], v[208:211], v[56:59]
  ds_read_b64_tr_b16 v[92:93], v199 offset:16384
  ds_read_b64_tr_b16 v[94:95], v199 offset:17408
  s_load_dwordx8 s[68:75], s[0:1], 56
  v_add_u32 v246, 131072, v245
  s_waitcnt vmcnt(17)
  s_waitcnt lgkmcnt(12)
  v_mfma_f32_16x16x32_bf16 v[0:3], v[64:67], v[216:219], v[0:3]
  v_mfma_f32_16x16x32_bf16 v[4:7], v[64:67], v[220:223], v[4:7]
  ds_read_b64_tr_b16 v[64:65], v192 offset:24576
  ds_read_b64_tr_b16 v[66:67], v192 offset:25600
  v_mfma_f32_16x16x32_bf16 v[12:15], v[68:71], v[220:223], v[12:15]
  v_mfma_f32_16x16x32_bf16 v[8:11], v[68:71], v[216:219], v[8:11]
  ds_read_b64_tr_b16 v[68:69], v193 offset:24576
  ds_read_b64_tr_b16 v[70:71], v193 offset:25600
  s_waitcnt lgkmcnt(12)
  v_mfma_f32_16x16x32_bf16 v[16:19], v[72:75], v[216:219], v[16:19]
  v_mfma_f32_16x16x32_bf16 v[20:23], v[72:75], v[220:223], v[20:23]
  ds_read_b64_tr_b16 v[72:73], v194 offset:24576
  ds_read_b64_tr_b16 v[74:75], v194 offset:25600
  v_mfma_f32_16x16x32_bf16 v[28:31], v[76:79], v[220:223], v[28:31]
  v_mfma_f32_16x16x32_bf16 v[24:27], v[76:79], v[216:219], v[24:27]
  ds_read_b64_tr_b16 v[76:77], v195 offset:24576
  ds_read_b64_tr_b16 v[78:79], v195 offset:25600
  s_waitcnt lgkmcnt(12)
  v_mfma_f32_16x16x32_bf16 v[32:35], v[80:83], v[216:219], v[32:35]
  v_mfma_f32_16x16x32_bf16 v[36:39], v[80:83], v[220:223], v[36:39]
  ds_read_b64_tr_b16 v[80:81], v196 offset:24576
  ds_read_b64_tr_b16 v[82:83], v196 offset:25600
  v_mfma_f32_16x16x32_bf16 v[44:47], v[84:87], v[220:223], v[44:47]
  v_mfma_f32_16x16x32_bf16 v[40:43], v[84:87], v[216:219], v[40:43]
  ds_read_b64_tr_b16 v[84:85], v197 offset:24576
  ds_read_b64_tr_b16 v[86:87], v197 offset:25600
  s_waitcnt lgkmcnt(12)
  v_mfma_f32_16x16x32_bf16 v[48:51], v[88:91], v[216:219], v[48:51]
  v_mfma_f32_16x16x32_bf16 v[52:55], v[88:91], v[220:223], v[52:55]
  ds_read_b64_tr_b16 v[88:89], v198 offset:24576
  ds_read_b64_tr_b16 v[90:91], v198 offset:25600
  v_mfma_f32_16x16x32_bf16 v[60:63], v[92:95], v[220:223], v[60:63]
  v_mfma_f32_16x16x32_bf16 v[56:59], v[92:95], v[216:219], v[56:59]
  ds_read_b64_tr_b16 v[92:93], v199 offset:24576
  ds_read_b64_tr_b16 v[94:95], v199 offset:25600
  s_waitcnt vmcnt(15)
  s_waitcnt lgkmcnt(12)
  v_mfma_f32_16x16x32_bf16 v[0:3], v[64:67], v[224:227], v[0:3]
  v_mfma_f32_16x16x32_bf16 v[4:7], v[64:67], v[228:231], v[4:7]
  v_mfma_f32_16x16x32_bf16 v[12:15], v[68:71], v[228:231], v[12:15]
  v_mfma_f32_16x16x32_bf16 v[8:11], v[68:71], v[224:227], v[8:11]
  s_waitcnt lgkmcnt(0)
  s_waitcnt vmcnt(0)
  s_barrier
  v_mfma_f32_16x16x32_bf16 v[16:19], v[72:75], v[224:227], v[16:19]
  v_mfma_f32_16x16x32_bf16 v[20:23], v[72:75], v[228:231], v[20:23]
  ds_read_b128 v[168:171], v246 offset:0
  ds_read_b128 v[172:175], v246 offset:1024
  v_mfma_f32_16x16x32_bf16 v[28:31], v[76:79], v[228:231], v[28:31]
  v_mfma_f32_16x16x32_bf16 v[24:27], v[76:79], v[224:227], v[24:27]
  ds_read_b128 v[176:179], v246 offset:2048
  ds_read_b128 v[180:183], v246 offset:3072
  v_mfma_f32_16x16x32_bf16 v[32:35], v[80:83], v[224:227], v[32:35]
  v_mfma_f32_16x16x32_bf16 v[36:39], v[80:83], v[228:231], v[36:39]
  ds_read_b128 v[184:187], v246 offset:4096
  ds_read_b128 v[188:191], v246 offset:5120
  v_cvt_pk_bf16_f32 v136, v0, v1
  v_cvt_pk_bf16_f32 v137, v2, v3
  v_cvt_pk_bf16_f32 v138, v8, v9
  v_cvt_pk_bf16_f32 v139, v10, v11
  v_cvt_pk_bf16_f32 v152, v4, v5
  v_cvt_pk_bf16_f32 v153, v6, v7
  v_cvt_pk_bf16_f32 v154, v12, v13
  v_cvt_pk_bf16_f32 v155, v14, v15
  v_mfma_f32_16x16x32_bf16 v[44:47], v[84:87], v[228:231], v[44:47]
  v_mfma_f32_16x16x32_bf16 v[40:43], v[84:87], v[224:227], v[40:43]
  ds_read_b128 v[192:195], v246 offset:6144
  ds_read_b128 v[196:199], v246 offset:7168
  v_mfma_f32_16x16x32_bf16 v[48:51], v[88:91], v[224:227], v[48:51]
  v_mfma_f32_16x16x32_bf16 v[52:55], v[88:91], v[228:231], v[52:55]
  v_cvt_pk_bf16_f32 v140, v16, v17
  v_cvt_pk_bf16_f32 v141, v18, v19
  v_cvt_pk_bf16_f32 v142, v24, v25
  v_cvt_pk_bf16_f32 v143, v26, v27
  v_cvt_pk_bf16_f32 v156, v20, v21
  v_cvt_pk_bf16_f32 v157, v22, v23
  v_cvt_pk_bf16_f32 v158, v28, v29
  v_cvt_pk_bf16_f32 v159, v30, v31
  v_mfma_f32_16x16x32_bf16 v[60:63], v[92:95], v[228:231], v[60:63]
  v_mfma_f32_16x16x32_bf16 v[56:59], v[92:95], v[224:227], v[56:59]
  v_cvt_pk_bf16_f32 v144, v32, v33
  v_cvt_pk_bf16_f32 v145, v34, v35
  v_cvt_pk_bf16_f32 v146, v40, v41
  v_cvt_pk_bf16_f32 v147, v42, v43
  v_cvt_pk_bf16_f32 v160, v36, v37
  v_cvt_pk_bf16_f32 v161, v38, v39
  v_cvt_pk_bf16_f32 v162, v44, v45
  v_cvt_pk_bf16_f32 v163, v46, v47
  v_cvt_pk_bf16_f32 v148, v48, v49
  v_cvt_pk_bf16_f32 v149, v50, v51
  v_cvt_pk_bf16_f32 v150, v56, v57
  v_cvt_pk_bf16_f32 v151, v58, v59
  v_cvt_pk_bf16_f32 v164, v52, v53
  v_cvt_pk_bf16_f32 v165, v54, v55
  v_cvt_pk_bf16_f32 v166, v60, v61
  v_cvt_pk_bf16_f32 v167, v62, v63
  s_waitcnt lgkmcnt(0)
  v_mfma_f32_16x16x32_bf16 v[64:67], v[168:171], v[136:139], 0
  v_mov_b32 v0, 0
  v_mov_b32 v1, 0
  v_mov_b32 v2, 0
  v_mov_b32 v3, 0
  v_mfma_f32_16x16x32_bf16 v[72:75], v[168:171], v[152:155], 0
  ds_read_b128 v[168:171], v246 offset:16384
  v_mov_b32 v4, 0
  v_mov_b32 v5, 0
  v_mov_b32 v6, 0
  v_mov_b32 v7, 0
  v_mfma_f32_16x16x32_bf16 v[64:67], v[172:175], v[140:143], v[64:67]
  v_mov_b32 v8, 0
  v_mov_b32 v9, 0
  v_mov_b32 v10, 0
  v_mov_b32 v11, 0
  v_mfma_f32_16x16x32_bf16 v[72:75], v[172:175], v[156:159], v[72:75]
  ds_read_b128 v[172:175], v246 offset:17408
  v_mov_b32 v12, 0
  v_mov_b32 v13, 0
  v_mov_b32 v14, 0
  v_mov_b32 v15, 0
  v_mfma_f32_16x16x32_bf16 v[64:67], v[176:179], v[144:147], v[64:67]
  v_mov_b32 v16, 0
  v_mov_b32 v17, 0
  v_mov_b32 v18, 0
  v_mov_b32 v19, 0
  v_mfma_f32_16x16x32_bf16 v[72:75], v[176:179], v[160:163], v[72:75]
  ds_read_b128 v[176:179], v246 offset:18432
  v_mov_b32 v20, 0
  v_mov_b32 v21, 0
  v_mov_b32 v22, 0
  v_mov_b32 v23, 0
  v_mfma_f32_16x16x32_bf16 v[64:67], v[180:183], v[148:151], v[64:67]
  v_mov_b32 v24, 0
  v_mov_b32 v25, 0
  v_mov_b32 v26, 0
  v_mov_b32 v27, 0
  v_mfma_f32_16x16x32_bf16 v[72:75], v[180:183], v[164:167], v[72:75]
  ds_read_b128 v[180:183], v246 offset:19456
  v_mov_b32 v28, 0
  v_mov_b32 v29, 0
  v_mov_b32 v30, 0
  v_mov_b32 v31, 0
  v_mfma_f32_16x16x32_bf16 v[68:71], v[184:187], v[136:139], 0
  v_mov_b32 v32, 0
  v_mov_b32 v33, 0
  v_mov_b32 v34, 0
  v_mov_b32 v35, 0
  v_mfma_f32_16x16x32_bf16 v[76:79], v[184:187], v[152:155], 0
  ds_read_b128 v[184:187], v246 offset:20480
  v_mov_b32 v36, 0
  v_mov_b32 v37, 0
  v_mov_b32 v38, 0
  v_mov_b32 v39, 0
  v_mfma_f32_16x16x32_bf16 v[68:71], v[188:191], v[140:143], v[68:71]
  v_mov_b32 v40, 0
  v_mov_b32 v41, 0
  v_mov_b32 v42, 0
  v_mov_b32 v43, 0
  v_mfma_f32_16x16x32_bf16 v[76:79], v[188:191], v[156:159], v[76:79]
  ds_read_b128 v[188:191], v246 offset:21504
  v_mov_b32 v44, 0
  v_mov_b32 v45, 0
  v_mov_b32 v46, 0
  v_mov_b32 v47, 0
  v_mfma_f32_16x16x32_bf16 v[68:71], v[192:195], v[144:147], v[68:71]
  v_mov_b32 v48, 0
  v_mov_b32 v49, 0
  v_mov_b32 v50, 0
  v_mov_b32 v51, 0
  v_mfma_f32_16x16x32_bf16 v[76:79], v[192:195], v[160:163], v[76:79]
  ds_read_b128 v[192:195], v246 offset:22528
  v_mov_b32 v52, 0
  v_mov_b32 v53, 0
  v_mov_b32 v54, 0
  v_mov_b32 v55, 0
  v_mfma_f32_16x16x32_bf16 v[68:71], v[196:199], v[148:151], v[68:71]
  v_mov_b32 v56, 0
  v_mov_b32 v57, 0
  v_mov_b32 v58, 0
  v_mov_b32 v59, 0
  v_mfma_f32_16x16x32_bf16 v[76:79], v[196:199], v[164:167], v[76:79]
  ds_read_b128 v[196:199], v246 offset:23552
  v_mov_b32 v60, 0
  v_mov_b32 v61, 0
  v_mov_b32 v62, 0
  v_mov_b32 v63, 0
  ds_read_b128 v[200:203], v246 offset:8192
  ds_read_b128 v[204:207], v246 offset:9216
  ds_read_b128 v[208:211], v246 offset:10240
  ds_read_b128 v[212:215], v246 offset:11264
  ds_read_b128 v[216:219], v246 offset:12288
  ds_read_b128 v[220:223], v246 offset:13312
  ds_read_b128 v[224:227], v246 offset:14336
  ds_read_b128 v[228:231], v246 offset:15360
  v_mov_b32 v128, 0
  v_mov_b32 v129, 0
  v_mov_b32 v130, 0
  v_mov_b32 v131, 0
  v_mov_b32 v132, 0
  v_mov_b32 v133, 0
  v_mov_b32 v134, 0
  v_mov_b32 v135, 0
  s_cmp_lg_u32 s31, 0
  s_cbranch_scc1 ka_kernel_nomask0_50
  v_cndmask_b32 v64, v244, v64, s[80:81]
  v_cndmask_b32 v65, v244, v65, s[82:83]
  v_cndmask_b32 v66, v244, v66, s[84:85]
  v_cndmask_b32 v67, v244, v67, s[86:87]
  v_mov_b32 v68, v244
  v_mov_b32 v69, v244
  v_mov_b32 v70, v244
  v_mov_b32 v71, v244
  v_cndmask_b32 v76, v244, v76, s[80:81]
  v_cndmask_b32 v77, v244, v77, s[82:83]
  v_cndmask_b32 v78, v244, v78, s[84:85]
  v_cndmask_b32 v79, v244, v79, s[86:87]
ka_kernel_nomask0_50:
  v_max3_f32 v248, v64, v65, v66
  v_max3_f32 v249, v72, v73, v74
  v_max3_f32 v248, v248, v67, v68
  v_max3_f32 v249, v249, v75, v76
  v_max3_f32 v248, v248, v69, v70
  v_max3_f32 v249, v249, v77, v78
  v_max_f32 v248, v248, v71
  v_max_f32 v249, v249, v79
  v_mov_b32 v250, v248
  v_mov_b32 v251, v249
  s_nop 0
  v_permlane16_swap_b32 v248, v250
  v_permlane16_swap_b32 v249, v251
  v_max_f32 v248, v248, v250
  v_max_f32 v249, v249, v251
  v_mov_b32 v250, v248
  v_mov_b32 v251, v249
  s_nop 0
  v_permlane32_swap_b32 v248, v250
  v_permlane32_swap_b32 v249, v251
  v_max_f32 v248, v248, v250
  v_max_f32 v249, v249, v251
  v_sub_f32 v64, v64, v248
  v_sub_f32 v65, v65, v248
  v_sub_f32 v66, v66, v248
  v_sub_f32 v67, v67, v248
  v_sub_f32 v68, v68, v248
  v_sub_f32 v69, v69, v248
  v_sub_f32 v70, v70, v248
  v_sub_f32 v71, v71, v248
  v_sub_f32 v112, 0, v248
  v_sub_f32 v113, 0, v248
  v_sub_f32 v114, 0, v248
  v_sub_f32 v115, 0, v248
  v_sub_f32 v72, v72, v249
  v_sub_f32 v73, v73, v249
  v_sub_f32 v74, v74, v249
  v_sub_f32 v75, v75, v249
  v_sub_f32 v76, v76, v249
  v_sub_f32 v77, v77, v249
  v_sub_f32 v78, v78, v249
  v_sub_f32 v79, v79, v249
  v_sub_f32 v116, 0, v249
  v_sub_f32 v117, 0, v249
  v_sub_f32 v118, 0, v249
  v_sub_f32 v119, 0, v249
  v_exp_f32 v232, v64
  v_exp_f32 v233, v65
  v_exp_f32 v234, v66
  v_cvt_pk_bf16_f32 v96, v232, v233
  v_exp_f32 v235, v67
  v_exp_f32 v236, v72
  v_cvt_pk_bf16_f32 v97, v234, v235
  v_exp_f32 v237, v73
  v_exp_f32 v238, v74
  v_cvt_pk_bf16_f32 v100, v236, v237
  v_exp_f32 v239, v75
  v_exp_f32 v232, v68
  v_cvt_pk_bf16_f32 v101, v238, v239
  v_exp_f32 v233, v69
  v_exp_f32 v234, v70
  v_cvt_pk_bf16_f32 v98, v232, v233
  s_cmp_eq_u32 s19, 0
  s_cbranch_scc1 ka_roleB
  s_setprio 1
  s_cmp_lt_u32 s31, 2
  s_cbranch_scc1 ka_tailEA
.p2align 5
ka_loopA:
  s_waitcnt lgkmcnt(8)
  v_mfma_f32_16x16x32_bf16 v[80:83], v[168:171], v[136:139], v[112:115]
  v_exp_f32 v235, v71
  v_mfma_f32_16x16x32_bf16 v[88:91], v[168:171], v[152:155], v[116:119]
  v_exp_f32 v236, v76
  v_mfma_f32_16x16x32_bf16 v[80:83], v[172:175], v[140:143], v[80:83]
  v_cvt_pk_bf16_f32 v99, v234, v235
  s_waitcnt vmcnt(16) lgkmcnt(0)
  s_barrier
  v_add_u32 v246, s30, v245
  v_mfma_f32_16x16x32_bf16 v[88:91], v[172:175], v[156:159], v[88:91]
  v_exp_f32 v237, v77
  v_mfma_f32_16x16x32_bf16 v[80:83], v[176:179], v[144:147], v[80:83]
  v_exp_f32 v238, v78
  v_mfma_f32_16x16x32_bf16 v[88:91], v[176:179], v[160:163], v[88:91]
  ds_read_b128 v[168:171], v246 offset:8192
  v_cvt_pk_bf16_f32 v102, v236, v237
  v_mfma_f32_16x16x32_bf16 v[80:83], v[180:183], v[148:151], v[80:83]
  v_exp_f32 v239, v79
  v_mfma_f32_16x16x32_bf16 v[88:91], v[180:183], v[164:167], v[88:91]
  ds_read_b128 v[172:175], v246 offset:9216
  v_cvt_pk_bf16_f32 v103, v238, v239
  v_mfma_f32_16x16x32_bf16 v[84:87], v[184:187], v[136:139], v[112:115]
  ds_read_b128 v[176:179], v246 offset:10240
  s_add_u32 s30, s30, 32768
  v_mfma_f32_16x16x32_bf16 v[120:123], v[240:243], v[96:99], v[128:131]
  ds_read_b128 v[180:183], v246 offset:11264
  s_and_b32 s30, s30, 0x1ffff
  v_mfma_f32_16x16x32_bf16 v[124:127], v[240:243], v[100:103], v[132:135]
  v_exp_f32 v232, v80
  v_mfma_f32_16x16x32_bf16 v[92:95], v[184:187], v[152:155], v[116:119]
  v_exp_f32 v233, v81
  v_mfma_f32_16x16x32_bf16 v[84:87], v[188:191], v[140:143], v[84:87]
  v_exp_f32 v234, v82
  v_mfma_f32_16x16x32_bf16 v[92:95], v[188:191], v[156:159], v[92:95]
  ds_read_b128 v[184:187], v246 offset:12288
  v_cvt_pk_bf16_f32 v104, v232, v233
  v_mfma_f32_16x16x32_bf16 v[84:87], v[192:195], v[144:147], v[84:87]
  ds_read_b128 v[188:191], v246 offset:13312
  s_sub_u32 s26, s26, 1
  v_mfma_f32_16x16x32_bf16 v[92:95], v[192:195], v[160:163], v[92:95]
  ds_read_b128 v[192:195], v246 offset:14336
  v_max_f32 v251, v120, v124
  v_mfma_f32_16x16x32_bf16 v[84:87], v[196:199], v[148:151], v[84:87]
  v_cmp_lt_f32 vcc, s33, v251
  v_mfma_f32_16x16x32_bf16 v[92:95], v[196:199], v[164:167], v[92:95]
  v_exp_f32 v235, v83
  s_cbranch_vccnz ka_kernel_fix_51
ka_kernel_ret_52:
  s_waitcnt lgkmcnt(7)
  v_mfma_f32_16x16x32_bf16 v[0:3], v[200:203], v[96:99], v[0:3]
  ds_read_b128 v[196:199], v246 offset:15360
  v_mfma_f32_16x16x32_bf16 v[4:7], v[200:203], v[100:103], v[4:7]
  v_exp_f32 v236, v88
  v_mfma_f32_16x16x32_bf16 v[12:15], v[204:207], v[100:103], v[12:15]
  ds_read_b128 v[200:203], v246 offset:0
  v_cvt_pk_bf16_f32 v105, v234, v235
  v_mfma_f32_16x16x32_bf16 v[8:11], v[204:207], v[96:99], v[8:11]
  v_exp_f32 v237, v89
  v_mfma_f32_16x16x32_bf16 v[16:19], v[208:211], v[96:99], v[16:19]
  v_exp_f32 v238, v90
  s_mov_b32 m0, s29
  s_add_u32 s35, s25, 4096
  buffer_load_dwordx4 v245, s[12:15], s25 offen offset:0 sc1 lds
  buffer_load_dwordx4 v245, s[12:15], s25 offen offset:1024 sc1 lds
  buffer_load_dwordx4 v245, s[12:15], s25 offen offset:2048 sc1 lds
  buffer_load_dwordx4 v245, s[12:15], s25 offen offset:3072 sc1 lds
  s_add_u32 m0, s29, 4096
  s_add_u32 s25, s25, 32768
  buffer_load_dwordx4 v245, s[12:15], s35 offen offset:0 sc1 lds
  buffer_load_dwordx4 v245, s[12:15], s35 offen offset:1024 sc1 lds
  buffer_load_dwordx4 v245, s[12:15], s35 offen offset:2048 sc1 lds
  buffer_load_dwordx4 v245, s[12:15], s35 offen offset:3072 sc1 lds
  s_min_u32 s25, s25, s27
  s_add_u32 s29, s29, 32768
  s_and_b32 s29, s29, 0x1ffff
  v_mfma_f32_16x16x32_bf16 v[20:23], v[208:211], v[100:103], v[20:23]
  ds_read_b128 v[204:207], v246 offset:1024
  v_cvt_pk_bf16_f32 v108, v236, v237
  v_mfma_f32_16x16x32_bf16 v[28:31], v[212:215], v[100:103], v[28:31]
  ds_read_b128 v[208:211], v246 offset:2048
  s_cmp_lt_u32 s31, 3
  v_mfma_f32_16x16x32_bf16 v[24:27], v[212:215], v[96:99], v[24:27]
  v_exp_f32 v239, v91
  v_mfma_f32_16x16x32_bf16 v[32:35], v[216:219], v[96:99], v[32:35]
  ds_read_b128 v[212:215], v246 offset:3072
  v_mfma_f32_16x16x32_bf16 v[36:39], v[216:219], v[100:103], v[36:39]
  v_exp_f32 v232, v84
  v_mfma_f32_16x16x32_bf16 v[44:47], v[220:223], v[100:103], v[44:47]
  ds_read_b128 v[216:219], v246 offset:4096
  v_cvt_pk_bf16_f32 v109, v238, v239
  v_mfma_f32_16x16x32_bf16 v[40:43], v[220:223], v[96:99], v[40:43]
  v_exp_f32 v233, v85
  v_mfma_f32_16x16x32_bf16 v[48:51], v[224:227], v[96:99], v[48:51]
  ds_read_b128 v[220:223], v246 offset:5120
  v_mfma_f32_16x16x32_bf16 v[52:55], v[224:227], v[100:103], v[52:55]
  v_exp_f32 v234, v86
  v_mfma_f32_16x16x32_bf16 v[60:63], v[228:231], v[100:103], v[60:63]
  ds_read_b128 v[224:227], v246 offset:6144
  v_cvt_pk_bf16_f32 v106, v232, v233
  v_mfma_f32_16x16x32_bf16 v[56:59], v[228:231], v[96:99], v[56:59]
  ds_read_b128 v[228:231], v246 offset:7168
  s_cbranch_scc1 ka_maskOA
  s_waitcnt lgkmcnt(8)
  v_mfma_f32_16x16x32_bf16 v[64:67], v[168:171], v[136:139], v[112:115]
  v_exp_f32 v235, v87
  v_mfma_f32_16x16x32_bf16 v[72:75], v[168:171], v[152:155], v[116:119]
  v_exp_f32 v236, v92
  v_mfma_f32_16x16x32_bf16 v[64:67], v[172:175], v[140:143], v[64:67]
  ds_read_b128 v[168:171], v246 offset:24576
  v_cvt_pk_bf16_f32 v107, v234, v235
  v_mfma_f32_16x16x32_bf16 v[72:75], v[172:175], v[156:159], v[72:75]
  v_exp_f32 v237, v93
  v_mfma_f32_16x16x32_bf16 v[64:67], v[176:179], v[144:147], v[64:67]
  v_exp_f32 v238, v94
  v_mfma_f32_16x16x32_bf16 v[72:75], v[176:179], v[160:163], v[72:75]
  ds_read_b128 v[172:175], v246 offset:25600
  v_cvt_pk_bf16_f32 v110, v236, v237
  v_mfma_f32_16x16x32_bf16 v[64:67], v[180:183], v[148:151], v[64:67]
  v_exp_f32 v239, v95
  v_mfma_f32_16x16x32_bf16 v[72:75], v[180:183], v[164:167], v[72:75]
  ds_read_b128 v[176:179], v246 offset:26624
  v_cvt_pk_bf16_f32 v111, v238, v239
  v_mfma_f32_16x16x32_bf16 v[68:71], v[184:187], v[136:139], v[112:115]
  ds_read_b128 v[180:183], v246 offset:27648
  v_mfma_f32_16x16x32_bf16 v[128:131], v[240:243], v[104:107], v[120:123]
  v_mfma_f32_16x16x32_bf16 v[132:135], v[240:243], v[108:111], v[124:127]
  v_exp_f32 v232, v64
  v_mfma_f32_16x16x32_bf16 v[76:79], v[184:187], v[152:155], v[116:119]
  v_exp_f32 v233, v65
  v_mfma_f32_16x16x32_bf16 v[68:71], v[188:191], v[140:143], v[68:71]
  v_exp_f32 v234, v66
  v_mfma_f32_16x16x32_bf16 v[76:79], v[188:191], v[156:159], v[76:79]
  ds_read_b128 v[184:187], v246 offset:28672
  v_cvt_pk_bf16_f32 v96, v232, v233
  v_mfma_f32_16x16x32_bf16 v[68:71], v[192:195], v[144:147], v[68:71]
  ds_read_b128 v[188:191], v246 offset:29696
  v_mfma_f32_16x16x32_bf16 v[76:79], v[192:195], v[160:163], v[76:79]
  ds_read_b128 v[192:195], v246 offset:30720
  v_max_f32 v251, v128, v132
  v_mfma_f32_16x16x32_bf16 v[68:71], v[196:199], v[148:151], v[68:71]
  v_cmp_lt_f32 vcc, s33, v251
  v_mfma_f32_16x16x32_bf16 v[76:79], v[196:199], v[164:167], v[76:79]
  v_exp_f32 v235, v67
  s_cbranch_vccnz ka_kernel_fix_53
ka_kernel_ret_54:
  s_waitcnt lgkmcnt(7)
  v_mfma_f32_16x16x32_bf16 v[0:3], v[200:203], v[104:107], v[0:3]
  ds_read_b128 v[196:199], v246 offset:31744
  s_sub_u32 s31, s31, 2
  v_mfma_f32_16x16x32_bf16 v[4:7], v[200:203], v[108:111], v[4:7]
  v_exp_f32 v236, v72
  v_mfma_f32_16x16x32_bf16 v[12:15], v[204:207], v[108:111], v[12:15]
  ds_read_b128 v[200:203], v246 offset:16384
  v_cvt_pk_bf16_f32 v97, v234, v235
  v_mfma_f32_16x16x32_bf16 v[8:11], v[204:207], v[104:107], v[8:11]
  v_exp_f32 v237, v73
  v_mfma_f32_16x16x32_bf16 v[16:19], v[208:211], v[104:107], v[16:19]
  v_exp_f32 v238, v74
  v_mfma_f32_16x16x32_bf16 v[20:23], v[208:211], v[108:111], v[20:23]
  ds_read_b128 v[204:207], v246 offset:17408
  v_cvt_pk_bf16_f32 v100, v236, v237
  v_mfma_f32_16x16x32_bf16 v[28:31], v[212:215], v[108:111], v[28:31]
  ds_read_b128 v[208:211], v246 offset:18432
  s_cmp_ge_u32 s31, 2
  v_mfma_f32_16x16x32_bf16 v[24:27], v[212:215], v[104:107], v[24:27]
  v_exp_f32 v239, v75
  v_mfma_f32_16x16x32_bf16 v[32:35], v[216:219], v[104:107], v[32:35]
  ds_read_b128 v[212:215], v246 offset:19456
  v_mfma_f32_16x16x32_bf16 v[36:39], v[216:219], v[108:111], v[36:39]
  v_exp_f32 v232, v68
  v_mfma_f32_16x16x32_bf16 v[44:47], v[220:223], v[108:111], v[44:47]
  ds_read_b128 v[216:219], v246 offset:20480
  v_cvt_pk_bf16_f32 v101, v238, v239
  v_mfma_f32_16x16x32_bf16 v[40:43], v[220:223], v[104:107], v[40:43]
  v_exp_f32 v233, v69
  v_mfma_f32_16x16x32_bf16 v[48:51], v[224:227], v[104:107], v[48:51]
  ds_read_b128 v[220:223], v246 offset:21504
  v_mfma_f32_16x16x32_bf16 v[52:55], v[224:227], v[108:111], v[52:55]
  v_exp_f32 v234, v70
  v_mfma_f32_16x16x32_bf16 v[60:63], v[228:231], v[108:111], v[60:63]
  ds_read_b128 v[224:227], v246 offset:22528
  v_cvt_pk_bf16_f32 v98, v232, v233
  v_mfma_f32_16x16x32_bf16 v[56:59], v[228:231], v[104:107], v[56:59]
  ds_read_b128 v[228:231], v246 offset:23552
  s_cbranch_scc1 ka_loopA
ka_tailEA:
  s_cmp_eq_u32 s31, 0
  s_cbranch_scc1 ka_lastEA
  s_waitcnt lgkmcnt(8)
  v_mfma_f32_16x16x32_bf16 v[80:83], v[168:171], v[136:139], v[112:115]
  v_exp_f32 v235, v71
  v_mfma_f32_16x16x32_bf16 v[88:91], v[168:171], v[152:155], v[116:119]
  v_exp_f32 v236, v76
  v_mfma_f32_16x16x32_bf16 v[80:83], v[172:175], v[140:143], v[80:83]
  v_cvt_pk_bf16_f32 v99, v234, v235
  s_waitcnt vmcnt(16) lgkmcnt(0)
  s_barrier
  v_add_u32 v246, s30, v245
  v_mfma_f32_16x16x32_bf16 v[88:91], v[172:175], v[156:159], v[88:91]
  v_exp_f32 v237, v77
  v_mfma_f32_16x16x32_bf16 v[80:83], v[176:179], v[144:147], v[80:83]
  v_exp_f32 v238, v78
  v_mfma_f32_16x16x32_bf16 v[88:91], v[176:179], v[160:163], v[88:91]
  v_cvt_pk_bf16_f32 v102, v236, v237
  s_add_u32 s30, s30, 32768
  v_mfma_f32_16x16x32_bf16 v[80:83], v[180:183], v[148:151], v[80:83]
  v_exp_f32 v239, v79
  v_mfma_f32_16x16x32_bf16 v[88:91], v[180:183], v[164:167], v[88:91]
  v_cvt_pk_bf16_f32 v103, v238, v239
  s_and_b32 s30, s30, 0x1ffff
  v_mfma_f32_16x16x32_bf16 v[84:87], v[184:187], v[136:139], v[112:115]
  s_sub_u32 s26, s26, 1
  v_mfma_f32_16x16x32_bf16 v[120:123], v[240:243], v[96:99], v[128:131]
  v_mfma_f32_16x16x32_bf16 v[124:127], v[240:243], v[100:103], v[132:135]
  v_cndmask_b32 v80, v244, v80, s[80:81]
  v_cndmask_b32 v81, v244, v81, s[82:83]
  v_mfma_f32_16x16x32_bf16 v[92:95], v[184:187], v[152:155], v[116:119]
  v_cndmask_b32 v82, v244, v82, s[84:85]
  v_cndmask_b32 v83, v244, v83, s[86:87]
  v_mfma_f32_16x16x32_bf16 v[84:87], v[188:191], v[140:143], v[84:87]
  v_exp_f32 v232, v80
  v_mfma_f32_16x16x32_bf16 v[92:95], v[188:191], v[156:159], v[92:95]
  v_exp_f32 v233, v81
  v_mfma_f32_16x16x32_bf16 v[84:87], v[192:195], v[144:147], v[84:87]
  v_exp_f32 v234, v82
  v_mfma_f32_16x16x32_bf16 v[92:95], v[192:195], v[160:163], v[92:95]
  v_max_f32 v251, v120, v124
  v_cvt_pk_bf16_f32 v104, v232, v233
  v_mfma_f32_16x16x32_bf16 v[84:87], v[196:199], v[148:151], v[84:87]
  v_cmp_lt_f32 vcc, s33, v251
  v_mfma_f32_16x16x32_bf16 v[92:95], v[196:199], v[164:167], v[92:95]
  v_exp_f32 v235, v83
  s_cbranch_vccnz ka_kernel_fix_55
ka_kernel_ret_56:
  s_waitcnt lgkmcnt(0)
  v_mfma_f32_16x16x32_bf16 v[0:3], v[200:203], v[96:99], v[0:3]
  v_exp_f32 v236, v88
  v_mfma_f32_16x16x32_bf16 v[4:7], v[200:203], v[100:103], v[4:7]
  ds_read_b128 v[200:203], v246 offset:0
  v_cvt_pk_bf16_f32 v105, v234, v235
  v_mfma_f32_16x16x32_bf16 v[12:15], v[204:207], v[100:103], v[12:15]
  v_exp_f32 v237, v89
  v_mfma_f32_16x16x32_bf16 v[8:11], v[204:207], v[96:99], v[8:11]
  v_exp_f32 v238, v90
  v_mfma_f32_16x16x32_bf16 v[16:19], v[208:211], v[96:99], v[16:19]
  ds_read_b128 v[204:207], v246 offset:1024
  v_cvt_pk_bf16_f32 v108, v236, v237
  s_mov_b32 m0, s29
  s_add_u32 s35, s25, 4096
  buffer_load_dwordx4 v245, s[12:15], s25 offen offset:0 sc1 lds
  buffer_load_dwordx4 v245, s[12:15], s25 offen offset:1024 sc1 lds
  buffer_load_dwordx4 v245, s[12:15], s25 offen offset:2048 sc1 lds
  buffer_load_dwordx4 v245, s[12:15], s25 offen offset:3072 sc1 lds
  s_add_u32 m0, s29, 4096
  s_add_u32 s25, s25, 32768
  buffer_load_dwordx4 v245, s[12:15], s35 offen offset:0 sc1 lds
  buffer_load_dwordx4 v245, s[12:15], s35 offen offset:1024 sc1 lds
  buffer_load_dwordx4 v245, s[12:15], s35 offen offset:2048 sc1 lds
  buffer_load_dwordx4 v245, s[12:15], s35 offen offset:3072 sc1 lds
  s_min_u32 s25, s25, s27
  s_add_u32 s29, s29, 32768
  s_and_b32 s29, s29, 0x1ffff
  v_mfma_f32_16x16x32_bf16 v[20:23], v[208:211], v[100:103], v[20:23]
  v_exp_f32 v239, v91
  v_mov_b32 v84, v244
  v_mfma_f32_16x16x32_bf16 v[28:31], v[212:215], v[100:103], v[28:31]
  v_mov_b32 v85, v244
  v_mov_b32 v86, v244
  v_mfma_f32_16x16x32_bf16 v[24:27], v[212:215], v[96:99], v[24:27]
  ds_read_b128 v[208:211], v246 offset:2048
  v_mov_b32 v87, v244
  v_mfma_f32_16x16x32_bf16 v[32:35], v[216:219], v[96:99], v[32:35]
  ds_read_b128 v[212:215], v246 offset:3072
  v_cndmask_b32 v92, v244, v92, s[80:81]
  v_mfma_f32_16x16x32_bf16 v[36:39], v[216:219], v[100:103], v[36:39]
  v_cndmask_b32 v93, v244, v93, s[82:83]
  v_cndmask_b32 v94, v244, v94, s[84:85]
  v_mfma_f32_16x16x32_bf16 v[44:47], v[220:223], v[100:103], v[44:47]
  ds_read_b128 v[216:219], v246 offset:4096
  v_cndmask_b32 v95, v244, v95, s[86:87]
  v_mfma_f32_16x16x32_bf16 v[40:43], v[220:223], v[96:99], v[40:43]
  v_exp_f32 v232, v84
  v_mfma_f32_16x16x32_bf16 v[48:51], v[224:227], v[96:99], v[48:51]
  ds_read_b128 v[220:223], v246 offset:5120
  v_cvt_pk_bf16_f32 v109, v238, v239
  v_mfma_f32_16x16x32_bf16 v[52:55], v[224:227], v[100:103], v[52:55]
  v_exp_f32 v233, v85
  v_mfma_f32_16x16x32_bf16 v[60:63], v[228:231], v[100:103], v[60:63]
  ds_read_b128 v[224:227], v246 offset:6144
  v_mfma_f32_16x16x32_bf16 v[56:59], v[228:231], v[96:99], v[56:59]
  ds_read_b128 v[228:231], v246 offset:7168
  v_exp_f32 v234, v86
  v_cvt_pk_bf16_f32 v106, v232, v233
  v_exp_f32 v235, v87
  v_exp_f32 v236, v92
  v_cvt_pk_bf16_f32 v107, v234, v235
  v_exp_f32 v237, v93
  v_exp_f32 v238, v94
  v_cvt_pk_bf16_f32 v110, v236, v237
  v_exp_f32 v239, v95
  s_nop 0
  v_cvt_pk_bf16_f32 v111, v238, v239
  v_mfma_f32_16x16x32_bf16 v[128:131], v[240:243], v[104:107], v[120:123]
  s_nop 0
  v_mfma_f32_16x16x32_bf16 v[132:135], v[240:243], v[108:111], v[124:127]
  s_nop 7
  v_max_f32 v251, v128, v132
  v_cmp_lt_f32 vcc, s33, v251
  s_cbranch_vccnz ka_kernel_fix_57
ka_kernel_ret_58:
  s_waitcnt lgkmcnt(0)
  v_mfma_f32_16x16x32_bf16 v[0:3], v[200:203], v[104:107], v[0:3]
  v_mfma_f32_16x16x32_bf16 v[4:7], v[200:203], v[108:111], v[4:7]
  v_mfma_f32_16x16x32_bf16 v[12:15], v[204:207], v[108:111], v[12:15]
  v_mfma_f32_16x16x32_bf16 v[8:11], v[204:207], v[104:107], v[8:11]
  v_mfma_f32_16x16x32_bf16 v[16:19], v[208:211], v[104:107], v[16:19]
  v_mfma_f32_16x16x32_bf16 v[20:23], v[208:211], v[108:111], v[20:23]
  v_mfma_f32_16x16x32_bf16 v[28:31], v[212:215], v[108:111], v[28:31]
  v_mfma_f32_16x16x32_bf16 v[24:27], v[212:215], v[104:107], v[24:27]
  v_mfma_f32_16x16x32_bf16 v[32:35], v[216:219], v[104:107], v[32:35]
  v_mfma_f32_16x16x32_bf16 v[36:39], v[216:219], v[108:111], v[36:39]
  v_mfma_f32_16x16x32_bf16 v[44:47], v[220:223], v[108:111], v[44:47]
  v_mfma_f32_16x16x32_bf16 v[40:43], v[220:223], v[104:107], v[40:43]
  v_mfma_f32_16x16x32_bf16 v[48:51], v[224:227], v[104:107], v[48:51]
  v_mfma_f32_16x16x32_bf16 v[52:55], v[224:227], v[108:111], v[52:55]
  v_mfma_f32_16x16x32_bf16 v[60:63], v[228:231], v[108:111], v[60:63]
  v_mfma_f32_16x16x32_bf16 v[56:59], v[228:231], v[104:107], v[56:59]
  v_rcp_f32 v248, v128
  v_rcp_f32 v249, v132
  s_branch ka_epi
ka_maskOA:
  s_waitcnt lgkmcnt(8)
  v_mfma_f32_16x16x32_bf16 v[64:67], v[168:171], v[136:139], v[112:115]
  v_exp_f32 v235, v87
  v_mfma_f32_16x16x32_bf16 v[72:75], v[168:171], v[152:155], v[116:119]
  v_exp_f32 v236, v92
  v_mfma_f32_16x16x32_bf16 v[64:67], v[172:175], v[140:143], v[64:67]
  v_cvt_pk_bf16_f32 v107, v234, v235
  v_mfma_f32_16x16x32_bf16 v[72:75], v[172:175], v[156:159], v[72:75]
  v_exp_f32 v237, v93
  v_mfma_f32_16x16x32_bf16 v[64:67], v[176:179], v[144:147], v[64:67]
  v_exp_f32 v238, v94
  v_mfma_f32_16x16x32_bf16 v[72:75], v[176:179], v[160:163], v[72:75]
  v_cvt_pk_bf16_f32 v110, v236, v237
  v_mfma_f32_16x16x32_bf16 v[64:67], v[180:183], v[148:151], v[64:67]
  v_exp_f32 v239, v95
  v_mfma_f32_16x16x32_bf16 v[72:75], v[180:183], v[164:167], v[72:75]
  v_cvt_pk_bf16_f32 v111, v238, v239
  v_mfma_f32_16x16x32_bf16 v[68:71], v[184:187], v[136:139], v[112:115]
  v_mfma_f32_16x16x32_bf16 v[128:131], v[240:243], v[104:107], v[120:123]
  v_mfma_f32_16x16x32_bf16 v[132:135], v[240:243], v[108:111], v[124:127]
  s_nop 1
  v_cndmask_b32 v64, v244, v64, s[80:81]
  v_cndmask_b32 v65, v244, v65, s[82:83]
  v_mfma_f32_16x16x32_bf16 v[76:79], v[184:187], v[152:155], v[116:119]
  v_cndmask_b32 v66, v244, v66, s[84:85]
  v_cndmask_b32 v67, v244, v67, s[86:87]
  v_mfma_f32_16x16x32_bf16 v[68:71], v[188:191], v[140:143], v[68:71]
  v_exp_f32 v232, v64
  v_mfma_f32_16x16x32_bf16 v[76:79], v[188:191], v[156:159], v[76:79]
  v_exp_f32 v233, v65
  v_mfma_f32_16x16x32_bf16 v[68:71], v[192:195], v[144:147], v[68:71]
  v_exp_f32 v234, v66
  v_mfma_f32_16x16x32_bf16 v[76:79], v[192:195], v[160:163], v[76:79]
  v_max_f32 v251, v128, v132
  v_cvt_pk_bf16_f32 v96, v232, v233
  v_mfma_f32_16x16x32_bf16 v[68:71], v[196:199], v[148:151], v[68:71]
  v_cmp_lt_f32 vcc, s33, v251
  v_mfma_f32_16x16x32_bf16 v[76:79], v[196:199], v[164:167], v[76:79]
  v_exp_f32 v235, v67
  s_cbranch_vccnz ka_kernel_fix_59
ka_kernel_ret_60:
  s_waitcnt lgkmcnt(0)
  v_mfma_f32_16x16x32_bf16 v[0:3], v[200:203], v[104:107], v[0:3]
  v_exp_f32 v236, v72
  v_mfma_f32_16x16x32_bf16 v[4:7], v[200:203], v[108:111], v[4:7]
  ds_read_b128 v[200:203], v246 offset:16384
  v_cvt_pk_bf16_f32 v97, v234, v235
  v_mfma_f32_16x16x32_bf16 v[12:15], v[204:207], v[108:111], v[12:15]
  v_exp_f32 v237, v73
  v_mfma_f32_16x16x32_bf16 v[8:11], v[204:207], v[104:107], v[8:11]
  v_exp_f32 v238, v74
  v_mfma_f32_16x16x32_bf16 v[16:19], v[208:211], v[104:107], v[16:19]
  ds_read_b128 v[204:207], v246 offset:17408
  v_cvt_pk_bf16_f32 v100, v236, v237
  v_mfma_f32_16x16x32_bf16 v[20:23], v[208:211], v[108:111], v[20:23]
  v_exp_f32 v239, v75
  v_mov_b32 v68, v244
  v_mfma_f32_16x16x32_bf16 v[28:31], v[212:215], v[108:111], v[28:31]
  v_mov_b32 v69, v244
  v_mov_b32 v70, v244
  v_mfma_f32_16x16x32_bf16 v[24:27], v[212:215], v[104:107], v[24:27]
  ds_read_b128 v[208:211], v246 offset:18432
  v_mov_b32 v71, v244
  v_mfma_f32_16x16x32_bf16 v[32:35], v[216:219], v[104:107], v[32:35]
  ds_read_b128 v[212:215], v246 offset:19456
  v_cndmask_b32 v76, v244, v76, s[80:81]
  v_mfma_f32_16x16x32_bf16 v[36:39], v[216:219], v[108:111], v[36:39]
  v_cndmask_b32 v77, v244, v77, s[82:83]
  v_cndmask_b32 v78, v244, v78, s[84:85]
  v_mfma_f32_16x16x32_bf16 v[44:47], v[220:223], v[108:111], v[44:47]
  ds_read_b128 v[216:219], v246 offset:20480
  v_cndmask_b32 v79, v244, v79, s[86:87]
  v_mfma_f32_16x16x32_bf16 v[40:43], v[220:223], v[104:107], v[40:43]
  v_exp_f32 v232, v68
  v_mfma_f32_16x16x32_bf16 v[48:51], v[224:227], v[104:107], v[48:51]
  ds_read_b128 v[220:223], v246 offset:21504
  v_cvt_pk_bf16_f32 v101, v238, v239
  v_mfma_f32_16x16x32_bf16 v[52:55], v[224:227], v[108:111], v[52:55]
  v_exp_f32 v233, v69
  v_mfma_f32_16x16x32_bf16 v[60:63], v[228:231], v[108:111], v[60:63]
  ds_read_b128 v[224:227], v246 offset:22528
  v_mfma_f32_16x16x32_bf16 v[56:59], v[228:231], v[104:107], v[56:59]
  ds_read_b128 v[228:231], v246 offset:23552
  v_exp_f32 v234, v70
  v_cvt_pk_bf16_f32 v98, v232, v233
ka_lastEA:
  v_exp_f32 v235, v71
  v_exp_f32 v236, v76
  v_cvt_pk_bf16_f32 v99, v234, v235
  v_exp_f32 v237, v77
  v_exp_f32 v238, v78
  v_cvt_pk_bf16_f32 v102, v236, v237
  v_exp_f32 v239, v79
  s_nop 0
  v_cvt_pk_bf16_f32 v103, v238, v239
  v_mfma_f32_16x16x32_bf16 v[120:123], v[240:243], v[96:99], v[128:131]
  s_nop 0
  v_mfma_f32_16x16x32_bf16 v[124:127], v[240:243], v[100:103], v[132:135]
  s_waitcnt vmcnt(16) lgkmcnt(0)
  s_barrier
  v_add_u32 v246, s30, v245
  s_add_u32 s30, s30, 32768
  s_and_b32 s30, s30, 0x1ffff
  s_sub_u32 s26, s26, 1
  s_mov_b32 m0, s29
  s_add_u32 s35, s25, 4096
  buffer_load_dwordx4 v245, s[12:15], s25 offen offset:0 sc1 lds
  buffer_load_dwordx4 v245, s[12:15], s25 offen offset:1024 sc1 lds
  buffer_load_dwordx4 v245, s[12:15], s25 offen offset:2048 sc1 lds
  buffer_load_dwordx4 v245, s[12:15], s25 offen offset:3072 sc1 lds
  s_add_u32 m0, s29, 4096
  s_add_u32 s25, s25, 32768
  buffer_load_dwordx4 v245, s[12:15], s35 offen offset:0 sc1 lds
  buffer_load_dwordx4 v245, s[12:15], s35 offen offset:1024 sc1 lds
  buffer_load_dwordx4 v245, s[12:15], s35 offen offset:2048 sc1 lds
  buffer_load_dwordx4 v245, s[12:15], s35 offen offset:3072 sc1 lds
  s_min_u32 s25, s25, s27
  s_add_u32 s29, s29, 32768
  s_and_b32 s29, s29, 0x1ffff
  v_max_f32 v251, v120, v124
  v_cmp_lt_f32 vcc, s33, v251
  s_cbranch_vccnz ka_kernel_fix_61
ka_kernel_ret_62:
  s_waitcnt lgkmcnt(0)
  v_mfma_f32_16x16x32_bf16 v[0:3], v[200:203], v[96:99], v[0:3]
  v_mfma_f32_16x16x32_bf16 v[4:7], v[200:203], v[100:103], v[4:7]
  v_mfma_f32_16x16x32_bf16 v[12:15], v[204:207], v[100:103], v[12:15]
  v_mfma_f32_16x16x32_bf16 v[8:11], v[204:207], v[96:99], v[8:11]
  v_mfma_f32_16x16x32_bf16 v[16:19], v[208:211], v[96:99], v[16:19]
  v_mfma_f32_16x16x32_bf16 v[20:23], v[208:211], v[100:103], v[20:23]
  v_mfma_f32_16x16x32_bf16 v[28:31], v[212:215], v[100:103], v[28:31]
  v_mfma_f32_16x16x32_bf16 v[24:27], v[212:215], v[96:99], v[24:27]
  v_mfma_f32_16x16x32_bf16 v[32:35], v[216:219], v[96:99], v[32:35]
  v_mfma_f32_16x16x32_bf16 v[36:39], v[216:219], v[100:103], v[36:39]
  v_mfma_f32_16x16x32_bf16 v[44:47], v[220:223], v[100:103], v[44:47]
  v_mfma_f32_16x16x32_bf16 v[40:43], v[220:223], v[96:99], v[40:43]
  v_mfma_f32_16x16x32_bf16 v[48:51], v[224:227], v[96:99], v[48:51]
  v_mfma_f32_16x16x32_bf16 v[52:55], v[224:227], v[100:103], v[52:55]
  v_mfma_f32_16x16x32_bf16 v[60:63], v[228:231], v[100:103], v[60:63]
  v_mfma_f32_16x16x32_bf16 v[56:59], v[228:231], v[96:99], v[56:59]
  v_rcp_f32 v248, v120
  v_rcp_f32 v249, v124
  s_branch ka_epi
ka_roleB:
  s_lshl_b32 s89, s2, 2
  s_add_u32 s89, s89, s20
  v_lshlrev_b32 v250, 3, v245
  s_mov_b32 s21, s89
  s_mov_b32 s22, s21
  s_mov_b32 s23, s68
  s_mov_b32 s24, s69
  s_mov_b32 s35, 0xc8000
  s_sub_u32 s88, s21, 100
  s_cmp_ge_u32 s21, 100
  s_cselect_b32 s22, s88, s22
  s_cselect_b32 s23, s72, s23
  s_cselect_b32 s24, s73, s24
  s_cselect_b32 s35, 0x21c000, s35
  s_sub_u32 s88, s21, 370
  s_cmp_ge_u32 s21, 370
  s_cselect_b32 s22, s88, s22
  s_cselect_b32 s23, s98, s23
  s_cselect_b32 s24, s99, s24
  s_cselect_b32 s35, 0x500000, s35
  s_sub_u32 s88, s21, 1010
  s_cmp_ge_u32 s21, 1010
  s_cselect_b32 s22, s88, s22
  s_cselect_b32 s23, s70, s23
  s_cselect_b32 s24, s71, s24
  s_cselect_b32 s35, 0xc8000, s35
  s_sub_u32 s88, s21, 1110
  s_cmp_ge_u32 s21, 1110
  s_cselect_b32 s22, s88, s22
  s_cselect_b32 s23, s74, s23
  s_cselect_b32 s24, s75, s24
  s_cselect_b32 s35, 0x21c000, s35
  s_mov_b32 s4, s23
  s_and_b32 s5, s24, 0xffff
  s_mov_b32 s6, s35
  s_mov_b32 s7, 0x20000
  s_lshl_b32 s22, s22, 13
  v_add_u32 v251, s22, v250
  buffer_load_dword v252, v251, s[4:7], 0 offen
  s_sub_u32 s21, 1791, s89
  s_cmp_lt_u32 s89, 768
  s_cselect_b32 s21, s21, 4096
  s_mov_b32 s22, s21
  s_mov_b32 s23, s68
  s_mov_b32 s24, s69
  s_mov_b32 s35, 0xc8000
  s_sub_u32 s88, s21, 100
  s_cmp_ge_u32 s21, 100
  s_cselect_b32 s22, s88, s22
  s_cselect_b32 s23, s72, s23
  s_cselect_b32 s24, s73, s24
  s_cselect_b32 s35, 0x21c000, s35
  s_sub_u32 s88, s21, 370
  s_cmp_ge_u32 s21, 370
  s_cselect_b32 s22, s88, s22
  s_cselect_b32 s23, s98, s23
  s_cselect_b32 s24, s99, s24
  s_cselect_b32 s35, 0x500000, s35
  s_sub_u32 s88, s21, 1010
  s_cmp_ge_u32 s21, 1010
  s_cselect_b32 s22, s88, s22
  s_cselect_b32 s23, s70, s23
  s_cselect_b32 s24, s71, s24
  s_cselect_b32 s35, 0xc8000, s35
  s_sub_u32 s88, s21, 1110
  s_cmp_ge_u32 s21, 1110
  s_cselect_b32 s22, s88, s22
  s_cselect_b32 s23, s74, s23
  s_cselect_b32 s24, s75, s24
  s_cselect_b32 s35, 0x21c000, s35
  s_mov_b32 s8, s23
  s_and_b32 s9, s24, 0xffff
  s_mov_b32 s10, s35
  s_mov_b32 s11, 0x20000
  s_lshl_b32 s22, s22, 13
  v_add_u32 v251, s22, v250
  buffer_load_dword v253, v251, s[8:11], 0 offen
  s_cmp_lt_u32 s31, 2
  s_cbranch_scc1 ka_tailEB
.p2align 5
ka_loopB:
  s_waitcnt lgkmcnt(8)
  v_mfma_f32_16x16x32_bf16 v[80:83], v[168:171], v[136:139], v[112:115]
  v_exp_f32 v235, v71
  v_mfma_f32_16x16x32_bf16 v[88:91], v[168:171], v[152:155], v[116:119]
  v_exp_f32 v236, v76
  v_mfma_f32_16x16x32_bf16 v[80:83], v[172:175], v[140:143], v[80:83]
  v_cvt_pk_bf16_f32 v99, v234, v235
  s_waitcnt lgkmcnt(0)
  s_barrier
  v_add_u32 v246, s30, v245
  v_mfma_f32_16x16x32_bf16 v[88:91], v[172:175], v[156:159], v[88:91]
  v_exp_f32 v237, v77
  v_mfma_f32_16x16x32_bf16 v[80:83], v[176:179], v[144:147], v[80:83]
  v_exp_f32 v238, v78
  v_mfma_f32_16x16x32_bf16 v[88:91], v[176:179], v[160:163], v[88:91]
  ds_read_b128 v[168:171], v246 offset:8192
  v_cvt_pk_bf16_f32 v102, v236, v237
  v_mfma_f32_16x16x32_bf16 v[80:83], v[180:183], v[148:151], v[80:83]
  v_exp_f32 v239, v79
  v_mfma_f32_16x16x32_bf16 v[88:91], v[180:183], v[164:167], v[88:91]
  ds_read_b128 v[172:175], v246 offset:9216
  v_cvt_pk_bf16_f32 v103, v238, v239
  v_mfma_f32_16x16x32_bf16 v[84:87], v[184:187], v[136:139], v[112:115]
  ds_read_b128 v[176:179], v246 offset:10240
  s_add_u32 s30, s30, 32768
  v_mfma_f32_16x16x32_bf16 v[120:123], v[240:243], v[96:99], v[128:131]
  ds_read_b128 v[180:183], v246 offset:11264
  s_and_b32 s30, s30, 0x1ffff
  v_mfma_f32_16x16x32_bf16 v[124:127], v[240:243], v[100:103], v[132:135]
  v_exp_f32 v232, v80
  v_mfma_f32_16x16x32_bf16 v[92:95], v[184:187], v[152:155], v[116:119]
  v_exp_f32 v233, v81
  v_mfma_f32_16x16x32_bf16 v[84:87], v[188:191], v[140:143], v[84:87]
  v_exp_f32 v234, v82
  v_mfma_f32_16x16x32_bf16 v[92:95], v[188:191], v[156:159], v[92:95]
  ds_read_b128 v[184:187], v246 offset:12288
  v_cvt_pk_bf16_f32 v104, v232, v233
  v_mfma_f32_16x16x32_bf16 v[84:87], v[192:195], v[144:147], v[84:87]
  ds_read_b128 v[188:191], v246 offset:13312
  v_mfma_f32_16x16x32_bf16 v[92:95], v[192:195], v[160:163], v[92:95]
  ds_read_b128 v[192:195], v246 offset:14336
  v_max_f32 v251, v120, v124
  v_mfma_f32_16x16x32_bf16 v[84:87], v[196:199], v[148:151], v[84:87]
  v_cmp_lt_f32 vcc, s33, v251
  v_mfma_f32_16x16x32_bf16 v[92:95], v[196:199], v[164:167], v[92:95]
  v_exp_f32 v235, v83
  s_cbranch_vccnz ka_kernel_fix_63
ka_kernel_ret_64:
  s_waitcnt lgkmcnt(7)
  v_mfma_f32_16x16x32_bf16 v[0:3], v[200:203], v[96:99], v[0:3]
  ds_read_b128 v[196:199], v246 offset:15360
  s_cmp_lt_u32 s31, 3
  v_mfma_f32_16x16x32_bf16 v[4:7], v[200:203], v[100:103], v[4:7]
  v_exp_f32 v236, v88
  v_mfma_f32_16x16x32_bf16 v[12:15], v[204:207], v[100:103], v[12:15]
  ds_read_b128 v[200:203], v246 offset:0
  v_cvt_pk_bf16_f32 v105, v234, v235
  v_mfma_f32_16x16x32_bf16 v[8:11], v[204:207], v[96:99], v[8:11]
  v_exp_f32 v237, v89
  v_mfma_f32_16x16x32_bf16 v[16:19], v[208:211], v[96:99], v[16:19]
  v_exp_f32 v238, v90
  v_mfma_f32_16x16x32_bf16 v[20:23], v[208:211], v[100:103], v[20:23]
  ds_read_b128 v[204:207], v246 offset:1024
  v_cvt_pk_bf16_f32 v108, v236, v237
  v_mfma_f32_16x16x32_bf16 v[28:31], v[212:215], v[100:103], v[28:31]
  ds_read_b128 v[208:211], v246 offset:2048
  v_mfma_f32_16x16x32_bf16 v[24:27], v[212:215], v[96:99], v[24:27]
  v_exp_f32 v239, v91
  v_mfma_f32_16x16x32_bf16 v[32:35], v[216:219], v[96:99], v[32:35]
  ds_read_b128 v[212:215], v246 offset:3072
  v_mfma_f32_16x16x32_bf16 v[36:39], v[216:219], v[100:103], v[36:39]
  v_exp_f32 v232, v84
  v_mfma_f32_16x16x32_bf16 v[44:47], v[220:223], v[100:103], v[44:47]
  ds_read_b128 v[216:219], v246 offset:4096
  v_cvt_pk_bf16_f32 v109, v238, v239
  v_mfma_f32_16x16x32_bf16 v[40:43], v[220:223], v[96:99], v[40:43]
  v_exp_f32 v233, v85
  v_mfma_f32_16x16x32_bf16 v[48:51], v[224:227], v[96:99], v[48:51]
  ds_read_b128 v[220:223], v246 offset:5120
  v_mfma_f32_16x16x32_bf16 v[52:55], v[224:227], v[100:103], v[52:55]
  v_exp_f32 v234, v86
  v_mfma_f32_16x16x32_bf16 v[60:63], v[228:231], v[100:103], v[60:63]
  ds_read_b128 v[224:227], v246 offset:6144
  v_cvt_pk_bf16_f32 v106, v232, v233
  v_mfma_f32_16x16x32_bf16 v[56:59], v[228:231], v[96:99], v[56:59]
  ds_read_b128 v[228:231], v246 offset:7168
  s_cbranch_scc1 ka_maskOB
  s_waitcnt lgkmcnt(8)
  v_mfma_f32_16x16x32_bf16 v[64:67], v[168:171], v[136:139], v[112:115]
  v_exp_f32 v235, v87
  v_mfma_f32_16x16x32_bf16 v[72:75], v[168:171], v[152:155], v[116:119]
  v_exp_f32 v236, v92
  v_mfma_f32_16x16x32_bf16 v[64:67], v[172:175], v[140:143], v[64:67]
  ds_read_b128 v[168:171], v246 offset:24576
  v_cvt_pk_bf16_f32 v107, v234, v235
  v_mfma_f32_16x16x32_bf16 v[72:75], v[172:175], v[156:159], v[72:75]
  v_exp_f32 v237, v93
  v_mfma_f32_16x16x32_bf16 v[64:67], v[176:179], v[144:147], v[64:67]
  v_exp_f32 v238, v94
  v_mfma_f32_16x16x32_bf16 v[72:75], v[176:179], v[160:163], v[72:75]
  ds_read_b128 v[172:175], v246 offset:25600
  v_cvt_pk_bf16_f32 v110, v236, v237
  v_mfma_f32_16x16x32_bf16 v[64:67], v[180:183], v[148:151], v[64:67]
  v_exp_f32 v239, v95
  v_mfma_f32_16x16x32_bf16 v[72:75], v[180:183], v[164:167], v[72:75]
  ds_read_b128 v[176:179], v246 offset:26624
  v_cvt_pk_bf16_f32 v111, v238, v239
  v_mfma_f32_16x16x32_bf16 v[68:71], v[184:187], v[136:139], v[112:115]
  ds_read_b128 v[180:183], v246 offset:27648
  v_mfma_f32_16x16x32_bf16 v[128:131], v[240:243], v[104:107], v[120:123]
  v_mfma_f32_16x16x32_bf16 v[132:135], v[240:243], v[108:111], v[124:127]
  v_exp_f32 v232, v64
  v_mfma_f32_16x16x32_bf16 v[76:79], v[184:187], v[152:155], v[116:119]
  v_exp_f32 v233, v65
  v_mfma_f32_16x16x32_bf16 v[68:71], v[188:191], v[140:143], v[68:71]
  v_exp_f32 v234, v66
  v_mfma_f32_16x16x32_bf16 v[76:79], v[188:191], v[156:159], v[76:79]
  ds_read_b128 v[184:187], v246 offset:28672
  v_cvt_pk_bf16_f32 v96, v232, v233
  v_mfma_f32_16x16x32_bf16 v[68:71], v[192:195], v[144:147], v[68:71]
  ds_read_b128 v[188:191], v246 offset:29696
  v_mfma_f32_16x16x32_bf16 v[76:79], v[192:195], v[160:163], v[76:79]
  ds_read_b128 v[192:195], v246 offset:30720
  v_max_f32 v251, v128, v132
  v_mfma_f32_16x16x32_bf16 v[68:71], v[196:199], v[148:151], v[68:71]
  v_cmp_lt_f32 vcc, s33, v251
  v_mfma_f32_16x16x32_bf16 v[76:79], v[196:199], v[164:167], v[76:79]
  v_exp_f32 v235, v67
  s_cbranch_vccnz ka_kernel_fix_65
ka_kernel_ret_66:
  s_waitcnt lgkmcnt(7)
  v_mfma_f32_16x16x32_bf16 v[0:3], v[200:203], v[104:107], v[0:3]
  ds_read_b128 v[196:199], v246 offset:31744
  s_sub_u32 s31, s31, 2
  v_mfma_f32_16x16x32_bf16 v[4:7], v[200:203], v[108:111], v[4:7]
  v_exp_f32 v236, v72
  v_mfma_f32_16x16x32_bf16 v[12:15], v[204:207], v[108:111], v[12:15]
  ds_read_b128 v[200:203], v246 offset:16384
  v_cvt_pk_bf16_f32 v97, v234, v235
  v_mfma_f32_16x16x32_bf16 v[8:11], v[204:207], v[104:107], v[8:11]
  v_exp_f32 v237, v73
  v_mfma_f32_16x16x32_bf16 v[16:19], v[208:211], v[104:107], v[16:19]
  v_exp_f32 v238, v74
  v_mfma_f32_16x16x32_bf16 v[20:23], v[208:211], v[108:111], v[20:23]
  ds_read_b128 v[204:207], v246 offset:17408
  v_cvt_pk_bf16_f32 v100, v236, v237
  v_mfma_f32_16x16x32_bf16 v[28:31], v[212:215], v[108:111], v[28:31]
  ds_read_b128 v[208:211], v246 offset:18432
  s_cmp_ge_u32 s31, 2
  v_mfma_f32_16x16x32_bf16 v[24:27], v[212:215], v[104:107], v[24:27]
  v_exp_f32 v239, v75
  v_mfma_f32_16x16x32_bf16 v[32:35], v[216:219], v[104:107], v[32:35]
  ds_read_b128 v[212:215], v246 offset:19456
  v_mfma_f32_16x16x32_bf16 v[36:39], v[216:219], v[108:111], v[36:39]
  v_exp_f32 v232, v68
  v_mfma_f32_16x16x32_bf16 v[44:47], v[220:223], v[108:111], v[44:47]
  ds_read_b128 v[216:219], v246 offset:20480
  v_cvt_pk_bf16_f32 v101, v238, v239
  v_mfma_f32_16x16x32_bf16 v[40:43], v[220:223], v[104:107], v[40:43]
  v_exp_f32 v233, v69
  v_mfma_f32_16x16x32_bf16 v[48:51], v[224:227], v[104:107], v[48:51]
  ds_read_b128 v[220:223], v246 offset:21504
  v_mfma_f32_16x16x32_bf16 v[52:55], v[224:227], v[108:111], v[52:55]
  v_exp_f32 v234, v70
  v_mfma_f32_16x16x32_bf16 v[60:63], v[228:231], v[108:111], v[60:63]
  ds_read_b128 v[224:227], v246 offset:22528
  v_cvt_pk_bf16_f32 v98, v232, v233
  v_mfma_f32_16x16x32_bf16 v[56:59], v[228:231], v[104:107], v[56:59]
  ds_read_b128 v[228:231], v246 offset:23552
  s_cbranch_scc1 ka_loopB
ka_tailEB:
  s_cmp_eq_u32 s31, 0
  s_cbranch_scc1 ka_lastEB
  s_waitcnt lgkmcnt(8)
  v_mfma_f32_16x16x32_bf16 v[80:83], v[168:171], v[136:139], v[112:115]
  v_exp_f32 v235, v71
  v_mfma_f32_16x16x32_bf16 v[88:91], v[168:171], v[152:155], v[116:119]
  v_exp_f32 v236, v76
  v_mfma_f32_16x16x32_bf16 v[80:83], v[172:175], v[140:143], v[80:83]
  v_cvt_pk_bf16_f32 v99, v234, v235
  s_waitcnt lgkmcnt(0)
  s_barrier
  v_add_u32 v246, s30, v245
  v_mfma_f32_16x16x32_bf16 v[88:91], v[172:175], v[156:159], v[88:91]
  v_exp_f32 v237, v77
  v_mfma_f32_16x16x32_bf16 v[80:83], v[176:179], v[144:147], v[80:83]
  v_exp_f32 v238, v78
  v_mfma_f32_16x16x32_bf16 v[88:91], v[176:179], v[160:163], v[88:91]
  v_cvt_pk_bf16_f32 v102, v236, v237
  s_add_u32 s30, s30, 32768
  v_mfma_f32_16x16x32_bf16 v[80:83], v[180:183], v[148:151], v[80:83]
  v_exp_f32 v239, v79
  v_mfma_f32_16x16x32_bf16 v[88:91], v[180:183], v[164:167], v[88:91]
  v_cvt_pk_bf16_f32 v103, v238, v239
  s_and_b32 s30, s30, 0x1ffff
  v_mfma_f32_16x16x32_bf16 v[84:87], v[184:187], v[136:139], v[112:115]
  v_mfma_f32_16x16x32_bf16 v[120:123], v[240:243], v[96:99], v[128:131]
  v_mfma_f32_16x16x32_bf16 v[124:127], v[240:243], v[100:103], v[132:135]
  s_nop 0
  v_cndmask_b32 v80, v244, v80, s[80:81]
  v_cndmask_b32 v81, v244, v81, s[82:83]
  v_mfma_f32_16x16x32_bf16 v[92:95], v[184:187], v[152:155], v[116:119]
  v_cndmask_b32 v82, v244, v82, s[84:85]
  v_cndmask_b32 v83, v244, v83, s[86:87]
  v_mfma_f32_16x16x32_bf16 v[84:87], v[188:191], v[140:143], v[84:87]
  v_exp_f32 v232, v80
  v_mfma_f32_16x16x32_bf16 v[92:95], v[188:191], v[156:159], v[92:95]
  v_exp_f32 v233, v81
  v_mfma_f32_16x16x32_bf16 v[84:87], v[192:195], v[144:147], v[84:87]
  v_exp_f32 v234, v82
  v_mfma_f32_16x16x32_bf16 v[92:95], v[192:195], v[160:163], v[92:95]
  v_max_f32 v251, v120, v124
  v_cvt_pk_bf16_f32 v104, v232, v233
  v_mfma_f32_16x16x32_bf16 v[84:87], v[196:199], v[148:151], v[84:87]
  v_cmp_lt_f32 vcc, s33, v251
  v_mfma_f32_16x16x32_bf16 v[92:95], v[196:199], v[164:167], v[92:95]
  v_exp_f32 v235, v83
  s_cbranch_vccnz ka_kernel_fix_67
ka_kernel_ret_68:
  s_waitcnt lgkmcnt(0)
  v_mfma_f32_16x16x32_bf16 v[0:3], v[200:203], v[96:99], v[0:3]
  v_exp_f32 v236, v88
  v_mfma_f32_16x16x32_bf16 v[4:7], v[200:203], v[100:103], v[4:7]
  ds_read_b128 v[200:203], v246 offset:0
  v_cvt_pk_bf16_f32 v105, v234, v235
  v_mfma_f32_16x16x32_bf16 v[12:15], v[204:207], v[100:103], v[12:15]
  v_exp_f32 v237, v89
  v_mfma_f32_16x16x32_bf16 v[8:11], v[204:207], v[96:99], v[8:11]
  v_exp_f32 v238, v90
  v_mfma_f32_16x16x32_bf16 v[16:19], v[208:211], v[96:99], v[16:19]
  ds_read_b128 v[204:207], v246 offset:1024
  v_cvt_pk_bf16_f32 v108, v236, v237
  v_mfma_f32_16x16x32_bf16 v[20:23], v[208:211], v[100:103], v[20:23]
  v_exp_f32 v239, v91
  v_mov_b32 v84, v244
  v_mfma_f32_16x16x32_bf16 v[28:31], v[212:215], v[100:103], v[28:31]
  v_mov_b32 v85, v244
  v_mov_b32 v86, v244
  v_mfma_f32_16x16x32_bf16 v[24:27], v[212:215], v[96:99], v[24:27]
  ds_read_b128 v[208:211], v246 offset:2048
  v_mov_b32 v87, v244
  v_mfma_f32_16x16x32_bf16 v[32:35], v[216:219], v[96:99], v[32:35]
  ds_read_b128 v[212:215], v246 offset:3072
  v_cndmask_b32 v92, v244, v92, s[80:81]
  v_mfma_f32_16x16x32_bf16 v[36:39], v[216:219], v[100:103], v[36:39]
  v_cndmask_b32 v93, v244, v93, s[82:83]
  v_cndmask_b32 v94, v244, v94, s[84:85]
  v_mfma_f32_16x16x32_bf16 v[44:47], v[220:223], v[100:103], v[44:47]
  ds_read_b128 v[216:219], v246 offset:4096
  v_cndmask_b32 v95, v244, v95, s[86:87]
  v_mfma_f32_16x16x32_bf16 v[40:43], v[220:223], v[96:99], v[40:43]
  v_exp_f32 v232, v84
  v_mfma_f32_16x16x32_bf16 v[48:51], v[224:227], v[96:99], v[48:51]
  ds_read_b128 v[220:223], v246 offset:5120
  v_cvt_pk_bf16_f32 v109, v238, v239
  v_mfma_f32_16x16x32_bf16 v[52:55], v[224:227], v[100:103], v[52:55]
  v_exp_f32 v233, v85
  v_mfma_f32_16x16x32_bf16 v[60:63], v[228:231], v[100:103], v[60:63]
  ds_read_b128 v[224:227], v246 offset:6144
  v_mfma_f32_16x16x32_bf16 v[56:59], v[228:231], v[96:99], v[56:59]
  ds_read_b128 v[228:231], v246 offset:7168
  v_exp_f32 v234, v86
  v_cvt_pk_bf16_f32 v106, v232, v233
  v_exp_f32 v235, v87
  v_exp_f32 v236, v92
  v_cvt_pk_bf16_f32 v107, v234, v235
  v_exp_f32 v237, v93
  v_exp_f32 v238, v94
  v_cvt_pk_bf16_f32 v110, v236, v237
  v_exp_f32 v239, v95
  s_nop 0
  v_cvt_pk_bf16_f32 v111, v238, v239
  v_mfma_f32_16x16x32_bf16 v[128:131], v[240:243], v[104:107], v[120:123]
  s_nop 0
  v_mfma_f32_16x16x32_bf16 v[132:135], v[240:243], v[108:111], v[124:127]
  s_nop 7
  v_max_f32 v251, v128, v132
  v_cmp_lt_f32 vcc, s33, v251
  s_cbranch_vccnz ka_kernel_fix_69
ka_kernel_ret_70:
  s_waitcnt lgkmcnt(0)
  v_mfma_f32_16x16x32_bf16 v[0:3], v[200:203], v[104:107], v[0:3]
  v_mfma_f32_16x16x32_bf16 v[4:7], v[200:203], v[108:111], v[4:7]
  v_mfma_f32_16x16x32_bf16 v[12:15], v[204:207], v[108:111], v[12:15]
  v_mfma_f32_16x16x32_bf16 v[8:11], v[204:207], v[104:107], v[8:11]
  v_mfma_f32_16x16x32_bf16 v[16:19], v[208:211], v[104:107], v[16:19]
  v_mfma_f32_16x16x32_bf16 v[20:23], v[208:211], v[108:111], v[20:23]
  v_mfma_f32_16x16x32_bf16 v[28:31], v[212:215], v[108:111], v[28:31]
  v_mfma_f32_16x16x32_bf16 v[24:27], v[212:215], v[104:107], v[24:27]
  v_mfma_f32_16x16x32_bf16 v[32:35], v[216:219], v[104:107], v[32:35]
  v_mfma_f32_16x16x32_bf16 v[36:39], v[216:219], v[108:111], v[36:39]
  v_mfma_f32_16x16x32_bf16 v[44:47], v[220:223], v[108:111], v[44:47]
  v_mfma_f32_16x16x32_bf16 v[40:43], v[220:223], v[104:107], v[40:43]
  v_mfma_f32_16x16x32_bf16 v[48:51], v[224:227], v[104:107], v[48:51]
  v_mfma_f32_16x16x32_bf16 v[52:55], v[224:227], v[108:111], v[52:55]
  v_mfma_f32_16x16x32_bf16 v[60:63], v[228:231], v[108:111], v[60:63]
  v_mfma_f32_16x16x32_bf16 v[56:59], v[228:231], v[104:107], v[56:59]
  v_rcp_f32 v248, v128
  v_rcp_f32 v249, v132
  s_branch ka_epi
ka_maskOB:
  s_waitcnt lgkmcnt(8)
  v_mfma_f32_16x16x32_bf16 v[64:67], v[168:171], v[136:139], v[112:115]
  v_exp_f32 v235, v87
  v_mfma_f32_16x16x32_bf16 v[72:75], v[168:171], v[152:155], v[116:119]
  v_exp_f32 v236, v92
  v_mfma_f32_16x16x32_bf16 v[64:67], v[172:175], v[140:143], v[64:67]
  v_cvt_pk_bf16_f32 v107, v234, v235
  v_mfma_f32_16x16x32_bf16 v[72:75], v[172:175], v[156:159], v[72:75]
  v_exp_f32 v237, v93
  v_mfma_f32_16x16x32_bf16 v[64:67], v[176:179], v[144:147], v[64:67]
  v_exp_f32 v238, v94
  v_mfma_f32_16x16x32_bf16 v[72:75], v[176:179], v[160:163], v[72:75]
  v_cvt_pk_bf16_f32 v110, v236, v237
  v_mfma_f32_16x16x32_bf16 v[64:67], v[180:183], v[148:151], v[64:67]
  v_exp_f32 v239, v95
  v_mfma_f32_16x16x32_bf16 v[72:75], v[180:183], v[164:167], v[72:75]
  v_cvt_pk_bf16_f32 v111, v238, v239
  v_mfma_f32_16x16x32_bf16 v[68:71], v[184:187], v[136:139], v[112:115]
  v_mfma_f32_16x16x32_bf16 v[128:131], v[240:243], v[104:107], v[120:123]
  v_mfma_f32_16x16x32_bf16 v[132:135], v[240:243], v[108:111], v[124:127]
  s_nop 1
  v_cndmask_b32 v64, v244, v64, s[80:81]
  v_cndmask_b32 v65, v244, v65, s[82:83]
  v_mfma_f32_16x16x32_bf16 v[76:79], v[184:187], v[152:155], v[116:119]
  v_cndmask_b32 v66, v244, v66, s[84:85]
  v_cndmask_b32 v67, v244, v67, s[86:87]
  v_mfma_f32_16x16x32_bf16 v[68:71], v[188:191], v[140:143], v[68:71]
  v_exp_f32 v232, v64
  v_mfma_f32_16x16x32_bf16 v[76:79], v[188:191], v[156:159], v[76:79]
  v_exp_f32 v233, v65
  v_mfma_f32_16x16x32_bf16 v[68:71], v[192:195], v[144:147], v[68:71]
  v_exp_f32 v234, v66
  v_mfma_f32_16x16x32_bf16 v[76:79], v[192:195], v[160:163], v[76:79]
  v_max_f32 v251, v128, v132
  v_cvt_pk_bf16_f32 v96, v232, v233
  v_mfma_f32_16x16x32_bf16 v[68:71], v[196:199], v[148:151], v[68:71]
  v_cmp_lt_f32 vcc, s33, v251
  v_mfma_f32_16x16x32_bf16 v[76:79], v[196:199], v[164:167], v[76:79]
  v_exp_f32 v235, v67
  s_cbranch_vccnz ka_kernel_fix_71
ka_kernel_ret_72:
  s_waitcnt lgkmcnt(0)
  v_mfma_f32_16x16x32_bf16 v[0:3], v[200:203], v[104:107], v[0:3]
  v_exp_f32 v236, v72
  v_mfma_f32_16x16x32_bf16 v[4:7], v[200:203], v[108:111], v[4:7]
  ds_read_b128 v[200:203], v246 offset:16384
  v_cvt_pk_bf16_f32 v97, v234, v235
  v_mfma_f32_16x16x32_bf16 v[12:15], v[204:207], v[108:111], v[12:15]
  v_exp_f32 v237, v73
  v_mfma_f32_16x16x32_bf16 v[8:11], v[204:207], v[104:107], v[8:11]
  v_exp_f32 v238, v74
  v_mfma_f32_16x16x32_bf16 v[16:19], v[208:211], v[104:107], v[16:19]
  ds_read_b128 v[204:207], v246 offset:17408
  v_cvt_pk_bf16_f32 v100, v236, v237
  v_mfma_f32_16x16x32_bf16 v[20:23], v[208:211], v[108:111], v[20:23]
  v_exp_f32 v239, v75
  v_mov_b32 v68, v244
  v_mfma_f32_16x16x32_bf16 v[28:31], v[212:215], v[108:111], v[28:31]
  v_mov_b32 v69, v244
  v_mov_b32 v70, v244
  v_mfma_f32_16x16x32_bf16 v[24:27], v[212:215], v[104:107], v[24:27]
  ds_read_b128 v[208:211], v246 offset:18432
  v_mov_b32 v71, v244
  v_mfma_f32_16x16x32_bf16 v[32:35], v[216:219], v[104:107], v[32:35]
  ds_read_b128 v[212:215], v246 offset:19456
  v_cndmask_b32 v76, v244, v76, s[80:81]
  v_mfma_f32_16x16x32_bf16 v[36:39], v[216:219], v[108:111], v[36:39]
  v_cndmask_b32 v77, v244, v77, s[82:83]
  v_cndmask_b32 v78, v244, v78, s[84:85]
  v_mfma_f32_16x16x32_bf16 v[44:47], v[220:223], v[108:111], v[44:47]
  ds_read_b128 v[216:219], v246 offset:20480
  v_cndmask_b32 v79, v244, v79, s[86:87]
  v_mfma_f32_16x16x32_bf16 v[40:43], v[220:223], v[104:107], v[40:43]
  v_exp_f32 v232, v68
  v_mfma_f32_16x16x32_bf16 v[48:51], v[224:227], v[104:107], v[48:51]
  ds_read_b128 v[220:223], v246 offset:21504
  v_cvt_pk_bf16_f32 v101, v238, v239
  v_mfma_f32_16x16x32_bf16 v[52:55], v[224:227], v[108:111], v[52:55]
  v_exp_f32 v233, v69
  v_mfma_f32_16x16x32_bf16 v[60:63], v[228:231], v[108:111], v[60:63]
  ds_read_b128 v[224:227], v246 offset:22528
  v_mfma_f32_16x16x32_bf16 v[56:59], v[228:231], v[104:107], v[56:59]
  ds_read_b128 v[228:231], v246 offset:23552
  v_exp_f32 v234, v70
  v_cvt_pk_bf16_f32 v98, v232, v233
ka_lastEB:
  v_exp_f32 v235, v71
  v_exp_f32 v236, v76
  v_cvt_pk_bf16_f32 v99, v234, v235
  v_exp_f32 v237, v77
  v_exp_f32 v238, v78
  v_cvt_pk_bf16_f32 v102, v236, v237
  v_exp_f32 v239, v79
  s_nop 0
  v_cvt_pk_bf16_f32 v103, v238, v239
  v_mfma_f32_16x16x32_bf16 v[120:123], v[240:243], v[96:99], v[128:131]
  s_nop 0
  v_mfma_f32_16x16x32_bf16 v[124:127], v[240:243], v[100:103], v[132:135]
  s_waitcnt lgkmcnt(0)
  s_barrier
  v_add_u32 v246, s30, v245
  s_nop 4
  v_max_f32 v251, v120, v124
  v_cmp_lt_f32 vcc, s33, v251
  s_cbranch_vccnz ka_kernel_fix_73
ka_kernel_ret_74:
  s_waitcnt lgkmcnt(0)
  v_mfma_f32_16x16x32_bf16 v[0:3], v[200:203], v[96:99], v[0:3]
  v_mfma_f32_16x16x32_bf16 v[4:7], v[200:203], v[100:103], v[4:7]
  v_mfma_f32_16x16x32_bf16 v[12:15], v[204:207], v[100:103], v[12:15]
  v_mfma_f32_16x16x32_bf16 v[8:11], v[204:207], v[96:99], v[8:11]
  v_mfma_f32_16x16x32_bf16 v[16:19], v[208:211], v[96:99], v[16:19]
  v_mfma_f32_16x16x32_bf16 v[20:23], v[208:211], v[100:103], v[20:23]
  v_mfma_f32_16x16x32_bf16 v[28:31], v[212:215], v[100:103], v[28:31]
  v_mfma_f32_16x16x32_bf16 v[24:27], v[212:215], v[96:99], v[24:27]
  v_mfma_f32_16x16x32_bf16 v[32:35], v[216:219], v[96:99], v[32:35]
  v_mfma_f32_16x16x32_bf16 v[36:39], v[216:219], v[100:103], v[36:39]
  v_mfma_f32_16x16x32_bf16 v[44:47], v[220:223], v[100:103], v[44:47]
  v_mfma_f32_16x16x32_bf16 v[40:43], v[220:223], v[96:99], v[40:43]
  v_mfma_f32_16x16x32_bf16 v[48:51], v[224:227], v[96:99], v[48:51]
  v_mfma_f32_16x16x32_bf16 v[52:55], v[224:227], v[100:103], v[52:55]
  v_mfma_f32_16x16x32_bf16 v[60:63], v[228:231], v[100:103], v[60:63]
  v_mfma_f32_16x16x32_bf16 v[56:59], v[228:231], v[96:99], v[56:59]
  v_rcp_f32 v248, v120
  v_rcp_f32 v249, v124
ka_epi:
  s_cmp_eq_u32 s19, 0
  s_cbranch_scc1 ka_epiB
  s_setprio 0
  s_waitcnt vmcnt(16)
  s_barrier
  s_sub_u32 s26, s26, 1
  s_mov_b32 m0, s29
  s_add_u32 s35, s25, 4096
  buffer_load_dwordx4 v245, s[12:15], s25 offen offset:0 sc1 lds
  buffer_load_dwordx4 v245, s[12:15], s25 offen offset:1024 sc1 lds
  buffer_load_dwordx4 v245, s[12:15], s25 offen offset:2048 sc1 lds
  buffer_load_dwordx4 v245, s[12:15], s25 offen offset:3072 sc1 lds
  s_add_u32 m0, s29, 4096
  s_add_u32 s25, s25, 32768
  buffer_load_dwordx4 v245, s[12:15], s35 offen offset:0 sc1 lds
  buffer_load_dwordx4 v245, s[12:15], s35 offen offset:1024 sc1 lds
  buffer_load_dwordx4 v245, s[12:15], s35 offen offset:2048 sc1 lds
  buffer_load_dwordx4 v245, s[12:15], s35 offen offset:3072 sc1 lds
  s_min_u32 s25, s25, s27
  s_add_u32 s29, s29, 32768
  s_and_b32 s29, s29, 0x1ffff
  s_branch ka_epi2
ka_epiB:
  s_lshr_b32 s22, s2, 1
  s_and_b32 s22, s22, 0x1c
  s_add_u32 s22, s22, s20
  s_getpc_b64 s[4:5]
ka_kernel_pc_75:
  s_add_u32 s4, s4, kb_kernel-ka_kernel_pc_75
  s_addc_u32 s5, s5, 0
  s_lshl_b32 s21, s22, 10
  v_add_u32 v250, s21, v245
  v_min_u32 v251, kb_cpa-kb_kernel-16, v250
  global_load_dwordx4 v[252:255], v251, s[4:5]
  s_cmp_ge_u32 s20, 2
  s_cbranch_scc1 ka_epi2
  s_barrier
ka_epi2:
  v_mul_f32 v0, v0, v248
  v_mul_f32 v1, v1, v248
  v_mul_f32 v2, v2, v248
  v_mul_f32 v3, v3, v248
  v_cvt_pk_bf16_f32 v64, v0, v1
  v_cvt_pk_bf16_f32 v65, v2, v3
  v_mul_f32 v8, v8, v248
  v_mul_f32 v9, v9, v248
  v_mul_f32 v10, v10, v248
  v_mul_f32 v11, v11, v248
  v_cvt_pk_bf16_f32 v66, v8, v9
  v_cvt_pk_bf16_f32 v67, v10, v11
  s_mov_b32 s21, 0
  buffer_store_dwordx4 v[64:67], v247, s[12:15], s21 offen offset:0
  v_mul_f32 v16, v16, v248
  v_mul_f32 v17, v17, v248
  v_mul_f32 v18, v18, v248
  v_mul_f32 v19, v19, v248
  v_cvt_pk_bf16_f32 v68, v16, v17
  v_cvt_pk_bf16_f32 v69, v18, v19
  v_mul_f32 v24, v24, v248
  v_mul_f32 v25, v25, v248
  v_mul_f32 v26, v26, v248
  v_mul_f32 v27, v27, v248
  v_cvt_pk_bf16_f32 v70, v24, v25
  v_cvt_pk_bf16_f32 v71, v26, v27
  buffer_store_dwordx4 v[68:71], v247, s[12:15], s21 offen offset:1024
  v_mul_f32 v32, v32, v248
  v_mul_f32 v33, v33, v248
  v_mul_f32 v34, v34, v248
  v_mul_f32 v35, v35, v248
  v_cvt_pk_bf16_f32 v72, v32, v33
  v_cvt_pk_bf16_f32 v73, v34, v35
  v_mul_f32 v40, v40, v248
  v_mul_f32 v41, v41, v248
  v_mul_f32 v42, v42, v248
  v_mul_f32 v43, v43, v248
  v_cvt_pk_bf16_f32 v74, v40, v41
  v_cvt_pk_bf16_f32 v75, v42, v43
  buffer_store_dwordx4 v[72:75], v247, s[12:15], s21 offen offset:2048
  v_mul_f32 v48, v48, v248
  v_mul_f32 v49, v49, v248
  v_mul_f32 v50, v50, v248
  v_mul_f32 v51, v51, v248
  v_cvt_pk_bf16_f32 v76, v48, v49
  v_cvt_pk_bf16_f32 v77, v50, v51
  v_mul_f32 v56, v56, v248
  v_mul_f32 v57, v57, v248
  v_mul_f32 v58, v58, v248
  v_mul_f32 v59, v59, v248
  v_cvt_pk_bf16_f32 v78, v56, v57
  v_cvt_pk_bf16_f32 v79, v58, v59
  buffer_store_dwordx4 v[76:79], v247, s[12:15], s21 offen offset:3072
  v_mul_f32 v4, v4, v249
  v_mul_f32 v5, v5, v249
  v_mul_f32 v6, v6, v249
  v_mul_f32 v7, v7, v249
  v_cvt_pk_bf16_f32 v80, v4, v5
  v_cvt_pk_bf16_f32 v81, v6, v7
  v_mul_f32 v12, v12, v249
  v_mul_f32 v13, v13, v249
  v_mul_f32 v14, v14, v249
  v_mul_f32 v15, v15, v249
  v_cvt_pk_bf16_f32 v82, v12, v13
  v_cvt_pk_bf16_f32 v83, v14, v15
  s_mov_b32 s21, 131072
  buffer_store_dwordx4 v[80:83], v247, s[12:15], s21 offen offset:0
  v_mul_f32 v20, v20, v249
  v_mul_f32 v21, v21, v249
  v_mul_f32 v22, v22, v249
  v_mul_f32 v23, v23, v249
  v_cvt_pk_bf16_f32 v84, v20, v21
  v_cvt_pk_bf16_f32 v85, v22, v23
  v_mul_f32 v28, v28, v249
  v_mul_f32 v29, v29, v249
  v_mul_f32 v30, v30, v249
  v_mul_f32 v31, v31, v249
  v_cvt_pk_bf16_f32 v86, v28, v29
  v_cvt_pk_bf16_f32 v87, v30, v31
  buffer_store_dwordx4 v[84:87], v247, s[12:15], s21 offen offset:1024
  v_mul_f32 v36, v36, v249
  v_mul_f32 v37, v37, v249
  v_mul_f32 v38, v38, v249
  v_mul_f32 v39, v39, v249
  v_cvt_pk_bf16_f32 v88, v36, v37
  v_cvt_pk_bf16_f32 v89, v38, v39
  v_mul_f32 v44, v44, v249
  v_mul_f32 v45, v45, v249
  v_mul_f32 v46, v46, v249
  v_mul_f32 v47, v47, v249
  v_cvt_pk_bf16_f32 v90, v44, v45
  v_cvt_pk_bf16_f32 v91, v46, v47
  buffer_store_dwordx4 v[88:91], v247, s[12:15], s21 offen offset:2048
  v_mul_f32 v52, v52, v249
  v_mul_f32 v53, v53, v249
  v_mul_f32 v54, v54, v249
  v_mul_f32 v55, v55, v249
  v_cvt_pk_bf16_f32 v92, v52, v53
  v_cvt_pk_bf16_f32 v93, v54, v55
  v_mul_f32 v60, v60, v249
  v_mul_f32 v61, v61, v249
  v_mul_f32 v62, v62, v249
  v_mul_f32 v63, v63, v249
  v_cvt_pk_bf16_f32 v94, v60, v61
  v_cvt_pk_bf16_f32 v95, v62, v63
  buffer_store_dwordx4 v[92:95], v247, s[12:15], s21 offen offset:3072
  s_cmp_eq_u32 s19, 0
  s_cbranch_scc1 ka_done
  s_waitcnt vmcnt(16)
  s_barrier
  s_sub_u32 s26, s26, 1
  s_mov_b32 m0, s29
  s_add_u32 s35, s25, 4096
  buffer_load_dwordx4 v245, s[12:15], s25 offen offset:0 sc1 lds
  buffer_load_dwordx4 v245, s[12:15], s25 offen offset:1024 sc1 lds
  buffer_load_dwordx4 v245, s[12:15], s25 offen offset:2048 sc1 lds
  buffer_load_dwordx4 v245, s[12:15], s25 offen offset:3072 sc1 lds
  s_add_u32 m0, s29, 4096
  s_add_u32 s25, s25, 32768
  buffer_load_dwordx4 v245, s[12:15], s35 offen offset:0 sc1 lds
  buffer_load_dwordx4 v245, s[12:15], s35 offen offset:1024 sc1 lds
  buffer_load_dwordx4 v245, s[12:15], s35 offen offset:2048 sc1 lds
  buffer_load_dwordx4 v245, s[12:15], s35 offen offset:3072 sc1 lds
  s_min_u32 s25, s25, s27
  s_add_u32 s29, s29, 32768
  s_and_b32 s29, s29, 0x1ffff
  s_cmp_ge_u32 s20, 2
  s_cbranch_scc1 ka_packer
  s_waitcnt vmcnt(16)
  s_barrier
  s_sub_u32 s26, s26, 1
  s_mov_b32 m0, s29
  s_add_u32 s35, s25, 4096
  buffer_load_dwordx4 v245, s[12:15], s25 offen offset:0 sc1 lds
  buffer_load_dwordx4 v245, s[12:15], s25 offen offset:1024 sc1 lds
  buffer_load_dwordx4 v245, s[12:15], s25 offen offset:2048 sc1 lds
  buffer_load_dwordx4 v245, s[12:15], s25 offen offset:3072 sc1 lds
  s_add_u32 m0, s29, 4096
  s_add_u32 s25, s25, 32768
  buffer_load_dwordx4 v245, s[12:15], s35 offen offset:0 sc1 lds
  buffer_load_dwordx4 v245, s[12:15], s35 offen offset:1024 sc1 lds
  buffer_load_dwordx4 v245, s[12:15], s35 offen offset:2048 sc1 lds
  buffer_load_dwordx4 v245, s[12:15], s35 offen offset:3072 sc1 lds
  s_min_u32 s25, s25, s27
  s_add_u32 s29, s29, 32768
  s_and_b32 s29, s29, 0x1ffff
  v_lshrrev_b32 v248, 4, v245
  v_min_u32 v248, 7, v248
  v_lshlrev_b32 v248, 2, v248
  s_lshl_b32 s21, s16, 7
  s_add_u32 s21, s21, 0xf0400
  v_add_u32 v248, s21, v248
  buffer_load_dword v252, v248, s[12:15], 0 offen sc1
  s_lshl_b32 s21, s20, 13
  s_add_u32 s25, s25, s21
  s_add_u32 s29, s29, s21
  s_mov_b32 s95, 0
ka_ld:
  s_cmp_eq_u32 s26, 0
  s_cbranch_scc1 ka_done
  s_cmp_lg_u32 s26, 1
  s_cbranch_scc1 ka_ld1
  s_waitcnt vmcnt(0)
ka_ld1:
  s_cmp_lt_u32 s26, 3
  s_cbranch_scc1 ka_ldc
  s_cmp_lt_u32 s95, 2
  s_cbranch_scc1 ka_ldc
  s_waitcnt vmcnt(32)
  s_cmp_lg_u32 s95, 2
  s_cbranch_scc1 ka_ldw
  v_lshrrev_b32 v248, 4, v245
  v_min_u32 v248, 7, v248
  v_lshlrev_b32 v248, 2, v248
  s_lshl_b32 s21, s16, 7
  s_add_u32 s21, s21, 0xf0400
  v_add_u32 v248, s21, v248
  s_mov_b32 s24, 0x40000
ka_kernel_spin_77:
  v_cmp_ne_u32 vcc, 0x1, v252
  s_cbranch_vccz ka_kernel_pok_76
  s_sleep 2
  buffer_load_dword v252, v248, s[12:15], 0 offen sc1
  s_waitcnt vmcnt(0)
  s_sub_u32 s24, s24, 1
  s_cmp_lg_u32 s24, 0
  s_cbranch_scc1 ka_kernel_spin_77
ka_kernel_pok_76:
  s_branch ka_ldw
ka_ldc:
  s_waitcnt vmcnt(16)
ka_ldw:
  s_barrier
  s_sub_u32 s26, s26, 1
  s_add_u32 s95, s95, 1
  s_cmp_lt_u32 s26, 3
  s_cbranch_scc1 ka_ld
  s_add_u32 s21, s25, 0
  s_min_u32 s21, s21, s27
  s_add_u32 m0, s29, 0
  s_nop 0
  buffer_load_dwordx4 v245, s[12:15], s21 offen offset:0 sc1 lds
  buffer_load_dwordx4 v245, s[12:15], s21 offen offset:1024 sc1 lds
  buffer_load_dwordx4 v245, s[12:15], s21 offen offset:2048 sc1 lds
  buffer_load_dwordx4 v245, s[12:15], s21 offen offset:3072 sc1 lds
  s_add_u32 m0, s29, 4096
  s_add_u32 s21, s21, 4096
  buffer_load_dwordx4 v245, s[12:15], s21 offen offset:0 sc1 lds
  buffer_load_dwordx4 v245, s[12:15], s21 offen offset:1024 sc1 lds
  buffer_load_dwordx4 v245, s[12:15], s21 offen offset:2048 sc1 lds
  buffer_load_dwordx4 v245, s[12:15], s21 offen offset:3072 sc1 lds
  s_add_u32 s21, s25, 8192
  s_min_u32 s21, s21, s27
  s_add_u32 m0, s29, 8192
  s_nop 0
  buffer_load_dwordx4 v245, s[12:15], s21 offen offset:0 sc1 lds
  buffer_load_dwordx4 v245, s[12:15], s21 offen offset:1024 sc1 lds
  buffer_load_dwordx4 v245, s[12:15], s21 offen offset:2048 sc1 lds
  buffer_load_dwordx4 v245, s[12:15], s21 offen offset:3072 sc1 lds
  s_add_u32 m0, s29, 12288
  s_add_u32 s21, s21, 4096
  buffer_load_dwordx4 v245, s[12:15], s21 offen offset:0 sc1 lds
  buffer_load_dwordx4 v245, s[12:15], s21 offen offset:1024 sc1 lds
  buffer_load_dwordx4 v245, s[12:15], s21 offen offset:2048 sc1 lds
  buffer_load_dwordx4 v245, s[12:15], s21 offen offset:3072 sc1 lds
  s_add_u32 s25, s25, 32768
  s_add_u32 s29, s29, 32768
  s_and_b32 s29, s29, 0x1ffff
  s_branch ka_ld
ka_packer:
  s_waitcnt vmcnt(16)
  s_cmp_eq_u32 s26, 0
  s_cbranch_scc1 ka_kernel_nob_78
  s_barrier
  s_sub_u32 s26, s26, 1
ka_kernel_nob_78:
  v_lshrrev_b32 v251, 4, v245
  v_min_u32 v251, 14, v251
  v_lshlrev_b32 v251, 2, v251
  v_add_u32 v251, 192, v251
  buffer_load_dword v252, v251, s[76:79], 0 offen sc1
  v_lshrrev_b32 v239, 4, v245
  s_lshl_b32 s21, s17, 1
  s_add_u32 s21, s21, s20
  s_sub_u32 s21, s21, 2
  s_lshl_b32 s21, s21, 5
  s_add_u32 s21, s21, s16
  s_mov_b32 s92, 0
  s_mov_b32 s93, 0x40000000
  s_mov_b32 s90, 1280
  s_mov_b32 s4, s98
  s_mov_b32 s5, s99
  s_mov_b32 s6, 0
  s_mov_b32 s88, 0
  s_mov_b32 s89, 0x40000000
  s_sub_u32 s22, s21, 0
  s_cmp_ge_u32 s22, 10
  s_cbranch_scc1 ka_kernel_tsk_80
  s_mul_i32 s23, s22, 65536
  s_lshr_b32 s23, s23, 16
  s_mul_i32 s24, s23, 1
  s_sub_u32 s24, s22, s24
  s_mul_i32 s24, s24, 819200
  s_lshl_b32 s88, s23, 7
  s_add_u32 s88, s88, s24
  s_lshl_b32 s89, s23, 12
  s_add_u32 s89, s89, s24
  s_add_u32 s89, s89, 0x4d00000
  s_mov_b32 s90, 1280
  s_mov_b32 s92, 20
  s_mov_b32 s4, s68
  s_mov_b32 s5, s69
  s_mov_b32 s6, 0xc8000
  s_lshl_b32 s93, s23, 8
  s_add_u32 s93, s93, 0x18000
  s_branch ka_kernel_pset_79
ka_kernel_tsk_80:
  s_sub_u32 s22, s21, 10
  s_cmp_ge_u32 s22, 27
  s_cbranch_scc1 ka_kernel_tsk_81
  s_mul_i32 s23, s22, 65536
  s_lshr_b32 s23, s23, 16
  s_mul_i32 s24, s23, 1
  s_sub_u32 s24, s22, s24
  s_mul_i32 s24, s24, 2211840
  s_lshl_b32 s88, s23, 7
  s_add_u32 s88, s88, s24
  s_lshl_b32 s89, s23, 12
  s_add_u32 s89, s89, s24
  s_add_u32 s89, s89, 0x4ea0000
  s_mov_b32 s90, 3456
  s_mov_b32 s92, 20
  s_mov_b32 s4, s72
  s_mov_b32 s5, s73
  s_mov_b32 s6, 0x21c000
  s_lshl_b32 s93, s23, 8
  s_add_u32 s93, s93, 0x1a000
  s_branch ka_kernel_pset_79
ka_kernel_tsk_81:
  s_sub_u32 s22, s21, 48
  s_cmp_ge_u32 s22, 80
  s_cbranch_scc1 ka_kernel_tsk_82
  s_mul_i32 s23, s22, 8192
  s_lshr_b32 s23, s23, 16
  s_mul_i32 s24, s23, 8
  s_sub_u32 s24, s22, s24
  s_mul_i32 s24, s24, 655360
  s_lshl_b32 s88, s23, 7
  s_add_u32 s88, s88, s24
  s_lshl_b32 s89, s23, 12
  s_add_u32 s89, s89, s24
  s_add_u32 s89, s89, 0x4800000
  s_mov_b32 s90, 1280
  s_mov_b32 s92, 16
  s_mov_b32 s4, s98
  s_mov_b32 s5, s99
  s_mov_b32 s6, 0x500000
  s_branch ka_kernel_pset_79
ka_kernel_tsk_82:
  s_sub_u32 s22, s21, 128
  s_cmp_ge_u32 s22, 20
  s_cbranch_scc1 ka_kernel_tsk_83
  s_mul_i32 s23, s22, 32768
  s_lshr_b32 s23, s23, 16
  s_mul_i32 s24, s23, 2
  s_sub_u32 s24, s22, s24
  s_mul_i32 s24, s24, 409600
  s_lshl_b32 s88, s23, 7
  s_add_u32 s88, s88, s24
  s_lshl_b32 s89, s23, 12
  s_add_u32 s89, s89, s24
  s_add_u32 s89, s89, 0x4dd0000
  s_mov_b32 s90, 1280
  s_mov_b32 s92, 10
  s_mov_b32 s4, s70
  s_mov_b32 s5, s71
  s_mov_b32 s6, 0xc8000
  s_branch ka_kernel_pset_79
ka_kernel_tsk_83:
  s_sub_u32 s22, s21, 148
  s_cmp_ge_u32 s22, 60
  s_cbranch_scc1 ka_kernel_tsk_84
  s_mul_i32 s23, s22, 10923
  s_lshr_b32 s23, s23, 16
  s_mul_i32 s24, s23, 6
  s_sub_u32 s24, s22, s24
  s_mul_i32 s24, s24, 368640
  s_lshl_b32 s88, s23, 7
  s_add_u32 s88, s88, s24
  s_lshl_b32 s89, s23, 12
  s_add_u32 s89, s89, s24
  s_add_u32 s89, s89, 0x50c0000
  s_mov_b32 s90, 1280
  s_mov_b32 s92, 9
  s_mov_b32 s4, s74
  s_mov_b32 s5, s75
  s_mov_b32 s6, 0x21c000
  s_branch ka_kernel_pset_79
ka_kernel_tsk_84:
ka_kernel_pset_79:
  s_and_b32 s5, s5, 0xffff
  s_mov_b32 s7, 0x20000
  s_lshl_b32 s94, s20, 14
  s_add_u32 s94, s94, 98304
  v_lshrrev_b32 v248, 3, v239
  v_and_b32 v249, 6, v248
  v_xor_b32 v249, v249, v239
  v_and_b32 v249, 7, v249
  v_lshlrev_b32 v249, 4, v249
  v_mad_u32_u24 v0, v248, s90, v249
  v_lshrrev_b32 v248, 2, v239
  v_lshlrev_b32 v248, 7, v248
  v_and_b32 v249, 3, v239
  v_lshl_add_u32 v1, v249, 3, v248
  v_and_b32 v249, 0x18, v239
  v_lshl_add_u32 v1, v249, 2, v1
  v_add_u32 v60, s94, v1
  v_xor_b32 v61, 32, v60
  v_xor_b32 v62, 64, v60
  v_xor_b32 v63, 96, v60
  v_and_b32 v248, 15, v239
  s_lshl_b32 s22, s90, 1
  v_mul_u32_u24 v2, s22, v248
  v_and_b32 v249, 0x30, v239
  v_add3_u32 v2, v2, v249, s93
  v_cmp_gt_u32 vcc, 3, v248
  v_mov_b32 v249, 0x40000000
  s_nop 0
  v_cndmask_b32 v2, v249, v2, vcc
  v_add_u32 v250, 0x8000, v245
  v_cndmask_b32 v250, v249, v250, vcc
  v_mov_b32 v20, 0
  v_mov_b32 v21, 0
  v_mov_b32 v22, 0
  v_mov_b32 v23, 0
  v_mov_b32 v24, 0
  v_mov_b32 v25, 0
  v_mov_b32 v26, 0
  v_mov_b32 v27, 0
  v_mov_b32 v28, 0
  v_mov_b32 v29, 0
  v_mov_b32 v30, 0
  v_mov_b32 v31, 0
  v_mov_b32 v32, 0
  v_mov_b32 v33, 0
  v_mov_b32 v34, 0
  v_mov_b32 v35, 0
  s_lshl_b32 s91, s90, 5
  s_lshl_b32 s90, s90, 3
  s_sub_u32 s90, s90, 1024
  s_mov_b32 s95, 0
  s_mov_b32 s96, 0
  s_waitcnt vmcnt(9)
  s_cmp_eq_u32 s26, 0
  s_cbranch_scc1 ka_kernel_nob_85
  s_barrier
  s_sub_u32 s26, s26, 1
ka_kernel_nob_85:
  s_waitcnt vmcnt(0)
  s_cmp_eq_u32 s92, 0
  s_cbranch_scc1 ka_done
  s_cmp_eq_u32 s26, 0
  s_cbranch_scc1 ka_kernel_nob_86
  s_barrier
  s_sub_u32 s26, s26, 1
ka_kernel_nob_86:
  v_lshrrev_b32 v251, 4, v245
  v_min_u32 v251, 14, v251
  v_lshlrev_b32 v251, 2, v251
  v_add_u32 v251, 192, v251
  s_mov_b32 s24, 0x40000
ka_kernel_spin_88:
  v_cmp_ne_u32 vcc, 0x1010101, v252
  s_cbranch_vccz ka_kernel_pok_87
  s_sleep 2
  buffer_load_dword v252, v251, s[76:79], 0 offen sc1
  s_waitcnt vmcnt(0)
  s_sub_u32 s24, s24, 1
  s_cmp_lg_u32 s24, 0
  s_cbranch_scc1 ka_kernel_spin_88
ka_kernel_pok_87:
  s_setprio 2
ka_pk:
  s_cmp_lt_u32 s95, 3
  s_cbranch_scc1 ka_kernel_nofin_89
  s_cmp_gt_u32 s95, s92
  s_cbranch_scc1 ka_kernel_wa_91
  s_cmp_lt_u32 s95, 5
  s_cbranch_scc1 ka_kernel_wb_92
  s_waitcnt vmcnt(18)
  s_branch ka_kernel_wd_93
ka_kernel_wa_91:
  s_waitcnt vmcnt(8)
  s_branch ka_kernel_wd_93
ka_kernel_wb_92:
  s_waitcnt vmcnt(10)
ka_kernel_wd_93:
  ds_read_b64_tr_b16 v[4:5], v60 offset:4096
  ds_read_b64_tr_b16 v[6:7], v60 offset:6144
  ds_read_b64_tr_b16 v[8:9], v61 offset:4096
  ds_read_b64_tr_b16 v[10:11], v61 offset:6144
  ds_read_b64_tr_b16 v[12:13], v62 offset:4096
  ds_read_b64_tr_b16 v[14:15], v62 offset:6144
  ds_read_b64_tr_b16 v[16:17], v63 offset:4096
  ds_read_b64_tr_b16 v[18:19], v63 offset:6144
  s_waitcnt lgkmcnt(0)
  buffer_store_dwordx4 v[4:7], v245, s[12:15], s89 offen offset:0
  buffer_store_dwordx4 v[8:11], v245, s[12:15], s89 offen offset:1024
  buffer_store_dwordx4 v[12:15], v245, s[12:15], s89 offen offset:2048
  buffer_store_dwordx4 v[16:19], v245, s[12:15], s89 offen offset:3072
  s_cmp_lg_u32 s92, 20
  s_cbranch_scc1 ka_kernel_nomf_94
  v_mfma_f32_16x16x32_bf16 v[20:23], v[4:7], v[44:47], v[20:23]
  v_mfma_f32_16x16x32_bf16 v[24:27], v[8:11], v[44:47], v[24:27]
  v_mfma_f32_16x16x32_bf16 v[28:31], v[12:15], v[44:47], v[28:31]
  v_mfma_f32_16x16x32_bf16 v[32:35], v[16:19], v[44:47], v[32:35]
ka_kernel_nomf_94:
  s_add_u32 s89, s89, s91
  s_add_u32 s21, s92, 2
  s_cmp_eq_u32 s95, s21
  s_cbranch_scc1 ka_pkend
ka_kernel_nofin_89:
  s_cmp_ge_u32 s95, s92
  s_cbranch_scc1 ka_kernel_noiss_90
  s_add_u32 m0, s94, 0
  s_mov_b32 s21, s88
  buffer_load_dwordx4 v0, s[4:7], s21 offen offset:0 lds
  s_add_u32 s21, s21, s90
  buffer_load_dwordx4 v0, s[4:7], s21 offen offset:1024 lds
  s_add_u32 s21, s21, s90
  buffer_load_dwordx4 v0, s[4:7], s21 offen offset:2048 lds
  s_add_u32 s21, s21, s90
  buffer_load_dwordx4 v0, s[4:7], s21 offen offset:3072 lds
  buffer_load_dwordx4 v[40:43], v250, s[12:15], s96 offen sc1
  s_add_u32 s88, s88, s91
  s_add_u32 s96, s96, 1024
ka_kernel_noiss_90:
  s_add_u32 s95, s95, 1
  s_cmp_eq_u32 s26, 0
  s_cbranch_scc1 ka_kernel_nob_95
  s_barrier
  s_sub_u32 s26, s26, 1
ka_kernel_nob_95:
  s_cmp_lt_u32 s95, 3
  s_cbranch_scc1 ka_kernel_nofin_96
  s_cmp_gt_u32 s95, s92
  s_cbranch_scc1 ka_kernel_wa_98
  s_cmp_lt_u32 s95, 5
  s_cbranch_scc1 ka_kernel_wb_99
  s_waitcnt vmcnt(18)
  s_branch ka_kernel_wd_100
ka_kernel_wa_98:
  s_waitcnt vmcnt(8)
  s_branch ka_kernel_wd_100
ka_kernel_wb_99:
  s_waitcnt vmcnt(10)
ka_kernel_wd_100:
  ds_read_b64_tr_b16 v[4:5], v60 offset:8192
  ds_read_b64_tr_b16 v[6:7], v60 offset:10240
  ds_read_b64_tr_b16 v[8:9], v61 offset:8192
  ds_read_b64_tr_b16 v[10:11], v61 offset:10240
  ds_read_b64_tr_b16 v[12:13], v62 offset:8192
  ds_read_b64_tr_b16 v[14:15], v62 offset:10240
  ds_read_b64_tr_b16 v[16:17], v63 offset:8192
  ds_read_b64_tr_b16 v[18:19], v63 offset:10240
  s_waitcnt lgkmcnt(0)
  buffer_store_dwordx4 v[4:7], v245, s[12:15], s89 offen offset:0
  buffer_store_dwordx4 v[8:11], v245, s[12:15], s89 offen offset:1024
  buffer_store_dwordx4 v[12:15], v245, s[12:15], s89 offen offset:2048
  buffer_store_dwordx4 v[16:19], v245, s[12:15], s89 offen offset:3072
  s_cmp_lg_u32 s92, 20
  s_cbranch_scc1 ka_kernel_nomf_101
  v_mfma_f32_16x16x32_bf16 v[20:23], v[4:7], v[48:51], v[20:23]
  v_mfma_f32_16x16x32_bf16 v[24:27], v[8:11], v[48:51], v[24:27]
  v_mfma_f32_16x16x32_bf16 v[28:31], v[12:15], v[48:51], v[28:31]
  v_mfma_f32_16x16x32_bf16 v[32:35], v[16:19], v[48:51], v[32:35]
ka_kernel_nomf_101:
  s_add_u32 s89, s89, s91
  s_add_u32 s21, s92, 2
  s_cmp_eq_u32 s95, s21
  s_cbranch_scc1 ka_pkend
ka_kernel_nofin_96:
  s_cmp_ge_u32 s95, s92
  s_cbranch_scc1 ka_kernel_noiss_97
  s_add_u32 m0, s94, 4096
  s_mov_b32 s21, s88
  buffer_load_dwordx4 v0, s[4:7], s21 offen offset:0 lds
  s_add_u32 s21, s21, s90
  buffer_load_dwordx4 v0, s[4:7], s21 offen offset:1024 lds
  s_add_u32 s21, s21, s90
  buffer_load_dwordx4 v0, s[4:7], s21 offen offset:2048 lds
  s_add_u32 s21, s21, s90
  buffer_load_dwordx4 v0, s[4:7], s21 offen offset:3072 lds
  buffer_load_dwordx4 v[44:47], v250, s[12:15], s96 offen sc1
  s_add_u32 s88, s88, s91
  s_add_u32 s96, s96, 1024
ka_kernel_noiss_97:
  s_add_u32 s95, s95, 1
  s_cmp_eq_u32 s26, 0
  s_cbranch_scc1 ka_kernel_nob_102
  s_barrier
  s_sub_u32 s26, s26, 1
ka_kernel_nob_102:
  s_cmp_lt_u32 s95, 3
  s_cbranch_scc1 ka_kernel_nofin_103
  s_cmp_gt_u32 s95, s92
  s_cbranch_scc1 ka_kernel_wa_105
  s_cmp_lt_u32 s95, 5
  s_cbranch_scc1 ka_kernel_wb_106
  s_waitcnt vmcnt(18)
  s_branch ka_kernel_wd_107
ka_kernel_wa_105:
  s_waitcnt vmcnt(8)
  s_branch ka_kernel_wd_107
ka_kernel_wb_106:
  s_waitcnt vmcnt(10)
ka_kernel_wd_107:
  ds_read_b64_tr_b16 v[4:5], v60 offset:12288
  ds_read_b64_tr_b16 v[6:7], v60 offset:14336
  ds_read_b64_tr_b16 v[8:9], v61 offset:12288
  ds_read_b64_tr_b16 v[10:11], v61 offset:14336
  ds_read_b64_tr_b16 v[12:13], v62 offset:12288
  ds_read_b64_tr_b16 v[14:15], v62 offset:14336
  ds_read_b64_tr_b16 v[16:17], v63 offset:12288
  ds_read_b64_tr_b16 v[18:19], v63 offset:14336
  s_waitcnt lgkmcnt(0)
  buffer_store_dwordx4 v[4:7], v245, s[12:15], s89 offen offset:0
  buffer_store_dwordx4 v[8:11], v245, s[12:15], s89 offen offset:1024
  buffer_store_dwordx4 v[12:15], v245, s[12:15], s89 offen offset:2048
  buffer_store_dwordx4 v[16:19], v245, s[12:15], s89 offen offset:3072
  s_cmp_lg_u32 s92, 20
  s_cbranch_scc1 ka_kernel_nomf_108
  v_mfma_f32_16x16x32_bf16 v[20:23], v[4:7], v[52:55], v[20:23]
  v_mfma_f32_16x16x32_bf16 v[24:27], v[8:11], v[52:55], v[24:27]
  v_mfma_f32_16x16x32_bf16 v[28:31], v[12:15], v[52:55], v[28:31]
  v_mfma_f32_16x16x32_bf16 v[32:35], v[16:19], v[52:55], v[32:35]
ka_kernel_nomf_108:
  s_add_u32 s89, s89, s91
  s_add_u32 s21, s92, 2
  s_cmp_eq_u32 s95, s21
  s_cbranch_scc1 ka_pkend
ka_kernel_nofin_103:
  s_cmp_ge_u32 s95, s92
  s_cbranch_scc1 ka_kernel_noiss_104
  s_add_u32 m0, s94, 8192
  s_mov_b32 s21, s88
  buffer_load_dwordx4 v0, s[4:7], s21 offen offset:0 lds
  s_add_u32 s21, s21, s90
  buffer_load_dwordx4 v0, s[4:7], s21 offen offset:1024 lds
  s_add_u32 s21, s21, s90
  buffer_load_dwordx4 v0, s[4:7], s21 offen offset:2048 lds
  s_add_u32 s21, s21, s90
  buffer_load_dwordx4 v0, s[4:7], s21 offen offset:3072 lds
  buffer_load_dwordx4 v[48:51], v250, s[12:15], s96 offen sc1
  s_add_u32 s88, s88, s91
  s_add_u32 s96, s96, 1024
ka_kernel_noiss_104:
  s_add_u32 s95, s95, 1
  s_cmp_eq_u32 s26, 0
  s_cbranch_scc1 ka_kernel_nob_109
  s_barrier
  s_sub_u32 s26, s26, 1
ka_kernel_nob_109:
  s_cmp_lt_u32 s95, 3
  s_cbranch_scc1 ka_kernel_nofin_110
  s_cmp_gt_u32 s95, s92
  s_cbranch_scc1 ka_kernel_wa_112
  s_cmp_lt_u32 s95, 5
  s_cbranch_scc1 ka_kernel_wb_113
  s_waitcnt vmcnt(18)
  s_branch ka_kernel_wd_114
ka_kernel_wa_112:
  s_waitcnt vmcnt(8)
  s_branch ka_kernel_wd_114
ka_kernel_wb_113:
  s_waitcnt vmcnt(10)
ka_kernel_wd_114:
  ds_read_b64_tr_b16 v[4:5], v60 offset:0
  ds_read_b64_tr_b16 v[6:7], v60 offset:2048
  ds_read_b64_tr_b16 v[8:9], v61 offset:0
  ds_read_b64_tr_b16 v[10:11], v61 offset:2048
  ds_read_b64_tr_b16 v[12:13], v62 offset:0
  ds_read_b64_tr_b16 v[14:15], v62 offset:2048
  ds_read_b64_tr_b16 v[16:17], v63 offset:0
  ds_read_b64_tr_b16 v[18:19], v63 offset:2048
  s_waitcnt lgkmcnt(0)
  buffer_store_dwordx4 v[4:7], v245, s[12:15], s89 offen offset:0
  buffer_store_dwordx4 v[8:11], v245, s[12:15], s89 offen offset:1024
  buffer_store_dwordx4 v[12:15], v245, s[12:15], s89 offen offset:2048
  buffer_store_dwordx4 v[16:19], v245, s[12:15], s89 offen offset:3072
  s_cmp_lg_u32 s92, 20
  s_cbranch_scc1 ka_kernel_nomf_115
  v_mfma_f32_16x16x32_bf16 v[20:23], v[4:7], v[40:43], v[20:23]
  v_mfma_f32_16x16x32_bf16 v[24:27], v[8:11], v[40:43], v[24:27]
  v_mfma_f32_16x16x32_bf16 v[28:31], v[12:15], v[40:43], v[28:31]
  v_mfma_f32_16x16x32_bf16 v[32:35], v[16:19], v[40:43], v[32:35]
ka_kernel_nomf_115:
  s_add_u32 s89, s89, s91
  s_add_u32 s21, s92, 2
  s_cmp_eq_u32 s95, s21
  s_cbranch_scc1 ka_pkend
ka_kernel_nofin_110:
  s_cmp_ge_u32 s95, s92
  s_cbranch_scc1 ka_kernel_noiss_111
  s_add_u32 m0, s94, 12288
  s_mov_b32 s21, s88
  buffer_load_dwordx4 v0, s[4:7], s21 offen offset:0 lds
  s_add_u32 s21, s21, s90
  buffer_load_dwordx4 v0, s[4:7], s21 offen offset:1024 lds
  s_add_u32 s21, s21, s90
  buffer_load_dwordx4 v0, s[4:7], s21 offen offset:2048 lds
  s_add_u32 s21, s21, s90
  buffer_load_dwordx4 v0, s[4:7], s21 offen offset:3072 lds
  buffer_load_dwordx4 v[52:55], v250, s[12:15], s96 offen sc1
  s_add_u32 s88, s88, s91
  s_add_u32 s96, s96, 1024
ka_kernel_noiss_111:
  s_add_u32 s95, s95, 1
  s_cmp_eq_u32 s26, 0
  s_cbranch_scc1 ka_kernel_nob_116
  s_barrier
  s_sub_u32 s26, s26, 1
ka_kernel_nob_116:
  s_branch ka_pk
ka_pkend:
  s_nop 7
  buffer_store_dwordx4 v[20:23], v2, s[12:15], 0 offen offset:0
  buffer_store_dwordx4 v[24:27], v2, s[12:15], 0 offen offset:64
  buffer_store_dwordx4 v[28:31], v2, s[12:15], 0 offen offset:128
  buffer_store_dwordx4 v[32:35], v2, s[12:15], 0 offen offset:192
ka_done:
  s_endpgm
ka_kernel_fix_51:
  s_nop 15
  v_max3_f32 v248, v64, v65, v66
  v_max3_f32 v248, v248, v67, v68
  v_max3_f32 v248, v248, v69, v70
  v_max_f32 v248, v248, v71
  v_mov_b32 v250, v248
  s_nop 1
  v_permlane16_swap_b32 v248, v250
  v_max_f32 v248, v248, v250
  v_mov_b32 v250, v248
  s_nop 1
  v_permlane32_swap_b32 v248, v250
  v_max_f32 v248, v248, v250
  v_log_f32 v249, v128
  s_nop 0
  v_max3_f32 v248, 0, v248, v249
  v_sub_f32 v249, 0, v248
  v_exp_f32 v249, v249
  v_sub_f32 v64, v64, v248
  v_sub_f32 v80, v80, v248
  v_sub_f32 v65, v65, v248
  v_sub_f32 v81, v81, v248
  v_sub_f32 v66, v66, v248
  v_sub_f32 v82, v82, v248
  v_sub_f32 v67, v67, v248
  v_sub_f32 v83, v83, v248
  v_sub_f32 v68, v68, v248
  v_sub_f32 v84, v84, v248
  v_sub_f32 v69, v69, v248
  v_sub_f32 v85, v85, v248
  v_sub_f32 v70, v70, v248
  v_sub_f32 v86, v86, v248
  v_sub_f32 v71, v71, v248
  v_sub_f32 v87, v87, v248
  v_sub_f32 v112, v112, v248
  v_mul_f32 v128, v128, v249
  v_sub_f32 v113, v113, v248
  v_mul_f32 v129, v129, v249
  v_sub_f32 v114, v114, v248
  v_mul_f32 v130, v130, v249
  v_sub_f32 v115, v115, v248
  v_mul_f32 v131, v131, v249
  v_mul_f32 v0, v0, v249
  v_mul_f32 v1, v1, v249
  v_mul_f32 v2, v2, v249
  v_mul_f32 v3, v3, v249
  v_mul_f32 v8, v8, v249
  v_mul_f32 v9, v9, v249
  v_mul_f32 v10, v10, v249
  v_mul_f32 v11, v11, v249
  v_mul_f32 v16, v16, v249
  v_mul_f32 v17, v17, v249
  v_mul_f32 v18, v18, v249
  v_mul_f32 v19, v19, v249
  v_mul_f32 v24, v24, v249
  v_mul_f32 v25, v25, v249
  v_mul_f32 v26, v26, v249
  v_mul_f32 v27, v27, v249
  v_mul_f32 v32, v32, v249
  v_mul_f32 v33, v33, v249
  v_mul_f32 v34, v34, v249
  v_mul_f32 v35, v35, v249
  v_mul_f32 v40, v40, v249
  v_mul_f32 v41, v41, v249
  v_mul_f32 v42, v42, v249
  v_mul_f32 v43, v43, v249
  v_mul_f32 v48, v48, v249
  v_mul_f32 v49, v49, v249
  v_mul_f32 v50, v50, v249
  v_mul_f32 v51, v51, v249
  v_mul_f32 v56, v56, v249
  v_mul_f32 v57, v57, v249
  v_mul_f32 v58, v58, v249
  v_mul_f32 v59, v59, v249
  v_max3_f32 v248, v72, v73, v74
  v_max3_f32 v248, v248, v75, v76
  v_max3_f32 v248, v248, v77, v78
  v_max_f32 v248, v248, v79
  v_mov_b32 v250, v248
  s_nop 1
  v_permlane16_swap_b32 v248, v250
  v_max_f32 v248, v248, v250
  v_mov_b32 v250, v248
  s_nop 1
  v_permlane32_swap_b32 v248, v250
  v_max_f32 v248, v248, v250
  v_log_f32 v249, v132
  s_nop 0
  v_max3_f32 v248, 0, v248, v249
  v_sub_f32 v249, 0, v248
  v_exp_f32 v249, v249
  v_sub_f32 v72, v72, v248
  v_sub_f32 v88, v88, v248
  v_sub_f32 v73, v73, v248
  v_sub_f32 v89, v89, v248
  v_sub_f32 v74, v74, v248
  v_sub_f32 v90, v90, v248
  v_sub_f32 v75, v75, v248
  v_sub_f32 v91, v91, v248
  v_sub_f32 v76, v76, v248
  v_sub_f32 v92, v92, v248
  v_sub_f32 v77, v77, v248
  v_sub_f32 v93, v93, v248
  v_sub_f32 v78, v78, v248
  v_sub_f32 v94, v94, v248
  v_sub_f32 v79, v79, v248
  v_sub_f32 v95, v95, v248
  v_sub_f32 v116, v116, v248
  v_mul_f32 v132, v132, v249
  v_sub_f32 v117, v117, v248
  v_mul_f32 v133, v133, v249
  v_sub_f32 v118, v118, v248
  v_mul_f32 v134, v134, v249
  v_sub_f32 v119, v119, v248
  v_mul_f32 v135, v135, v249
  v_mul_f32 v4, v4, v249
  v_mul_f32 v5, v5, v249
  v_mul_f32 v6, v6, v249
  v_mul_f32 v7, v7, v249
  v_mul_f32 v12, v12, v249
  v_mul_f32 v13, v13, v249
  v_mul_f32 v14, v14, v249
  v_mul_f32 v15, v15, v249
  v_mul_f32 v20, v20, v249
  v_mul_f32 v21, v21, v249
  v_mul_f32 v22, v22, v249
  v_mul_f32 v23, v23, v249
  v_mul_f32 v28, v28, v249
  v_mul_f32 v29, v29, v249
  v_mul_f32 v30, v30, v249
  v_mul_f32 v31, v31, v249
  v_mul_f32 v36, v36, v249
  v_mul_f32 v37, v37, v249
  v_mul_f32 v38, v38, v249
  v_mul_f32 v39, v39, v249
  v_mul_f32 v44, v44, v249
  v_mul_f32 v45, v45, v249
  v_mul_f32 v46, v46, v249
  v_mul_f32 v47, v47, v249
  v_mul_f32 v52, v52, v249
  v_mul_f32 v53, v53, v249
  v_mul_f32 v54, v54, v249
  v_mul_f32 v55, v55, v249
  v_mul_f32 v60, v60, v249
  v_mul_f32 v61, v61, v249
  v_mul_f32 v62, v62, v249
  v_mul_f32 v63, v63, v249
  v_exp_f32 v232, v64
  v_exp_f32 v233, v65
  v_exp_f32 v234, v66
  v_cvt_pk_bf16_f32 v96, v232, v233
  v_exp_f32 v235, v67
  v_exp_f32 v236, v72
  v_cvt_pk_bf16_f32 v97, v234, v235
  v_exp_f32 v237, v73
  v_exp_f32 v238, v74
  v_cvt_pk_bf16_f32 v100, v236, v237
  v_exp_f32 v239, v75
  v_exp_f32 v232, v68
  v_cvt_pk_bf16_f32 v101, v238, v239
  v_exp_f32 v233, v69
  v_exp_f32 v234, v70
  v_cvt_pk_bf16_f32 v98, v232, v233
  v_exp_f32 v235, v71
  v_exp_f32 v236, v76
  v_cvt_pk_bf16_f32 v99, v234, v235
  v_exp_f32 v237, v77
  v_exp_f32 v238, v78
  v_cvt_pk_bf16_f32 v102, v236, v237
  v_exp_f32 v239, v79
  s_nop 0
  v_cvt_pk_bf16_f32 v103, v238, v239
  v_mfma_f32_16x16x32_bf16 v[120:123], v[240:243], v[96:99], v[128:131]
  s_nop 0
  v_mfma_f32_16x16x32_bf16 v[124:127], v[240:243], v[100:103], v[132:135]
  v_exp_f32 v232, v80
  v_exp_f32 v233, v81
  v_exp_f32 v234, v82
  v_cvt_pk_bf16_f32 v104, v232, v233
  v_exp_f32 v235, v83
  s_nop 7
  s_branch ka_kernel_ret_52
ka_kernel_fix_53:
  s_nop 15
  v_max3_f32 v248, v80, v81, v82
  v_max3_f32 v248, v248, v83, v84
  v_max3_f32 v248, v248, v85, v86
  v_max_f32 v248, v248, v87
  v_mov_b32 v250, v248
  s_nop 1
  v_permlane16_swap_b32 v248, v250
  v_max_f32 v248, v248, v250
  v_mov_b32 v250, v248
  s_nop 1
  v_permlane32_swap_b32 v248, v250
  v_max_f32 v248, v248, v250
  v_log_f32 v249, v120
  s_nop 0
  v_max3_f32 v248, 0, v248, v249
  v_sub_f32 v249, 0, v248
  v_exp_f32 v249, v249
  v_sub_f32 v80, v80, v248
  v_sub_f32 v64, v64, v248
  v_sub_f32 v81, v81, v248
  v_sub_f32 v65, v65, v248
  v_sub_f32 v82, v82, v248
  v_sub_f32 v66, v66, v248
  v_sub_f32 v83, v83, v248
  v_sub_f32 v67, v67, v248
  v_sub_f32 v84, v84, v248
  v_sub_f32 v68, v68, v248
  v_sub_f32 v85, v85, v248
  v_sub_f32 v69, v69, v248
  v_sub_f32 v86, v86, v248
  v_sub_f32 v70, v70, v248
  v_sub_f32 v87, v87, v248
  v_sub_f32 v71, v71, v248
  v_sub_f32 v112, v112, v248
  v_mul_f32 v120, v120, v249
  v_sub_f32 v113, v113, v248
  v_mul_f32 v121, v121, v249
  v_sub_f32 v114, v114, v248
  v_mul_f32 v122, v122, v249
  v_sub_f32 v115, v115, v248
  v_mul_f32 v123, v123, v249
  v_mul_f32 v0, v0, v249
  v_mul_f32 v1, v1, v249
  v_mul_f32 v2, v2, v249
  v_mul_f32 v3, v3, v249
  v_mul_f32 v8, v8, v249
  v_mul_f32 v9, v9, v249
  v_mul_f32 v10, v10, v249
  v_mul_f32 v11, v11, v249
  v_mul_f32 v16, v16, v249
  v_mul_f32 v17, v17, v249
  v_mul_f32 v18, v18, v249
  v_mul_f32 v19, v19, v249
  v_mul_f32 v24, v24, v249
  v_mul_f32 v25, v25, v249
  v_mul_f32 v26, v26, v249
  v_mul_f32 v27, v27, v249
  v_mul_f32 v32, v32, v249
  v_mul_f32 v33, v33, v249
  v_mul_f32 v34, v34, v249
  v_mul_f32 v35, v35, v249
  v_mul_f32 v40, v40, v249
  v_mul_f32 v41, v41, v249
  v_mul_f32 v42, v42, v249
  v_mul_f32 v43, v43, v249
  v_mul_f32 v48, v48, v249
  v_mul_f32 v49, v49, v249
  v_mul_f32 v50, v50, v249
  v_mul_f32 v51, v51, v249
  v_mul_f32 v56, v56, v249
  v_mul_f32 v57, v57, v249
  v_mul_f32 v58, v58, v249
  v_mul_f32 v59, v59, v249
  v_max3_f32 v248, v88, v89, v90
  v_max3_f32 v248, v248, v91, v92
  v_max3_f32 v248, v248, v93, v94
  v_max_f32 v248, v248, v95
  v_mov_b32 v250, v248
  s_nop 1
  v_permlane16_swap_b32 v248, v250
  v_max_f32 v248, v248, v250
  v_mov_b32 v250, v248
  s_nop 1
  v_permlane32_swap_b32 v248, v250
  v_max_f32 v248, v248, v250
  v_log_f32 v249, v124
  s_nop 0
  v_max3_f32 v248, 0, v248, v249
  v_sub_f32 v249, 0, v248
  v_exp_f32 v249, v249
  v_sub_f32 v88, v88, v248
  v_sub_f32 v72, v72, v248
  v_sub_f32 v89, v89, v248
  v_sub_f32 v73, v73, v248
  v_sub_f32 v90, v90, v248
  v_sub_f32 v74, v74, v248
  v_sub_f32 v91, v91, v248
  v_sub_f32 v75, v75, v248
  v_sub_f32 v92, v92, v248
  v_sub_f32 v76, v76, v248
  v_sub_f32 v93, v93, v248
  v_sub_f32 v77, v77, v248
  v_sub_f32 v94, v94, v248
  v_sub_f32 v78, v78, v248
  v_sub_f32 v95, v95, v248
  v_sub_f32 v79, v79, v248
  v_sub_f32 v116, v116, v248
  v_mul_f32 v124, v124, v249
  v_sub_f32 v117, v117, v248
  v_mul_f32 v125, v125, v249
  v_sub_f32 v118, v118, v248
  v_mul_f32 v126, v126, v249
  v_sub_f32 v119, v119, v248
  v_mul_f32 v127, v127, v249
  v_mul_f32 v4, v4, v249
  v_mul_f32 v5, v5, v249
  v_mul_f32 v6, v6, v249
  v_mul_f32 v7, v7, v249
  v_mul_f32 v12, v12, v249
  v_mul_f32 v13, v13, v249
  v_mul_f32 v14, v14, v249
  v_mul_f32 v15, v15, v249
  v_mul_f32 v20, v20, v249
  v_mul_f32 v21, v21, v249
  v_mul_f32 v22, v22, v249
  v_mul_f32 v23, v23, v249
  v_mul_f32 v28, v28, v249
  v_mul_f32 v29, v29, v249
  v_mul_f32 v30, v30, v249
  v_mul_f32 v31, v31, v249
  v_mul_f32 v36, v36, v249
  v_mul_f32 v37, v37, v249
  v_mul_f32 v38, v38, v249
  v_mul_f32 v39, v39, v249
  v_mul_f32 v44, v44, v249
  v_mul_f32 v45, v45, v249
  v_mul_f32 v46, v46, v249
  v_mul_f32 v47, v47, v249
  v_mul_f32 v52, v52, v249
  v_mul_f32 v53, v53, v249
  v_mul_f32 v54, v54, v249
  v_mul_f32 v55, v55, v249
  v_mul_f32 v60, v60, v249
  v_mul_f32 v61, v61, v249
  v_mul_f32 v62, v62, v249
  v_mul_f32 v63, v63, v249
  v_exp_f32 v232, v80
  v_exp_f32 v233, v81
  v_exp_f32 v234, v82
  v_cvt_pk_bf16_f32 v104, v232, v233
  v_exp_f32 v235, v83
  v_exp_f32 v236, v88
  v_cvt_pk_bf16_f32 v105, v234, v235
  v_exp_f32 v237, v89
  v_exp_f32 v238, v90
  v_cvt_pk_bf16_f32 v108, v236, v237
  v_exp_f32 v239, v91
  v_exp_f32 v232, v84
  v_cvt_pk_bf16_f32 v109, v238, v239
  v_exp_f32 v233, v85
  v_exp_f32 v234, v86
  v_cvt_pk_bf16_f32 v106, v232, v233
  v_exp_f32 v235, v87
  v_exp_f32 v236, v92
  v_cvt_pk_bf16_f32 v107, v234, v235
  v_exp_f32 v237, v93
  v_exp_f32 v238, v94
  v_cvt_pk_bf16_f32 v110, v236, v237
  v_exp_f32 v239, v95
  s_nop 0
  v_cvt_pk_bf16_f32 v111, v238, v239
  v_mfma_f32_16x16x32_bf16 v[128:131], v[240:243], v[104:107], v[120:123]
  s_nop 0
  v_mfma_f32_16x16x32_bf16 v[132:135], v[240:243], v[108:111], v[124:127]
  v_exp_f32 v232, v64
  v_exp_f32 v233, v65
  v_exp_f32 v234, v66
  v_cvt_pk_bf16_f32 v96, v232, v233
  v_exp_f32 v235, v67
  s_nop 7
  s_branch ka_kernel_ret_54
ka_kernel_fix_55:
  s_nop 15
  v_max3_f32 v248, v64, v65, v66
  v_max3_f32 v248, v248, v67, v68
  v_max3_f32 v248, v248, v69, v70
  v_max_f32 v248, v248, v71
  v_mov_b32 v250, v248
  s_nop 1
  v_permlane16_swap_b32 v248, v250
  v_max_f32 v248, v248, v250
  v_mov_b32 v250, v248
  s_nop 1
  v_permlane32_swap_b32 v248, v250
  v_max_f32 v248, v248, v250
  v_log_f32 v249, v128
  s_nop 0
  v_max3_f32 v248, 0, v248, v249
  v_sub_f32 v249, 0, v248
  v_exp_f32 v249, v249
  v_sub_f32 v64, v64, v248
  v_sub_f32 v80, v80, v248
  v_sub_f32 v65, v65, v248
  v_sub_f32 v81, v81, v248
  v_sub_f32 v66, v66, v248
  v_sub_f32 v82, v82, v248
  v_sub_f32 v67, v67, v248
  v_sub_f32 v83, v83, v248
  v_sub_f32 v68, v68, v248
  v_sub_f32 v84, v84, v248
  v_sub_f32 v69, v69, v248
  v_sub_f32 v85, v85, v248
  v_sub_f32 v70, v70, v248
  v_sub_f32 v86, v86, v248
  v_sub_f32 v71, v71, v248
  v_sub_f32 v87, v87, v248
  v_sub_f32 v112, v112, v248
  v_mul_f32 v128, v128, v249
  v_sub_f32 v113, v113, v248
  v_mul_f32 v129, v129, v249
  v_sub_f32 v114, v114, v248
  v_mul_f32 v130, v130, v249
  v_sub_f32 v115, v115, v248
  v_mul_f32 v131, v131, v249
  v_mul_f32 v0, v0, v249
  v_mul_f32 v1, v1, v249
  v_mul_f32 v2, v2, v249
  v_mul_f32 v3, v3, v249
  v_mul_f32 v8, v8, v249
  v_mul_f32 v9, v9, v249
  v_mul_f32 v10, v10, v249
  v_mul_f32 v11, v11, v249
  v_mul_f32 v16, v16, v249
  v_mul_f32 v17, v17, v249
  v_mul_f32 v18, v18, v249
  v_mul_f32 v19, v19, v249
  v_mul_f32 v24, v24, v249
  v_mul_f32 v25, v25, v249
  v_mul_f32 v26, v26, v249
  v_mul_f32 v27, v27, v249
  v_mul_f32 v32, v32, v249
  v_mul_f32 v33, v33, v249
  v_mul_f32 v34, v34, v249
  v_mul_f32 v35, v35, v249
  v_mul_f32 v40, v40, v249
  v_mul_f32 v41, v41, v249
  v_mul_f32 v42, v42, v249
  v_mul_f32 v43, v43, v249
  v_mul_f32 v48, v48, v249
  v_mul_f32 v49, v49, v249
  v_mul_f32 v50, v50, v249
  v_mul_f32 v51, v51, v249
  v_mul_f32 v56, v56, v249
  v_mul_f32 v57, v57, v249
  v_mul_f32 v58, v58, v249
  v_mul_f32 v59, v59, v249
  v_max3_f32 v248, v72, v73, v74
  v_max3_f32 v248, v248, v75, v76
  v_max3_f32 v248, v248, v77, v78
  v_max_f32 v248, v248, v79
  v_mov_b32 v250, v248
  s_nop 1
  v_permlane16_swap_b32 v248, v250
  v_max_f32 v248, v248, v250
  v_mov_b32 v250, v248
  s_nop 1
  v_permlane32_swap_b32 v248, v250
  v_max_f32 v248, v248, v250
  v_log_f32 v249, v132
  s_nop 0
  v_max3_f32 v248, 0, v248, v249
  v_sub_f32 v249, 0, v248
  v_exp_f32 v249, v249
  v_sub_f32 v72, v72, v248
  v_sub_f32 v88, v88, v248
  v_sub_f32 v73, v73, v248
  v_sub_f32 v89, v89, v248
  v_sub_f32 v74, v74, v248
  v_sub_f32 v90, v90, v248
  v_sub_f32 v75, v75, v248
  v_sub_f32 v91, v91, v248
  v_sub_f32 v76, v76, v248
  v_sub_f32 v92, v92, v248
  v_sub_f32 v77, v77, v248
  v_sub_f32 v93, v93, v248
  v_sub_f32 v78, v78, v248
  v_sub_f32 v94, v94, v248
  v_sub_f32 v79, v79, v248
  v_sub_f32 v95, v95, v248
  v_sub_f32 v116, v116, v248
  v_mul_f32 v132, v132, v249
  v_sub_f32 v117, v117, v248
  v_mul_f32 v133, v133, v249
  v_sub_f32 v118, v118, v248
  v_mul_f32 v134, v134, v249
  v_sub_f32 v119, v119, v248
  v_mul_f32 v135, v135, v249
  v_mul_f32 v4, v4, v249
  v_mul_f32 v5, v5, v249
  v_mul_f32 v6, v6, v249
  v_mul_f32 v7, v7, v249
  v_mul_f32 v12, v12, v249
  v_mul_f32 v13, v13, v249
  v_mul_f32 v14, v14, v249
  v_mul_f32 v15, v15, v249
  v_mul_f32 v20, v20, v249
  v_mul_f32 v21, v21, v249
  v_mul_f32 v22, v22, v249
  v_mul_f32 v23, v23, v249
  v_mul_f32 v28, v28, v249
  v_mul_f32 v29, v29, v249
  v_mul_f32 v30, v30, v249
  v_mul_f32 v31, v31, v249
  v_mul_f32 v36, v36, v249
  v_mul_f32 v37, v37, v249
  v_mul_f32 v38, v38, v249
  v_mul_f32 v39, v39, v249
  v_mul_f32 v44, v44, v249
  v_mul_f32 v45, v45, v249
  v_mul_f32 v46, v46, v249
  v_mul_f32 v47, v47, v249
  v_mul_f32 v52, v52, v249
  v_mul_f32 v53, v53, v249
  v_mul_f32 v54, v54, v249
  v_mul_f32 v55, v55, v249
  v_mul_f32 v60, v60, v249
  v_mul_f32 v61, v61, v249
  v_mul_f32 v62, v62, v249
  v_mul_f32 v63, v63, v249
  v_exp_f32 v232, v64
  v_exp_f32 v233, v65
  v_exp_f32 v234, v66
  v_cvt_pk_bf16_f32 v96, v232, v233
  v_exp_f32 v235, v67
  v_exp_f32 v236, v72
  v_cvt_pk_bf16_f32 v97, v234, v235
  v_exp_f32 v237, v73
  v_exp_f32 v238, v74
  v_cvt_pk_bf16_f32 v100, v236, v237
  v_exp_f32 v239, v75
  v_exp_f32 v232, v68
  v_cvt_pk_bf16_f32 v101, v238, v239
  v_exp_f32 v233, v69
  v_exp_f32 v234, v70
  v_cvt_pk_bf16_f32 v98, v232, v233
  v_exp_f32 v235, v71
  v_exp_f32 v236, v76
  v_cvt_pk_bf16_f32 v99, v234, v235
  v_exp_f32 v237, v77
  v_exp_f32 v238, v78
  v_cvt_pk_bf16_f32 v102, v236, v237
  v_exp_f32 v239, v79
  s_nop 0
  v_cvt_pk_bf16_f32 v103, v238, v239
  v_mfma_f32_16x16x32_bf16 v[120:123], v[240:243], v[96:99], v[128:131]
  s_nop 0
  v_mfma_f32_16x16x32_bf16 v[124:127], v[240:243], v[100:103], v[132:135]
  v_exp_f32 v232, v80
  v_exp_f32 v233, v81
  v_exp_f32 v234, v82
  v_cvt_pk_bf16_f32 v104, v232, v233
  v_exp_f32 v235, v83
  s_nop 7
  s_branch ka_kernel_ret_56
ka_kernel_fix_57:
  s_nop 15
  v_max3_f32 v248, v80, v81, v82
  v_max3_f32 v248, v248, v83, v84
  v_max3_f32 v248, v248, v85, v86
  v_max_f32 v248, v248, v87
  v_mov_b32 v250, v248
  s_nop 1
  v_permlane16_swap_b32 v248, v250
  v_max_f32 v248, v248, v250
  v_mov_b32 v250, v248
  s_nop 1
  v_permlane32_swap_b32 v248, v250
  v_max_f32 v248, v248, v250
  v_log_f32 v249, v120
  s_nop 0
  v_max3_f32 v248, 0, v248, v249
  v_sub_f32 v249, 0, v248
  v_exp_f32 v249, v249
  v_sub_f32 v80, v80, v248
  v_sub_f32 v64, v64, v248
  v_sub_f32 v81, v81, v248
  v_sub_f32 v65, v65, v248
  v_sub_f32 v82, v82, v248
  v_sub_f32 v66, v66, v248
  v_sub_f32 v83, v83, v248
  v_sub_f32 v67, v67, v248
  v_sub_f32 v84, v84, v248
  v_sub_f32 v68, v68, v248
  v_sub_f32 v85, v85, v248
  v_sub_f32 v69, v69, v248
  v_sub_f32 v86, v86, v248
  v_sub_f32 v70, v70, v248
  v_sub_f32 v87, v87, v248
  v_sub_f32 v71, v71, v248
  v_sub_f32 v112, v112, v248
  v_mul_f32 v120, v120, v249
  v_sub_f32 v113, v113, v248
  v_mul_f32 v121, v121, v249
  v_sub_f32 v114, v114, v248
  v_mul_f32 v122, v122, v249
  v_sub_f32 v115, v115, v248
  v_mul_f32 v123, v123, v249
  v_mul_f32 v0, v0, v249
  v_mul_f32 v1, v1, v249
  v_mul_f32 v2, v2, v249
  v_mul_f32 v3, v3, v249
  v_mul_f32 v8, v8, v249
  v_mul_f32 v9, v9, v249
  v_mul_f32 v10, v10, v249
  v_mul_f32 v11, v11, v249
  v_mul_f32 v16, v16, v249
  v_mul_f32 v17, v17, v249
  v_mul_f32 v18, v18, v249
  v_mul_f32 v19, v19, v249
  v_mul_f32 v24, v24, v249
  v_mul_f32 v25, v25, v249
  v_mul_f32 v26, v26, v249
  v_mul_f32 v27, v27, v249
  v_mul_f32 v32, v32, v249
  v_mul_f32 v33, v33, v249
  v_mul_f32 v34, v34, v249
  v_mul_f32 v35, v35, v249
  v_mul_f32 v40, v40, v249
  v_mul_f32 v41, v41, v249
  v_mul_f32 v42, v42, v249
  v_mul_f32 v43, v43, v249
  v_mul_f32 v48, v48, v249
  v_mul_f32 v49, v49, v249
  v_mul_f32 v50, v50, v249
  v_mul_f32 v51, v51, v249
  v_mul_f32 v56, v56, v249
  v_mul_f32 v57, v57, v249
  v_mul_f32 v58, v58, v249
  v_mul_f32 v59, v59, v249
  v_max3_f32 v248, v88, v89, v90
  v_max3_f32 v248, v248, v91, v92
  v_max3_f32 v248, v248, v93, v94
  v_max_f32 v248, v248, v95
  v_mov_b32 v250, v248
  s_nop 1
  v_permlane16_swap_b32 v248, v250
  v_max_f32 v248, v248, v250
  v_mov_b32 v250, v248
  s_nop 1
  v_permlane32_swap_b32 v248, v250
  v_max_f32 v248, v248, v250
  v_log_f32 v249, v124
  s_nop 0
  v_max3_f32 v248, 0, v248, v249
  v_sub_f32 v249, 0, v248
  v_exp_f32 v249, v249
  v_sub_f32 v88, v88, v248
  v_sub_f32 v72, v72, v248
  v_sub_f32 v89, v89, v248
  v_sub_f32 v73, v73, v248
  v_sub_f32 v90, v90, v248
  v_sub_f32 v74, v74, v248
  v_sub_f32 v91, v91, v248
  v_sub_f32 v75, v75, v248
  v_sub_f32 v92, v92, v248
  v_sub_f32 v76, v76, v248
  v_sub_f32 v93, v93, v248
  v_sub_f32 v77, v77, v248
  v_sub_f32 v94, v94, v248
  v_sub_f32 v78, v78, v248
  v_sub_f32 v95, v95, v248
  v_sub_f32 v79, v79, v248
  v_sub_f32 v116, v116, v248
  v_mul_f32 v124, v124, v249
  v_sub_f32 v117, v117, v248
  v_mul_f32 v125, v125, v249
  v_sub_f32 v118, v118, v248
  v_mul_f32 v126, v126, v249
  v_sub_f32 v119, v119, v248
  v_mul_f32 v127, v127, v249
  v_mul_f32 v4, v4, v249
  v_mul_f32 v5, v5, v249
  v_mul_f32 v6, v6, v249
  v_mul_f32 v7, v7, v249
  v_mul_f32 v12, v12, v249
  v_mul_f32 v13, v13, v249
  v_mul_f32 v14, v14, v249
  v_mul_f32 v15, v15, v249
  v_mul_f32 v20, v20, v249
  v_mul_f32 v21, v21, v249
  v_mul_f32 v22, v22, v249
  v_mul_f32 v23, v23, v249
  v_mul_f32 v28, v28, v249
  v_mul_f32 v29, v29, v249
  v_mul_f32 v30, v30, v249
  v_mul_f32 v31, v31, v249
  v_mul_f32 v36, v36, v249
  v_mul_f32 v37, v37, v249
  v_mul_f32 v38, v38, v249
  v_mul_f32 v39, v39, v249
  v_mul_f32 v44, v44, v249
  v_mul_f32 v45, v45, v249
  v_mul_f32 v46, v46, v249
  v_mul_f32 v47, v47, v249
  v_mul_f32 v52, v52, v249
  v_mul_f32 v53, v53, v249
  v_mul_f32 v54, v54, v249
  v_mul_f32 v55, v55, v249
  v_mul_f32 v60, v60, v249
  v_mul_f32 v61, v61, v249
  v_mul_f32 v62, v62, v249
  v_mul_f32 v63, v63, v249
  v_exp_f32 v232, v80
  v_exp_f32 v233, v81
  v_exp_f32 v234, v82
  v_cvt_pk_bf16_f32 v104, v232, v233
  v_exp_f32 v235, v83
  v_exp_f32 v236, v88
  v_cvt_pk_bf16_f32 v105, v234, v235
  v_exp_f32 v237, v89
  v_exp_f32 v238, v90
  v_cvt_pk_bf16_f32 v108, v236, v237
  v_exp_f32 v239, v91
  v_exp_f32 v232, v84
  v_cvt_pk_bf16_f32 v109, v238, v239
  v_exp_f32 v233, v85
  v_exp_f32 v234, v86
  v_cvt_pk_bf16_f32 v106, v232, v233
  v_exp_f32 v235, v87
  v_exp_f32 v236, v92
  v_cvt_pk_bf16_f32 v107, v234, v235
  v_exp_f32 v237, v93
  v_exp_f32 v238, v94
  v_cvt_pk_bf16_f32 v110, v236, v237
  v_exp_f32 v239, v95
  s_nop 0
  v_cvt_pk_bf16_f32 v111, v238, v239
  v_mfma_f32_16x16x32_bf16 v[128:131], v[240:243], v[104:107], v[120:123]
  s_nop 0
  v_mfma_f32_16x16x32_bf16 v[132:135], v[240:243], v[108:111], v[124:127]
  s_nop 7
  s_branch ka_kernel_ret_58
ka_kernel_fix_59:
  s_nop 15
  v_max3_f32 v248, v80, v81, v82
  v_max3_f32 v248, v248, v83, v84
  v_max3_f32 v248, v248, v85, v86
  v_max_f32 v248, v248, v87
  v_mov_b32 v250, v248
  s_nop 1
  v_permlane16_swap_b32 v248, v250
  v_max_f32 v248, v248, v250
  v_mov_b32 v250, v248
  s_nop 1
  v_permlane32_swap_b32 v248, v250
  v_max_f32 v248, v248, v250
  v_log_f32 v249, v120
  s_nop 0
  v_max3_f32 v248, 0, v248, v249
  v_sub_f32 v249, 0, v248
  v_exp_f32 v249, v249
  v_sub_f32 v80, v80, v248
  v_sub_f32 v64, v64, v248
  v_sub_f32 v81, v81, v248
  v_sub_f32 v65, v65, v248
  v_sub_f32 v82, v82, v248
  v_sub_f32 v66, v66, v248
  v_sub_f32 v83, v83, v248
  v_sub_f32 v67, v67, v248
  v_sub_f32 v84, v84, v248
  v_sub_f32 v68, v68, v248
  v_sub_f32 v85, v85, v248
  v_sub_f32 v69, v69, v248
  v_sub_f32 v86, v86, v248
  v_sub_f32 v70, v70, v248
  v_sub_f32 v87, v87, v248
  v_sub_f32 v71, v71, v248
  v_sub_f32 v112, v112, v248
  v_mul_f32 v120, v120, v249
  v_sub_f32 v113, v113, v248
  v_mul_f32 v121, v121, v249
  v_sub_f32 v114, v114, v248
  v_mul_f32 v122, v122, v249
  v_sub_f32 v115, v115, v248
  v_mul_f32 v123, v123, v249
  v_mul_f32 v0, v0, v249
  v_mul_f32 v1, v1, v249
  v_mul_f32 v2, v2, v249
  v_mul_f32 v3, v3, v249
  v_mul_f32 v8, v8, v249
  v_mul_f32 v9, v9, v249
  v_mul_f32 v10, v10, v249
  v_mul_f32 v11, v11, v249
  v_mul_f32 v16, v16, v249
  v_mul_f32 v17, v17, v249
  v_mul_f32 v18, v18, v249
  v_mul_f32 v19, v19, v249
  v_mul_f32 v24, v24, v249
  v_mul_f32 v25, v25, v249
  v_mul_f32 v26, v26, v249
  v_mul_f32 v27, v27, v249
  v_mul_f32 v32, v32, v249
  v_mul_f32 v33, v33, v249
  v_mul_f32 v34, v34, v249
  v_mul_f32 v35, v35, v249
  v_mul_f32 v40, v40, v249
  v_mul_f32 v41, v41, v249
  v_mul_f32 v42, v42, v249
  v_mul_f32 v43, v43, v249
  v_mul_f32 v48, v48, v249
  v_mul_f32 v49, v49, v249
  v_mul_f32 v50, v50, v249
  v_mul_f32 v51, v51, v249
  v_mul_f32 v56, v56, v249
  v_mul_f32 v57, v57, v249
  v_mul_f32 v58, v58, v249
  v_mul_f32 v59, v59, v249
  v_max3_f32 v248, v88, v89, v90
  v_max3_f32 v248, v248, v91, v92
  v_max3_f32 v248, v248, v93, v94
  v_max_f32 v248, v248, v95
  v_mov_b32 v250, v248
  s_nop 1
  v_permlane16_swap_b32 v248, v250
  v_max_f32 v248, v248, v250
  v_mov_b32 v250, v248
  s_nop 1
  v_permlane32_swap_b32 v248, v250
  v_max_f32 v248, v248, v250
  v_log_f32 v249, v124
  s_nop 0
  v_max3_f32 v248, 0, v248, v249
  v_sub_f32 v249, 0, v248
  v_exp_f32 v249, v249
  v_sub_f32 v88, v88, v248
  v_sub_f32 v72, v72, v248
  v_sub_f32 v89, v89, v248
  v_sub_f32 v73, v73, v248
  v_sub_f32 v90, v90, v248
  v_sub_f32 v74, v74, v248
  v_sub_f32 v91, v91, v248
  v_sub_f32 v75, v75, v248
  v_sub_f32 v92, v92, v248
  v_sub_f32 v76, v76, v248
  v_sub_f32 v93, v93, v248
  v_sub_f32 v77, v77, v248
  v_sub_f32 v94, v94, v248
  v_sub_f32 v78, v78, v248
  v_sub_f32 v95, v95, v248
  v_sub_f32 v79, v79, v248
  v_sub_f32 v116, v116, v248
  v_mul_f32 v124, v124, v249
  v_sub_f32 v117, v117, v248
  v_mul_f32 v125, v125, v249
  v_sub_f32 v118, v118, v248
  v_mul_f32 v126, v126, v249
  v_sub_f32 v119, v119, v248
  v_mul_f32 v127, v127, v249
  v_mul_f32 v4, v4, v249
  v_mul_f32 v5, v5, v249
  v_mul_f32 v6, v6, v249
  v_mul_f32 v7, v7, v249
  v_mul_f32 v12, v12, v249
  v_mul_f32 v13, v13, v249
  v_mul_f32 v14, v14, v249
  v_mul_f32 v15, v15, v249
  v_mul_f32 v20, v20, v249
  v_mul_f32 v21, v21, v249
  v_mul_f32 v22, v22, v249
  v_mul_f32 v23, v23, v249
  v_mul_f32 v28, v28, v249
  v_mul_f32 v29, v29, v249
  v_mul_f32 v30, v30, v249
  v_mul_f32 v31, v31, v249
  v_mul_f32 v36, v36, v249
  v_mul_f32 v37, v37, v249
  v_mul_f32 v38, v38, v249
  v_mul_f32 v39, v39, v249
  v_mul_f32 v44, v44, v249
  v_mul_f32 v45, v45, v249
  v_mul_f32 v46, v46, v249
  v_mul_f32 v47, v47, v249
  v_mul_f32 v52, v52, v249
  v_mul_f32 v53, v53, v249
  v_mul_f32 v54, v54, v249
  v_mul_f32 v55, v55, v249
  v_mul_f32 v60, v60, v249
  v_mul_f32 v61, v61, v249
  v_mul_f32 v62, v62, v249
  v_mul_f32 v63, v63, v249
  v_exp_f32 v232, v80
  v_exp_f32 v233, v81
  v_exp_f32 v234, v82
  v_cvt_pk_bf16_f32 v104, v232, v233
  v_exp_f32 v235, v83
  v_exp_f32 v236, v88
  v_cvt_pk_bf16_f32 v105, v234, v235
  v_exp_f32 v237, v89
  v_exp_f32 v238, v90
  v_cvt_pk_bf16_f32 v108, v236, v237
  v_exp_f32 v239, v91
  v_exp_f32 v232, v84
  v_cvt_pk_bf16_f32 v109, v238, v239
  v_exp_f32 v233, v85
  v_exp_f32 v234, v86
  v_cvt_pk_bf16_f32 v106, v232, v233
  v_exp_f32 v235, v87
  v_exp_f32 v236, v92
  v_cvt_pk_bf16_f32 v107, v234, v235
  v_exp_f32 v237, v93
  v_exp_f32 v238, v94
  v_cvt_pk_bf16_f32 v110, v236, v237
  v_exp_f32 v239, v95
  s_nop 0
  v_cvt_pk_bf16_f32 v111, v238, v239
  v_mfma_f32_16x16x32_bf16 v[128:131], v[240:243], v[104:107], v[120:123]
  s_nop 0
  v_mfma_f32_16x16x32_bf16 v[132:135], v[240:243], v[108:111], v[124:127]
  v_exp_f32 v232, v64
  v_exp_f32 v233, v65
  v_exp_f32 v234, v66
  v_cvt_pk_bf16_f32 v96, v232, v233
  v_exp_f32 v235, v67
  s_nop 7
  s_branch ka_kernel_ret_60
ka_kernel_fix_61:
  s_nop 15
  v_max3_f32 v248, v64, v65, v66
  v_max3_f32 v248, v248, v67, v68
  v_max3_f32 v248, v248, v69, v70
  v_max_f32 v248, v248, v71
  v_mov_b32 v250, v248
  s_nop 1
  v_permlane16_swap_b32 v248, v250
  v_max_f32 v248, v248, v250
  v_mov_b32 v250, v248
  s_nop 1
  v_permlane32_swap_b32 v248, v250
  v_max_f32 v248, v248, v250
  v_log_f32 v249, v128
  s_nop 0
  v_max3_f32 v248, 0, v248, v249
  v_sub_f32 v249, 0, v248
  v_exp_f32 v249, v249
  v_sub_f32 v64, v64, v248
  v_sub_f32 v80, v80, v248
  v_sub_f32 v65, v65, v248
  v_sub_f32 v81, v81, v248
  v_sub_f32 v66, v66, v248
  v_sub_f32 v82, v82, v248
  v_sub_f32 v67, v67, v248
  v_sub_f32 v83, v83, v248
  v_sub_f32 v68, v68, v248
  v_sub_f32 v84, v84, v248
  v_sub_f32 v69, v69, v248
  v_sub_f32 v85, v85, v248
  v_sub_f32 v70, v70, v248
  v_sub_f32 v86, v86, v248
  v_sub_f32 v71, v71, v248
  v_sub_f32 v87, v87, v248
  v_sub_f32 v112, v112, v248
  v_mul_f32 v128, v128, v249
  v_sub_f32 v113, v113, v248
  v_mul_f32 v129, v129, v249
  v_sub_f32 v114, v114, v248
  v_mul_f32 v130, v130, v249
  v_sub_f32 v115, v115, v248
  v_mul_f32 v131, v131, v249
  v_mul_f32 v0, v0, v249
  v_mul_f32 v1, v1, v249
  v_mul_f32 v2, v2, v249
  v_mul_f32 v3, v3, v249
  v_mul_f32 v8, v8, v249
  v_mul_f32 v9, v9, v249
  v_mul_f32 v10, v10, v249
  v_mul_f32 v11, v11, v249
  v_mul_f32 v16, v16, v249
  v_mul_f32 v17, v17, v249
  v_mul_f32 v18, v18, v249
  v_mul_f32 v19, v19, v249
  v_mul_f32 v24, v24, v249
  v_mul_f32 v25, v25, v249
  v_mul_f32 v26, v26, v249
  v_mul_f32 v27, v27, v249
  v_mul_f32 v32, v32, v249
  v_mul_f32 v33, v33, v249
  v_mul_f32 v34, v34, v249
  v_mul_f32 v35, v35, v249
  v_mul_f32 v40, v40, v249
  v_mul_f32 v41, v41, v249
  v_mul_f32 v42, v42, v249
  v_mul_f32 v43, v43, v249
  v_mul_f32 v48, v48, v249
  v_mul_f32 v49, v49, v249
  v_mul_f32 v50, v50, v249
  v_mul_f32 v51, v51, v249
  v_mul_f32 v56, v56, v249
  v_mul_f32 v57, v57, v249
  v_mul_f32 v58, v58, v249
  v_mul_f32 v59, v59, v249
  v_max3_f32 v248, v72, v73, v74
  v_max3_f32 v248, v248, v75, v76
  v_max3_f32 v248, v248, v77, v78
  v_max_f32 v248, v248, v79
  v_mov_b32 v250, v248
  s_nop 1
  v_permlane16_swap_b32 v248, v250
  v_max_f32 v248, v248, v250
  v_mov_b32 v250, v248
  s_nop 1
  v_permlane32_swap_b32 v248, v250
  v_max_f32 v248, v248, v250
  v_log_f32 v249, v132
  s_nop 0
  v_max3_f32 v248, 0, v248, v249
  v_sub_f32 v249, 0, v248
  v_exp_f32 v249, v249
  v_sub_f32 v72, v72, v248
  v_sub_f32 v88, v88, v248
  v_sub_f32 v73, v73, v248
  v_sub_f32 v89, v89, v248
  v_sub_f32 v74, v74, v248
  v_sub_f32 v90, v90, v248
  v_sub_f32 v75, v75, v248
  v_sub_f32 v91, v91, v248
  v_sub_f32 v76, v76, v248
  v_sub_f32 v92, v92, v248
  v_sub_f32 v77, v77, v248
  v_sub_f32 v93, v93, v248
  v_sub_f32 v78, v78, v248
  v_sub_f32 v94, v94, v248
  v_sub_f32 v79, v79, v248
  v_sub_f32 v95, v95, v248
  v_sub_f32 v116, v116, v248
  v_mul_f32 v132, v132, v249
  v_sub_f32 v117, v117, v248
  v_mul_f32 v133, v133, v249
  v_sub_f32 v118, v118, v248
  v_mul_f32 v134, v134, v249
  v_sub_f32 v119, v119, v248
  v_mul_f32 v135, v135, v249
  v_mul_f32 v4, v4, v249
  v_mul_f32 v5, v5, v249
  v_mul_f32 v6, v6, v249
  v_mul_f32 v7, v7, v249
  v_mul_f32 v12, v12, v249
  v_mul_f32 v13, v13, v249
  v_mul_f32 v14, v14, v249
  v_mul_f32 v15, v15, v249
  v_mul_f32 v20, v20, v249
  v_mul_f32 v21, v21, v249
  v_mul_f32 v22, v22, v249
  v_mul_f32 v23, v23, v249
  v_mul_f32 v28, v28, v249
  v_mul_f32 v29, v29, v249
  v_mul_f32 v30, v30, v249
  v_mul_f32 v31, v31, v249
  v_mul_f32 v36, v36, v249
  v_mul_f32 v37, v37, v249
  v_mul_f32 v38, v38, v249
  v_mul_f32 v39, v39, v249
  v_mul_f32 v44, v44, v249
  v_mul_f32 v45, v45, v249
  v_mul_f32 v46, v46, v249
  v_mul_f32 v47, v47, v249
  v_mul_f32 v52, v52, v249
  v_mul_f32 v53, v53, v249
  v_mul_f32 v54, v54, v249
  v_mul_f32 v55, v55, v249
  v_mul_f32 v60, v60, v249
  v_mul_f32 v61, v61, v249
  v_mul_f32 v62, v62, v249
  v_mul_f32 v63, v63, v249
  v_exp_f32 v232, v64
  v_exp_f32 v233, v65
  v_exp_f32 v234, v66
  v_cvt_pk_bf16_f32 v96, v232, v233
  v_exp_f32 v235, v67
  v_exp_f32 v236, v72
  v_cvt_pk_bf16_f32 v97, v234, v235
  v_exp_f32 v237, v73
  v_exp_f32 v238, v74
  v_cvt_pk_bf16_f32 v100, v236, v237
  v_exp_f32 v239, v75
  v_exp_f32 v232, v68
  v_cvt_pk_bf16_f32 v101, v238, v239
  v_exp_f32 v233, v69
  v_exp_f32 v234, v70
  v_cvt_pk_bf16_f32 v98, v232, v233
  v_exp_f32 v235, v71
  v_exp_f32 v236, v76
  v_cvt_pk_bf16_f32 v99, v234, v235
  v_exp_f32 v237, v77
  v_exp_f32 v238, v78
  v_cvt_pk_bf16_f32 v102, v236, v237
  v_exp_f32 v239, v79
  s_nop 0
  v_cvt_pk_bf16_f32 v103, v238, v239
  v_mfma_f32_16x16x32_bf16 v[120:123], v[240:243], v[96:99], v[128:131]
  s_nop 0
  v_mfma_f32_16x16x32_bf16 v[124:127], v[240:243], v[100:103], v[132:135]
  s_nop 7
  s_branch ka_kernel_ret_62
ka_kernel_fix_63:
  s_nop 15
  v_max3_f32 v248, v64, v65, v66
  v_max3_f32 v248, v248, v67, v68
  v_max3_f32 v248, v248, v69, v70
  v_max_f32 v248, v248, v71
  v_mov_b32 v250, v248
  s_nop 1
  v_permlane16_swap_b32 v248, v250
  v_max_f32 v248, v248, v250
  v_mov_b32 v250, v248
  s_nop 1
  v_permlane32_swap_b32 v248, v250
  v_max_f32 v248, v248, v250
  v_log_f32 v249, v128
  s_nop 0
  v_max3_f32 v248, 0, v248, v249
  v_sub_f32 v249, 0, v248
  v_exp_f32 v249, v249
  v_sub_f32 v64, v64, v248
  v_sub_f32 v80, v80, v248
  v_sub_f32 v65, v65, v248
  v_sub_f32 v81, v81, v248
  v_sub_f32 v66, v66, v248
  v_sub_f32 v82, v82, v248
  v_sub_f32 v67, v67, v248
  v_sub_f32 v83, v83, v248
  v_sub_f32 v68, v68, v248
  v_sub_f32 v84, v84, v248
  v_sub_f32 v69, v69, v248
  v_sub_f32 v85, v85, v248
  v_sub_f32 v70, v70, v248
  v_sub_f32 v86, v86, v248
  v_sub_f32 v71, v71, v248
  v_sub_f32 v87, v87, v248
  v_sub_f32 v112, v112, v248
  v_mul_f32 v128, v128, v249
  v_sub_f32 v113, v113, v248
  v_mul_f32 v129, v129, v249
  v_sub_f32 v114, v114, v248
  v_mul_f32 v130, v130, v249
  v_sub_f32 v115, v115, v248
  v_mul_f32 v131, v131, v249
  v_mul_f32 v0, v0, v249
  v_mul_f32 v1, v1, v249
  v_mul_f32 v2, v2, v249
  v_mul_f32 v3, v3, v249
  v_mul_f32 v8, v8, v249
  v_mul_f32 v9, v9, v249
  v_mul_f32 v10, v10, v249
  v_mul_f32 v11, v11, v249
  v_mul_f32 v16, v16, v249
  v_mul_f32 v17, v17, v249
  v_mul_f32 v18, v18, v249
  v_mul_f32 v19, v19, v249
  v_mul_f32 v24, v24, v249
  v_mul_f32 v25, v25, v249
  v_mul_f32 v26, v26, v249
  v_mul_f32 v27, v27, v249
  v_mul_f32 v32, v32, v249
  v_mul_f32 v33, v33, v249
  v_mul_f32 v34, v34, v249
  v_mul_f32 v35, v35, v249
  v_mul_f32 v40, v40, v249
  v_mul_f32 v41, v41, v249
  v_mul_f32 v42, v42, v249
  v_mul_f32 v43, v43, v249
  v_mul_f32 v48, v48, v249
  v_mul_f32 v49, v49, v249
  v_mul_f32 v50, v50, v249
  v_mul_f32 v51, v51, v249
  v_mul_f32 v56, v56, v249
  v_mul_f32 v57, v57, v249
  v_mul_f32 v58, v58, v249
  v_mul_f32 v59, v59, v249
  v_max3_f32 v248, v72, v73, v74
  v_max3_f32 v248, v248, v75, v76
  v_max3_f32 v248, v248, v77, v78
  v_max_f32 v248, v248, v79
  v_mov_b32 v250, v248
  s_nop 1
  v_permlane16_swap_b32 v248, v250
  v_max_f32 v248, v248, v250
  v_mov_b32 v250, v248
  s_nop 1
  v_permlane32_swap_b32 v248, v250
  v_max_f32 v248, v248, v250
  v_log_f32 v249, v132
  s_nop 0
  v_max3_f32 v248, 0, v248, v249
  v_sub_f32 v249, 0, v248
  v_exp_f32 v249, v249
  v_sub_f32 v72, v72, v248
  v_sub_f32 v88, v88, v248
  v_sub_f32 v73, v73, v248
  v_sub_f32 v89, v89, v248
  v_sub_f32 v74, v74, v248
  v_sub_f32 v90, v90, v248
  v_sub_f32 v75, v75, v248
  v_sub_f32 v91, v91, v248
  v_sub_f32 v76, v76, v248
  v_sub_f32 v92, v92, v248
  v_sub_f32 v77, v77, v248
  v_sub_f32 v93, v93, v248
  v_sub_f32 v78, v78, v248
  v_sub_f32 v94, v94, v248
  v_sub_f32 v79, v79, v248
  v_sub_f32 v95, v95, v248
  v_sub_f32 v116, v116, v248
  v_mul_f32 v132, v132, v249
  v_sub_f32 v117, v117, v248
  v_mul_f32 v133, v133, v249
  v_sub_f32 v118, v118, v248
  v_mul_f32 v134, v134, v249
  v_sub_f32 v119, v119, v248
  v_mul_f32 v135, v135, v249
  v_mul_f32 v4, v4, v249
  v_mul_f32 v5, v5, v249
  v_mul_f32 v6, v6, v249
  v_mul_f32 v7, v7, v249
  v_mul_f32 v12, v12, v249
  v_mul_f32 v13, v13, v249
  v_mul_f32 v14, v14, v249
  v_mul_f32 v15, v15, v249
  v_mul_f32 v20, v20, v249
  v_mul_f32 v21, v21, v249
  v_mul_f32 v22, v22, v249
  v_mul_f32 v23, v23, v249
  v_mul_f32 v28, v28, v249
  v_mul_f32 v29, v29, v249
  v_mul_f32 v30, v30, v249
  v_mul_f32 v31, v31, v249
  v_mul_f32 v36, v36, v249
  v_mul_f32 v37, v37, v249
  v_mul_f32 v38, v38, v249
  v_mul_f32 v39, v39, v249
  v_mul_f32 v44, v44, v249
  v_mul_f32 v45, v45, v249
  v_mul_f32 v46, v46, v249
  v_mul_f32 v47, v47, v249
  v_mul_f32 v52, v52, v249
  v_mul_f32 v53, v53, v249
  v_mul_f32 v54, v54, v249
  v_mul_f32 v55, v55, v249
  v_mul_f32 v60, v60, v249
  v_mul_f32 v61, v61, v249
  v_mul_f32 v62, v62, v249
  v_mul_f32 v63, v63, v249
  v_exp_f32 v232, v64
  v_exp_f32 v233, v65
  v_exp_f32 v234, v66
  v_cvt_pk_bf16_f32 v96, v232, v233
  v_exp_f32 v235, v67
  v_exp_f32 v236, v72
  v_cvt_pk_bf16_f32 v97, v234, v235
  v_exp_f32 v237, v73
  v_exp_f32 v238, v74
  v_cvt_pk_bf16_f32 v100, v236, v237
  v_exp_f32 v239, v75
  v_exp_f32 v232, v68
  v_cvt_pk_bf16_f32 v101, v238, v239
  v_exp_f32 v233, v69
  v_exp_f32 v234, v70
  v_cvt_pk_bf16_f32 v98, v232, v233
  v_exp_f32 v235, v71
  v_exp_f32 v236, v76
  v_cvt_pk_bf16_f32 v99, v234, v235
  v_exp_f32 v237, v77
  v_exp_f32 v238, v78
  v_cvt_pk_bf16_f32 v102, v236, v237
  v_exp_f32 v239, v79
  s_nop 0
  v_cvt_pk_bf16_f32 v103, v238, v239
  v_mfma_f32_16x16x32_bf16 v[120:123], v[240:243], v[96:99], v[128:131]
  s_nop 0
  v_mfma_f32_16x16x32_bf16 v[124:127], v[240:243], v[100:103], v[132:135]
  v_exp_f32 v232, v80
  v_exp_f32 v233, v81
  v_exp_f32 v234, v82
  v_cvt_pk_bf16_f32 v104, v232, v233
  v_exp_f32 v235, v83
  s_nop 7
  s_branch ka_kernel_ret_64
ka_kernel_fix_65:
  s_nop 15
  v_max3_f32 v248, v80, v81, v82
  v_max3_f32 v248, v248, v83, v84
  v_max3_f32 v248, v248, v85, v86
  v_max_f32 v248, v248, v87
  v_mov_b32 v250, v248
  s_nop 1
  v_permlane16_swap_b32 v248, v250
  v_max_f32 v248, v248, v250
  v_mov_b32 v250, v248
  s_nop 1
  v_permlane32_swap_b32 v248, v250
  v_max_f32 v248, v248, v250
  v_log_f32 v249, v120
  s_nop 0
  v_max3_f32 v248, 0, v248, v249
  v_sub_f32 v249, 0, v248
  v_exp_f32 v249, v249
  v_sub_f32 v80, v80, v248
  v_sub_f32 v64, v64, v248
  v_sub_f32 v81, v81, v248
  v_sub_f32 v65, v65, v248
  v_sub_f32 v82, v82, v248
  v_sub_f32 v66, v66, v248
  v_sub_f32 v83, v83, v248
  v_sub_f32 v67, v67, v248
  v_sub_f32 v84, v84, v248
  v_sub_f32 v68, v68, v248
  v_sub_f32 v85, v85, v248
  v_sub_f32 v69, v69, v248
  v_sub_f32 v86, v86, v248
  v_sub_f32 v70, v70, v248
  v_sub_f32 v87, v87, v248
  v_sub_f32 v71, v71, v248
  v_sub_f32 v112, v112, v248
  v_mul_f32 v120, v120, v249
  v_sub_f32 v113, v113, v248
  v_mul_f32 v121, v121, v249
  v_sub_f32 v114, v114, v248
  v_mul_f32 v122, v122, v249
  v_sub_f32 v115, v115, v248
  v_mul_f32 v123, v123, v249
  v_mul_f32 v0, v0, v249
  v_mul_f32 v1, v1, v249
  v_mul_f32 v2, v2, v249
  v_mul_f32 v3, v3, v249
  v_mul_f32 v8, v8, v249
  v_mul_f32 v9, v9, v249
  v_mul_f32 v10, v10, v249
  v_mul_f32 v11, v11, v249
  v_mul_f32 v16, v16, v249
  v_mul_f32 v17, v17, v249
  v_mul_f32 v18, v18, v249
  v_mul_f32 v19, v19, v249
  v_mul_f32 v24, v24, v249
  v_mul_f32 v25, v25, v249
  v_mul_f32 v26, v26, v249
  v_mul_f32 v27, v27, v249
  v_mul_f32 v32, v32, v249
  v_mul_f32 v33, v33, v249
  v_mul_f32 v34, v34, v249
  v_mul_f32 v35, v35, v249
  v_mul_f32 v40, v40, v249
  v_mul_f32 v41, v41, v249
  v_mul_f32 v42, v42, v249
  v_mul_f32 v43, v43, v249
  v_mul_f32 v48, v48, v249
  v_mul_f32 v49, v49, v249
  v_mul_f32 v50, v50, v249
  v_mul_f32 v51, v51, v249
  v_mul_f32 v56, v56, v249
  v_mul_f32 v57, v57, v249
  v_mul_f32 v58, v58, v249
  v_mul_f32 v59, v59, v249
  v_max3_f32 v248, v88, v89, v90
  v_max3_f32 v248, v248, v91, v92
  v_max3_f32 v248, v248, v93, v94
  v_max_f32 v248, v248, v95
  v_mov_b32 v250, v248
  s_nop 1
  v_permlane16_swap_b32 v248, v250
  v_max_f32 v248, v248, v250
  v_mov_b32 v250, v248
  s_nop 1
  v_permlane32_swap_b32 v248, v250
  v_max_f32 v248, v248, v250
  v_log_f32 v249, v124
  s_nop 0
  v_max3_f32 v248, 0, v248, v249
  v_sub_f32 v249, 0, v248
  v_exp_f32 v249, v249
  v_sub_f32 v88, v88, v248
  v_sub_f32 v72, v72, v248
  v_sub_f32 v89, v89, v248
  v_sub_f32 v73, v73, v248
  v_sub_f32 v90, v90, v248
  v_sub_f32 v74, v74, v248
  v_sub_f32 v91, v91, v248
  v_sub_f32 v75, v75, v248
  v_sub_f32 v92, v92, v248
  v_sub_f32 v76, v76, v248
  v_sub_f32 v93, v93, v248
  v_sub_f32 v77, v77, v248
  v_sub_f32 v94, v94, v248
  v_sub_f32 v78, v78, v248
  v_sub_f32 v95, v95, v248
  v_sub_f32 v79, v79, v248
  v_sub_f32 v116, v116, v248
  v_mul_f32 v124, v124, v249
  v_sub_f32 v117, v117, v248
  v_mul_f32 v125, v125, v249
  v_sub_f32 v118, v118, v248
  v_mul_f32 v126, v126, v249
  v_sub_f32 v119, v119, v248
  v_mul_f32 v127, v127, v249
  v_mul_f32 v4, v4, v249
  v_mul_f32 v5, v5, v249
  v_mul_f32 v6, v6, v249
  v_mul_f32 v7, v7, v249
  v_mul_f32 v12, v12, v249
  v_mul_f32 v13, v13, v249
  v_mul_f32 v14, v14, v249
  v_mul_f32 v15, v15, v249
  v_mul_f32 v20, v20, v249
  v_mul_f32 v21, v21, v249
  v_mul_f32 v22, v22, v249
  v_mul_f32 v23, v23, v249
  v_mul_f32 v28, v28, v249
  v_mul_f32 v29, v29, v249
  v_mul_f32 v30, v30, v249
  v_mul_f32 v31, v31, v249
  v_mul_f32 v36, v36, v249
  v_mul_f32 v37, v37, v249
  v_mul_f32 v38, v38, v249
  v_mul_f32 v39, v39, v249
  v_mul_f32 v44, v44, v249
  v_mul_f32 v45, v45, v249
  v_mul_f32 v46, v46, v249
  v_mul_f32 v47, v47, v249
  v_mul_f32 v52, v52, v249
  v_mul_f32 v53, v53, v249
  v_mul_f32 v54, v54, v249
  v_mul_f32 v55, v55, v249
  v_mul_f32 v60, v60, v249
  v_mul_f32 v61, v61, v249
  v_mul_f32 v62, v62, v249
  v_mul_f32 v63, v63, v249
  v_exp_f32 v232, v80
  v_exp_f32 v233, v81
  v_exp_f32 v234, v82
  v_cvt_pk_bf16_f32 v104, v232, v233
  v_exp_f32 v235, v83
  v_exp_f32 v236, v88
  v_cvt_pk_bf16_f32 v105, v234, v235
  v_exp_f32 v237, v89
  v_exp_f32 v238, v90
  v_cvt_pk_bf16_f32 v108, v236, v237
  v_exp_f32 v239, v91
  v_exp_f32 v232, v84
  v_cvt_pk_bf16_f32 v109, v238, v239
  v_exp_f32 v233, v85
  v_exp_f32 v234, v86
  v_cvt_pk_bf16_f32 v106, v232, v233
  v_exp_f32 v235, v87
  v_exp_f32 v236, v92
  v_cvt_pk_bf16_f32 v107, v234, v235
  v_exp_f32 v237, v93
  v_exp_f32 v238, v94
  v_cvt_pk_bf16_f32 v110, v236, v237
  v_exp_f32 v239, v95
  s_nop 0
  v_cvt_pk_bf16_f32 v111, v238, v239
  v_mfma_f32_16x16x32_bf16 v[128:131], v[240:243], v[104:107], v[120:123]
  s_nop 0
  v_mfma_f32_16x16x32_bf16 v[132:135], v[240:243], v[108:111], v[124:127]
  v_exp_f32 v232, v64
  v_exp_f32 v233, v65
  v_exp_f32 v234, v66
  v_cvt_pk_bf16_f32 v96, v232, v233
  v_exp_f32 v235, v67
  s_nop 7
  s_branch ka_kernel_ret_66
ka_kernel_fix_67:
  s_nop 15
  v_max3_f32 v248, v64, v65, v66
  v_max3_f32 v248, v248, v67, v68
  v_max3_f32 v248, v248, v69, v70
  v_max_f32 v248, v248, v71
  v_mov_b32 v250, v248
  s_nop 1
  v_permlane16_swap_b32 v248, v250
  v_max_f32 v248, v248, v250
  v_mov_b32 v250, v248
  s_nop 1
  v_permlane32_swap_b32 v248, v250
  v_max_f32 v248, v248, v250
  v_log_f32 v249, v128
  s_nop 0
  v_max3_f32 v248, 0, v248, v249
  v_sub_f32 v249, 0, v248
  v_exp_f32 v249, v249
  v_sub_f32 v64, v64, v248
  v_sub_f32 v80, v80, v248
  v_sub_f32 v65, v65, v248
  v_sub_f32 v81, v81, v248
  v_sub_f32 v66, v66, v248
  v_sub_f32 v82, v82, v248
  v_sub_f32 v67, v67, v248
  v_sub_f32 v83, v83, v248
  v_sub_f32 v68, v68, v248
  v_sub_f32 v84, v84, v248
  v_sub_f32 v69, v69, v248
  v_sub_f32 v85, v85, v248
  v_sub_f32 v70, v70, v248
  v_sub_f32 v86, v86, v248
  v_sub_f32 v71, v71, v248
  v_sub_f32 v87, v87, v248
  v_sub_f32 v112, v112, v248
  v_mul_f32 v128, v128, v249
  v_sub_f32 v113, v113, v248
  v_mul_f32 v129, v129, v249
  v_sub_f32 v114, v114, v248
  v_mul_f32 v130, v130, v249
  v_sub_f32 v115, v115, v248
  v_mul_f32 v131, v131, v249
  v_mul_f32 v0, v0, v249
  v_mul_f32 v1, v1, v249
  v_mul_f32 v2, v2, v249
  v_mul_f32 v3, v3, v249
  v_mul_f32 v8, v8, v249
  v_mul_f32 v9, v9, v249
  v_mul_f32 v10, v10, v249
  v_mul_f32 v11, v11, v249
  v_mul_f32 v16, v16, v249
  v_mul_f32 v17, v17, v249
  v_mul_f32 v18, v18, v249
  v_mul_f32 v19, v19, v249
  v_mul_f32 v24, v24, v249
  v_mul_f32 v25, v25, v249
  v_mul_f32 v26, v26, v249
  v_mul_f32 v27, v27, v249
  v_mul_f32 v32, v32, v249
  v_mul_f32 v33, v33, v249
  v_mul_f32 v34, v34, v249
  v_mul_f32 v35, v35, v249
  v_mul_f32 v40, v40, v249
  v_mul_f32 v41, v41, v249
  v_mul_f32 v42, v42, v249
  v_mul_f32 v43, v43, v249
  v_mul_f32 v48, v48, v249
  v_mul_f32 v49, v49, v249
  v_mul_f32 v50, v50, v249
  v_mul_f32 v51, v51, v249
  v_mul_f32 v56, v56, v249
  v_mul_f32 v57, v57, v249
  v_mul_f32 v58, v58, v249
  v_mul_f32 v59, v59, v249
  v_max3_f32 v248, v72, v73, v74
  v_max3_f32 v248, v248, v75, v76
  v_max3_f32 v248, v248, v77, v78
  v_max_f32 v248, v248, v79
  v_mov_b32 v250, v248
  s_nop 1
  v_permlane16_swap_b32 v248, v250
  v_max_f32 v248, v248, v250
  v_mov_b32 v250, v248
  s_nop 1
  v_permlane32_swap_b32 v248, v250
  v_max_f32 v248, v248, v250
  v_log_f32 v249, v132
  s_nop 0
  v_max3_f32 v248, 0, v248, v249
  v_sub_f32 v249, 0, v248
  v_exp_f32 v249, v249
  v_sub_f32 v72, v72, v248
  v_sub_f32 v88, v88, v248
  v_sub_f32 v73, v73, v248
  v_sub_f32 v89, v89, v248
  v_sub_f32 v74, v74, v248
  v_sub_f32 v90, v90, v248
  v_sub_f32 v75, v75, v248
  v_sub_f32 v91, v91, v248
  v_sub_f32 v76, v76, v248
  v_sub_f32 v92, v92, v248
  v_sub_f32 v77, v77, v248
  v_sub_f32 v93, v93, v248
  v_sub_f32 v78, v78, v248
  v_sub_f32 v94, v94, v248
  v_sub_f32 v79, v79, v248
  v_sub_f32 v95, v95, v248
  v_sub_f32 v116, v116, v248
  v_mul_f32 v132, v132, v249
  v_sub_f32 v117, v117, v248
  v_mul_f32 v133, v133, v249
  v_sub_f32 v118, v118, v248
  v_mul_f32 v134, v134, v249
  v_sub_f32 v119, v119, v248
  v_mul_f32 v135, v135, v249
  v_mul_f32 v4, v4, v249
  v_mul_f32 v5, v5, v249
  v_mul_f32 v6, v6, v249
  v_mul_f32 v7, v7, v249
  v_mul_f32 v12, v12, v249
  v_mul_f32 v13, v13, v249
  v_mul_f32 v14, v14, v249
  v_mul_f32 v15, v15, v249
  v_mul_f32 v20, v20, v249
  v_mul_f32 v21, v21, v249
  v_mul_f32 v22, v22, v249
  v_mul_f32 v23, v23, v249
  v_mul_f32 v28, v28, v249
  v_mul_f32 v29, v29, v249
  v_mul_f32 v30, v30, v249
  v_mul_f32 v31, v31, v249
  v_mul_f32 v36, v36, v249
  v_mul_f32 v37, v37, v249
  v_mul_f32 v38, v38, v249
  v_mul_f32 v39, v39, v249
  v_mul_f32 v44, v44, v249
  v_mul_f32 v45, v45, v249
  v_mul_f32 v46, v46, v249
  v_mul_f32 v47, v47, v249
  v_mul_f32 v52, v52, v249
  v_mul_f32 v53, v53, v249
  v_mul_f32 v54, v54, v249
  v_mul_f32 v55, v55, v249
  v_mul_f32 v60, v60, v249
  v_mul_f32 v61, v61, v249
  v_mul_f32 v62, v62, v249
  v_mul_f32 v63, v63, v249
  v_exp_f32 v232, v64
  v_exp_f32 v233, v65
  v_exp_f32 v234, v66
  v_cvt_pk_bf16_f32 v96, v232, v233
  v_exp_f32 v235, v67
  v_exp_f32 v236, v72
  v_cvt_pk_bf16_f32 v97, v234, v235
  v_exp_f32 v237, v73
  v_exp_f32 v238, v74
  v_cvt_pk_bf16_f32 v100, v236, v237
  v_exp_f32 v239, v75
  v_exp_f32 v232, v68
  v_cvt_pk_bf16_f32 v101, v238, v239
  v_exp_f32 v233, v69
  v_exp_f32 v234, v70
  v_cvt_pk_bf16_f32 v98, v232, v233
  v_exp_f32 v235, v71
  v_exp_f32 v236, v76
  v_cvt_pk_bf16_f32 v99, v234, v235
  v_exp_f32 v237, v77
  v_exp_f32 v238, v78
  v_cvt_pk_bf16_f32 v102, v236, v237
  v_exp_f32 v239, v79
  s_nop 0
  v_cvt_pk_bf16_f32 v103, v238, v239
  v_mfma_f32_16x16x32_bf16 v[120:123], v[240:243], v[96:99], v[128:131]
  s_nop 0
  v_mfma_f32_16x16x32_bf16 v[124:127], v[240:243], v[100:103], v[132:135]
  v_exp_f32 v232, v80
  v_exp_f32 v233, v81
  v_exp_f32 v234, v82
  v_cvt_pk_bf16_f32 v104, v232, v233
  v_exp_f32 v235, v83
  s_nop 7
  s_branch ka_kernel_ret_68
ka_kernel_fix_69:
  s_nop 15
  v_max3_f32 v248, v80, v81, v82
  v_max3_f32 v248, v248, v83, v84
  v_max3_f32 v248, v248, v85, v86
  v_max_f32 v248, v248, v87
  v_mov_b32 v250, v248
  s_nop 1
  v_permlane16_swap_b32 v248, v250
  v_max_f32 v248, v248, v250
  v_mov_b32 v250, v248
  s_nop 1
  v_permlane32_swap_b32 v248, v250
  v_max_f32 v248, v248, v250
  v_log_f32 v249, v120
  s_nop 0
  v_max3_f32 v248, 0, v248, v249
  v_sub_f32 v249, 0, v248
  v_exp_f32 v249, v249
  v_sub_f32 v80, v80, v248
  v_sub_f32 v64, v64, v248
  v_sub_f32 v81, v81, v248
  v_sub_f32 v65, v65, v248
  v_sub_f32 v82, v82, v248
  v_sub_f32 v66, v66, v248
  v_sub_f32 v83, v83, v248
  v_sub_f32 v67, v67, v248
  v_sub_f32 v84, v84, v248
  v_sub_f32 v68, v68, v248
  v_sub_f32 v85, v85, v248
  v_sub_f32 v69, v69, v248
  v_sub_f32 v86, v86, v248
  v_sub_f32 v70, v70, v248
  v_sub_f32 v87, v87, v248
  v_sub_f32 v71, v71, v248
  v_sub_f32 v112, v112, v248
  v_mul_f32 v120, v120, v249
  v_sub_f32 v113, v113, v248
  v_mul_f32 v121, v121, v249
  v_sub_f32 v114, v114, v248
  v_mul_f32 v122, v122, v249
  v_sub_f32 v115, v115, v248
  v_mul_f32 v123, v123, v249
  v_mul_f32 v0, v0, v249
  v_mul_f32 v1, v1, v249
  v_mul_f32 v2, v2, v249
  v_mul_f32 v3, v3, v249
  v_mul_f32 v8, v8, v249
  v_mul_f32 v9, v9, v249
  v_mul_f32 v10, v10, v249
  v_mul_f32 v11, v11, v249
  v_mul_f32 v16, v16, v249
  v_mul_f32 v17, v17, v249
  v_mul_f32 v18, v18, v249
  v_mul_f32 v19, v19, v249
  v_mul_f32 v24, v24, v249
  v_mul_f32 v25, v25, v249
  v_mul_f32 v26, v26, v249
  v_mul_f32 v27, v27, v249
  v_mul_f32 v32, v32, v249
  v_mul_f32 v33, v33, v249
  v_mul_f32 v34, v34, v249
  v_mul_f32 v35, v35, v249
  v_mul_f32 v40, v40, v249
  v_mul_f32 v41, v41, v249
  v_mul_f32 v42, v42, v249
  v_mul_f32 v43, v43, v249
  v_mul_f32 v48, v48, v249
  v_mul_f32 v49, v49, v249
  v_mul_f32 v50, v50, v249
  v_mul_f32 v51, v51, v249
  v_mul_f32 v56, v56, v249
  v_mul_f32 v57, v57, v249
  v_mul_f32 v58, v58, v249
  v_mul_f32 v59, v59, v249
  v_max3_f32 v248, v88, v89, v90
  v_max3_f32 v248, v248, v91, v92
  v_max3_f32 v248, v248, v93, v94
  v_max_f32 v248, v248, v95
  v_mov_b32 v250, v248
  s_nop 1
  v_permlane16_swap_b32 v248, v250
  v_max_f32 v248, v248, v250
  v_mov_b32 v250, v248
  s_nop 1
  v_permlane32_swap_b32 v248, v250
  v_max_f32 v248, v248, v250
  v_log_f32 v249, v124
  s_nop 0
  v_max3_f32 v248, 0, v248, v249
  v_sub_f32 v249, 0, v248
  v_exp_f32 v249, v249
  v_sub_f32 v88, v88, v248
  v_sub_f32 v72, v72, v248
  v_sub_f32 v89, v89, v248
  v_sub_f32 v73, v73, v248
  v_sub_f32 v90, v90, v248
  v_sub_f32 v74, v74, v248
  v_sub_f32 v91, v91, v248
  v_sub_f32 v75, v75, v248
  v_sub_f32 v92, v92, v248
  v_sub_f32 v76, v76, v248
  v_sub_f32 v93, v93, v248
  v_sub_f32 v77, v77, v248
  v_sub_f32 v94, v94, v248
  v_sub_f32 v78, v78, v248
  v_sub_f32 v95, v95, v248
  v_sub_f32 v79, v79, v248
  v_sub_f32 v116, v116, v248
  v_mul_f32 v124, v124, v249
  v_sub_f32 v117, v117, v248
  v_mul_f32 v125, v125, v249
  v_sub_f32 v118, v118, v248
  v_mul_f32 v126, v126, v249
  v_sub_f32 v119, v119, v248
  v_mul_f32 v127, v127, v249
  v_mul_f32 v4, v4, v249
  v_mul_f32 v5, v5, v249
  v_mul_f32 v6, v6, v249
  v_mul_f32 v7, v7, v249
  v_mul_f32 v12, v12, v249
  v_mul_f32 v13, v13, v249
  v_mul_f32 v14, v14, v249
  v_mul_f32 v15, v15, v249
  v_mul_f32 v20, v20, v249
  v_mul_f32 v21, v21, v249
  v_mul_f32 v22, v22, v249
  v_mul_f32 v23, v23, v249
  v_mul_f32 v28, v28, v249
  v_mul_f32 v29, v29, v249
  v_mul_f32 v30, v30, v249
  v_mul_f32 v31, v31, v249
  v_mul_f32 v36, v36, v249
  v_mul_f32 v37, v37, v249
  v_mul_f32 v38, v38, v249
  v_mul_f32 v39, v39, v249
  v_mul_f32 v44, v44, v249
  v_mul_f32 v45, v45, v249
  v_mul_f32 v46, v46, v249
  v_mul_f32 v47, v47, v249
  v_mul_f32 v52, v52, v249
  v_mul_f32 v53, v53, v249
  v_mul_f32 v54, v54, v249
  v_mul_f32 v55, v55, v249
  v_mul_f32 v60, v60, v249
  v_mul_f32 v61, v61, v249
  v_mul_f32 v62, v62, v249
  v_mul_f32 v63, v63, v249
  v_exp_f32 v232, v80
  v_exp_f32 v233, v81
  v_exp_f32 v234, v82
  v_cvt_pk_bf16_f32 v104, v232, v233
  v_exp_f32 v235, v83
  v_exp_f32 v236, v88
  v_cvt_pk_bf16_f32 v105, v234, v235
  v_exp_f32 v237, v89
  v_exp_f32 v238, v90
  v_cvt_pk_bf16_f32 v108, v236, v237
  v_exp_f32 v239, v91
  v_exp_f32 v232, v84
  v_cvt_pk_bf16_f32 v109, v238, v239
  v_exp_f32 v233, v85
  v_exp_f32 v234, v86
  v_cvt_pk_bf16_f32 v106, v232, v233
  v_exp_f32 v235, v87
  v_exp_f32 v236, v92
  v_cvt_pk_bf16_f32 v107, v234, v235
  v_exp_f32 v237, v93
  v_exp_f32 v238, v94
  v_cvt_pk_bf16_f32 v110, v236, v237
  v_exp_f32 v239, v95
  s_nop 0
  v_cvt_pk_bf16_f32 v111, v238, v239
  v_mfma_f32_16x16x32_bf16 v[128:131], v[240:243], v[104:107], v[120:123]
  s_nop 0
  v_mfma_f32_16x16x32_bf16 v[132:135], v[240:243], v[108:111], v[124:127]
  s_nop 7
  s_branch ka_kernel_ret_70
ka_kernel_fix_71:
  s_nop 15
  v_max3_f32 v248, v80, v81, v82
  v_max3_f32 v248, v248, v83, v84
  v_max3_f32 v248, v248, v85, v86
  v_max_f32 v248, v248, v87
  v_mov_b32 v250, v248
  s_nop 1
  v_permlane16_swap_b32 v248, v250
  v_max_f32 v248, v248, v250
  v_mov_b32 v250, v248
  s_nop 1
  v_permlane32_swap_b32 v248, v250
  v_max_f32 v248, v248, v250
  v_log_f32 v249, v120
  s_nop 0
  v_max3_f32 v248, 0, v248, v249
  v_sub_f32 v249, 0, v248
  v_exp_f32 v249, v249
  v_sub_f32 v80, v80, v248
  v_sub_f32 v64, v64, v248
  v_sub_f32 v81, v81, v248
  v_sub_f32 v65, v65, v248
  v_sub_f32 v82, v82, v248
  v_sub_f32 v66, v66, v248
  v_sub_f32 v83, v83, v248
  v_sub_f32 v67, v67, v248
  v_sub_f32 v84, v84, v248
  v_sub_f32 v68, v68, v248
  v_sub_f32 v85, v85, v248
  v_sub_f32 v69, v69, v248
  v_sub_f32 v86, v86, v248
  v_sub_f32 v70, v70, v248
  v_sub_f32 v87, v87, v248
  v_sub_f32 v71, v71, v248
  v_sub_f32 v112, v112, v248
  v_mul_f32 v120, v120, v249
  v_sub_f32 v113, v113, v248
  v_mul_f32 v121, v121, v249
  v_sub_f32 v114, v114, v248
  v_mul_f32 v122, v122, v249
  v_sub_f32 v115, v115, v248
  v_mul_f32 v123, v123, v249
  v_mul_f32 v0, v0, v249
  v_mul_f32 v1, v1, v249
  v_mul_f32 v2, v2, v249
  v_mul_f32 v3, v3, v249
  v_mul_f32 v8, v8, v249
  v_mul_f32 v9, v9, v249
  v_mul_f32 v10, v10, v249
  v_mul_f32 v11, v11, v249
  v_mul_f32 v16, v16, v249
  v_mul_f32 v17, v17, v249
  v_mul_f32 v18, v18, v249
  v_mul_f32 v19, v19, v249
  v_mul_f32 v24, v24, v249
  v_mul_f32 v25, v25, v249
  v_mul_f32 v26, v26, v249
  v_mul_f32 v27, v27, v249
  v_mul_f32 v32, v32, v249
  v_mul_f32 v33, v33, v249
  v_mul_f32 v34, v34, v249
  v_mul_f32 v35, v35, v249
  v_mul_f32 v40, v40, v249
  v_mul_f32 v41, v41, v249
  v_mul_f32 v42, v42, v249
  v_mul_f32 v43, v43, v249
  v_mul_f32 v48, v48, v249
  v_mul_f32 v49, v49, v249
  v_mul_f32 v50, v50, v249
  v_mul_f32 v51, v51, v249
  v_mul_f32 v56, v56, v249
  v_mul_f32 v57, v57, v249
  v_mul_f32 v58, v58, v249
  v_mul_f32 v59, v59, v249
  v_max3_f32 v248, v88, v89, v90
  v_max3_f32 v248, v248, v91, v92
  v_max3_f32 v248, v248, v93, v94
  v_max_f32 v248, v248, v95
  v_mov_b32 v250, v248
  s_nop 1
  v_permlane16_swap_b32 v248, v250
  v_max_f32 v248, v248, v250
  v_mov_b32 v250, v248
  s_nop 1
  v_permlane32_swap_b32 v248, v250
  v_max_f32 v248, v248, v250
  v_log_f32 v249, v124
  s_nop 0
  v_max3_f32 v248, 0, v248, v249
  v_sub_f32 v249, 0, v248
  v_exp_f32 v249, v249
  v_sub_f32 v88, v88, v248
  v_sub_f32 v72, v72, v248
  v_sub_f32 v89, v89, v248
  v_sub_f32 v73, v73, v248
  v_sub_f32 v90, v90, v248
  v_sub_f32 v74, v74, v248
  v_sub_f32 v91, v91, v248
  v_sub_f32 v75, v75, v248
  v_sub_f32 v92, v92, v248
  v_sub_f32 v76, v76, v248
  v_sub_f32 v93, v93, v248
  v_sub_f32 v77, v77, v248
  v_sub_f32 v94, v94, v248
  v_sub_f32 v78, v78, v248
  v_sub_f32 v95, v95, v248
  v_sub_f32 v79, v79, v248
  v_sub_f32 v116, v116, v248
  v_mul_f32 v124, v124, v249
  v_sub_f32 v117, v117, v248
  v_mul_f32 v125, v125, v249
  v_sub_f32 v118, v118, v248
  v_mul_f32 v126, v126, v249
  v_sub_f32 v119, v119, v248
  v_mul_f32 v127, v127, v249
  v_mul_f32 v4, v4, v249
  v_mul_f32 v5, v5, v249
  v_mul_f32 v6, v6, v249
  v_mul_f32 v7, v7, v249
  v_mul_f32 v12, v12, v249
  v_mul_f32 v13, v13, v249
  v_mul_f32 v14, v14, v249
  v_mul_f32 v15, v15, v249
  v_mul_f32 v20, v20, v249
  v_mul_f32 v21, v21, v249
  v_mul_f32 v22, v22, v249
  v_mul_f32 v23, v23, v249
  v_mul_f32 v28, v28, v249
  v_mul_f32 v29, v29, v249
  v_mul_f32 v30, v30, v249
  v_mul_f32 v31, v31, v249
  v_mul_f32 v36, v36, v249
  v_mul_f32 v37, v37, v249
  v_mul_f32 v38, v38, v249
  v_mul_f32 v39, v39, v249
  v_mul_f32 v44, v44, v249
  v_mul_f32 v45, v45, v249
  v_mul_f32 v46, v46, v249
  v_mul_f32 v47, v47, v249
  v_mul_f32 v52, v52, v249
  v_mul_f32 v53, v53, v249
  v_mul_f32 v54, v54, v249
  v_mul_f32 v55, v55, v249
  v_mul_f32 v60, v60, v249
  v_mul_f32 v61, v61, v249
  v_mul_f32 v62, v62, v249
  v_mul_f32 v63, v63, v249
  v_exp_f32 v232, v80
  v_exp_f32 v233, v81
  v_exp_f32 v234, v82
  v_cvt_pk_bf16_f32 v104, v232, v233
  v_exp_f32 v235, v83
  v_exp_f32 v236, v88
  v_cvt_pk_bf16_f32 v105, v234, v235
  v_exp_f32 v237, v89
  v_exp_f32 v238, v90
  v_cvt_pk_bf16_f32 v108, v236, v237
  v_exp_f32 v239, v91
  v_exp_f32 v232, v84
  v_cvt_pk_bf16_f32 v109, v238, v239
  v_exp_f32 v233, v85
  v_exp_f32 v234, v86
  v_cvt_pk_bf16_f32 v106, v232, v233
  v_exp_f32 v235, v87
  v_exp_f32 v236, v92
  v_cvt_pk_bf16_f32 v107, v234, v235
  v_exp_f32 v237, v93
  v_exp_f32 v238, v94
  v_cvt_pk_bf16_f32 v110, v236, v237
  v_exp_f32 v239, v95
  s_nop 0
  v_cvt_pk_bf16_f32 v111, v238, v239
  v_mfma_f32_16x16x32_bf16 v[128:131], v[240:243], v[104:107], v[120:123]
  s_nop 0
  v_mfma_f32_16x16x32_bf16 v[132:135], v[240:243], v[108:111], v[124:127]
  v_exp_f32 v232, v64
  v_exp_f32 v233, v65
  v_exp_f32 v234, v66
  v_cvt_pk_bf16_f32 v96, v232, v233
  v_exp_f32 v235, v67
  s_nop 7
  s_branch ka_kernel_ret_72
ka_kernel_fix_73:
  s_nop 15
  v_max3_f32 v248, v64, v65, v66
  v_max3_f32 v248, v248, v67, v68
  v_max3_f32 v248, v248, v69, v70
  v_max_f32 v248, v248, v71
  v_mov_b32 v250, v248
  s_nop 1
  v_permlane16_swap_b32 v248, v250
  v_max_f32 v248, v248, v250
  v_mov_b32 v250, v248
  s_nop 1
  v_permlane32_swap_b32 v248, v250
  v_max_f32 v248, v248, v250
  v_log_f32 v249, v128
  s_nop 0
  v_max3_f32 v248, 0, v248, v249
  v_sub_f32 v249, 0, v248
  v_exp_f32 v249, v249
  v_sub_f32 v64, v64, v248
  v_sub_f32 v80, v80, v248
  v_sub_f32 v65, v65, v248
  v_sub_f32 v81, v81, v248
  v_sub_f32 v66, v66, v248
  v_sub_f32 v82, v82, v248
  v_sub_f32 v67, v67, v248
  v_sub_f32 v83, v83, v248
  v_sub_f32 v68, v68, v248
  v_sub_f32 v84, v84, v248
  v_sub_f32 v69, v69, v248
  v_sub_f32 v85, v85, v248
  v_sub_f32 v70, v70, v248
  v_sub_f32 v86, v86, v248
  v_sub_f32 v71, v71, v248
  v_sub_f32 v87, v87, v248
  v_sub_f32 v112, v112, v248
  v_mul_f32 v128, v128, v249
  v_sub_f32 v113, v113, v248
  v_mul_f32 v129, v129, v249
  v_sub_f32 v114, v114, v248
  v_mul_f32 v130, v130, v249
  v_sub_f32 v115, v115, v248
  v_mul_f32 v131, v131, v249
  v_mul_f32 v0, v0, v249
  v_mul_f32 v1, v1, v249
  v_mul_f32 v2, v2, v249
  v_mul_f32 v3, v3, v249
  v_mul_f32 v8, v8, v249
  v_mul_f32 v9, v9, v249
  v_mul_f32 v10, v10, v249
  v_mul_f32 v11, v11, v249
  v_mul_f32 v16, v16, v249
  v_mul_f32 v17, v17, v249
  v_mul_f32 v18, v18, v249
  v_mul_f32 v19, v19, v249
  v_mul_f32 v24, v24, v249
  v_mul_f32 v25, v25, v249
  v_mul_f32 v26, v26, v249
  v_mul_f32 v27, v27, v249
  v_mul_f32 v32, v32, v249
  v_mul_f32 v33, v33, v249
  v_mul_f32 v34, v34, v249
  v_mul_f32 v35, v35, v249
  v_mul_f32 v40, v40, v249
  v_mul_f32 v41, v41, v249
  v_mul_f32 v42, v42, v249
  v_mul_f32 v43, v43, v249
  v_mul_f32 v48, v48, v249
  v_mul_f32 v49, v49, v249
  v_mul_f32 v50, v50, v249
  v_mul_f32 v51, v51, v249
  v_mul_f32 v56, v56, v249
  v_mul_f32 v57, v57, v249
  v_mul_f32 v58, v58, v249
  v_mul_f32 v59, v59, v249
  v_max3_f32 v248, v72, v73, v74
  v_max3_f32 v248, v248, v75, v76
  v_max3_f32 v248, v248, v77, v78
  v_max_f32 v248, v248, v79
  v_mov_b32 v250, v248
  s_nop 1
  v_permlane16_swap_b32 v248, v250
  v_max_f32 v248, v248, v250
  v_mov_b32 v250, v248
  s_nop 1
  v_permlane32_swap_b32 v248, v250
  v_max_f32 v248, v248, v250
  v_log_f32 v249, v132
  s_nop 0
  v_max3_f32 v248, 0, v248, v249
  v_sub_f32 v249, 0, v248
  v_exp_f32 v249, v249
  v_sub_f32 v72, v72, v248
  v_sub_f32 v88, v88, v248
  v_sub_f32 v73, v73, v248
  v_sub_f32 v89, v89, v248
  v_sub_f32 v74, v74, v248
  v_sub_f32 v90, v90, v248
  v_sub_f32 v75, v75, v248
  v_sub_f32 v91, v91, v248
  v_sub_f32 v76, v76, v248
  v_sub_f32 v92, v92, v248
  v_sub_f32 v77, v77, v248
  v_sub_f32 v93, v93, v248
  v_sub_f32 v78, v78, v248
  v_sub_f32 v94, v94, v248
  v_sub_f32 v79, v79, v248
  v_sub_f32 v95, v95, v248
  v_sub_f32 v116, v116, v248
  v_mul_f32 v132, v132, v249
  v_sub_f32 v117, v117, v248
  v_mul_f32 v133, v133, v249
  v_sub_f32 v118, v118, v248
  v_mul_f32 v134, v134, v249
  v_sub_f32 v119, v119, v248
  v_mul_f32 v135, v135, v249
  v_mul_f32 v4, v4, v249
  v_mul_f32 v5, v5, v249
  v_mul_f32 v6, v6, v249
  v_mul_f32 v7, v7, v249
  v_mul_f32 v12, v12, v249
  v_mul_f32 v13, v13, v249
  v_mul_f32 v14, v14, v249
  v_mul_f32 v15, v15, v249
  v_mul_f32 v20, v20, v249
  v_mul_f32 v21, v21, v249
  v_mul_f32 v22, v22, v249
  v_mul_f32 v23, v23, v249
  v_mul_f32 v28, v28, v249
  v_mul_f32 v29, v29, v249
  v_mul_f32 v30, v30, v249
  v_mul_f32 v31, v31, v249
  v_mul_f32 v36, v36, v249
  v_mul_f32 v37, v37, v249
  v_mul_f32 v38, v38, v249
  v_mul_f32 v39, v39, v249
  v_mul_f32 v44, v44, v249
  v_mul_f32 v45, v45, v249
  v_mul_f32 v46, v46, v249
  v_mul_f32 v47, v47, v249
  v_mul_f32 v52, v52, v249
  v_mul_f32 v53, v53, v249
  v_mul_f32 v54, v54, v249
  v_mul_f32 v55, v55, v249
  v_mul_f32 v60, v60, v249
  v_mul_f32 v61, v61, v249
  v_mul_f32 v62, v62, v249
  v_mul_f32 v63, v63, v249
  v_exp_f32 v232, v64
  v_exp_f32 v233, v65
  v_exp_f32 v234, v66
  v_cvt_pk_bf16_f32 v96, v232, v233
  v_exp_f32 v235, v67
  v_exp_f32 v236, v72
  v_cvt_pk_bf16_f32 v97, v234, v235
  v_exp_f32 v237, v73
  v_exp_f32 v238, v74
  v_cvt_pk_bf16_f32 v100, v236, v237
  v_exp_f32 v239, v75
  v_exp_f32 v232, v68
  v_cvt_pk_bf16_f32 v101, v238, v239
  v_exp_f32 v233, v69
  v_exp_f32 v234, v70
  v_cvt_pk_bf16_f32 v98, v232, v233
  v_exp_f32 v235, v71
  v_exp_f32 v236, v76
  v_cvt_pk_bf16_f32 v99, v234, v235
  v_exp_f32 v237, v77
  v_exp_f32 v238, v78
  v_cvt_pk_bf16_f32 v102, v236, v237
  v_exp_f32 v239, v79
  s_nop 0
  v_cvt_pk_bf16_f32 v103, v238, v239
  v_mfma_f32_16x16x32_bf16 v[120:123], v[240:243], v[96:99], v[128:131]
  s_nop 0
  v_mfma_f32_16x16x32_bf16 v[124:127], v[240:243], v[100:103], v[132:135]
  s_nop 7
  s_branch ka_kernel_ret_74
ka_kernel_kf_13:
  buffer_store_dwordx4 v[128:131], v244, s[12:15], s35 offen offset:0 sc1
  s_branch ka_kernel_kj_14
ka_kernel_kf_15:
  buffer_store_dwordx4 v[132:135], v244, s[12:15], s35 offen offset:1024 sc1
  s_branch ka_kernel_kj_16
ka_kernel_kf_17:
  buffer_store_dwordx4 v[136:139], v246, s[12:15], s35 offen offset:0 sc1
  s_branch ka_kernel_kj_18
ka_kernel_kf_19:
  buffer_store_dwordx4 v[140:143], v246, s[12:15], s35 offen offset:1024 sc1
  s_branch ka_kernel_kj_20
ka_kernel_kf_21:
  buffer_store_dwordx4 v[144:147], v244, s[12:15], s35 offen offset:0 sc1
  s_branch ka_kernel_kj_22
ka_kernel_kf_23:
  buffer_store_dwordx4 v[148:151], v244, s[12:15], s35 offen offset:1024 sc1
  s_branch ka_kernel_kj_24
ka_kernel_kf_25:
  buffer_store_dwordx4 v[152:155], v246, s[12:15], s35 offen offset:0 sc1
  s_branch ka_kernel_kj_26
ka_kernel_kf_27:
  buffer_store_dwordx4 v[156:159], v246, s[12:15], s35 offen offset:1024 sc1
  s_branch ka_kernel_kj_28
ka_kernel_kf_29:
  buffer_store_dwordx4 v[160:163], v244, s[12:15], s35 offen offset:0 sc1
  s_branch ka_kernel_kj_30
ka_kernel_kf_31:
  buffer_store_dwordx4 v[164:167], v244, s[12:15], s35 offen offset:1024 sc1
  s_branch ka_kernel_kj_32
ka_kernel_kf_33:
  buffer_store_dwordx4 v[168:171], v246, s[12:15], s35 offen offset:0 sc1
  s_branch ka_kernel_kj_34
ka_kernel_kf_35:
  buffer_store_dwordx4 v[172:175], v246, s[12:15], s35 offen offset:1024 sc1
  s_branch ka_kernel_kj_36
ka_kernel_kf_37:
  buffer_store_dwordx4 v[176:179], v244, s[12:15], s35 offen offset:0 sc1
  s_branch ka_kernel_kj_38
ka_kernel_kf_39:
  buffer_store_dwordx4 v[180:183], v244, s[12:15], s35 offen offset:1024 sc1
  s_branch ka_kernel_kj_40
ka_kernel_kf_41:
  buffer_store_dwordx4 v[184:187], v246, s[12:15], s35 offen offset:0 sc1
  s_branch ka_kernel_kj_42
ka_kernel_kf_43:
  buffer_store_dwordx4 v[188:191], v246, s[12:15], s35 offen offset:1024 sc1
  s_branch ka_kernel_kj_44
ka_end:
  s_endpgm
.text
.globl kb_kernel
.p2align 8
.type kb_kernel,@function
kb_kernel:
  s_cmp_ge_u32 s2, 256
  s_cbranch_scc1 kb_end
  s_load_dwordx2 s[36:37], s[0:1], 120
  s_load_dwordx2 s[38:39], s[0:1], 0
  s_load_dwordx2 s[40:41], s[0:1], 104
  v_lshrrev_b32 v3, 6, v0
  v_and_b32 v2, 63, v0
  v_readfirstlane_b32 s16, v3
  v_lshlrev_b32 v1, 4, v2
  s_and_b32 s22, s2, 7
  s_lshr_b32 s23, s2, 3
  s_and_b32 s18, s23, 3
  s_lshl_b32 s22, s22, 2
  s_add_u32 s18, s18, s22
  s_lshr_b32 s19, s2, 5
  s_mul_i32 s20, s19, 5
  s_mul_i32 s21, s19, 14
  s_min_u32 s21, s21, 94
  s_and_b32 s42, s19, 1
  s_and_b32 s17, s16, 3
  s_lshl_b32 s27, s18, 2
  s_add_u32 s27, s27, s17
  s_cmp_lt_u32 s16, 4
  s_cbranch_scc1 kb_compute
  s_mul_i32 s44, s17, 5120
  s_mul_i32 s45, s17, 7168
  s_lshl_b32 s46, s17, 12
  s_lshl_b32 s47, s17, 11
  s_cmp_eq_u32 s42, 0
  s_mov_b32 s28, -1024
  s_cselect_b32 s28, 4096, s28
  s_and_b32 s24, s17, 1
  s_cmp_eq_u32 s24, 0
  s_mov_b32 s29, -1024
  s_cselect_b32 s29, 6144, s29
  s_mul_i32 s22, s17, 40
  s_add_u32 s22, s22, s20
  s_add_u32 s22, s22, s42
  s_and_b32 s34, s18, 1
  s_lshl_b32 s34, s34, 6
  s_mul_i32 s23, s34, 40
  s_add_u32 s22, s22, s23
  s_lshl_b32 s35, s17, 13
  s_lshl_b32 s22, s22, 10
  s_add_u32 s48, s22, 0x4800000
  s_mul_i32 s22, s17, 40
  s_add_u32 s22, s22, s20
  s_add_u32 s22, s22, s42
  s_lshl_b32 s22, s22, 10
  s_add_u32 s49, s22, 0x4d00000
  s_mul_i32 s22, s17, 40
  s_add_u32 s22, s22, s20
  s_add_u32 s22, s22, s42
  s_lshl_b32 s22, s22, 10
  s_add_u32 s50, s22, 0x4dd0000
  s_lshr_b32 s22, s17, 1
  s_mul_i32 s22, s22, 108
  s_lshl_b32 s23, s24, 3
  s_add_u32 s22, s22, s23
  s_add_u32 s22, s22, s21
  s_lshl_b32 s22, s22, 10
  s_add_u32 s51, s22, 0x4ea0000
  s_mul_i32 s22, s17, 40
  s_add_u32 s22, s22, s20
  s_add_u32 s22, s22, s42
  s_lshl_b32 s22, s22, 10
  s_add_u32 s52, s22, 0x50c0000
  s_lshl_b32 s22, s27, 7
  s_add_u32 s22, s22, s34
  s_lshl_b32 s22, s22, 10
  s_add_u32 s23, s22, 0x2400000
  v_add_u32 v4, s23, v1
  s_xor_b32 s22, s22, 0x80000
  s_add_u32 s23, s22, 0x2400000
  v_add_u32 v5, s23, v1
  s_waitcnt lgkmcnt(0)
  s_mov_b32 s8, s36
  s_and_b32 s9, s37, 0xffff
  s_mov_b32 s10, 0x10000000
  s_mov_b32 s11, 0x20000
  s_mov_b32 s26, 0
  s_add_u32 m0, s35, 65536
  s_nop 0
  buffer_load_dwordx4 v4, s[8:11], s26 offen offset:0 lds
  buffer_load_dwordx4 v4, s[8:11], s26 offen offset:1024 lds
  buffer_load_dwordx4 v4, s[8:11], s26 offen offset:2048 lds
  buffer_load_dwordx4 v4, s[8:11], s26 offen offset:3072 lds
  s_add_u32 m0, s35, 69632
  s_nop 0
  buffer_load_dwordx4 v5, s[8:11], s26 offen offset:0 lds
  buffer_load_dwordx4 v5, s[8:11], s26 offen offset:1024 lds
  buffer_load_dwordx4 v5, s[8:11], s26 offen offset:2048 lds
  buffer_load_dwordx4 v5, s[8:11], s26 offen offset:3072 lds
  s_add_u32 m0, s44, 0
  s_add_u32 s26, s48, 0
  buffer_load_dwordx4 v1, s[8:11], s26 offen offset:0 lds
  buffer_load_dwordx4 v1, s[8:11], s26 offen offset:1024 lds
  buffer_load_dwordx4 v1, s[8:11], s26 offen offset:2048 lds
  buffer_load_dwordx4 v1, s[8:11], s26 offen offset:3072 lds
  s_add_u32 m0, s44, 4096
  s_add_u32 s26, s26, s28
  buffer_load_dwordx4 v1, s[8:11], s26 offen offset:0 lds
  s_mov_b32 s26, 4096
  s_add_u32 m0, s35, 98304
  s_nop 0
  buffer_load_dwordx4 v4, s[8:11], s26 offen offset:0 lds
  buffer_load_dwordx4 v4, s[8:11], s26 offen offset:1024 lds
  buffer_load_dwordx4 v4, s[8:11], s26 offen offset:2048 lds
  buffer_load_dwordx4 v4, s[8:11], s26 offen offset:3072 lds
  s_add_u32 m0, s35, 102400
  s_nop 0
  buffer_load_dwordx4 v5, s[8:11], s26 offen offset:0 lds
  buffer_load_dwordx4 v5, s[8:11], s26 offen offset:1024 lds
  buffer_load_dwordx4 v5, s[8:11], s26 offen offset:2048 lds
  buffer_load_dwordx4 v5, s[8:11], s26 offen offset:3072 lds
  s_add_u32 m0, s44, 20480
  s_add_u32 s26, s48, 163840
  buffer_load_dwordx4 v1, s[8:11], s26 offen offset:0 lds
  buffer_load_dwordx4 v1, s[8:11], s26 offen offset:1024 lds
  buffer_load_dwordx4 v1, s[8:11], s26 offen offset:2048 lds
  buffer_load_dwordx4 v1, s[8:11], s26 offen offset:3072 lds
  s_add_u32 m0, s44, 24576
  s_add_u32 s26, s26, s28
  buffer_load_dwordx4 v1, s[8:11], s26 offen offset:0 lds
  s_waitcnt vmcnt(13)
  s_barrier
  s_mov_b32 s26, 8192
  s_add_u32 m0, s35, 131072
  s_nop 0
  buffer_load_dwordx4 v4, s[8:11], s26 offen offset:0 lds
  buffer_load_dwordx4 v4, s[8:11], s26 offen offset:1024 lds
  buffer_load_dwordx4 v4, s[8:11], s26 offen offset:2048 lds
  buffer_load_dwordx4 v4, s[8:11], s26 offen offset:3072 lds
  s_add_u32 m0, s35, 135168
  s_nop 0
  buffer_load_dwordx4 v5, s[8:11], s26 offen offset:0 lds
  buffer_load_dwordx4 v5, s[8:11], s26 offen offset:1024 lds
  buffer_load_dwordx4 v5, s[8:11], s26 offen offset:2048 lds
  buffer_load_dwordx4 v5, s[8:11], s26 offen offset:3072 lds
  s_add_u32 m0, s44, 40960
  s_add_u32 s26, s48, 327680
  buffer_load_dwordx4 v1, s[8:11], s26 offen offset:0 lds
  buffer_load_dwordx4 v1, s[8:11], s26 offen offset:1024 lds
  buffer_load_dwordx4 v1, s[8:11], s26 offen offset:2048 lds
  buffer_load_dwordx4 v1, s[8:11], s26 offen offset:3072 lds
  s_add_u32 m0, s44, 45056
  s_add_u32 s26, s26, s28
  buffer_load_dwordx4 v1, s[8:11], s26 offen offset:0 lds
  s_waitcnt vmcnt(13)
  s_barrier
  s_mov_b32 s26, 12288
  s_add_u32 m0, s35, 65536
  s_nop 0
  buffer_load_dwordx4 v4, s[8:11], s26 offen offset:0 lds
  buffer_load_dwordx4 v4, s[8:11], s26 offen offset:1024 lds
  buffer_load_dwordx4 v4, s[8:11], s26 offen offset:2048 lds
  buffer_load_dwordx4 v4, s[8:11], s26 offen offset:3072 lds
  s_add_u32 m0, s35, 69632
  s_nop 0
  buffer_load_dwordx4 v5, s[8:11], s26 offen offset:0 lds
  buffer_load_dwordx4 v5, s[8:11], s26 offen offset:1024 lds
  buffer_load_dwordx4 v5, s[8:11], s26 offen offset:2048 lds
  buffer_load_dwordx4 v5, s[8:11], s26 offen offset:3072 lds
  s_add_u32 m0, s44, 0
  s_add_u32 s26, s48, 491520
  buffer_load_dwordx4 v1, s[8:11], s26 offen offset:0 lds
  buffer_load_dwordx4 v1, s[8:11], s26 offen offset:1024 lds
  buffer_load_dwordx4 v1, s[8:11], s26 offen offset:2048 lds
  buffer_load_dwordx4 v1, s[8:11], s26 offen offset:3072 lds
  s_add_u32 m0, s44, 4096
  s_add_u32 s26, s26, s28
  buffer_load_dwordx4 v1, s[8:11], s26 offen offset:0 lds
  s_waitcnt vmcnt(13)
  s_barrier
  s_mov_b32 s26, 16384
  s_add_u32 m0, s35, 98304
  s_nop 0
  buffer_load_dwordx4 v4, s[8:11], s26 offen offset:0 lds
  buffer_load_dwordx4 v4, s[8:11], s26 offen offset:1024 lds
  buffer_load_dwordx4 v4, s[8:11], s26 offen offset:2048 lds
  buffer_load_dwordx4 v4, s[8:11], s26 offen offset:3072 lds
  s_add_u32 m0, s35, 102400
  s_nop 0
  buffer_load_dwordx4 v5, s[8:11], s26 offen offset:0 lds
  buffer_load_dwordx4 v5, s[8:11], s26 offen offset:1024 lds
  buffer_load_dwordx4 v5, s[8:11], s26 offen offset:2048 lds
  buffer_load_dwordx4 v5, s[8:11], s26 offen offset:3072 lds
  s_add_u32 m0, s44, 20480
  s_add_u32 s26, s48, 655360
  buffer_load_dwordx4 v1, s[8:11], s26 offen offset:0 lds
  buffer_load_dwordx4 v1, s[8:11], s26 offen offset:1024 lds
  buffer_load_dwordx4 v1, s[8:11], s26 offen offset:2048 lds
  buffer_load_dwordx4 v1, s[8:11], s26 offen offset:3072 lds
  s_add_u32 m0, s44, 24576
  s_add_u32 s26, s26, s28
  buffer_load_dwordx4 v1, s[8:11], s26 offen offset:0 lds
  s_waitcnt vmcnt(13)
  s_barrier
  s_mov_b32 s26, 20480
  s_add_u32 m0, s35, 131072
  s_nop 0
  buffer_load_dwordx4 v4, s[8:11], s26 offen offset:0 lds
  buffer_load_dwordx4 v4, s[8:11], s26 offen offset:1024 lds
  buffer_load_dwordx4 v4, s[8:11], s26 offen offset:2048 lds
  buffer_load_dwordx4 v4, s[8:11], s26 offen offset:3072 lds
  s_add_u32 m0, s35, 135168
  s_nop 0
  buffer_load_dwordx4 v5, s[8:11], s26 offen offset:0 lds
  buffer_load_dwordx4 v5, s[8:11], s26 offen offset:1024 lds
  buffer_load_dwordx4 v5, s[8:11], s26 offen offset:2048 lds
  buffer_load_dwordx4 v5, s[8:11], s26 offen offset:3072 lds
  s_add_u32 m0, s44, 40960
  s_add_u32 s26, s48, 819200
  buffer_load_dwordx4 v1, s[8:11], s26 offen offset:0 lds
  buffer_load_dwordx4 v1, s[8:11], s26 offen offset:1024 lds
  buffer_load_dwordx4 v1, s[8:11], s26 offen offset:2048 lds
  buffer_load_dwordx4 v1, s[8:11], s26 offen offset:3072 lds
  s_add_u32 m0, s44, 45056
  s_add_u32 s26, s26, s28
  buffer_load_dwordx4 v1, s[8:11], s26 offen offset:0 lds
  s_waitcnt vmcnt(13)
  s_barrier
  s_mov_b32 s26, 24576
  s_add_u32 m0, s35, 65536
  s_nop 0
  buffer_load_dwordx4 v4, s[8:11], s26 offen offset:0 lds
  buffer_load_dwordx4 v4, s[8:11], s26 offen offset:1024 lds
  buffer_load_dwordx4 v4, s[8:11], s26 offen offset:2048 lds
  buffer_load_dwordx4 v4, s[8:11], s26 offen offset:3072 lds
  s_add_u32 m0, s35, 69632
  s_nop 0
  buffer_load_dwordx4 v5, s[8:11], s26 offen offset:0 lds
  buffer_load_dwordx4 v5, s[8:11], s26 offen offset:1024 lds
  buffer_load_dwordx4 v5, s[8:11], s26 offen offset:2048 lds
  buffer_load_dwordx4 v5, s[8:11], s26 offen offset:3072 lds
  s_add_u32 m0, s44, 0
  s_add_u32 s26, s48, 983040
  buffer_load_dwordx4 v1, s[8:11], s26 offen offset:0 lds
  buffer_load_dwordx4 v1, s[8:11], s26 offen offset:1024 lds
  buffer_load_dwordx4 v1, s[8:11], s26 offen offset:2048 lds
  buffer_load_dwordx4 v1, s[8:11], s26 offen offset:3072 lds
  s_add_u32 m0, s44, 4096
  s_add_u32 s26, s26, s28
  buffer_load_dwordx4 v1, s[8:11], s26 offen offset:0 lds
  s_waitcnt vmcnt(13)
  s_barrier
  s_mov_b32 s26, 28672
  s_add_u32 m0, s35, 98304
  s_nop 0
  buffer_load_dwordx4 v4, s[8:11], s26 offen offset:0 lds
  buffer_load_dwordx4 v4, s[8:11], s26 offen offset:1024 lds
  buffer_load_dwordx4 v4, s[8:11], s26 offen offset:2048 lds
  buffer_load_dwordx4 v4, s[8:11], s26 offen offset:3072 lds
  s_add_u32 m0, s35, 102400
  s_nop 0
  buffer_load_dwordx4 v5, s[8:11], s26 offen offset:0 lds
  buffer_load_dwordx4 v5, s[8:11], s26 offen offset:1024 lds
  buffer_load_dwordx4 v5, s[8:11], s26 offen offset:2048 lds
  buffer_load_dwordx4 v5, s[8:11], s26 offen offset:3072 lds
  s_add_u32 m0, s44, 20480
  s_add_u32 s26, s48, 1146880
  buffer_load_dwordx4 v1, s[8:11], s26 offen offset:0 lds
  buffer_load_dwordx4 v1, s[8:11], s26 offen offset:1024 lds
  buffer_load_dwordx4 v1, s[8:11], s26 offen offset:2048 lds
  buffer_load_dwordx4 v1, s[8:11], s26 offen offset:3072 lds
  s_add_u32 m0, s44, 24576
  s_add_u32 s26, s26, s28
  buffer_load_dwordx4 v1, s[8:11], s26 offen offset:0 lds
  s_waitcnt vmcnt(13)
  s_barrier
  s_mov_b32 s26, 32768
  s_add_u32 m0, s35, 131072
  s_nop 0
  buffer_load_dwordx4 v4, s[8:11], s26 offen offset:0 lds
  buffer_load_dwordx4 v4, s[8:11], s26 offen offset:1024 lds
  buffer_load_dwordx4 v4, s[8:11], s26 offen offset:2048 lds
  buffer_load_dwordx4 v4, s[8:11], s26 offen offset:3072 lds
  s_add_u32 m0, s35, 135168
  s_nop 0
  buffer_load_dwordx4 v5, s[8:11], s26 offen offset:0 lds
  buffer_load_dwordx4 v5, s[8:11], s26 offen offset:1024 lds
  buffer_load_dwordx4 v5, s[8:11], s26 offen offset:2048 lds
  buffer_load_dwordx4 v5, s[8:11], s26 offen offset:3072 lds
  s_add_u32 m0, s44, 40960
  s_add_u32 s26, s48, 1310720
  buffer_load_dwordx4 v1, s[8:11], s26 offen offset:0 lds
  buffer_load_dwordx4 v1, s[8:11], s26 offen offset:1024 lds
  buffer_load_dwordx4 v1, s[8:11], s26 offen offset:2048 lds
  buffer_load_dwordx4 v1, s[8:11], s26 offen offset:3072 lds
  s_add_u32 m0, s44, 45056
  s_add_u32 s26, s26, s28
  buffer_load_dwordx4 v1, s[8:11], s26 offen offset:0 lds
  s_and_b32 s23, s27, 15
  s_getpc_b64 s[30:31]
kb_kernel_pc_1:
  s_add_u32 s30, s30, kb_cpa-kb_kernel_pc_1
  s_addc_u32 s31, s31, 0
  s_lshl_b32 s22, s23, 10
  v_add_u32 v36, s22, v1
  v_min_u32 v37, kb_end2-kb_cpa-16, v36
  global_load_dwordx4 v[32:35], v37, s[30:31]
  v_add_u32 v36, 16384, v36
  v_min_u32 v37, kb_end2-kb_cpa-16, v36
  global_load_dwordx4 v[32:35], v37, s[30:31]
  s_getpc_b64 s[30:31]
kb_kernel_pc_2:
  s_add_u32 s30, s30, kb_lpa-kb_kernel_pc_2
  s_addc_u32 s31, s31, 0
  s_lshl_b32 s22, s23, 10
  v_add_u32 v36, s22, v1
  v_min_u32 v37, kb_compute-kb_lpa-16, v36
  global_load_dwordx4 v[32:35], v37, s[30:31]
  s_waitcnt vmcnt(16)
  s_barrier
  s_mov_b32 s26, 36864
  s_add_u32 m0, s35, 65536
  s_nop 0
  buffer_load_dwordx4 v4, s[8:11], s26 offen offset:0 lds
  buffer_load_dwordx4 v4, s[8:11], s26 offen offset:1024 lds
  buffer_load_dwordx4 v4, s[8:11], s26 offen offset:2048 lds
  buffer_load_dwordx4 v4, s[8:11], s26 offen offset:3072 lds
  s_add_u32 m0, s35, 69632
  s_nop 0
  buffer_load_dwordx4 v5, s[8:11], s26 offen offset:0 lds
  buffer_load_dwordx4 v5, s[8:11], s26 offen offset:1024 lds
  buffer_load_dwordx4 v5, s[8:11], s26 offen offset:2048 lds
  buffer_load_dwordx4 v5, s[8:11], s26 offen offset:3072 lds
  s_add_u32 m0, s44, 0
  s_add_u32 s26, s48, 1474560
  buffer_load_dwordx4 v1, s[8:11], s26 offen offset:0 lds
  buffer_load_dwordx4 v1, s[8:11], s26 offen offset:1024 lds
  buffer_load_dwordx4 v1, s[8:11], s26 offen offset:2048 lds
  buffer_load_dwordx4 v1, s[8:11], s26 offen offset:3072 lds
  s_add_u32 m0, s44, 4096
  s_add_u32 s26, s26, s28
  buffer_load_dwordx4 v1, s[8:11], s26 offen offset:0 lds
  s_waitcnt vmcnt(16)
  s_barrier
  s_mov_b32 s26, 40960
  s_add_u32 m0, s35, 98304
  s_nop 0
  buffer_load_dwordx4 v4, s[8:11], s26 offen offset:0 lds
  buffer_load_dwordx4 v4, s[8:11], s26 offen offset:1024 lds
  buffer_load_dwordx4 v4, s[8:11], s26 offen offset:2048 lds
  buffer_load_dwordx4 v4, s[8:11], s26 offen offset:3072 lds
  s_add_u32 m0, s35, 102400
  s_nop 0
  buffer_load_dwordx4 v5, s[8:11], s26 offen offset:0 lds
  buffer_load_dwordx4 v5, s[8:11], s26 offen offset:1024 lds
  buffer_load_dwordx4 v5, s[8:11], s26 offen offset:2048 lds
  buffer_load_dwordx4 v5, s[8:11], s26 offen offset:3072 lds
  s_add_u32 m0, s44, 20480
  s_add_u32 s26, s48, 1638400
  buffer_load_dwordx4 v1, s[8:11], s26 offen offset:0 lds
  buffer_load_dwordx4 v1, s[8:11], s26 offen offset:1024 lds
  buffer_load_dwordx4 v1, s[8:11], s26 offen offset:2048 lds
  buffer_load_dwordx4 v1, s[8:11], s26 offen offset:3072 lds
  s_add_u32 m0, s44, 24576
  s_add_u32 s26, s26, s28
  buffer_load_dwordx4 v1, s[8:11], s26 offen offset:0 lds
  s_waitcnt vmcnt(13)
  s_barrier
  s_mov_b32 s26, 45056
  s_add_u32 m0, s35, 131072
  s_nop 0
  buffer_load_dwordx4 v4, s[8:11], s26 offen offset:0 lds
  buffer_load_dwordx4 v4, s[8:11], s26 offen offset:1024 lds
  buffer_load_dwordx4 v4, s[8:11], s26 offen offset:2048 lds
  buffer_load_dwordx4 v4, s[8:11], s26 offen offset:3072 lds
  s_add_u32 m0, s35, 135168
  s_nop 0
  buffer_load_dwordx4 v5, s[8:11], s26 offen offset:0 lds
  buffer_load_dwordx4 v5, s[8:11], s26 offen offset:1024 lds
  buffer_load_dwordx4 v5, s[8:11], s26 offen offset:2048 lds
  buffer_load_dwordx4 v5, s[8:11], s26 offen offset:3072 lds
  s_add_u32 m0, s44, 40960
  s_add_u32 s26, s48, 1802240
  buffer_load_dwordx4 v1, s[8:11], s26 offen offset:0 lds
  buffer_load_dwordx4 v1, s[8:11], s26 offen offset:1024 lds
  buffer_load_dwordx4 v1, s[8:11], s26 offen offset:2048 lds
  buffer_load_dwordx4 v1, s[8:11], s26 offen offset:3072 lds
  s_add_u32 m0, s44, 45056
  s_add_u32 s26, s26, s28
  buffer_load_dwordx4 v1, s[8:11], s26 offen offset:0 lds
  s_waitcnt vmcnt(13)
  s_barrier
  s_mov_b32 s26, 49152
  s_add_u32 m0, s35, 65536
  s_nop 0
  buffer_load_dwordx4 v4, s[8:11], s26 offen offset:0 lds
  buffer_load_dwordx4 v4, s[8:11], s26 offen offset:1024 lds
  buffer_load_dwordx4 v4, s[8:11], s26 offen offset:2048 lds
  buffer_load_dwordx4 v4, s[8:11], s26 offen offset:3072 lds
  s_add_u32 m0, s35, 69632
  s_nop 0
  buffer_load_dwordx4 v5, s[8:11], s26 offen offset:0 lds
  buffer_load_dwordx4 v5, s[8:11], s26 offen offset:1024 lds
  buffer_load_dwordx4 v5, s[8:11], s26 offen offset:2048 lds
  buffer_load_dwordx4 v5, s[8:11], s26 offen offset:3072 lds
  s_add_u32 m0, s44, 0
  s_add_u32 s26, s48, 1966080
  buffer_load_dwordx4 v1, s[8:11], s26 offen offset:0 lds
  buffer_load_dwordx4 v1, s[8:11], s26 offen offset:1024 lds
  buffer_load_dwordx4 v1, s[8:11], s26 offen offset:2048 lds
  buffer_load_dwordx4 v1, s[8:11], s26 offen offset:3072 lds
  s_add_u32 m0, s44, 4096
  s_add_u32 s26, s26, s28
  buffer_load_dwordx4 v1, s[8:11], s26 offen offset:0 lds
  s_waitcnt vmcnt(13)
  s_barrier
  s_mov_b32 s26, 53248
  s_add_u32 m0, s35, 98304
  s_nop 0
  buffer_load_dwordx4 v4, s[8:11], s26 offen offset:0 lds
  buffer_load_dwordx4 v4, s[8:11], s26 offen offset:1024 lds
  buffer_load_dwordx4 v4, s[8:11], s26 offen offset:2048 lds
  buffer_load_dwordx4 v4, s[8:11], s26 offen offset:3072 lds
  s_add_u32 m0, s35, 102400
  s_nop 0
  buffer_load_dwordx4 v5, s[8:11], s26 offen offset:0 lds
  buffer_load_dwordx4 v5, s[8:11], s26 offen offset:1024 lds
  buffer_load_dwordx4 v5, s[8:11], s26 offen offset:2048 lds
  buffer_load_dwordx4 v5, s[8:11], s26 offen offset:3072 lds
  s_add_u32 m0, s44, 20480
  s_add_u32 s26, s48, 2129920
  buffer_load_dwordx4 v1, s[8:11], s26 offen offset:0 lds
  buffer_load_dwordx4 v1, s[8:11], s26 offen offset:1024 lds
  buffer_load_dwordx4 v1, s[8:11], s26 offen offset:2048 lds
  buffer_load_dwordx4 v1, s[8:11], s26 offen offset:3072 lds
  s_add_u32 m0, s44, 24576
  s_add_u32 s26, s26, s28
  buffer_load_dwordx4 v1, s[8:11], s26 offen offset:0 lds
  s_waitcnt vmcnt(13)
  s_barrier
  s_mov_b32 s26, 57344
  s_add_u32 m0, s35, 131072
  s_nop 0
  buffer_load_dwordx4 v4, s[8:11], s26 offen offset:0 lds
  buffer_load_dwordx4 v4, s[8:11], s26 offen offset:1024 lds
  buffer_load_dwordx4 v4, s[8:11], s26 offen offset:2048 lds
  buffer_load_dwordx4 v4, s[8:11], s26 offen offset:3072 lds
  s_add_u32 m0, s35, 135168
  s_nop 0
  buffer_load_dwordx4 v5, s[8:11], s26 offen offset:0 lds
  buffer_load_dwordx4 v5, s[8:11], s26 offen offset:1024 lds
  buffer_load_dwordx4 v5, s[8:11], s26 offen offset:2048 lds
  buffer_load_dwordx4 v5, s[8:11], s26 offen offset:3072 lds
  s_add_u32 m0, s44, 40960
  s_add_u32 s26, s48, 2293760
  buffer_load_dwordx4 v1, s[8:11], s26 offen offset:0 lds
  buffer_load_dwordx4 v1, s[8:11], s26 offen offset:1024 lds
  buffer_load_dwordx4 v1, s[8:11], s26 offen offset:2048 lds
  buffer_load_dwordx4 v1, s[8:11], s26 offen offset:3072 lds
  s_add_u32 m0, s44, 45056
  s_add_u32 s26, s26, s28
  buffer_load_dwordx4 v1, s[8:11], s26 offen offset:0 lds
  s_waitcnt vmcnt(13)
  s_barrier
  s_mov_b32 s26, 61440
  s_add_u32 m0, s35, 65536
  s_nop 0
  buffer_load_dwordx4 v4, s[8:11], s26 offen offset:0 lds
  buffer_load_dwordx4 v4, s[8:11], s26 offen offset:1024 lds
  buffer_load_dwordx4 v4, s[8:11], s26 offen offset:2048 lds
  buffer_load_dwordx4 v4, s[8:11], s26 offen offset:3072 lds
  s_add_u32 m0, s35, 69632
  s_nop 0
  buffer_load_dwordx4 v5, s[8:11], s26 offen offset:0 lds
  buffer_load_dwordx4 v5, s[8:11], s26 offen offset:1024 lds
  buffer_load_dwordx4 v5, s[8:11], s26 offen offset:2048 lds
  buffer_load_dwordx4 v5, s[8:11], s26 offen offset:3072 lds
  s_add_u32 m0, s44, 0
  s_add_u32 s26, s48, 2457600
  buffer_load_dwordx4 v1, s[8:11], s26 offen offset:0 lds
  buffer_load_dwordx4 v1, s[8:11], s26 offen offset:1024 lds
  buffer_load_dwordx4 v1, s[8:11], s26 offen offset:2048 lds
  buffer_load_dwordx4 v1, s[8:11], s26 offen offset:3072 lds
  s_add_u32 m0, s44, 4096
  s_add_u32 s26, s26, s28
  buffer_load_dwordx4 v1, s[8:11], s26 offen offset:0 lds
  s_waitcnt vmcnt(13)
  s_barrier
  s_add_u32 m0, s44, 20480
  s_add_u32 s26, s49, 0
  buffer_load_dwordx4 v1, s[8:11], s26 offen offset:0 lds
  buffer_load_dwordx4 v1, s[8:11], s26 offen offset:1024 lds
  buffer_load_dwordx4 v1, s[8:11], s26 offen offset:2048 lds
  buffer_load_dwordx4 v1, s[8:11], s26 offen offset:3072 lds
  s_add_u32 m0, s44, 24576
  s_add_u32 s26, s26, s28
  buffer_load_dwordx4 v1, s[8:11], s26 offen offset:0 lds
kb_lpa:
  s_waitcnt vmcnt(5)
  s_barrier
  s_add_u32 m0, s44, 40960
  s_add_u32 s26, s49, 163840
  buffer_load_dwordx4 v1, s[8:11], s26 offen offset:0 lds
  buffer_load_dwordx4 v1, s[8:11], s26 offen offset:1024 lds
  buffer_load_dwordx4 v1, s[8:11], s26 offen offset:2048 lds
  buffer_load_dwordx4 v1, s[8:11], s26 offen offset:3072 lds
  s_add_u32 m0, s44, 45056
  s_add_u32 s26, s26, s28
  buffer_load_dwordx4 v1, s[8:11], s26 offen offset:0 lds
  s_barrier
  s_add_u32 m0, s44, 0
  s_add_u32 s26, s49, 327680
  buffer_load_dwordx4 v1, s[8:11], s26 offen offset:0 lds
  buffer_load_dwordx4 v1, s[8:11], s26 offen offset:1024 lds
  buffer_load_dwordx4 v1, s[8:11], s26 offen offset:2048 lds
  buffer_load_dwordx4 v1, s[8:11], s26 offen offset:3072 lds
  s_add_u32 m0, s44, 4096
  s_add_u32 s26, s26, s28
  buffer_load_dwordx4 v1, s[8:11], s26 offen offset:0 lds
  s_add_u32 m0, s44, 61440
  s_add_u32 s26, s49, 491520
  buffer_load_dwordx4 v1, s[8:11], s26 offen offset:0 lds
  buffer_load_dwordx4 v1, s[8:11], s26 offen offset:1024 lds
  buffer_load_dwordx4 v1, s[8:11], s26 offen offset:2048 lds
  buffer_load_dwordx4 v1, s[8:11], s26 offen offset:3072 lds
  s_add_u32 m0, s44, 65536
  s_add_u32 s26, s26, s28
  buffer_load_dwordx4 v1, s[8:11], s26 offen offset:0 lds
  s_lshl_b32 s22, s27, 7
  v_mov_b32 v10, s22
  v_and_b32 v11, 14, v2
  v_lshl_add_u32 v8, v11, 2, v10
  v_add_u32 v8, 0xe0000, v8
  s_mul_i32 s22, s27, 20480
  s_add_u32 s22, s22, 0x400000
  v_add_u32 v4, s22, v1
  s_mov_b32 s25, 0x40000
  s_barrier
kb_kernel_poll_3:
  buffer_load_dword v20, v8, s[8:11], 0 offen sc1
  s_waitcnt vmcnt(0)
  v_cmp_eq_u32 vcc, 0, v20
  s_cbranch_vccz kb_kernel_pok_4
  s_sleep 1
  s_sub_u32 s25, s25, 1
  s_cmp_lg_u32 s25, 0
  s_cbranch_scc1 kb_kernel_poll_3
kb_kernel_pok_4:
  s_add_u32 m0, s46, 98304
  s_mov_b32 s26, 0
  buffer_load_dwordx4 v4, s[8:11], s26 offen offset:0 sc1 lds
  buffer_load_dwordx4 v4, s[8:11], s26 offen offset:1024 sc1 lds
  buffer_load_dwordx4 v4, s[8:11], s26 offen offset:2048 sc1 lds
  buffer_load_dwordx4 v4, s[8:11], s26 offen offset:3072 sc1 lds
  s_add_u32 m0, s46, 114688
  s_mov_b32 s26, 4096
  buffer_load_dwordx4 v4, s[8:11], s26 offen offset:0 sc1 lds
  buffer_load_dwordx4 v4, s[8:11], s26 offen offset:1024 sc1 lds
  buffer_load_dwordx4 v4, s[8:11], s26 offen offset:2048 sc1 lds
  buffer_load_dwordx4 v4, s[8:11], s26 offen offset:3072 sc1 lds
  s_add_u32 m0, s46, 131072
  s_mov_b32 s26, 8192
  buffer_load_dwordx4 v4, s[8:11], s26 offen offset:0 sc1 lds
  buffer_load_dwordx4 v4, s[8:11], s26 offen offset:1024 sc1 lds
  buffer_load_dwordx4 v4, s[8:11], s26 offen offset:2048 sc1 lds
  buffer_load_dwordx4 v4, s[8:11], s26 offen offset:3072 sc1 lds
  s_waitcnt vmcnt(8)
  s_barrier
  s_add_u32 m0, s46, 147456
  s_mov_b32 s26, 12288
  buffer_load_dwordx4 v4, s[8:11], s26 offen offset:0 sc1 lds
  buffer_load_dwordx4 v4, s[8:11], s26 offen offset:1024 sc1 lds
  buffer_load_dwordx4 v4, s[8:11], s26 offen offset:2048 sc1 lds
  buffer_load_dwordx4 v4, s[8:11], s26 offen offset:3072 sc1 lds
  s_waitcnt vmcnt(8)
  s_barrier
  s_add_u32 m0, s46, 81920
  s_mov_b32 s26, 16384
  buffer_load_dwordx4 v4, s[8:11], s26 offen offset:0 sc1 lds
  buffer_load_dwordx4 v4, s[8:11], s26 offen offset:1024 sc1 lds
  buffer_load_dwordx4 v4, s[8:11], s26 offen offset:2048 sc1 lds
  buffer_load_dwordx4 v4, s[8:11], s26 offen offset:3072 sc1 lds
  s_add_u32 m0, s44, 20480
  s_add_u32 s26, s49, 655360
  buffer_load_dwordx4 v1, s[8:11], s26 offen offset:0 lds
  buffer_load_dwordx4 v1, s[8:11], s26 offen offset:1024 lds
  buffer_load_dwordx4 v1, s[8:11], s26 offen offset:2048 lds
  buffer_load_dwordx4 v1, s[8:11], s26 offen offset:3072 lds
  s_add_u32 m0, s44, 24576
  s_add_u32 s26, s26, s28
  buffer_load_dwordx4 v1, s[8:11], s26 offen offset:0 lds
  s_waitcnt vmcnt(13)
  s_barrier
  s_waitcnt vmcnt(9)
  s_barrier
  s_add_u32 m0, s44, 40960
  s_add_u32 s26, s50, 0
  buffer_load_dwordx4 v1, s[8:11], s26 offen offset:0 lds
  buffer_load_dwordx4 v1, s[8:11], s26 offen offset:1024 lds
  buffer_load_dwordx4 v1, s[8:11], s26 offen offset:2048 lds
  buffer_load_dwordx4 v1, s[8:11], s26 offen offset:3072 lds
  s_add_u32 m0, s44, 45056
  s_add_u32 s26, s26, s28
  buffer_load_dwordx4 v1, s[8:11], s26 offen offset:0 lds
  s_add_u32 m0, s44, 0
  s_add_u32 s26, s50, 163840
  buffer_load_dwordx4 v1, s[8:11], s26 offen offset:0 lds
  buffer_load_dwordx4 v1, s[8:11], s26 offen offset:1024 lds
  buffer_load_dwordx4 v1, s[8:11], s26 offen offset:2048 lds
  buffer_load_dwordx4 v1, s[8:11], s26 offen offset:3072 lds
  s_add_u32 m0, s44, 4096
  s_add_u32 s26, s26, s28
  buffer_load_dwordx4 v1, s[8:11], s26 offen offset:0 lds
  s_waitcnt vmcnt(10)
  s_barrier
  s_add_u32 m0, s44, 61440
  s_add_u32 s26, s50, 327680
  buffer_load_dwordx4 v1, s[8:11], s26 offen offset:0 lds
  buffer_load_dwordx4 v1, s[8:11], s26 offen offset:1024 lds
  buffer_load_dwordx4 v1, s[8:11], s26 offen offset:2048 lds
  buffer_load_dwordx4 v1, s[8:11], s26 offen offset:3072 lds
  s_add_u32 m0, s44, 65536
  s_add_u32 s26, s26, s28
  buffer_load_dwordx4 v1, s[8:11], s26 offen offset:0 lds
  s_barrier
  s_add_u32 m0, s44, 20480
  s_add_u32 s26, s50, 491520
  buffer_load_dwordx4 v1, s[8:11], s26 offen offset:0 lds
  buffer_load_dwordx4 v1, s[8:11], s26 offen offset:1024 lds
  buffer_load_dwordx4 v1, s[8:11], s26 offen offset:2048 lds
  buffer_load_dwordx4 v1, s[8:11], s26 offen offset:3072 lds
  s_add_u32 m0, s44, 24576
  s_add_u32 s26, s26, s28
  buffer_load_dwordx4 v1, s[8:11], s26 offen offset:0 lds
  v_lshrrev_b32 v10, 4, v2
  v_min_u32 v10, 2, v10
  s_sub_u32 s22, s27, 1
  v_add_u32 v10, s22, v10
  v_max_i32 v10, 0, v10
  v_min_i32 v10, 127, v10
  v_lshlrev_b32 v10, 7, v10
  v_and_b32 v11, 14, v2
  v_lshl_add_u32 v8, v11, 2, v10
  v_add_u32 v8, 0xe4000, v8
  v_and_b32 v10, 15, v2
  s_lshl_b32 s22, s27, 4
  v_add_u32 v10, s22, v10
  v_and_b32 v11, 0x300, v1
  v_add_u32 v11, 0x680000, v11
  v_mov_b32 v14, 0x40000000
  v_add_u32 v12, -1, v10
  v_cmp_gt_u32 vcc, 2048, v12
  v_lshrrev_b32 v13, 4, v12
  v_mul_u32_u24 v13, 20480, v13
  v_and_b32 v12, 15, v12
  v_lshl_add_u32 v13, v12, 4, v13
  v_add_u32 v13, v13, v11
  v_cndmask_b32 v4, v14, v13, vcc
  v_add_u32 v12, 1, v10
  v_cmp_gt_u32 vcc, 2048, v12
  v_lshrrev_b32 v13, 4, v12
  v_mul_u32_u24 v13, 20480, v13
  v_and_b32 v12, 15, v12
  v_lshl_add_u32 v13, v12, 4, v13
  v_add_u32 v13, v13, v11
  v_cndmask_b32 v5, v14, v13, vcc
  v_add_u32 v12, -2, v10
  v_cmp_gt_u32 vcc, 2048, v12
  v_lshrrev_b32 v13, 4, v12
  v_mul_u32_u24 v13, 20480, v13
  v_and_b32 v12, 15, v12
  v_lshl_add_u32 v13, v12, 4, v13
  v_add_u32 v13, v13, v11
  v_cndmask_b32 v6, v14, v13, vcc
  v_add_u32 v12, 2, v10
  v_cmp_gt_u32 vcc, 2048, v12
  v_lshrrev_b32 v13, 4, v12
  v_mul_u32_u24 v13, 20480, v13
  v_and_b32 v12, 15, v12
  v_lshl_add_u32 v13, v12, 4, v13
  v_add_u32 v13, v13, v11
  v_cndmask_b32 v7, v14, v13, vcc
  s_mov_b32 s25, 0x40000
  s_barrier
kb_kernel_poll_5:
  buffer_load_dword v20, v8, s[8:11], 0 offen sc1
  s_waitcnt vmcnt(0)
  v_cmp_eq_u32 vcc, 0, v20
  s_cbranch_vccz kb_kernel_pok_6
  s_sleep 1
  s_sub_u32 s25, s25, 1
  s_cmp_lg_u32 s25, 0
  s_cbranch_scc1 kb_kernel_poll_5
kb_kernel_pok_6:
  s_add_u32 m0, s46, 98304
  s_mov_b32 s26, 0
  buffer_load_dwordx4 v4, s[8:11], s26 offen offset:0 sc1 lds
  buffer_load_dwordx4 v4, s[8:11], s26 offen offset:1024 sc1 lds
  buffer_load_dwordx4 v4, s[8:11], s26 offen offset:2048 sc1 lds
  buffer_load_dwordx4 v4, s[8:11], s26 offen offset:3072 sc1 lds
  s_add_u32 m0, s46, 114688
  s_mov_b32 s26, 4096
  buffer_load_dwordx4 v4, s[8:11], s26 offen offset:0 sc1 lds
  buffer_load_dwordx4 v5, s[8:11], s26 offen offset:1024 sc1 lds
  buffer_load_dwordx4 v5, s[8:11], s26 offen offset:2048 sc1 lds
  buffer_load_dwordx4 v5, s[8:11], s26 offen offset:3072 sc1 lds
  s_add_u32 m0, s46, 131072
  s_mov_b32 s26, 8192
  buffer_load_dwordx4 v5, s[8:11], s26 offen offset:0 sc1 lds
  buffer_load_dwordx4 v5, s[8:11], s26 offen offset:1024 sc1 lds
  buffer_load_dwordx4 v6, s[8:11], s26 offen offset:2048 sc1 lds
  buffer_load_dwordx4 v6, s[8:11], s26 offen offset:3072 sc1 lds
  s_waitcnt vmcnt(8)
  s_barrier
  s_add_u32 m0, s46, 147456
  s_mov_b32 s26, 12288
  buffer_load_dwordx4 v6, s[8:11], s26 offen offset:0 sc1 lds
  buffer_load_dwordx4 v6, s[8:11], s26 offen offset:1024 sc1 lds
  buffer_load_dwordx4 v6, s[8:11], s26 offen offset:2048 sc1 lds
  buffer_load_dwordx4 v7, s[8:11], s26 offen offset:3072 sc1 lds
  s_waitcnt vmcnt(8)
  s_barrier
  s_add_u32 m0, s46, 81920
  s_mov_b32 s26, 16384
  buffer_load_dwordx4 v7, s[8:11], s26 offen offset:0 sc1 lds
  buffer_load_dwordx4 v7, s[8:11], s26 offen offset:1024 sc1 lds
  buffer_load_dwordx4 v7, s[8:11], s26 offen offset:2048 sc1 lds
  buffer_load_dwordx4 v7, s[8:11], s26 offen offset:3072 sc1 lds
  s_add_u32 m0, s44, 40960
  s_add_u32 s26, s50, 655360
  buffer_load_dwordx4 v1, s[8:11], s26 offen offset:0 lds
  buffer_load_dwordx4 v1, s[8:11], s26 offen offset:1024 lds
  buffer_load_dwordx4 v1, s[8:11], s26 offen offset:2048 lds
  buffer_load_dwordx4 v1, s[8:11], s26 offen offset:3072 lds
  s_add_u32 m0, s44, 45056
  s_add_u32 s26, s26, s28
  buffer_load_dwordx4 v1, s[8:11], s26 offen offset:0 lds
  s_waitcnt vmcnt(13)
  s_barrier
  s_waitcnt vmcnt(9)
  s_barrier
  s_waitcnt vmcnt(0)
  s_barrier
  s_add_u32 m0, s45, 0
  s_add_u32 s26, s51, 0
  buffer_load_dwordx4 v1, s[8:11], s26 offen offset:0 lds
  buffer_load_dwordx4 v1, s[8:11], s26 offen offset:1024 lds
  buffer_load_dwordx4 v1, s[8:11], s26 offen offset:2048 lds
  buffer_load_dwordx4 v1, s[8:11], s26 offen offset:3072 lds
  s_add_u32 m0, s45, 6144
  s_add_u32 s26, s26, s29
  buffer_load_dwordx4 v1, s[8:11], s26 offen offset:0 lds
  s_add_u32 m0, s45, 4096
  s_add_u32 s26, s51, 4096
  buffer_load_dwordx4 v1, s[8:11], s26 offen offset:0 lds
  buffer_load_dwordx4 v1, s[8:11], s26 offen offset:1024 lds
  s_barrier
  s_add_u32 m0, s45, 28672
  s_add_u32 s26, s51, 221184
  buffer_load_dwordx4 v1, s[8:11], s26 offen offset:0 lds
  buffer_load_dwordx4 v1, s[8:11], s26 offen offset:1024 lds
  buffer_load_dwordx4 v1, s[8:11], s26 offen offset:2048 lds
  buffer_load_dwordx4 v1, s[8:11], s26 offen offset:3072 lds
  s_add_u32 m0, s45, 34816
  s_add_u32 s26, s26, s29
  buffer_load_dwordx4 v1, s[8:11], s26 offen offset:0 lds
  s_add_u32 m0, s45, 32768
  s_add_u32 s26, s51, 225280
  buffer_load_dwordx4 v1, s[8:11], s26 offen offset:0 lds
  buffer_load_dwordx4 v1, s[8:11], s26 offen offset:1024 lds
  s_add_u32 m0, s45, 57344
  s_add_u32 s26, s51, 442368
  buffer_load_dwordx4 v1, s[8:11], s26 offen offset:0 lds
  buffer_load_dwordx4 v1, s[8:11], s26 offen offset:1024 lds
  buffer_load_dwordx4 v1, s[8:11], s26 offen offset:2048 lds
  buffer_load_dwordx4 v1, s[8:11], s26 offen offset:3072 lds
  s_add_u32 m0, s45, 63488
  s_add_u32 s26, s26, s29
  buffer_load_dwordx4 v1, s[8:11], s26 offen offset:0 lds
  s_add_u32 m0, s45, 61440
  s_add_u32 s26, s51, 446464
  buffer_load_dwordx4 v1, s[8:11], s26 offen offset:0 lds
  buffer_load_dwordx4 v1, s[8:11], s26 offen offset:1024 lds
  s_add_u32 m0, s45, 86016
  s_add_u32 s26, s51, 663552
  buffer_load_dwordx4 v1, s[8:11], s26 offen offset:0 lds
  buffer_load_dwordx4 v1, s[8:11], s26 offen offset:1024 lds
  buffer_load_dwordx4 v1, s[8:11], s26 offen offset:2048 lds
  buffer_load_dwordx4 v1, s[8:11], s26 offen offset:3072 lds
  s_add_u32 m0, s45, 92160
  s_add_u32 s26, s26, s29
  buffer_load_dwordx4 v1, s[8:11], s26 offen offset:0 lds
  s_add_u32 m0, s45, 90112
  s_add_u32 s26, s51, 667648
  buffer_load_dwordx4 v1, s[8:11], s26 offen offset:0 lds
  buffer_load_dwordx4 v1, s[8:11], s26 offen offset:1024 lds
  s_lshl_b32 s22, s27, 7
  v_mov_b32 v10, s22
  v_and_b32 v11, 14, v2
  v_lshl_add_u32 v8, v11, 2, v10
  v_add_u32 v8, 0xe8000, v8
  s_mul_i32 s22, s27, 20480
  s_add_u32 s22, s22, 0x900000
  v_add_u32 v4, s22, v1
  s_mov_b32 s25, 0x40000
  s_barrier
kb_kernel_poll_7:
  buffer_load_dword v20, v8, s[8:11], 0 offen sc1
  s_waitcnt vmcnt(0)
  v_cmp_eq_u32 vcc, 0, v20
  s_cbranch_vccz kb_kernel_pok_8
  s_sleep 1
  s_sub_u32 s25, s25, 1
  s_cmp_lg_u32 s25, 0
  s_cbranch_scc1 kb_kernel_poll_7
kb_kernel_pok_8:
  s_add_u32 m0, s47, 114688
  s_mov_b32 s26, 0
  buffer_load_dwordx4 v4, s[8:11], s26 offen offset:0 sc1 lds
  buffer_load_dwordx4 v4, s[8:11], s26 offen offset:1024 sc1 lds
  s_add_u32 m0, s47, 122880
  s_mov_b32 s26, 2048
  buffer_load_dwordx4 v4, s[8:11], s26 offen offset:0 sc1 lds
  buffer_load_dwordx4 v4, s[8:11], s26 offen offset:1024 sc1 lds
  s_add_u32 m0, s47, 131072
  s_mov_b32 s26, 4096
  buffer_load_dwordx4 v4, s[8:11], s26 offen offset:0 sc1 lds
  buffer_load_dwordx4 v4, s[8:11], s26 offen offset:1024 sc1 lds
  s_waitcnt vmcnt(4)
  s_barrier
  s_add_u32 m0, s47, 139264
  s_mov_b32 s26, 6144
  buffer_load_dwordx4 v4, s[8:11], s26 offen offset:0 sc1 lds
  buffer_load_dwordx4 v4, s[8:11], s26 offen offset:1024 sc1 lds
  s_waitcnt vmcnt(4)
  s_barrier
  s_add_u32 m0, s47, 147456
  s_mov_b32 s26, 8192
  buffer_load_dwordx4 v4, s[8:11], s26 offen offset:0 sc1 lds
  buffer_load_dwordx4 v4, s[8:11], s26 offen offset:1024 sc1 lds
  s_add_u32 m0, s45, 0
  s_add_u32 s26, s51, 884736
  buffer_load_dwordx4 v1, s[8:11], s26 offen offset:0 lds
  buffer_load_dwordx4 v1, s[8:11], s26 offen offset:1024 lds
  buffer_load_dwordx4 v1, s[8:11], s26 offen offset:2048 lds
  buffer_load_dwordx4 v1, s[8:11], s26 offen offset:3072 lds
  s_add_u32 m0, s45, 6144
  s_add_u32 s26, s26, s29
  buffer_load_dwordx4 v1, s[8:11], s26 offen offset:0 lds
  s_add_u32 m0, s45, 4096
  s_add_u32 s26, s51, 888832
  buffer_load_dwordx4 v1, s[8:11], s26 offen offset:0 lds
  buffer_load_dwordx4 v1, s[8:11], s26 offen offset:1024 lds
  s_waitcnt vmcnt(11)
  s_barrier
  s_add_u32 m0, s47, 155648
  s_mov_b32 s26, 10240
  buffer_load_dwordx4 v4, s[8:11], s26 offen offset:0 sc1 lds
  buffer_load_dwordx4 v4, s[8:11], s26 offen offset:1024 sc1 lds
  s_add_u32 m0, s45, 28672
  s_add_u32 s26, s51, 1105920
  buffer_load_dwordx4 v1, s[8:11], s26 offen offset:0 lds
  buffer_load_dwordx4 v1, s[8:11], s26 offen offset:1024 lds
  buffer_load_dwordx4 v1, s[8:11], s26 offen offset:2048 lds
  buffer_load_dwordx4 v1, s[8:11], s26 offen offset:3072 lds
  s_add_u32 m0, s45, 34816
  s_add_u32 s26, s26, s29
  buffer_load_dwordx4 v1, s[8:11], s26 offen offset:0 lds
  s_add_u32 m0, s45, 32768
  s_add_u32 s26, s51, 1110016
  buffer_load_dwordx4 v1, s[8:11], s26 offen offset:0 lds
  buffer_load_dwordx4 v1, s[8:11], s26 offen offset:1024 lds
  s_waitcnt vmcnt(18)
  s_barrier
  s_add_u32 m0, s47, 114688
  s_mov_b32 s26, 12288
  buffer_load_dwordx4 v4, s[8:11], s26 offen offset:0 sc1 lds
  buffer_load_dwordx4 v4, s[8:11], s26 offen offset:1024 sc1 lds
  s_add_u32 m0, s45, 57344
  s_add_u32 s26, s51, 1327104
  buffer_load_dwordx4 v1, s[8:11], s26 offen offset:0 lds
  buffer_load_dwordx4 v1, s[8:11], s26 offen offset:1024 lds
  buffer_load_dwordx4 v1, s[8:11], s26 offen offset:2048 lds
  buffer_load_dwordx4 v1, s[8:11], s26 offen offset:3072 lds
  s_add_u32 m0, s45, 63488
  s_add_u32 s26, s26, s29
  buffer_load_dwordx4 v1, s[8:11], s26 offen offset:0 lds
  s_add_u32 m0, s45, 61440
  s_add_u32 s26, s51, 1331200
  buffer_load_dwordx4 v1, s[8:11], s26 offen offset:0 lds
  buffer_load_dwordx4 v1, s[8:11], s26 offen offset:1024 lds
  s_waitcnt vmcnt(18)
  s_barrier
  s_add_u32 m0, s47, 122880
  s_mov_b32 s26, 14336
  buffer_load_dwordx4 v4, s[8:11], s26 offen offset:0 sc1 lds
  buffer_load_dwordx4 v4, s[8:11], s26 offen offset:1024 sc1 lds
  s_add_u32 m0, s45, 86016
  s_add_u32 s26, s51, 1548288
  buffer_load_dwordx4 v1, s[8:11], s26 offen offset:0 lds
  buffer_load_dwordx4 v1, s[8:11], s26 offen offset:1024 lds
  buffer_load_dwordx4 v1, s[8:11], s26 offen offset:2048 lds
  buffer_load_dwordx4 v1, s[8:11], s26 offen offset:3072 lds
  s_add_u32 m0, s45, 92160
  s_add_u32 s26, s26, s29
  buffer_load_dwordx4 v1, s[8:11], s26 offen offset:0 lds
  s_add_u32 m0, s45, 90112
  s_add_u32 s26, s51, 1552384
  buffer_load_dwordx4 v1, s[8:11], s26 offen offset:0 lds
  buffer_load_dwordx4 v1, s[8:11], s26 offen offset:1024 lds
  s_waitcnt vmcnt(18)
  s_barrier
  s_add_u32 m0, s47, 131072
  s_mov_b32 s26, 16384
  buffer_load_dwordx4 v4, s[8:11], s26 offen offset:0 sc1 lds
  buffer_load_dwordx4 v4, s[8:11], s26 offen offset:1024 sc1 lds
  s_add_u32 m0, s45, 0
  s_add_u32 s26, s51, 1769472
  buffer_load_dwordx4 v1, s[8:11], s26 offen offset:0 lds
  buffer_load_dwordx4 v1, s[8:11], s26 offen offset:1024 lds
  buffer_load_dwordx4 v1, s[8:11], s26 offen offset:2048 lds
  buffer_load_dwordx4 v1, s[8:11], s26 offen offset:3072 lds
  s_add_u32 m0, s45, 6144
  s_add_u32 s26, s26, s29
  buffer_load_dwordx4 v1, s[8:11], s26 offen offset:0 lds
  s_add_u32 m0, s45, 4096
  s_add_u32 s26, s51, 1773568
  buffer_load_dwordx4 v1, s[8:11], s26 offen offset:0 lds
  buffer_load_dwordx4 v1, s[8:11], s26 offen offset:1024 lds
  s_waitcnt vmcnt(18)
  s_barrier
  s_add_u32 m0, s47, 139264
  s_mov_b32 s26, 18432
  buffer_load_dwordx4 v4, s[8:11], s26 offen offset:0 sc1 lds
  buffer_load_dwordx4 v4, s[8:11], s26 offen offset:1024 sc1 lds
  s_add_u32 m0, s45, 28672
  s_add_u32 s26, s51, 1990656
  buffer_load_dwordx4 v1, s[8:11], s26 offen offset:0 lds
  buffer_load_dwordx4 v1, s[8:11], s26 offen offset:1024 lds
  buffer_load_dwordx4 v1, s[8:11], s26 offen offset:2048 lds
  buffer_load_dwordx4 v1, s[8:11], s26 offen offset:3072 lds
  s_add_u32 m0, s45, 34816
  s_add_u32 s26, s26, s29
  buffer_load_dwordx4 v1, s[8:11], s26 offen offset:0 lds
  s_add_u32 m0, s45, 32768
  s_add_u32 s26, s51, 1994752
  buffer_load_dwordx4 v1, s[8:11], s26 offen offset:0 lds
  buffer_load_dwordx4 v1, s[8:11], s26 offen offset:1024 lds
  s_waitcnt vmcnt(18)
  s_barrier
  s_waitcnt vmcnt(9)
  s_barrier
  s_add_u32 m0, s44, 61440
  s_add_u32 s26, s52, 0
  buffer_load_dwordx4 v1, s[8:11], s26 offen offset:0 lds
  buffer_load_dwordx4 v1, s[8:11], s26 offen offset:1024 lds
  buffer_load_dwordx4 v1, s[8:11], s26 offen offset:2048 lds
  buffer_load_dwordx4 v1, s[8:11], s26 offen offset:3072 lds
  s_add_u32 m0, s44, 65536
  s_add_u32 s26, s26, s28
  buffer_load_dwordx4 v1, s[8:11], s26 offen offset:0 lds
  s_waitcnt vmcnt(5)
  s_barrier
  s_add_u32 m0, s44, 0
  s_add_u32 s26, s52, 163840
  buffer_load_dwordx4 v1, s[8:11], s26 offen offset:0 lds
  buffer_load_dwordx4 v1, s[8:11], s26 offen offset:1024 lds
  buffer_load_dwordx4 v1, s[8:11], s26 offen offset:2048 lds
  buffer_load_dwordx4 v1, s[8:11], s26 offen offset:3072 lds
  s_add_u32 m0, s44, 4096
  s_add_u32 s26, s26, s28
  buffer_load_dwordx4 v1, s[8:11], s26 offen offset:0 lds
  s_barrier
  s_add_u32 m0, s44, 20480
  s_add_u32 s26, s52, 327680
  buffer_load_dwordx4 v1, s[8:11], s26 offen offset:0 lds
  buffer_load_dwordx4 v1, s[8:11], s26 offen offset:1024 lds
  buffer_load_dwordx4 v1, s[8:11], s26 offen offset:2048 lds
  buffer_load_dwordx4 v1, s[8:11], s26 offen offset:3072 lds
  s_add_u32 m0, s44, 24576
  s_add_u32 s26, s26, s28
  buffer_load_dwordx4 v1, s[8:11], s26 offen offset:0 lds
  s_add_u32 m0, s44, 40960
  s_add_u32 s26, s52, 491520
  buffer_load_dwordx4 v1, s[8:11], s26 offen offset:0 lds
  buffer_load_dwordx4 v1, s[8:11], s26 offen offset:1024 lds
  buffer_load_dwordx4 v1, s[8:11], s26 offen offset:2048 lds
  buffer_load_dwordx4 v1, s[8:11], s26 offen offset:3072 lds
  s_add_u32 m0, s44, 45056
  s_add_u32 s26, s26, s28
  buffer_load_dwordx4 v1, s[8:11], s26 offen offset:0 lds
  s_lshl_b32 s22, s27, 7
  v_mov_b32 v10, s22
  v_and_b32 v11, 15, v2
  v_lshl_add_u32 v8, v11, 2, v10
  v_add_u32 v8, 0xec000, v8
  s_mul_i32 s22, s27, 55296
  s_add_u32 s22, s22, 0xb80000
  v_add_u32 v4, s22, v1
  s_mov_b32 s25, 0x40000
  s_barrier
kb_kernel_poll_9:
  buffer_load_dword v20, v8, s[8:11], 0 offen sc1
  s_waitcnt vmcnt(0)
  v_cmp_eq_u32 vcc, 0, v20
  s_cbranch_vccz kb_kernel_pok_10
  s_sleep 1
  s_sub_u32 s25, s25, 1
  s_cmp_lg_u32 s25, 0
  s_cbranch_scc1 kb_kernel_poll_9
kb_kernel_pok_10:
  s_add_u32 m0, s46, 147456
  s_mov_b32 s26, 0
  buffer_load_dwordx4 v4, s[8:11], s26 offen offset:0 sc1 lds
  buffer_load_dwordx4 v4, s[8:11], s26 offen offset:1024 sc1 lds
  buffer_load_dwordx4 v4, s[8:11], s26 offen offset:2048 sc1 lds
  buffer_load_dwordx4 v4, s[8:11], s26 offen offset:3072 sc1 lds
  s_add_u32 m0, s46, 81920
  s_mov_b32 s26, 4096
  buffer_load_dwordx4 v4, s[8:11], s26 offen offset:0 sc1 lds
  buffer_load_dwordx4 v4, s[8:11], s26 offen offset:1024 sc1 lds
  buffer_load_dwordx4 v4, s[8:11], s26 offen offset:2048 sc1 lds
  buffer_load_dwordx4 v4, s[8:11], s26 offen offset:3072 sc1 lds
  s_add_u32 m0, s46, 98304
  s_mov_b32 s26, 8192
  buffer_load_dwordx4 v4, s[8:11], s26 offen offset:0 sc1 lds
  buffer_load_dwordx4 v4, s[8:11], s26 offen offset:1024 sc1 lds
  buffer_load_dwordx4 v4, s[8:11], s26 offen offset:2048 sc1 lds
  buffer_load_dwordx4 v4, s[8:11], s26 offen offset:3072 sc1 lds
  s_waitcnt vmcnt(8)
  s_barrier
  s_add_u32 m0, s46, 114688
  s_mov_b32 s26, 12288
  buffer_load_dwordx4 v4, s[8:11], s26 offen offset:0 sc1 lds
  buffer_load_dwordx4 v4, s[8:11], s26 offen offset:1024 sc1 lds
  buffer_load_dwordx4 v4, s[8:11], s26 offen offset:2048 sc1 lds
  buffer_load_dwordx4 v4, s[8:11], s26 offen offset:3072 sc1 lds
  s_waitcnt vmcnt(8)
  s_barrier
  s_add_u32 m0, s46, 131072
  s_mov_b32 s26, 16384
  buffer_load_dwordx4 v4, s[8:11], s26 offen offset:0 sc1 lds
  buffer_load_dwordx4 v4, s[8:11], s26 offen offset:1024 sc1 lds
  buffer_load_dwordx4 v4, s[8:11], s26 offen offset:2048 sc1 lds
  buffer_load_dwordx4 v4, s[8:11], s26 offen offset:3072 sc1 lds
  s_add_u32 m0, s44, 61440
  s_add_u32 s26, s52, 655360
  buffer_load_dwordx4 v1, s[8:11], s26 offen offset:0 lds
  buffer_load_dwordx4 v1, s[8:11], s26 offen offset:1024 lds
  buffer_load_dwordx4 v1, s[8:11], s26 offen offset:2048 lds
  buffer_load_dwordx4 v1, s[8:11], s26 offen offset:3072 lds
  s_add_u32 m0, s44, 65536
  s_add_u32 s26, s26, s28
  buffer_load_dwordx4 v1, s[8:11], s26 offen offset:0 lds
  s_waitcnt vmcnt(13)
  s_barrier
  s_add_u32 m0, s46, 147456
  s_mov_b32 s26, 20480
  buffer_load_dwordx4 v4, s[8:11], s26 offen offset:0 sc1 lds
  buffer_load_dwordx4 v4, s[8:11], s26 offen offset:1024 sc1 lds
  buffer_load_dwordx4 v4, s[8:11], s26 offen offset:2048 sc1 lds
  buffer_load_dwordx4 v4, s[8:11], s26 offen offset:3072 sc1 lds
  s_add_u32 m0, s44, 0
  s_add_u32 s26, s52, 819200
  buffer_load_dwordx4 v1, s[8:11], s26 offen offset:0 lds
  buffer_load_dwordx4 v1, s[8:11], s26 offen offset:1024 lds
  buffer_load_dwordx4 v1, s[8:11], s26 offen offset:2048 lds
  buffer_load_dwordx4 v1, s[8:11], s26 offen offset:3072 lds
  s_add_u32 m0, s44, 4096
  s_add_u32 s26, s26, s28
  buffer_load_dwordx4 v1, s[8:11], s26 offen offset:0 lds
  s_waitcnt vmcnt(18)
  s_barrier
  s_add_u32 m0, s46, 81920
  s_mov_b32 s26, 24576
  buffer_load_dwordx4 v4, s[8:11], s26 offen offset:0 sc1 lds
  buffer_load_dwordx4 v4, s[8:11], s26 offen offset:1024 sc1 lds
  buffer_load_dwordx4 v4, s[8:11], s26 offen offset:2048 sc1 lds
  buffer_load_dwordx4 v4, s[8:11], s26 offen offset:3072 sc1 lds
  s_add_u32 m0, s44, 20480
  s_add_u32 s26, s52, 983040
  buffer_load_dwordx4 v1, s[8:11], s26 offen offset:0 lds
  buffer_load_dwordx4 v1, s[8:11], s26 offen offset:1024 lds
  buffer_load_dwordx4 v1, s[8:11], s26 offen offset:2048 lds
  buffer_load_dwordx4 v1, s[8:11], s26 offen offset:3072 lds
  s_add_u32 m0, s44, 24576
  s_add_u32 s26, s26, s28
  buffer_load_dwordx4 v1, s[8:11], s26 offen offset:0 lds
  s_waitcnt vmcnt(18)
  s_barrier
  s_add_u32 m0, s46, 98304
  s_mov_b32 s26, 28672
  buffer_load_dwordx4 v4, s[8:11], s26 offen offset:0 sc1 lds
  buffer_load_dwordx4 v4, s[8:11], s26 offen offset:1024 sc1 lds
  buffer_load_dwordx4 v4, s[8:11], s26 offen offset:2048 sc1 lds
  buffer_load_dwordx4 v4, s[8:11], s26 offen offset:3072 sc1 lds
  s_add_u32 m0, s44, 40960
  s_add_u32 s26, s52, 1146880
  buffer_load_dwordx4 v1, s[8:11], s26 offen offset:0 lds
  buffer_load_dwordx4 v1, s[8:11], s26 offen offset:1024 lds
  buffer_load_dwordx4 v1, s[8:11], s26 offen offset:2048 lds
  buffer_load_dwordx4 v1, s[8:11], s26 offen offset:3072 lds
  s_add_u32 m0, s44, 45056
  s_add_u32 s26, s26, s28
  buffer_load_dwordx4 v1, s[8:11], s26 offen offset:0 lds
  s_waitcnt vmcnt(18)
  s_barrier
  s_add_u32 m0, s46, 114688
  s_mov_b32 s26, 32768
  buffer_load_dwordx4 v4, s[8:11], s26 offen offset:0 sc1 lds
  buffer_load_dwordx4 v4, s[8:11], s26 offen offset:1024 sc1 lds
  buffer_load_dwordx4 v4, s[8:11], s26 offen offset:2048 sc1 lds
  buffer_load_dwordx4 v4, s[8:11], s26 offen offset:3072 sc1 lds
  s_add_u32 m0, s44, 61440
  s_add_u32 s26, s52, 1310720
  buffer_load_dwordx4 v1, s[8:11], s26 offen offset:0 lds
  buffer_load_dwordx4 v1, s[8:11], s26 offen offset:1024 lds
  buffer_load_dwordx4 v1, s[8:11], s26 offen offset:2048 lds
  buffer_load_dwordx4 v1, s[8:11], s26 offen offset:3072 lds
  s_add_u32 m0, s44, 65536
  s_add_u32 s26, s26, s28
  buffer_load_dwordx4 v1, s[8:11], s26 offen offset:0 lds
  s_waitcnt vmcnt(18)
  s_barrier
  s_add_u32 m0, s46, 131072
  s_mov_b32 s26, 36864
  buffer_load_dwordx4 v4, s[8:11], s26 offen offset:0 sc1 lds
  buffer_load_dwordx4 v4, s[8:11], s26 offen offset:1024 sc1 lds
  buffer_load_dwordx4 v4, s[8:11], s26 offen offset:2048 sc1 lds
  buffer_load_dwordx4 v4, s[8:11], s26 offen offset:3072 sc1 lds
  s_add_u32 m0, s44, 0
  s_add_u32 s26, s52, 1474560
  buffer_load_dwordx4 v1, s[8:11], s26 offen offset:0 lds
  buffer_load_dwordx4 v1, s[8:11], s26 offen offset:1024 lds
  buffer_load_dwordx4 v1, s[8:11], s26 offen offset:2048 lds
  buffer_load_dwordx4 v1, s[8:11], s26 offen offset:3072 lds
  s_add_u32 m0, s44, 4096
  s_add_u32 s26, s26, s28
  buffer_load_dwordx4 v1, s[8:11], s26 offen offset:0 lds
  s_waitcnt vmcnt(18)
  s_barrier
  s_add_u32 m0, s46, 147456
  s_mov_b32 s26, 40960
  buffer_load_dwordx4 v4, s[8:11], s26 offen offset:0 sc1 lds
  buffer_load_dwordx4 v4, s[8:11], s26 offen offset:1024 sc1 lds
  buffer_load_dwordx4 v4, s[8:11], s26 offen offset:2048 sc1 lds
  buffer_load_dwordx4 v4, s[8:11], s26 offen offset:3072 sc1 lds
  s_add_u32 m0, s44, 20480
  s_add_u32 s26, s52, 1638400
  buffer_load_dwordx4 v1, s[8:11], s26 offen offset:0 lds
  buffer_load_dwordx4 v1, s[8:11], s26 offen offset:1024 lds
  buffer_load_dwordx4 v1, s[8:11], s26 offen offset:2048 lds
  buffer_load_dwordx4 v1, s[8:11], s26 offen offset:3072 lds
  s_add_u32 m0, s44, 24576
  s_add_u32 s26, s26, s28
  buffer_load_dwordx4 v1, s[8:11], s26 offen offset:0 lds
  s_waitcnt vmcnt(18)
  s_barrier
  s_add_u32 m0, s46, 81920
  s_mov_b32 s26, 45056
  buffer_load_dwordx4 v4, s[8:11], s26 offen offset:0 sc1 lds
  buffer_load_dwordx4 v4, s[8:11], s26 offen offset:1024 sc1 lds
  buffer_load_dwordx4 v4, s[8:11], s26 offen offset:2048 sc1 lds
  buffer_load_dwordx4 v4, s[8:11], s26 offen offset:3072 sc1 lds
  s_add_u32 m0, s44, 40960
  s_add_u32 s26, s52, 1802240
  buffer_load_dwordx4 v1, s[8:11], s26 offen offset:0 lds
  buffer_load_dwordx4 v1, s[8:11], s26 offen offset:1024 lds
  buffer_load_dwordx4 v1, s[8:11], s26 offen offset:2048 lds
  buffer_load_dwordx4 v1, s[8:11], s26 offen offset:3072 lds
  s_add_u32 m0, s44, 45056
  s_add_u32 s26, s26, s28
  buffer_load_dwordx4 v1, s[8:11], s26 offen offset:0 lds
  s_waitcnt vmcnt(18)
  s_barrier
  s_add_u32 m0, s46, 98304
  s_mov_b32 s26, 49152
  buffer_load_dwordx4 v4, s[8:11], s26 offen offset:0 sc1 lds
  buffer_load_dwordx4 v4, s[8:11], s26 offen offset:1024 sc1 lds
  buffer_load_dwordx4 v4, s[8:11], s26 offen offset:2048 sc1 lds
  buffer_load_dwordx4 v4, s[8:11], s26 offen offset:3072 sc1 lds
  s_add_u32 m0, s44, 61440
  s_add_u32 s26, s52, 1966080
  buffer_load_dwordx4 v1, s[8:11], s26 offen offset:0 lds
  buffer_load_dwordx4 v1, s[8:11], s26 offen offset:1024 lds
  buffer_load_dwordx4 v1, s[8:11], s26 offen offset:2048 lds
  buffer_load_dwordx4 v1, s[8:11], s26 offen offset:3072 lds
  s_add_u32 m0, s44, 65536
  s_add_u32 s26, s26, s28
  buffer_load_dwordx4 v1, s[8:11], s26 offen offset:0 lds
  s_waitcnt vmcnt(18)
  s_barrier
  s_add_u32 m0, s46, 114688
  s_mov_b32 s26, 53248
  buffer_load_dwordx4 v4, s[8:11], s26 offen offset:0 sc1 lds
  buffer_load_dwordx4 v4, s[8:11], s26 offen offset:1024 sc1 lds
  s_add_u32 m0, s44, 0
  s_add_u32 s26, s52, 2129920
  buffer_load_dwordx4 v1, s[8:11], s26 offen offset:0 lds
  buffer_load_dwordx4 v1, s[8:11], s26 offen offset:1024 lds
  buffer_load_dwordx4 v1, s[8:11], s26 offen offset:2048 lds
  buffer_load_dwordx4 v1, s[8:11], s26 offen offset:3072 lds
  s_add_u32 m0, s44, 4096
  s_add_u32 s26, s26, s28
  buffer_load_dwordx4 v1, s[8:11], s26 offen offset:0 lds
  s_waitcnt vmcnt(16)
  s_barrier
  s_waitcnt vmcnt(7)
  s_barrier
  s_waitcnt vmcnt(0)
  s_barrier
  s_endpgm
kb_compute:
  v_mov_b32 v232, v1
  v_add_u32 v233, 65536, v232
  s_add_u32 s24, s20, s42
  s_lshl_b32 s28, s24, 9
  s_lshr_b32 s22, s19, 1
  s_mul_i32 s22, s22, 5120
  s_lshl_b32 s23, s42, 3
  s_add_u32 s22, s22, s23
  s_add_u32 s29, s22, 2048
  s_add_u32 s25, s20, 4
  s_cmp_eq_u32 s42, 0
  s_cselect_b32 s25, s25, s20
  v_and_b32 v212, 0x30, v2
  s_lshl_b32 s24, s24, 6
  s_lshl_b32 s25, s25, 6
  v_add_u32 v234, s24, v212
  v_add_u32 v235, s25, v212
  s_mul_i32 s22, s27, 20480
  v_add_u32 v236, s22, v1
  s_lshl_b32 s22, s17, 12
  s_add_u32 s22, s22, 81920
  v_add_u32 v239, s22, v1
  v_add_u32 v240, 65536, v239
  v_mov_b32 v232, v1
  v_add_u32 v233, 65536, v232
  v_and_b32 v237, 15, v2
  s_add_u32 s22, s27, 0
  s_lshl_b32 s22, s22, 4
  v_add_u32 v237, s22, v237
  v_mul_u32_u24 v237, 1280, v237
  v_lshrrev_b32 v212, 1, v235
  v_add_u32 v238, v237, v212
  v_lshrrev_b32 v212, 1, v234
  v_add_u32 v237, v237, v212
  s_waitcnt lgkmcnt(0)
  s_mov_b32 s8, s36
  s_and_b32 s9, s37, 0xffff
  s_mov_b32 s10, 0x10000000
  s_mov_b32 s11, 0x20000
  s_mov_b32 s12, s38
  s_and_b32 s13, s39, 0xffff
  s_mov_b32 s14, 0x280000
  s_mov_b32 s15, 0x20000
  s_getreg_b32 s32, hwreg(HW_REG_XCC_ID)
  s_and_b32 s32, s32, 15
  s_add_u32 s32, s32, 1
  s_lshl_b32 s22, s18, 7
  s_lshl_b32 s23, s19, 2
  s_add_u32 s22, s22, s23
  s_add_u32 s22, s22, 0xf2000
  s_cmp_eq_u32 s16, 0
  s_cselect_b32 s22, s22, 0x40000000
  v_mov_b32 v212, s22
  v_mov_b32 v213, s32
  s_mov_b64 exec, 1
  buffer_store_dword v213, v212, s[8:11], 0 offen sc1
  s_mov_b64 exec, -1
  s_mov_b32 s44, 0xbdd2d3e8
  s_mov_b32 s45, 0xbdd2d3e8
  s_mov_b32 s46, 1.0
  s_mov_b32 s47, 1.0
  v_mov_b32 v230, 0xc0135761
  v_mov_b32 v231, 0xc0135761
  s_lshl_b32 s22, s17, 13
  s_add_u32 s22, s22, 65536
  v_add_u32 v239, s22, v1
  v_add_u32 v240, 65536, v239
  v_mul_u32_u24 v223, 40, v2
  s_mov_b32 s26, 10240
  buffer_load_dwordx4 v[44:47], v223, s[8:11], s26 offen
  buffer_load_dwordx4 v[48:51], v223, s[8:11], s26 offen offset:16
  buffer_load_dwordx2 v[52:53], v223, s[8:11], s26 offen offset:32
  s_mov_b32 s26, 7680
  buffer_load_dwordx4 v[212:215], v223, s[8:11], s26 offen
  buffer_load_dwordx4 v[216:219], v223, s[8:11], s26 offen offset:16
  buffer_load_dwordx2 v[220:221], v223, s[8:11], s26 offen offset:32
  s_waitcnt vmcnt(0)
  v_mov_b32 v54, 0
  v_mov_b32 v55, 0
  v_mov_b32 v56, 0
  v_mov_b32 v57, 0
  v_mov_b32 v58, 0
  v_add_f32 v54, v54, v44
  v_add_f32 v55, v55, v212
  v_fmac_f32 v56, v44, v44
  v_fmac_f32 v57, v44, v212
  v_fmac_f32 v58, v212, v212
  v_add_f32 v54, v54, v45
  v_add_f32 v55, v55, v213
  v_fmac_f32 v56, v45, v45
  v_fmac_f32 v57, v45, v213
  v_fmac_f32 v58, v213, v213
  v_add_f32 v54, v54, v46
  v_add_f32 v55, v55, v214
  v_fmac_f32 v56, v46, v46
  v_fmac_f32 v57, v46, v214
  v_fmac_f32 v58, v214, v214
  v_add_f32 v54, v54, v47
  v_add_f32 v55, v55, v215
  v_fmac_f32 v56, v47, v47
  v_fmac_f32 v57, v47, v215
  v_fmac_f32 v58, v215, v215
  v_add_f32 v54, v54, v48
  v_add_f32 v55, v55, v216
  v_fmac_f32 v56, v48, v48
  v_fmac_f32 v57, v48, v216
  v_fmac_f32 v58, v216, v216
  v_add_f32 v54, v54, v49
  v_add_f32 v55, v55, v217
  v_fmac_f32 v56, v49, v49
  v_fmac_f32 v57, v49, v217
  v_fmac_f32 v58, v217, v217
  v_add_f32 v54, v54, v50
  v_add_f32 v55, v55, v218
  v_fmac_f32 v56, v50, v50
  v_fmac_f32 v57, v50, v218
  v_fmac_f32 v58, v218, v218
  v_add_f32 v54, v54, v51
  v_add_f32 v55, v55, v219
  v_fmac_f32 v56, v51, v51
  v_fmac_f32 v57, v51, v219
  v_fmac_f32 v58, v219, v219
  v_add_f32 v54, v54, v52
  v_add_f32 v55, v55, v220
  v_fmac_f32 v56, v52, v52
  v_fmac_f32 v57, v52, v220
  v_fmac_f32 v58, v220, v220
  v_add_f32 v54, v54, v53
  v_add_f32 v55, v55, v221
  v_fmac_f32 v56, v53, v53
  v_fmac_f32 v57, v53, v221
  v_fmac_f32 v58, v221, v221
  v_mul_f32 v54, 0x3acccccd, v54
  s_nop 1
  v_add_f32_dpp v54, v54, v54 row_ror:1 row_mask:0xf bank_mask:0xf
  s_nop 1
  v_add_f32_dpp v54, v54, v54 row_ror:2 row_mask:0xf bank_mask:0xf
  s_nop 1
  v_add_f32_dpp v54, v54, v54 row_ror:4 row_mask:0xf bank_mask:0xf
  s_nop 1
  v_add_f32_dpp v54, v54, v54 row_ror:8 row_mask:0xf bank_mask:0xf
  s_nop 1
  v_add_f32_dpp v54, v54, v54 row_bcast:15 row_mask:0xa bank_mask:0xf
  s_nop 1
  v_add_f32_dpp v54, v54, v54 row_bcast:31 row_mask:0xc bank_mask:0xf
  s_nop 0
  v_readlane_b32 s48, v54, 63
  v_mul_f32 v55, 0x3acccccd, v55
  s_nop 1
  v_add_f32_dpp v55, v55, v55 row_ror:1 row_mask:0xf bank_mask:0xf
  s_nop 1
  v_add_f32_dpp v55, v55, v55 row_ror:2 row_mask:0xf bank_mask:0xf
  s_nop 1
  v_add_f32_dpp v55, v55, v55 row_ror:4 row_mask:0xf bank_mask:0xf
  s_nop 1
  v_add_f32_dpp v55, v55, v55 row_ror:8 row_mask:0xf bank_mask:0xf
  s_nop 1
  v_add_f32_dpp v55, v55, v55 row_bcast:15 row_mask:0xa bank_mask:0xf
  s_nop 1
  v_add_f32_dpp v55, v55, v55 row_bcast:31 row_mask:0xc bank_mask:0xf
  s_nop 0
  v_readlane_b32 s49, v55, 63
  v_mul_f32 v56, 0x3acccccd, v56
  s_nop 1
  v_add_f32_dpp v56, v56, v56 row_ror:1 row_mask:0xf bank_mask:0xf
  s_nop 1
  v_add_f32_dpp v56, v56, v56 row_ror:2 row_mask:0xf bank_mask:0xf
  s_nop 1
  v_add_f32_dpp v56, v56, v56 row_ror:4 row_mask:0xf bank_mask:0xf
  s_nop 1
  v_add_f32_dpp v56, v56, v56 row_ror:8 row_mask:0xf bank_mask:0xf
  s_nop 1
  v_add_f32_dpp v56, v56, v56 row_bcast:15 row_mask:0xa bank_mask:0xf
  s_nop 1
  v_add_f32_dpp v56, v56, v56 row_bcast:31 row_mask:0xc bank_mask:0xf
  s_nop 0
  v_readlane_b32 s50, v56, 63
  v_mul_f32 v57, 0x3acccccd, v57
  s_nop 1
  v_add_f32_dpp v57, v57, v57 row_ror:1 row_mask:0xf bank_mask:0xf
  s_nop 1
  v_add_f32_dpp v57, v57, v57 row_ror:2 row_mask:0xf bank_mask:0xf
  s_nop 1
  v_add_f32_dpp v57, v57, v57 row_ror:4 row_mask:0xf bank_mask:0xf
  s_nop 1
  v_add_f32_dpp v57, v57, v57 row_ror:8 row_mask:0xf bank_mask:0xf
  s_nop 1
  v_add_f32_dpp v57, v57, v57 row_bcast:15 row_mask:0xa bank_mask:0xf
  s_nop 1
  v_add_f32_dpp v57, v57, v57 row_bcast:31 row_mask:0xc bank_mask:0xf
  s_nop 0
  v_readlane_b32 s51, v57, 63
  v_mul_f32 v58, 0x3acccccd, v58
  s_nop 1
  v_add_f32_dpp v58, v58, v58 row_ror:1 row_mask:0xf bank_mask:0xf
  s_nop 1
  v_add_f32_dpp v58, v58, v58 row_ror:2 row_mask:0xf bank_mask:0xf
  s_nop 1
  v_add_f32_dpp v58, v58, v58 row_ror:4 row_mask:0xf bank_mask:0xf
  s_nop 1
  v_add_f32_dpp v58, v58, v58 row_ror:8 row_mask:0xf bank_mask:0xf
  s_nop 1
  v_add_f32_dpp v58, v58, v58 row_bcast:15 row_mask:0xa bank_mask:0xf
  s_nop 1
  v_add_f32_dpp v58, v58, v58 row_bcast:31 row_mask:0xc bank_mask:0xf
  s_nop 0
  v_readlane_b32 s52, v58, 63
  buffer_load_dwordx2 v[242:243], v237, s[12:15], 0 offen offset:0
  buffer_load_dwordx2 v[244:245], v237, s[12:15], 0 offen offset:32
  buffer_load_dwordx2 v[246:247], v237, s[12:15], 0 offen offset:64
  buffer_load_dwordx2 v[248:249], v237, s[12:15], 0 offen offset:96
  buffer_load_dwordx2 v[250:251], v238, s[12:15], 0 offen offset:0
  s_barrier
  ds_read_b128 v[44:47], v239 offset:0
  ds_read_b128 v[48:51], v239 offset:4096
  ds_read_b128 v[52:55], v232 offset:0
  ds_read_b128 v[56:59], v232 offset:1024
  ds_read_b128 v[60:63], v232 offset:2048
  ds_read_b128 v[64:67], v232 offset:3072
  ds_read_b128 v[68:71], v232 offset:4096
  ds_read_b128 v[72:75], v239 offset:1024
  ds_read_b128 v[76:79], v239 offset:5120
  ds_read_b128 v[80:83], v232 offset:5120
  ds_read_b128 v[84:87], v232 offset:6144
  ds_read_b128 v[88:91], v232 offset:7168
  ds_read_b128 v[92:95], v232 offset:8192
  ds_read_b128 v[96:99], v232 offset:9216
  s_waitcnt lgkmcnt(7)
  v_mfma_f32_16x16x32_bf16 v[4:7], v[52:55], v[44:47], 0
  ds_read_b128 v[100:103], v239 offset:2048
  v_mfma_f32_16x16x32_bf16 v[24:27], v[52:55], v[48:51], 0
  ds_read_b128 v[104:107], v239 offset:6144
  v_mfma_f32_16x16x32_bf16 v[8:11], v[56:59], v[44:47], 0
  ds_read_b128 v[108:111], v232 offset:10240
  v_mfma_f32_16x16x32_bf16 v[28:31], v[56:59], v[48:51], 0
  ds_read_b128 v[112:115], v232 offset:11264
  v_mfma_f32_16x16x32_bf16 v[12:15], v[60:63], v[44:47], 0
  ds_read_b128 v[116:119], v232 offset:12288
  v_mfma_f32_16x16x32_bf16 v[32:35], v[60:63], v[48:51], 0
  ds_read_b128 v[120:123], v232 offset:13312
  v_mfma_f32_16x16x32_bf16 v[16:19], v[64:67], v[44:47], 0
  ds_read_b128 v[124:127], v232 offset:14336
  v_mfma_f32_16x16x32_bf16 v[36:39], v[64:67], v[48:51], 0
  v_mfma_f32_16x16x32_bf16 v[20:23], v[68:71], v[44:47], 0
  v_mfma_f32_16x16x32_bf16 v[40:43], v[68:71], v[48:51], 0
  s_waitcnt lgkmcnt(7)
  v_mfma_f32_16x16x32_bf16 v[4:7], v[80:83], v[72:75], v[4:7]
  ds_read_b128 v[44:47], v239 offset:3072
  v_mfma_f32_16x16x32_bf16 v[24:27], v[80:83], v[76:79], v[24:27]
  ds_read_b128 v[48:51], v239 offset:7168
  v_mfma_f32_16x16x32_bf16 v[8:11], v[84:87], v[72:75], v[8:11]
  ds_read_b128 v[52:55], v232 offset:15360
  v_mfma_f32_16x16x32_bf16 v[28:31], v[84:87], v[76:79], v[28:31]
  ds_read_b128 v[56:59], v232 offset:16384
  v_mfma_f32_16x16x32_bf16 v[12:15], v[88:91], v[72:75], v[12:15]
  ds_read_b128 v[60:63], v232 offset:17408
  v_mfma_f32_16x16x32_bf16 v[32:35], v[88:91], v[76:79], v[32:35]
  ds_read_b128 v[64:67], v232 offset:18432
  v_mfma_f32_16x16x32_bf16 v[16:19], v[92:95], v[72:75], v[16:19]
  ds_read_b128 v[68:71], v232 offset:19456
  v_mfma_f32_16x16x32_bf16 v[36:39], v[92:95], v[76:79], v[36:39]
  v_mfma_f32_16x16x32_bf16 v[20:23], v[96:99], v[72:75], v[20:23]
  v_mfma_f32_16x16x32_bf16 v[40:43], v[96:99], v[76:79], v[40:43]
  s_waitcnt lgkmcnt(0)
  s_barrier
  v_mfma_f32_16x16x32_bf16 v[4:7], v[108:111], v[100:103], v[4:7]
  ds_read_b128 v[72:75], v239 offset:32768
  v_mfma_f32_16x16x32_bf16 v[24:27], v[108:111], v[104:107], v[24:27]
  ds_read_b128 v[76:79], v239 offset:36864
  v_mfma_f32_16x16x32_bf16 v[8:11], v[112:115], v[100:103], v[8:11]
  ds_read_b128 v[80:83], v232 offset:20480
  v_mfma_f32_16x16x32_bf16 v[28:31], v[112:115], v[104:107], v[28:31]
  ds_read_b128 v[84:87], v232 offset:21504
  v_mfma_f32_16x16x32_bf16 v[12:15], v[116:119], v[100:103], v[12:15]
  ds_read_b128 v[88:91], v232 offset:22528
  v_mfma_f32_16x16x32_bf16 v[32:35], v[116:119], v[104:107], v[32:35]
  ds_read_b128 v[92:95], v232 offset:23552
  v_mfma_f32_16x16x32_bf16 v[16:19], v[120:123], v[100:103], v[16:19]
  ds_read_b128 v[96:99], v232 offset:24576
  v_mfma_f32_16x16x32_bf16 v[36:39], v[120:123], v[104:107], v[36:39]
  v_mfma_f32_16x16x32_bf16 v[20:23], v[124:127], v[100:103], v[20:23]
  v_mfma_f32_16x16x32_bf16 v[40:43], v[124:127], v[104:107], v[40:43]
  s_mov_b32 s26, 5120
  buffer_load_dwordx4 v[172:175], v234, s[8:11], s26 offen offset:0
  buffer_load_dwordx4 v[176:179], v234, s[8:11], s26 offen offset:64
  s_waitcnt lgkmcnt(7)
  v_mfma_f32_16x16x32_bf16 v[4:7], v[52:55], v[44:47], v[4:7]
  ds_read_b128 v[100:103], v239 offset:33792
  v_mfma_f32_16x16x32_bf16 v[24:27], v[52:55], v[48:51], v[24:27]
  ds_read_b128 v[104:107], v239 offset:37888
  v_mfma_f32_16x16x32_bf16 v[8:11], v[56:59], v[44:47], v[8:11]
  ds_read_b128 v[108:111], v232 offset:25600
  v_mfma_f32_16x16x32_bf16 v[28:31], v[56:59], v[48:51], v[28:31]
  ds_read_b128 v[112:115], v232 offset:26624
  v_mfma_f32_16x16x32_bf16 v[12:15], v[60:63], v[44:47], v[12:15]
  ds_read_b128 v[116:119], v232 offset:27648
  v_mfma_f32_16x16x32_bf16 v[32:35], v[60:63], v[48:51], v[32:35]
  ds_read_b128 v[120:123], v232 offset:28672
  v_mfma_f32_16x16x32_bf16 v[16:19], v[64:67], v[44:47], v[16:19]
  ds_read_b128 v[124:127], v232 offset:29696
  v_mfma_f32_16x16x32_bf16 v[36:39], v[64:67], v[48:51], v[36:39]
  v_mfma_f32_16x16x32_bf16 v[20:23], v[68:71], v[44:47], v[20:23]
  v_mfma_f32_16x16x32_bf16 v[40:43], v[68:71], v[48:51], v[40:43]
  buffer_load_dwordx4 v[180:183], v234, s[8:11], s26 offen offset:128
  buffer_load_dwordx4 v[184:187], v234, s[8:11], s26 offen offset:192
  buffer_load_dwordx4 v[188:191], v235, s[8:11], s26 offen offset:0
  s_waitcnt lgkmcnt(7)
  v_mfma_f32_16x16x32_bf16 v[4:7], v[80:83], v[72:75], v[4:7]
  ds_read_b128 v[44:47], v239 offset:34816
  v_mfma_f32_16x16x32_bf16 v[24:27], v[80:83], v[76:79], v[24:27]
  ds_read_b128 v[48:51], v239 offset:38912
  v_mfma_f32_16x16x32_bf16 v[8:11], v[84:87], v[72:75], v[8:11]
  ds_read_b128 v[52:55], v232 offset:30720
  v_mfma_f32_16x16x32_bf16 v[28:31], v[84:87], v[76:79], v[28:31]
  ds_read_b128 v[56:59], v232 offset:31744
  v_mfma_f32_16x16x32_bf16 v[12:15], v[88:91], v[72:75], v[12:15]
  ds_read_b128 v[60:63], v232 offset:32768
  v_mfma_f32_16x16x32_bf16 v[32:35], v[88:91], v[76:79], v[32:35]
  ds_read_b128 v[64:67], v232 offset:33792
  v_mfma_f32_16x16x32_bf16 v[16:19], v[92:95], v[72:75], v[16:19]
  ds_read_b128 v[68:71], v232 offset:34816
  v_mfma_f32_16x16x32_bf16 v[36:39], v[92:95], v[76:79], v[36:39]
  v_mfma_f32_16x16x32_bf16 v[20:23], v[96:99], v[72:75], v[20:23]
  v_mfma_f32_16x16x32_bf16 v[40:43], v[96:99], v[76:79], v[40:43]
  s_mov_b32 s26, 10240
  buffer_load_dwordx4 v[192:195], v234, s[8:11], s26 offen offset:0
  buffer_load_dwordx4 v[196:199], v234, s[8:11], s26 offen offset:64
  s_waitcnt lgkmcnt(7)
  v_mfma_f32_16x16x32_bf16 v[4:7], v[108:111], v[100:103], v[4:7]
  ds_read_b128 v[72:75], v239 offset:35840
  v_mfma_f32_16x16x32_bf16 v[24:27], v[108:111], v[104:107], v[24:27]
  ds_read_b128 v[76:79], v239 offset:39936
  v_mfma_f32_16x16x32_bf16 v[8:11], v[112:115], v[100:103], v[8:11]
  ds_read_b128 v[80:83], v232 offset:35840
  v_mfma_f32_16x16x32_bf16 v[28:31], v[112:115], v[104:107], v[28:31]
  ds_read_b128 v[84:87], v232 offset:36864
  v_mfma_f32_16x16x32_bf16 v[12:15], v[116:119], v[100:103], v[12:15]
  ds_read_b128 v[88:91], v232 offset:37888
  v_mfma_f32_16x16x32_bf16 v[32:35], v[116:119], v[104:107], v[32:35]
  ds_read_b128 v[92:95], v232 offset:38912
  v_mfma_f32_16x16x32_bf16 v[16:19], v[120:123], v[100:103], v[16:19]
  ds_read_b128 v[96:99], v232 offset:39936
  v_mfma_f32_16x16x32_bf16 v[36:39], v[120:123], v[104:107], v[36:39]
  v_mfma_f32_16x16x32_bf16 v[20:23], v[124:127], v[100:103], v[20:23]
  v_mfma_f32_16x16x32_bf16 v[40:43], v[124:127], v[104:107], v[40:43]
  buffer_load_dwordx4 v[200:203], v234, s[8:11], s26 offen offset:128
  buffer_load_dwordx4 v[204:207], v234, s[8:11], s26 offen offset:192
  buffer_load_dwordx4 v[208:211], v235, s[8:11], s26 offen offset:0
  s_waitcnt lgkmcnt(0)
  s_barrier
  v_mfma_f32_16x16x32_bf16 v[4:7], v[52:55], v[44:47], v[4:7]
  ds_read_b128 v[100:103], v240 offset:0
  v_mfma_f32_16x16x32_bf16 v[24:27], v[52:55], v[48:51], v[24:27]
  ds_read_b128 v[104:107], v240 offset:4096
  v_mfma_f32_16x16x32_bf16 v[8:11], v[56:59], v[44:47], v[8:11]
  ds_read_b128 v[108:111], v232 offset:40960
  v_mfma_f32_16x16x32_bf16 v[28:31], v[56:59], v[48:51], v[28:31]
  ds_read_b128 v[112:115], v232 offset:41984
  v_mfma_f32_16x16x32_bf16 v[12:15], v[60:63], v[44:47], v[12:15]
  ds_read_b128 v[116:119], v232 offset:43008
  v_mfma_f32_16x16x32_bf16 v[32:35], v[60:63], v[48:51], v[32:35]
  ds_read_b128 v[120:123], v232 offset:44032
  v_mfma_f32_16x16x32_bf16 v[16:19], v[64:67], v[44:47], v[16:19]
  ds_read_b128 v[124:127], v232 offset:45056
  v_mfma_f32_16x16x32_bf16 v[36:39], v[64:67], v[48:51], v[36:39]
  v_mfma_f32_16x16x32_bf16 v[20:23], v[68:71], v[44:47], v[20:23]
  v_mfma_f32_16x16x32_bf16 v[40:43], v[68:71], v[48:51], v[40:43]
  s_mov_b32 s26, 7680
  buffer_load_dwordx4 v[152:155], v234, s[8:11], s26 offen offset:0
  buffer_load_dwordx4 v[156:159], v234, s[8:11], s26 offen offset:64
  s_waitcnt lgkmcnt(7)
  v_mfma_f32_16x16x32_bf16 v[4:7], v[80:83], v[72:75], v[4:7]
  ds_read_b128 v[44:47], v240 offset:1024
  v_mfma_f32_16x16x32_bf16 v[24:27], v[80:83], v[76:79], v[24:27]
  ds_read_b128 v[48:51], v240 offset:5120
  v_mfma_f32_16x16x32_bf16 v[8:11], v[84:87], v[72:75], v[8:11]
  ds_read_b128 v[52:55], v232 offset:46080
  v_mfma_f32_16x16x32_bf16 v[28:31], v[84:87], v[76:79], v[28:31]
  ds_read_b128 v[56:59], v232 offset:47104
  v_mfma_f32_16x16x32_bf16 v[12:15], v[88:91], v[72:75], v[12:15]
  ds_read_b128 v[60:63], v232 offset:48128
  v_mfma_f32_16x16x32_bf16 v[32:35], v[88:91], v[76:79], v[32:35]
  ds_read_b128 v[64:67], v232 offset:49152
  v_mfma_f32_16x16x32_bf16 v[16:19], v[92:95], v[72:75], v[16:19]
  ds_read_b128 v[68:71], v232 offset:50176
  v_mfma_f32_16x16x32_bf16 v[36:39], v[92:95], v[76:79], v[36:39]
  v_mfma_f32_16x16x32_bf16 v[20:23], v[96:99], v[72:75], v[20:23]
  v_mfma_f32_16x16x32_bf16 v[40:43], v[96:99], v[76:79], v[40:43]
  buffer_load_dwordx4 v[160:163], v234, s[8:11], s26 offen offset:128
  buffer_load_dwordx4 v[164:167], v234, s[8:11], s26 offen offset:192
  buffer_load_dwordx4 v[168:171], v235, s[8:11], s26 offen offset:0
  s_waitcnt lgkmcnt(7)
  v_mfma_f32_16x16x32_bf16 v[4:7], v[108:111], v[100:103], v[4:7]
  ds_read_b128 v[72:75], v240 offset:2048
  v_mfma_f32_16x16x32_bf16 v[24:27], v[108:111], v[104:107], v[24:27]
  ds_read_b128 v[76:79], v240 offset:6144
  v_mfma_f32_16x16x32_bf16 v[8:11], v[112:115], v[100:103], v[8:11]
  ds_read_b128 v[80:83], v232 offset:51200
  v_mfma_f32_16x16x32_bf16 v[28:31], v[112:115], v[104:107], v[28:31]
  ds_read_b128 v[84:87], v232 offset:52224
  v_mfma_f32_16x16x32_bf16 v[12:15], v[116:119], v[100:103], v[12:15]
  ds_read_b128 v[88:91], v232 offset:53248
  v_mfma_f32_16x16x32_bf16 v[32:35], v[116:119], v[104:107], v[32:35]
  ds_read_b128 v[92:95], v232 offset:54272
  v_mfma_f32_16x16x32_bf16 v[16:19], v[120:123], v[100:103], v[16:19]
  ds_read_b128 v[96:99], v232 offset:55296
  v_mfma_f32_16x16x32_bf16 v[36:39], v[120:123], v[104:107], v[36:39]
  v_mfma_f32_16x16x32_bf16 v[20:23], v[124:127], v[100:103], v[20:23]
  v_mfma_f32_16x16x32_bf16 v[40:43], v[124:127], v[104:107], v[40:43]
  s_waitcnt lgkmcnt(7)
  v_mfma_f32_16x16x32_bf16 v[4:7], v[52:55], v[44:47], v[4:7]
  ds_read_b128 v[100:103], v240 offset:3072
  v_mfma_f32_16x16x32_bf16 v[24:27], v[52:55], v[48:51], v[24:27]
  ds_read_b128 v[104:107], v240 offset:7168
  v_mfma_f32_16x16x32_bf16 v[8:11], v[56:59], v[44:47], v[8:11]
  ds_read_b128 v[108:111], v232 offset:56320
  v_mfma_f32_16x16x32_bf16 v[28:31], v[56:59], v[48:51], v[28:31]
  ds_read_b128 v[112:115], v232 offset:57344
  v_mfma_f32_16x16x32_bf16 v[12:15], v[60:63], v[44:47], v[12:15]
  ds_read_b128 v[116:119], v232 offset:58368
  v_mfma_f32_16x16x32_bf16 v[32:35], v[60:63], v[48:51], v[32:35]
  ds_read_b128 v[120:123], v232 offset:59392
  v_mfma_f32_16x16x32_bf16 v[16:19], v[64:67], v[44:47], v[16:19]
  ds_read_b128 v[124:127], v232 offset:60416
  v_mfma_f32_16x16x32_bf16 v[36:39], v[64:67], v[48:51], v[36:39]
  v_mfma_f32_16x16x32_bf16 v[20:23], v[68:71], v[44:47], v[20:23]
  v_mfma_f32_16x16x32_bf16 v[40:43], v[68:71], v[48:51], v[40:43]
  s_waitcnt lgkmcnt(0)
  s_barrier
  v_mfma_f32_16x16x32_bf16 v[4:7], v[80:83], v[72:75], v[4:7]
  ds_read_b128 v[44:47], v239 offset:0
  v_mfma_f32_16x16x32_bf16 v[24:27], v[80:83], v[76:79], v[24:27]
  ds_read_b128 v[48:51], v239 offset:4096
  v_mfma_f32_16x16x32_bf16 v[8:11], v[84:87], v[72:75], v[8:11]
  ds_read_b128 v[52:55], v232 offset:0
  v_mfma_f32_16x16x32_bf16 v[28:31], v[84:87], v[76:79], v[28:31]
  ds_read_b128 v[56:59], v232 offset:1024
  v_mfma_f32_16x16x32_bf16 v[12:15], v[88:91], v[72:75], v[12:15]
  ds_read_b128 v[60:63], v232 offset:2048
  v_mfma_f32_16x16x32_bf16 v[32:35], v[88:91], v[76:79], v[32:35]
  ds_read_b128 v[64:67], v232 offset:3072
  v_mfma_f32_16x16x32_bf16 v[16:19], v[92:95], v[72:75], v[16:19]
  ds_read_b128 v[68:71], v232 offset:4096
  v_mfma_f32_16x16x32_bf16 v[36:39], v[92:95], v[76:79], v[36:39]
  v_mfma_f32_16x16x32_bf16 v[20:23], v[96:99], v[72:75], v[20:23]
  v_mfma_f32_16x16x32_bf16 v[40:43], v[96:99], v[76:79], v[40:43]
  s_waitcnt lgkmcnt(7)
  v_mfma_f32_16x16x32_bf16 v[4:7], v[108:111], v[100:103], v[4:7]
  ds_read_b128 v[72:75], v239 offset:1024
  v_mfma_f32_16x16x32_bf16 v[24:27], v[108:111], v[104:107], v[24:27]
  ds_read_b128 v[76:79], v239 offset:5120
  v_mfma_f32_16x16x32_bf16 v[8:11], v[112:115], v[100:103], v[8:11]
  ds_read_b128 v[80:83], v232 offset:5120
  v_mfma_f32_16x16x32_bf16 v[28:31], v[112:115], v[104:107], v[28:31]
  ds_read_b128 v[84:87], v232 offset:6144
  v_mfma_f32_16x16x32_bf16 v[12:15], v[116:119], v[100:103], v[12:15]
  ds_read_b128 v[88:91], v232 offset:7168
  v_mfma_f32_16x16x32_bf16 v[32:35], v[116:119], v[104:107], v[32:35]
  ds_read_b128 v[92:95], v232 offset:8192
  v_mfma_f32_16x16x32_bf16 v[16:19], v[120:123], v[100:103], v[16:19]
  ds_read_b128 v[96:99], v232 offset:9216
  v_mfma_f32_16x16x32_bf16 v[36:39], v[120:123], v[104:107], v[36:39]
  v_mfma_f32_16x16x32_bf16 v[20:23], v[124:127], v[100:103], v[20:23]
  v_mfma_f32_16x16x32_bf16 v[40:43], v[124:127], v[104:107], v[40:43]
  s_waitcnt lgkmcnt(7)
  v_mfma_f32_16x16x32_bf16 v[4:7], v[52:55], v[44:47], v[4:7]
  ds_read_b128 v[100:103], v239 offset:2048
  v_mfma_f32_16x16x32_bf16 v[24:27], v[52:55], v[48:51], v[24:27]
  ds_read_b128 v[104:107], v239 offset:6144
  v_mfma_f32_16x16x32_bf16 v[8:11], v[56:59], v[44:47], v[8:11]
  ds_read_b128 v[108:111], v232 offset:10240
  v_mfma_f32_16x16x32_bf16 v[28:31], v[56:59], v[48:51], v[28:31]
  ds_read_b128 v[112:115], v232 offset:11264
  v_mfma_f32_16x16x32_bf16 v[12:15], v[60:63], v[44:47], v[12:15]
  ds_read_b128 v[116:119], v232 offset:12288
  v_mfma_f32_16x16x32_bf16 v[32:35], v[60:63], v[48:51], v[32:35]
  ds_read_b128 v[120:123], v232 offset:13312
  v_mfma_f32_16x16x32_bf16 v[16:19], v[64:67], v[44:47], v[16:19]
  ds_read_b128 v[124:127], v232 offset:14336
  v_mfma_f32_16x16x32_bf16 v[36:39], v[64:67], v[48:51], v[36:39]
  v_mfma_f32_16x16x32_bf16 v[20:23], v[68:71], v[44:47], v[20:23]
  v_mfma_f32_16x16x32_bf16 v[40:43], v[68:71], v[48:51], v[40:43]
  s_waitcnt lgkmcnt(7)
  v_mfma_f32_16x16x32_bf16 v[4:7], v[80:83], v[72:75], v[4:7]
  ds_read_b128 v[44:47], v239 offset:3072
  v_mfma_f32_16x16x32_bf16 v[24:27], v[80:83], v[76:79], v[24:27]
  ds_read_b128 v[48:51], v239 offset:7168
  v_mfma_f32_16x16x32_bf16 v[8:11], v[84:87], v[72:75], v[8:11]
  ds_read_b128 v[52:55], v232 offset:15360
  v_mfma_f32_16x16x32_bf16 v[28:31], v[84:87], v[76:79], v[28:31]
  ds_read_b128 v[56:59], v232 offset:16384
  v_mfma_f32_16x16x32_bf16 v[12:15], v[88:91], v[72:75], v[12:15]
  ds_read_b128 v[60:63], v232 offset:17408
  v_mfma_f32_16x16x32_bf16 v[32:35], v[88:91], v[76:79], v[32:35]
  ds_read_b128 v[64:67], v232 offset:18432
  v_mfma_f32_16x16x32_bf16 v[16:19], v[92:95], v[72:75], v[16:19]
  ds_read_b128 v[68:71], v232 offset:19456
  v_mfma_f32_16x16x32_bf16 v[36:39], v[92:95], v[76:79], v[36:39]
  v_mfma_f32_16x16x32_bf16 v[20:23], v[96:99], v[72:75], v[20:23]
  v_mfma_f32_16x16x32_bf16 v[40:43], v[96:99], v[76:79], v[40:43]
  s_waitcnt lgkmcnt(0)
  s_barrier
  v_mfma_f32_16x16x32_bf16 v[4:7], v[108:111], v[100:103], v[4:7]
  ds_read_b128 v[72:75], v239 offset:32768
  v_mfma_f32_16x16x32_bf16 v[24:27], v[108:111], v[104:107], v[24:27]
  ds_read_b128 v[76:79], v239 offset:36864
  v_mfma_f32_16x16x32_bf16 v[8:11], v[112:115], v[100:103], v[8:11]
  ds_read_b128 v[80:83], v232 offset:20480
  v_mfma_f32_16x16x32_bf16 v[28:31], v[112:115], v[104:107], v[28:31]
  ds_read_b128 v[84:87], v232 offset:21504
  v_mfma_f32_16x16x32_bf16 v[12:15], v[116:119], v[100:103], v[12:15]
  ds_read_b128 v[88:91], v232 offset:22528
  v_mfma_f32_16x16x32_bf16 v[32:35], v[116:119], v[104:107], v[32:35]
  ds_read_b128 v[92:95], v232 offset:23552
  v_mfma_f32_16x16x32_bf16 v[16:19], v[120:123], v[100:103], v[16:19]
  ds_read_b128 v[96:99], v232 offset:24576
  v_mfma_f32_16x16x32_bf16 v[36:39], v[120:123], v[104:107], v[36:39]
  v_mfma_f32_16x16x32_bf16 v[20:23], v[124:127], v[100:103], v[20:23]
  v_mfma_f32_16x16x32_bf16 v[40:43], v[124:127], v[104:107], v[40:43]
  s_waitcnt lgkmcnt(7)
  v_mfma_f32_16x16x32_bf16 v[4:7], v[52:55], v[44:47], v[4:7]
  ds_read_b128 v[100:103], v239 offset:33792
  v_mfma_f32_16x16x32_bf16 v[24:27], v[52:55], v[48:51], v[24:27]
  ds_read_b128 v[104:107], v239 offset:37888
  v_mfma_f32_16x16x32_bf16 v[8:11], v[56:59], v[44:47], v[8:11]
  ds_read_b128 v[108:111], v232 offset:25600
  v_mfma_f32_16x16x32_bf16 v[28:31], v[56:59], v[48:51], v[28:31]
  ds_read_b128 v[112:115], v232 offset:26624
  v_mfma_f32_16x16x32_bf16 v[12:15], v[60:63], v[44:47], v[12:15]
  ds_read_b128 v[116:119], v232 offset:27648
  v_mfma_f32_16x16x32_bf16 v[32:35], v[60:63], v[48:51], v[32:35]
  ds_read_b128 v[120:123], v232 offset:28672
  v_mfma_f32_16x16x32_bf16 v[16:19], v[64:67], v[44:47], v[16:19]
  ds_read_b128 v[124:127], v232 offset:29696
  v_mfma_f32_16x16x32_bf16 v[36:39], v[64:67], v[48:51], v[36:39]
  v_mfma_f32_16x16x32_bf16 v[20:23], v[68:71], v[44:47], v[20:23]
  v_mfma_f32_16x16x32_bf16 v[40:43], v[68:71], v[48:51], v[40:43]
  s_waitcnt lgkmcnt(7)
  v_mfma_f32_16x16x32_bf16 v[4:7], v[80:83], v[72:75], v[4:7]
  ds_read_b128 v[44:47], v239 offset:34816
  v_mfma_f32_16x16x32_bf16 v[24:27], v[80:83], v[76:79], v[24:27]
  ds_read_b128 v[48:51], v239 offset:38912
  v_mfma_f32_16x16x32_bf16 v[8:11], v[84:87], v[72:75], v[8:11]
  ds_read_b128 v[52:55], v232 offset:30720
  v_mfma_f32_16x16x32_bf16 v[28:31], v[84:87], v[76:79], v[28:31]
  ds_read_b128 v[56:59], v232 offset:31744
  v_mfma_f32_16x16x32_bf16 v[12:15], v[88:91], v[72:75], v[12:15]
  ds_read_b128 v[60:63], v232 offset:32768
  v_mfma_f32_16x16x32_bf16 v[32:35], v[88:91], v[76:79], v[32:35]
  ds_read_b128 v[64:67], v232 offset:33792
  v_mfma_f32_16x16x32_bf16 v[16:19], v[92:95], v[72:75], v[16:19]
  ds_read_b128 v[68:71], v232 offset:34816
  v_mfma_f32_16x16x32_bf16 v[36:39], v[92:95], v[76:79], v[36:39]
  v_mfma_f32_16x16x32_bf16 v[20:23], v[96:99], v[72:75], v[20:23]
  v_mfma_f32_16x16x32_bf16 v[40:43], v[96:99], v[76:79], v[40:43]
  s_waitcnt lgkmcnt(7)
  v_mfma_f32_16x16x32_bf16 v[4:7], v[108:111], v[100:103], v[4:7]
  ds_read_b128 v[72:75], v239 offset:35840
  v_mfma_f32_16x16x32_bf16 v[24:27], v[108:111], v[104:107], v[24:27]
  ds_read_b128 v[76:79], v239 offset:39936
  v_mfma_f32_16x16x32_bf16 v[8:11], v[112:115], v[100:103], v[8:11]
  ds_read_b128 v[80:83], v232 offset:35840
  v_mfma_f32_16x16x32_bf16 v[28:31], v[112:115], v[104:107], v[28:31]
  ds_read_b128 v[84:87], v232 offset:36864
  v_mfma_f32_16x16x32_bf16 v[12:15], v[116:119], v[100:103], v[12:15]
  ds_read_b128 v[88:91], v232 offset:37888
  v_mfma_f32_16x16x32_bf16 v[32:35], v[116:119], v[104:107], v[32:35]
  ds_read_b128 v[92:95], v232 offset:38912
  v_mfma_f32_16x16x32_bf16 v[16:19], v[120:123], v[100:103], v[16:19]
  ds_read_b128 v[96:99], v232 offset:39936
  v_mfma_f32_16x16x32_bf16 v[36:39], v[120:123], v[104:107], v[36:39]
  v_mfma_f32_16x16x32_bf16 v[20:23], v[124:127], v[100:103], v[20:23]
  v_mfma_f32_16x16x32_bf16 v[40:43], v[124:127], v[104:107], v[40:43]
  s_waitcnt lgkmcnt(0)
  s_barrier
  v_mfma_f32_16x16x32_bf16 v[4:7], v[52:55], v[44:47], v[4:7]
  ds_read_b128 v[100:103], v240 offset:0
  v_mfma_f32_16x16x32_bf16 v[24:27], v[52:55], v[48:51], v[24:27]
  ds_read_b128 v[104:107], v240 offset:4096
  v_mfma_f32_16x16x32_bf16 v[8:11], v[56:59], v[44:47], v[8:11]
  ds_read_b128 v[108:111], v232 offset:40960
  v_mfma_f32_16x16x32_bf16 v[28:31], v[56:59], v[48:51], v[28:31]
  ds_read_b128 v[112:115], v232 offset:41984
  v_mfma_f32_16x16x32_bf16 v[12:15], v[60:63], v[44:47], v[12:15]
  ds_read_b128 v[116:119], v232 offset:43008
  v_mfma_f32_16x16x32_bf16 v[32:35], v[60:63], v[48:51], v[32:35]
  ds_read_b128 v[120:123], v232 offset:44032
  v_mfma_f32_16x16x32_bf16 v[16:19], v[64:67], v[44:47], v[16:19]
  ds_read_b128 v[124:127], v232 offset:45056
  v_mfma_f32_16x16x32_bf16 v[36:39], v[64:67], v[48:51], v[36:39]
  v_mfma_f32_16x16x32_bf16 v[20:23], v[68:71], v[44:47], v[20:23]
  v_mfma_f32_16x16x32_bf16 v[40:43], v[68:71], v[48:51], v[40:43]
  s_waitcnt lgkmcnt(7)
  v_mfma_f32_16x16x32_bf16 v[4:7], v[80:83], v[72:75], v[4:7]
  ds_read_b128 v[44:47], v240 offset:1024
  v_mfma_f32_16x16x32_bf16 v[24:27], v[80:83], v[76:79], v[24:27]
  ds_read_b128 v[48:51], v240 offset:5120
  v_mfma_f32_16x16x32_bf16 v[8:11], v[84:87], v[72:75], v[8:11]
  ds_read_b128 v[52:55], v232 offset:46080
  v_mfma_f32_16x16x32_bf16 v[28:31], v[84:87], v[76:79], v[28:31]
  ds_read_b128 v[56:59], v232 offset:47104
  v_mfma_f32_16x16x32_bf16 v[12:15], v[88:91], v[72:75], v[12:15]
  ds_read_b128 v[60:63], v232 offset:48128
  v_mfma_f32_16x16x32_bf16 v[32:35], v[88:91], v[76:79], v[32:35]
  ds_read_b128 v[64:67], v232 offset:49152
  v_mfma_f32_16x16x32_bf16 v[16:19], v[92:95], v[72:75], v[16:19]
  ds_read_b128 v[68:71], v232 offset:50176
  v_mfma_f32_16x16x32_bf16 v[36:39], v[92:95], v[76:79], v[36:39]
  v_mfma_f32_16x16x32_bf16 v[20:23], v[96:99], v[72:75], v[20:23]
  v_mfma_f32_16x16x32_bf16 v[40:43], v[96:99], v[76:79], v[40:43]
  s_waitcnt lgkmcnt(7)
  v_mfma_f32_16x16x32_bf16 v[4:7], v[108:111], v[100:103], v[4:7]
  ds_read_b128 v[72:75], v240 offset:2048
  v_mfma_f32_16x16x32_bf16 v[24:27], v[108:111], v[104:107], v[24:27]
  ds_read_b128 v[76:79], v240 offset:6144
  v_mfma_f32_16x16x32_bf16 v[8:11], v[112:115], v[100:103], v[8:11]
  ds_read_b128 v[80:83], v232 offset:51200
  v_mfma_f32_16x16x32_bf16 v[28:31], v[112:115], v[104:107], v[28:31]
  ds_read_b128 v[84:87], v232 offset:52224
  v_mfma_f32_16x16x32_bf16 v[12:15], v[116:119], v[100:103], v[12:15]
  ds_read_b128 v[88:91], v232 offset:53248
  v_mfma_f32_16x16x32_bf16 v[32:35], v[116:119], v[104:107], v[32:35]
  ds_read_b128 v[92:95], v232 offset:54272
  v_mfma_f32_16x16x32_bf16 v[16:19], v[120:123], v[100:103], v[16:19]
  ds_read_b128 v[96:99], v232 offset:55296
  v_mfma_f32_16x16x32_bf16 v[36:39], v[120:123], v[104:107], v[36:39]
  v_mfma_f32_16x16x32_bf16 v[20:23], v[124:127], v[100:103], v[20:23]
  v_mfma_f32_16x16x32_bf16 v[40:43], v[124:127], v[104:107], v[40:43]
  s_waitcnt lgkmcnt(7)
  v_mfma_f32_16x16x32_bf16 v[4:7], v[52:55], v[44:47], v[4:7]
  ds_read_b128 v[100:103], v240 offset:3072
  v_mfma_f32_16x16x32_bf16 v[24:27], v[52:55], v[48:51], v[24:27]
  ds_read_b128 v[104:107], v240 offset:7168
  v_mfma_f32_16x16x32_bf16 v[8:11], v[56:59], v[44:47], v[8:11]
  ds_read_b128 v[108:111], v232 offset:56320
  v_mfma_f32_16x16x32_bf16 v[28:31], v[56:59], v[48:51], v[28:31]
  ds_read_b128 v[112:115], v232 offset:57344
  v_mfma_f32_16x16x32_bf16 v[12:15], v[60:63], v[44:47], v[12:15]
  ds_read_b128 v[116:119], v232 offset:58368
  v_mfma_f32_16x16x32_bf16 v[32:35], v[60:63], v[48:51], v[32:35]
  ds_read_b128 v[120:123], v232 offset:59392
  v_mfma_f32_16x16x32_bf16 v[16:19], v[64:67], v[44:47], v[16:19]
  ds_read_b128 v[124:127], v232 offset:60416
  v_mfma_f32_16x16x32_bf16 v[36:39], v[64:67], v[48:51], v[36:39]
  v_mfma_f32_16x16x32_bf16 v[20:23], v[68:71], v[44:47], v[20:23]
  v_mfma_f32_16x16x32_bf16 v[40:43], v[68:71], v[48:51], v[40:43]
  s_waitcnt lgkmcnt(0)
  s_barrier
  v_mfma_f32_16x16x32_bf16 v[4:7], v[80:83], v[72:75], v[4:7]
  ds_read_b128 v[44:47], v239 offset:0
  v_mfma_f32_16x16x32_bf16 v[24:27], v[80:83], v[76:79], v[24:27]
  ds_read_b128 v[48:51], v239 offset:4096
  v_mfma_f32_16x16x32_bf16 v[8:11], v[84:87], v[72:75], v[8:11]
  ds_read_b128 v[52:55], v232 offset:0
  v_mfma_f32_16x16x32_bf16 v[28:31], v[84:87], v[76:79], v[28:31]
  ds_read_b128 v[56:59], v232 offset:1024
  v_mfma_f32_16x16x32_bf16 v[12:15], v[88:91], v[72:75], v[12:15]
  ds_read_b128 v[60:63], v232 offset:2048
  v_mfma_f32_16x16x32_bf16 v[32:35], v[88:91], v[76:79], v[32:35]
  ds_read_b128 v[64:67], v232 offset:3072
  v_mfma_f32_16x16x32_bf16 v[16:19], v[92:95], v[72:75], v[16:19]
  ds_read_b128 v[68:71], v232 offset:4096
  v_mfma_f32_16x16x32_bf16 v[36:39], v[92:95], v[76:79], v[36:39]
  v_mfma_f32_16x16x32_bf16 v[20:23], v[96:99], v[72:75], v[20:23]
  v_mfma_f32_16x16x32_bf16 v[40:43], v[96:99], v[76:79], v[40:43]
  s_waitcnt lgkmcnt(7)
  v_mfma_f32_16x16x32_bf16 v[4:7], v[108:111], v[100:103], v[4:7]
  ds_read_b128 v[72:75], v239 offset:1024
  v_mfma_f32_16x16x32_bf16 v[24:27], v[108:111], v[104:107], v[24:27]
  ds_read_b128 v[76:79], v239 offset:5120
  v_mfma_f32_16x16x32_bf16 v[8:11], v[112:115], v[100:103], v[8:11]
  ds_read_b128 v[80:83], v232 offset:5120
  v_mfma_f32_16x16x32_bf16 v[28:31], v[112:115], v[104:107], v[28:31]
  ds_read_b128 v[84:87], v232 offset:6144
  v_mfma_f32_16x16x32_bf16 v[12:15], v[116:119], v[100:103], v[12:15]
  ds_read_b128 v[88:91], v232 offset:7168
  v_mfma_f32_16x16x32_bf16 v[32:35], v[116:119], v[104:107], v[32:35]
  ds_read_b128 v[92:95], v232 offset:8192
  v_mfma_f32_16x16x32_bf16 v[16:19], v[120:123], v[100:103], v[16:19]
  ds_read_b128 v[96:99], v232 offset:9216
  v_mfma_f32_16x16x32_bf16 v[36:39], v[120:123], v[104:107], v[36:39]
  v_mfma_f32_16x16x32_bf16 v[20:23], v[124:127], v[100:103], v[20:23]
  v_mfma_f32_16x16x32_bf16 v[40:43], v[124:127], v[104:107], v[40:43]
  s_waitcnt lgkmcnt(7)
  v_mfma_f32_16x16x32_bf16 v[4:7], v[52:55], v[44:47], v[4:7]
  ds_read_b128 v[100:103], v239 offset:2048
  v_mfma_f32_16x16x32_bf16 v[24:27], v[52:55], v[48:51], v[24:27]
  ds_read_b128 v[104:107], v239 offset:6144
  v_mfma_f32_16x16x32_bf16 v[8:11], v[56:59], v[44:47], v[8:11]
  ds_read_b128 v[108:111], v232 offset:10240
  v_mfma_f32_16x16x32_bf16 v[28:31], v[56:59], v[48:51], v[28:31]
  ds_read_b128 v[112:115], v232 offset:11264
  v_mfma_f32_16x16x32_bf16 v[12:15], v[60:63], v[44:47], v[12:15]
  ds_read_b128 v[116:119], v232 offset:12288
  v_mfma_f32_16x16x32_bf16 v[32:35], v[60:63], v[48:51], v[32:35]
  ds_read_b128 v[120:123], v232 offset:13312
  v_mfma_f32_16x16x32_bf16 v[16:19], v[64:67], v[44:47], v[16:19]
  ds_read_b128 v[124:127], v232 offset:14336
  v_mfma_f32_16x16x32_bf16 v[36:39], v[64:67], v[48:51], v[36:39]
  v_mfma_f32_16x16x32_bf16 v[20:23], v[68:71], v[44:47], v[20:23]
  v_mfma_f32_16x16x32_bf16 v[40:43], v[68:71], v[48:51], v[40:43]
  s_waitcnt lgkmcnt(7)
  v_mfma_f32_16x16x32_bf16 v[4:7], v[80:83], v[72:75], v[4:7]
  ds_read_b128 v[44:47], v239 offset:3072
  v_mfma_f32_16x16x32_bf16 v[24:27], v[80:83], v[76:79], v[24:27]
  ds_read_b128 v[48:51], v239 offset:7168
  v_mfma_f32_16x16x32_bf16 v[8:11], v[84:87], v[72:75], v[8:11]
  ds_read_b128 v[52:55], v232 offset:15360
  v_mfma_f32_16x16x32_bf16 v[28:31], v[84:87], v[76:79], v[28:31]
  ds_read_b128 v[56:59], v232 offset:16384
  v_mfma_f32_16x16x32_bf16 v[12:15], v[88:91], v[72:75], v[12:15]
  ds_read_b128 v[60:63], v232 offset:17408
  v_mfma_f32_16x16x32_bf16 v[32:35], v[88:91], v[76:79], v[32:35]
  ds_read_b128 v[64:67], v232 offset:18432
  v_mfma_f32_16x16x32_bf16 v[16:19], v[92:95], v[72:75], v[16:19]
  ds_read_b128 v[68:71], v232 offset:19456
  v_mfma_f32_16x16x32_bf16 v[36:39], v[92:95], v[76:79], v[36:39]
  v_mfma_f32_16x16x32_bf16 v[20:23], v[96:99], v[72:75], v[20:23]
  v_mfma_f32_16x16x32_bf16 v[40:43], v[96:99], v[76:79], v[40:43]
  s_waitcnt lgkmcnt(0)
  s_barrier
  v_mfma_f32_16x16x32_bf16 v[4:7], v[108:111], v[100:103], v[4:7]
  ds_read_b128 v[72:75], v239 offset:32768
  v_mfma_f32_16x16x32_bf16 v[24:27], v[108:111], v[104:107], v[24:27]
  ds_read_b128 v[76:79], v239 offset:36864
  v_mfma_f32_16x16x32_bf16 v[8:11], v[112:115], v[100:103], v[8:11]
  ds_read_b128 v[80:83], v232 offset:20480
  v_mfma_f32_16x16x32_bf16 v[28:31], v[112:115], v[104:107], v[28:31]
  ds_read_b128 v[84:87], v232 offset:21504
  v_mfma_f32_16x16x32_bf16 v[12:15], v[116:119], v[100:103], v[12:15]
  ds_read_b128 v[88:91], v232 offset:22528
  v_mfma_f32_16x16x32_bf16 v[32:35], v[116:119], v[104:107], v[32:35]
  ds_read_b128 v[92:95], v232 offset:23552
  v_mfma_f32_16x16x32_bf16 v[16:19], v[120:123], v[100:103], v[16:19]
  ds_read_b128 v[96:99], v232 offset:24576
  v_mfma_f32_16x16x32_bf16 v[36:39], v[120:123], v[104:107], v[36:39]
  v_mfma_f32_16x16x32_bf16 v[20:23], v[124:127], v[100:103], v[20:23]
  v_mfma_f32_16x16x32_bf16 v[40:43], v[124:127], v[104:107], v[40:43]
  s_waitcnt lgkmcnt(7)
  v_mfma_f32_16x16x32_bf16 v[4:7], v[52:55], v[44:47], v[4:7]
  ds_read_b128 v[100:103], v239 offset:33792
  v_mfma_f32_16x16x32_bf16 v[24:27], v[52:55], v[48:51], v[24:27]
  ds_read_b128 v[104:107], v239 offset:37888
  v_mfma_f32_16x16x32_bf16 v[8:11], v[56:59], v[44:47], v[8:11]
  ds_read_b128 v[108:111], v232 offset:25600
  v_mfma_f32_16x16x32_bf16 v[28:31], v[56:59], v[48:51], v[28:31]
  ds_read_b128 v[112:115], v232 offset:26624
  v_mfma_f32_16x16x32_bf16 v[12:15], v[60:63], v[44:47], v[12:15]
  ds_read_b128 v[116:119], v232 offset:27648
  v_mfma_f32_16x16x32_bf16 v[32:35], v[60:63], v[48:51], v[32:35]
  ds_read_b128 v[120:123], v232 offset:28672
  v_mfma_f32_16x16x32_bf16 v[16:19], v[64:67], v[44:47], v[16:19]
  ds_read_b128 v[124:127], v232 offset:29696
  v_mfma_f32_16x16x32_bf16 v[36:39], v[64:67], v[48:51], v[36:39]
  v_mfma_f32_16x16x32_bf16 v[20:23], v[68:71], v[44:47], v[20:23]
  v_mfma_f32_16x16x32_bf16 v[40:43], v[68:71], v[48:51], v[40:43]
  s_waitcnt lgkmcnt(7)
  v_mfma_f32_16x16x32_bf16 v[4:7], v[80:83], v[72:75], v[4:7]
  ds_read_b128 v[44:47], v239 offset:34816
  v_mfma_f32_16x16x32_bf16 v[24:27], v[80:83], v[76:79], v[24:27]
  ds_read_b128 v[48:51], v239 offset:38912
  v_mfma_f32_16x16x32_bf16 v[8:11], v[84:87], v[72:75], v[8:11]
  ds_read_b128 v[52:55], v232 offset:30720
  v_mfma_f32_16x16x32_bf16 v[28:31], v[84:87], v[76:79], v[28:31]
  ds_read_b128 v[56:59], v232 offset:31744
  v_mfma_f32_16x16x32_bf16 v[12:15], v[88:91], v[72:75], v[12:15]
  ds_read_b128 v[60:63], v232 offset:32768
  v_mfma_f32_16x16x32_bf16 v[32:35], v[88:91], v[76:79], v[32:35]
  ds_read_b128 v[64:67], v232 offset:33792
  v_mfma_f32_16x16x32_bf16 v[16:19], v[92:95], v[72:75], v[16:19]
  ds_read_b128 v[68:71], v232 offset:34816
  v_mfma_f32_16x16x32_bf16 v[36:39], v[92:95], v[76:79], v[36:39]
  v_mfma_f32_16x16x32_bf16 v[20:23], v[96:99], v[72:75], v[20:23]
  v_mfma_f32_16x16x32_bf16 v[40:43], v[96:99], v[76:79], v[40:43]
  s_waitcnt lgkmcnt(7)
  v_mfma_f32_16x16x32_bf16 v[4:7], v[108:111], v[100:103], v[4:7]
  ds_read_b128 v[72:75], v239 offset:35840
  v_mfma_f32_16x16x32_bf16 v[24:27], v[108:111], v[104:107], v[24:27]
  ds_read_b128 v[76:79], v239 offset:39936
  v_mfma_f32_16x16x32_bf16 v[8:11], v[112:115], v[100:103], v[8:11]
  ds_read_b128 v[80:83], v232 offset:35840
  v_mfma_f32_16x16x32_bf16 v[28:31], v[112:115], v[104:107], v[28:31]
  ds_read_b128 v[84:87], v232 offset:36864
  v_mfma_f32_16x16x32_bf16 v[12:15], v[116:119], v[100:103], v[12:15]
  ds_read_b128 v[88:91], v232 offset:37888
  v_mfma_f32_16x16x32_bf16 v[32:35], v[116:119], v[104:107], v[32:35]
  ds_read_b128 v[92:95], v232 offset:38912
  v_mfma_f32_16x16x32_bf16 v[16:19], v[120:123], v[100:103], v[16:19]
  ds_read_b128 v[96:99], v232 offset:39936
  v_mfma_f32_16x16x32_bf16 v[36:39], v[120:123], v[104:107], v[36:39]
  v_mfma_f32_16x16x32_bf16 v[20:23], v[124:127], v[100:103], v[20:23]
  v_mfma_f32_16x16x32_bf16 v[40:43], v[124:127], v[104:107], v[40:43]
  s_waitcnt lgkmcnt(0)
  s_barrier
  v_mfma_f32_16x16x32_bf16 v[4:7], v[52:55], v[44:47], v[4:7]
  ds_read_b128 v[100:103], v240 offset:0
  v_mfma_f32_16x16x32_bf16 v[24:27], v[52:55], v[48:51], v[24:27]
  ds_read_b128 v[104:107], v240 offset:4096
  v_mfma_f32_16x16x32_bf16 v[8:11], v[56:59], v[44:47], v[8:11]
  ds_read_b128 v[108:111], v232 offset:40960
  v_mfma_f32_16x16x32_bf16 v[28:31], v[56:59], v[48:51], v[28:31]
  ds_read_b128 v[112:115], v232 offset:41984
  v_mfma_f32_16x16x32_bf16 v[12:15], v[60:63], v[44:47], v[12:15]
  ds_read_b128 v[116:119], v232 offset:43008
  v_mfma_f32_16x16x32_bf16 v[32:35], v[60:63], v[48:51], v[32:35]
  ds_read_b128 v[120:123], v232 offset:44032
  v_mfma_f32_16x16x32_bf16 v[16:19], v[64:67], v[44:47], v[16:19]
  ds_read_b128 v[124:127], v232 offset:45056
  v_mfma_f32_16x16x32_bf16 v[36:39], v[64:67], v[48:51], v[36:39]
  v_mfma_f32_16x16x32_bf16 v[20:23], v[68:71], v[44:47], v[20:23]
  v_mfma_f32_16x16x32_bf16 v[40:43], v[68:71], v[48:51], v[40:43]
  s_waitcnt lgkmcnt(7)
  v_mfma_f32_16x16x32_bf16 v[4:7], v[80:83], v[72:75], v[4:7]
  ds_read_b128 v[44:47], v240 offset:1024
  v_mfma_f32_16x16x32_bf16 v[24:27], v[80:83], v[76:79], v[24:27]
  ds_read_b128 v[48:51], v240 offset:5120
  v_mfma_f32_16x16x32_bf16 v[8:11], v[84:87], v[72:75], v[8:11]
  ds_read_b128 v[52:55], v232 offset:46080
  v_mfma_f32_16x16x32_bf16 v[28:31], v[84:87], v[76:79], v[28:31]
  ds_read_b128 v[56:59], v232 offset:47104
  v_mfma_f32_16x16x32_bf16 v[12:15], v[88:91], v[72:75], v[12:15]
  ds_read_b128 v[60:63], v232 offset:48128
  v_mfma_f32_16x16x32_bf16 v[32:35], v[88:91], v[76:79], v[32:35]
  ds_read_b128 v[64:67], v232 offset:49152
  v_mfma_f32_16x16x32_bf16 v[16:19], v[92:95], v[72:75], v[16:19]
  ds_read_b128 v[68:71], v232 offset:50176
  v_mfma_f32_16x16x32_bf16 v[36:39], v[92:95], v[76:79], v[36:39]
  v_mfma_f32_16x16x32_bf16 v[20:23], v[96:99], v[72:75], v[20:23]
  v_mfma_f32_16x16x32_bf16 v[40:43], v[96:99], v[76:79], v[40:43]
  s_waitcnt lgkmcnt(7)
  v_mfma_f32_16x16x32_bf16 v[4:7], v[108:111], v[100:103], v[4:7]
  ds_read_b128 v[72:75], v240 offset:2048
  v_mfma_f32_16x16x32_bf16 v[24:27], v[108:111], v[104:107], v[24:27]
  ds_read_b128 v[76:79], v240 offset:6144
  v_mfma_f32_16x16x32_bf16 v[8:11], v[112:115], v[100:103], v[8:11]
  ds_read_b128 v[80:83], v232 offset:51200
  v_mfma_f32_16x16x32_bf16 v[28:31], v[112:115], v[104:107], v[28:31]
  ds_read_b128 v[84:87], v232 offset:52224
  v_mfma_f32_16x16x32_bf16 v[12:15], v[116:119], v[100:103], v[12:15]
  ds_read_b128 v[88:91], v232 offset:53248
  v_mfma_f32_16x16x32_bf16 v[32:35], v[116:119], v[104:107], v[32:35]
  ds_read_b128 v[92:95], v232 offset:54272
  v_mfma_f32_16x16x32_bf16 v[16:19], v[120:123], v[100:103], v[16:19]
  ds_read_b128 v[96:99], v232 offset:55296
  v_mfma_f32_16x16x32_bf16 v[36:39], v[120:123], v[104:107], v[36:39]
  v_mfma_f32_16x16x32_bf16 v[20:23], v[124:127], v[100:103], v[20:23]
  v_mfma_f32_16x16x32_bf16 v[40:43], v[124:127], v[104:107], v[40:43]
  s_waitcnt lgkmcnt(7)
  v_mfma_f32_16x16x32_bf16 v[4:7], v[52:55], v[44:47], v[4:7]
  ds_read_b128 v[100:103], v240 offset:3072
  v_mfma_f32_16x16x32_bf16 v[24:27], v[52:55], v[48:51], v[24:27]
  ds_read_b128 v[104:107], v240 offset:7168
  v_mfma_f32_16x16x32_bf16 v[8:11], v[56:59], v[44:47], v[8:11]
  ds_read_b128 v[108:111], v232 offset:56320
  v_mfma_f32_16x16x32_bf16 v[28:31], v[56:59], v[48:51], v[28:31]
  ds_read_b128 v[112:115], v232 offset:57344
  v_mfma_f32_16x16x32_bf16 v[12:15], v[60:63], v[44:47], v[12:15]
  ds_read_b128 v[116:119], v232 offset:58368
  v_mfma_f32_16x16x32_bf16 v[32:35], v[60:63], v[48:51], v[32:35]
  ds_read_b128 v[120:123], v232 offset:59392
  v_mfma_f32_16x16x32_bf16 v[16:19], v[64:67], v[44:47], v[16:19]
  ds_read_b128 v[124:127], v232 offset:60416
  v_mfma_f32_16x16x32_bf16 v[36:39], v[64:67], v[48:51], v[36:39]
  v_mfma_f32_16x16x32_bf16 v[20:23], v[68:71], v[44:47], v[20:23]
  v_mfma_f32_16x16x32_bf16 v[40:43], v[68:71], v[48:51], v[40:43]
  s_waitcnt lgkmcnt(0)
  s_barrier
  v_mfma_f32_16x16x32_bf16 v[4:7], v[80:83], v[72:75], v[4:7]
  ds_read_b128 v[44:47], v239 offset:0
  v_mfma_f32_16x16x32_bf16 v[24:27], v[80:83], v[76:79], v[24:27]
  ds_read_b128 v[48:51], v239 offset:4096
  v_mfma_f32_16x16x32_bf16 v[8:11], v[84:87], v[72:75], v[8:11]
  ds_read_b128 v[52:55], v232 offset:0
  v_mfma_f32_16x16x32_bf16 v[28:31], v[84:87], v[76:79], v[28:31]
  ds_read_b128 v[56:59], v232 offset:1024
  v_mfma_f32_16x16x32_bf16 v[12:15], v[88:91], v[72:75], v[12:15]
  ds_read_b128 v[60:63], v232 offset:2048
  v_mfma_f32_16x16x32_bf16 v[32:35], v[88:91], v[76:79], v[32:35]
  ds_read_b128 v[64:67], v232 offset:3072
  v_mfma_f32_16x16x32_bf16 v[16:19], v[92:95], v[72:75], v[16:19]
  ds_read_b128 v[68:71], v232 offset:4096
  v_mfma_f32_16x16x32_bf16 v[36:39], v[92:95], v[76:79], v[36:39]
  v_mfma_f32_16x16x32_bf16 v[20:23], v[96:99], v[72:75], v[20:23]
  v_mfma_f32_16x16x32_bf16 v[40:43], v[96:99], v[76:79], v[40:43]
  s_waitcnt lgkmcnt(7)
  v_mfma_f32_16x16x32_bf16 v[4:7], v[108:111], v[100:103], v[4:7]
  ds_read_b128 v[72:75], v239 offset:1024
  v_mfma_f32_16x16x32_bf16 v[24:27], v[108:111], v[104:107], v[24:27]
  ds_read_b128 v[76:79], v239 offset:5120
  v_mfma_f32_16x16x32_bf16 v[8:11], v[112:115], v[100:103], v[8:11]
  ds_read_b128 v[80:83], v232 offset:5120
  v_mfma_f32_16x16x32_bf16 v[28:31], v[112:115], v[104:107], v[28:31]
  ds_read_b128 v[84:87], v232 offset:6144
  v_mfma_f32_16x16x32_bf16 v[12:15], v[116:119], v[100:103], v[12:15]
  ds_read_b128 v[88:91], v232 offset:7168
  v_mfma_f32_16x16x32_bf16 v[32:35], v[116:119], v[104:107], v[32:35]
  ds_read_b128 v[92:95], v232 offset:8192
  v_mfma_f32_16x16x32_bf16 v[16:19], v[120:123], v[100:103], v[16:19]
  ds_read_b128 v[96:99], v232 offset:9216
  v_mfma_f32_16x16x32_bf16 v[36:39], v[120:123], v[104:107], v[36:39]
  v_mfma_f32_16x16x32_bf16 v[20:23], v[124:127], v[100:103], v[20:23]
  v_mfma_f32_16x16x32_bf16 v[40:43], v[124:127], v[104:107], v[40:43]
  s_waitcnt lgkmcnt(7)
  v_mfma_f32_16x16x32_bf16 v[4:7], v[52:55], v[44:47], v[4:7]
  ds_read_b128 v[100:103], v239 offset:2048
  v_mfma_f32_16x16x32_bf16 v[24:27], v[52:55], v[48:51], v[24:27]
  ds_read_b128 v[104:107], v239 offset:6144
  v_mfma_f32_16x16x32_bf16 v[8:11], v[56:59], v[44:47], v[8:11]
  ds_read_b128 v[108:111], v232 offset:10240
  v_mfma_f32_16x16x32_bf16 v[28:31], v[56:59], v[48:51], v[28:31]
  ds_read_b128 v[112:115], v232 offset:11264
  v_mfma_f32_16x16x32_bf16 v[12:15], v[60:63], v[44:47], v[12:15]
  ds_read_b128 v[116:119], v232 offset:12288
  v_mfma_f32_16x16x32_bf16 v[32:35], v[60:63], v[48:51], v[32:35]
  ds_read_b128 v[120:123], v232 offset:13312
  v_mfma_f32_16x16x32_bf16 v[16:19], v[64:67], v[44:47], v[16:19]
  ds_read_b128 v[124:127], v232 offset:14336
  v_mfma_f32_16x16x32_bf16 v[36:39], v[64:67], v[48:51], v[36:39]
  v_mfma_f32_16x16x32_bf16 v[20:23], v[68:71], v[44:47], v[20:23]
  v_mfma_f32_16x16x32_bf16 v[40:43], v[68:71], v[48:51], v[40:43]
  s_waitcnt lgkmcnt(7)
  v_mfma_f32_16x16x32_bf16 v[4:7], v[80:83], v[72:75], v[4:7]
  ds_read_b128 v[44:47], v239 offset:3072
  v_mfma_f32_16x16x32_bf16 v[24:27], v[80:83], v[76:79], v[24:27]
  ds_read_b128 v[48:51], v239 offset:7168
  v_mfma_f32_16x16x32_bf16 v[8:11], v[84:87], v[72:75], v[8:11]
  ds_read_b128 v[52:55], v232 offset:15360
  v_mfma_f32_16x16x32_bf16 v[28:31], v[84:87], v[76:79], v[28:31]
  ds_read_b128 v[56:59], v232 offset:16384
  v_mfma_f32_16x16x32_bf16 v[12:15], v[88:91], v[72:75], v[12:15]
  ds_read_b128 v[60:63], v232 offset:17408
  v_mfma_f32_16x16x32_bf16 v[32:35], v[88:91], v[76:79], v[32:35]
  ds_read_b128 v[64:67], v232 offset:18432
  v_mfma_f32_16x16x32_bf16 v[16:19], v[92:95], v[72:75], v[16:19]
  ds_read_b128 v[68:71], v232 offset:19456
  v_mfma_f32_16x16x32_bf16 v[36:39], v[92:95], v[76:79], v[36:39]
  v_mfma_f32_16x16x32_bf16 v[20:23], v[96:99], v[72:75], v[20:23]
  v_mfma_f32_16x16x32_bf16 v[40:43], v[96:99], v[76:79], v[40:43]
  s_waitcnt lgkmcnt(0)
  s_barrier
  v_mfma_f32_16x16x32_bf16 v[4:7], v[108:111], v[100:103], v[4:7]
  ds_read_b128 v[72:75], v239 offset:32768
  v_mfma_f32_16x16x32_bf16 v[24:27], v[108:111], v[104:107], v[24:27]
  ds_read_b128 v[76:79], v239 offset:36864
  v_mfma_f32_16x16x32_bf16 v[8:11], v[112:115], v[100:103], v[8:11]
  ds_read_b128 v[80:83], v232 offset:20480
  v_mfma_f32_16x16x32_bf16 v[28:31], v[112:115], v[104:107], v[28:31]
  ds_read_b128 v[84:87], v232 offset:21504
  v_mfma_f32_16x16x32_bf16 v[12:15], v[116:119], v[100:103], v[12:15]
  ds_read_b128 v[88:91], v232 offset:22528
  v_mfma_f32_16x16x32_bf16 v[32:35], v[116:119], v[104:107], v[32:35]
  ds_read_b128 v[92:95], v232 offset:23552
  v_mfma_f32_16x16x32_bf16 v[16:19], v[120:123], v[100:103], v[16:19]
  ds_read_b128 v[96:99], v232 offset:24576
  v_mfma_f32_16x16x32_bf16 v[36:39], v[120:123], v[104:107], v[36:39]
  v_mfma_f32_16x16x32_bf16 v[20:23], v[124:127], v[100:103], v[20:23]
  v_mfma_f32_16x16x32_bf16 v[40:43], v[124:127], v[104:107], v[40:43]
  s_waitcnt lgkmcnt(7)
  v_mfma_f32_16x16x32_bf16 v[4:7], v[52:55], v[44:47], v[4:7]
  ds_read_b128 v[100:103], v239 offset:33792
  v_mfma_f32_16x16x32_bf16 v[24:27], v[52:55], v[48:51], v[24:27]
  ds_read_b128 v[104:107], v239 offset:37888
  v_mfma_f32_16x16x32_bf16 v[8:11], v[56:59], v[44:47], v[8:11]
  ds_read_b128 v[108:111], v232 offset:25600
  v_mfma_f32_16x16x32_bf16 v[28:31], v[56:59], v[48:51], v[28:31]
  ds_read_b128 v[112:115], v232 offset:26624
  v_mfma_f32_16x16x32_bf16 v[12:15], v[60:63], v[44:47], v[12:15]
  ds_read_b128 v[116:119], v232 offset:27648
  v_mfma_f32_16x16x32_bf16 v[32:35], v[60:63], v[48:51], v[32:35]
  ds_read_b128 v[120:123], v232 offset:28672
  v_mfma_f32_16x16x32_bf16 v[16:19], v[64:67], v[44:47], v[16:19]
  ds_read_b128 v[124:127], v232 offset:29696
  v_mfma_f32_16x16x32_bf16 v[36:39], v[64:67], v[48:51], v[36:39]
  v_mfma_f32_16x16x32_bf16 v[20:23], v[68:71], v[44:47], v[20:23]
  v_mfma_f32_16x16x32_bf16 v[40:43], v[68:71], v[48:51], v[40:43]
  s_waitcnt lgkmcnt(7)
  v_mfma_f32_16x16x32_bf16 v[4:7], v[80:83], v[72:75], v[4:7]
  ds_read_b128 v[44:47], v239 offset:34816
  v_mfma_f32_16x16x32_bf16 v[24:27], v[80:83], v[76:79], v[24:27]
  ds_read_b128 v[48:51], v239 offset:38912
  v_mfma_f32_16x16x32_bf16 v[8:11], v[84:87], v[72:75], v[8:11]
  ds_read_b128 v[52:55], v232 offset:30720
  v_mfma_f32_16x16x32_bf16 v[28:31], v[84:87], v[76:79], v[28:31]
  ds_read_b128 v[56:59], v232 offset:31744
  v_mfma_f32_16x16x32_bf16 v[12:15], v[88:91], v[72:75], v[12:15]
  ds_read_b128 v[60:63], v232 offset:32768
  v_mfma_f32_16x16x32_bf16 v[32:35], v[88:91], v[76:79], v[32:35]
  ds_read_b128 v[64:67], v232 offset:33792
  v_mfma_f32_16x16x32_bf16 v[16:19], v[92:95], v[72:75], v[16:19]
  ds_read_b128 v[68:71], v232 offset:34816
  v_mfma_f32_16x16x32_bf16 v[36:39], v[92:95], v[76:79], v[36:39]
  v_mfma_f32_16x16x32_bf16 v[20:23], v[96:99], v[72:75], v[20:23]
  v_mfma_f32_16x16x32_bf16 v[40:43], v[96:99], v[76:79], v[40:43]
  v_lshrrev_b32 v212, 3, v2
  v_min_u32 v212, 2, v212
  v_cmp_eq_u32 vcc, 1, v212
  v_lshrrev_b32 v212, 1, v212
  s_nop 0
  v_cndmask_b32 v212, v212, -1, vcc
  v_add_u32 v212, s18, v212
  v_max_i32 v212, 0, v212
  v_min_i32 v212, 31, v212
  v_lshlrev_b32 v212, 7, v212
  v_and_b32 v213, 7, v2
  v_lshl_add_u32 v212, v213, 2, v212
  v_add_u32 v212, 0xf2000, v212
  buffer_load_dword v214, v212, s[8:11], 0 offen sc1
  s_waitcnt lgkmcnt(7)
  v_mfma_f32_16x16x32_bf16 v[4:7], v[108:111], v[100:103], v[4:7]
  ds_read_b128 v[72:75], v239 offset:35840
  v_mfma_f32_16x16x32_bf16 v[24:27], v[108:111], v[104:107], v[24:27]
  ds_read_b128 v[76:79], v239 offset:39936
  v_mfma_f32_16x16x32_bf16 v[8:11], v[112:115], v[100:103], v[8:11]
  ds_read_b128 v[80:83], v232 offset:35840
  v_mfma_f32_16x16x32_bf16 v[28:31], v[112:115], v[104:107], v[28:31]
  ds_read_b128 v[84:87], v232 offset:36864
  v_mfma_f32_16x16x32_bf16 v[12:15], v[116:119], v[100:103], v[12:15]
  ds_read_b128 v[88:91], v232 offset:37888
  v_mfma_f32_16x16x32_bf16 v[32:35], v[116:119], v[104:107], v[32:35]
  ds_read_b128 v[92:95], v232 offset:38912
  v_mfma_f32_16x16x32_bf16 v[16:19], v[120:123], v[100:103], v[16:19]
  ds_read_b128 v[96:99], v232 offset:39936
  v_mfma_f32_16x16x32_bf16 v[36:39], v[120:123], v[104:107], v[36:39]
  v_mfma_f32_16x16x32_bf16 v[20:23], v[124:127], v[100:103], v[20:23]
  v_mfma_f32_16x16x32_bf16 v[40:43], v[124:127], v[104:107], v[40:43]
  s_waitcnt lgkmcnt(0)
  s_barrier
  v_mfma_f32_16x16x32_bf16 v[4:7], v[52:55], v[44:47], v[4:7]
  ds_read_b128 v[100:103], v240 offset:0
  v_mfma_f32_16x16x32_bf16 v[24:27], v[52:55], v[48:51], v[24:27]
  ds_read_b128 v[104:107], v240 offset:4096
  v_mfma_f32_16x16x32_bf16 v[8:11], v[56:59], v[44:47], v[8:11]
  ds_read_b128 v[108:111], v232 offset:40960
  v_mfma_f32_16x16x32_bf16 v[28:31], v[56:59], v[48:51], v[28:31]
  ds_read_b128 v[112:115], v232 offset:41984
  v_mfma_f32_16x16x32_bf16 v[12:15], v[60:63], v[44:47], v[12:15]
  ds_read_b128 v[116:119], v232 offset:43008
  v_mfma_f32_16x16x32_bf16 v[32:35], v[60:63], v[48:51], v[32:35]
  ds_read_b128 v[120:123], v232 offset:44032
  v_mfma_f32_16x16x32_bf16 v[16:19], v[64:67], v[44:47], v[16:19]
  ds_read_b128 v[124:127], v232 offset:45056
  v_mfma_f32_16x16x32_bf16 v[36:39], v[64:67], v[48:51], v[36:39]
  v_mfma_f32_16x16x32_bf16 v[20:23], v[68:71], v[44:47], v[20:23]
  v_mfma_f32_16x16x32_bf16 v[40:43], v[68:71], v[48:51], v[40:43]
  s_waitcnt lgkmcnt(7)
  v_mfma_f32_16x16x32_bf16 v[4:7], v[80:83], v[72:75], v[4:7]
  ds_read_b128 v[44:47], v240 offset:1024
  v_mfma_f32_16x16x32_bf16 v[24:27], v[80:83], v[76:79], v[24:27]
  ds_read_b128 v[48:51], v240 offset:5120
  v_mfma_f32_16x16x32_bf16 v[8:11], v[84:87], v[72:75], v[8:11]
  ds_read_b128 v[52:55], v232 offset:46080
  v_mfma_f32_16x16x32_bf16 v[28:31], v[84:87], v[76:79], v[28:31]
  ds_read_b128 v[56:59], v232 offset:47104
  v_mfma_f32_16x16x32_bf16 v[12:15], v[88:91], v[72:75], v[12:15]
  ds_read_b128 v[60:63], v232 offset:48128
  v_mfma_f32_16x16x32_bf16 v[32:35], v[88:91], v[76:79], v[32:35]
  ds_read_b128 v[64:67], v232 offset:49152
  v_mfma_f32_16x16x32_bf16 v[16:19], v[92:95], v[72:75], v[16:19]
  ds_read_b128 v[68:71], v232 offset:50176
  v_mfma_f32_16x16x32_bf16 v[36:39], v[92:95], v[76:79], v[36:39]
  v_mfma_f32_16x16x32_bf16 v[20:23], v[96:99], v[72:75], v[20:23]
  v_mfma_f32_16x16x32_bf16 v[40:43], v[96:99], v[76:79], v[40:43]
  s_waitcnt lgkmcnt(7)
  v_mfma_f32_16x16x32_bf16 v[4:7], v[108:111], v[100:103], v[4:7]
  ds_read_b128 v[72:75], v240 offset:2048
  v_mfma_f32_16x16x32_bf16 v[24:27], v[108:111], v[104:107], v[24:27]
  ds_read_b128 v[76:79], v240 offset:6144
  v_mfma_f32_16x16x32_bf16 v[8:11], v[112:115], v[100:103], v[8:11]
  ds_read_b128 v[80:83], v232 offset:51200
  v_mfma_f32_16x16x32_bf16 v[28:31], v[112:115], v[104:107], v[28:31]
  ds_read_b128 v[84:87], v232 offset:52224
  v_mfma_f32_16x16x32_bf16 v[12:15], v[116:119], v[100:103], v[12:15]
  ds_read_b128 v[88:91], v232 offset:53248
  v_mfma_f32_16x16x32_bf16 v[32:35], v[116:119], v[104:107], v[32:35]
  ds_read_b128 v[92:95], v232 offset:54272
  v_mfma_f32_16x16x32_bf16 v[16:19], v[120:123], v[100:103], v[16:19]
  ds_read_b128 v[96:99], v232 offset:55296
  v_mfma_f32_16x16x32_bf16 v[36:39], v[120:123], v[104:107], v[36:39]
  v_mfma_f32_16x16x32_bf16 v[20:23], v[124:127], v[100:103], v[20:23]
  v_mfma_f32_16x16x32_bf16 v[40:43], v[124:127], v[104:107], v[40:43]
  s_waitcnt lgkmcnt(7)
  v_mfma_f32_16x16x32_bf16 v[4:7], v[52:55], v[44:47], v[4:7]
  ds_read_b128 v[100:103], v240 offset:3072
  v_mfma_f32_16x16x32_bf16 v[24:27], v[52:55], v[48:51], v[24:27]
  ds_read_b128 v[104:107], v240 offset:7168
  v_mfma_f32_16x16x32_bf16 v[8:11], v[56:59], v[44:47], v[8:11]
  ds_read_b128 v[108:111], v232 offset:56320
  v_mfma_f32_16x16x32_bf16 v[28:31], v[56:59], v[48:51], v[28:31]
  ds_read_b128 v[112:115], v232 offset:57344
  v_mfma_f32_16x16x32_bf16 v[12:15], v[60:63], v[44:47], v[12:15]
  ds_read_b128 v[116:119], v232 offset:58368
  v_mfma_f32_16x16x32_bf16 v[32:35], v[60:63], v[48:51], v[32:35]
  ds_read_b128 v[120:123], v232 offset:59392
  v_mfma_f32_16x16x32_bf16 v[16:19], v[64:67], v[44:47], v[16:19]
  ds_read_b128 v[124:127], v232 offset:60416
  v_mfma_f32_16x16x32_bf16 v[36:39], v[64:67], v[48:51], v[36:39]
  v_mfma_f32_16x16x32_bf16 v[20:23], v[68:71], v[44:47], v[20:23]
  v_mfma_f32_16x16x32_bf16 v[40:43], v[68:71], v[48:51], v[40:43]
  s_waitcnt lgkmcnt(0)
  s_barrier
  v_mfma_f32_16x16x32_bf16 v[4:7], v[80:83], v[72:75], v[4:7]
  ds_read_b128 v[44:47], v239 offset:0
  v_mfma_f32_16x16x32_bf16 v[24:27], v[80:83], v[76:79], v[24:27]
  ds_read_b128 v[48:51], v239 offset:4096
  v_mfma_f32_16x16x32_bf16 v[8:11], v[84:87], v[72:75], v[8:11]
  ds_read_b128 v[52:55], v232 offset:0
  v_mfma_f32_16x16x32_bf16 v[28:31], v[84:87], v[76:79], v[28:31]
  ds_read_b128 v[56:59], v232 offset:1024
  v_mfma_f32_16x16x32_bf16 v[12:15], v[88:91], v[72:75], v[12:15]
  ds_read_b128 v[60:63], v232 offset:2048
  v_mfma_f32_16x16x32_bf16 v[32:35], v[88:91], v[76:79], v[32:35]
  ds_read_b128 v[64:67], v232 offset:3072
  v_mfma_f32_16x16x32_bf16 v[16:19], v[92:95], v[72:75], v[16:19]
  ds_read_b128 v[68:71], v232 offset:4096
  v_mfma_f32_16x16x32_bf16 v[36:39], v[92:95], v[76:79], v[36:39]
  v_mfma_f32_16x16x32_bf16 v[20:23], v[96:99], v[72:75], v[20:23]
  v_mfma_f32_16x16x32_bf16 v[40:43], v[96:99], v[76:79], v[40:43]
  s_waitcnt lgkmcnt(7)
  v_mfma_f32_16x16x32_bf16 v[4:7], v[108:111], v[100:103], v[4:7]
  ds_read_b128 v[72:75], v239 offset:1024
  v_mfma_f32_16x16x32_bf16 v[24:27], v[108:111], v[104:107], v[24:27]
  ds_read_b128 v[76:79], v239 offset:5120
  v_mfma_f32_16x16x32_bf16 v[8:11], v[112:115], v[100:103], v[8:11]
  ds_read_b128 v[80:83], v232 offset:5120
  v_mfma_f32_16x16x32_bf16 v[28:31], v[112:115], v[104:107], v[28:31]
  ds_read_b128 v[84:87], v232 offset:6144
  v_mfma_f32_16x16x32_bf16 v[12:15], v[116:119], v[100:103], v[12:15]
  ds_read_b128 v[88:91], v232 offset:7168
  v_mfma_f32_16x16x32_bf16 v[32:35], v[116:119], v[104:107], v[32:35]
  ds_read_b128 v[92:95], v232 offset:8192
  v_mfma_f32_16x16x32_bf16 v[16:19], v[120:123], v[100:103], v[16:19]
  ds_read_b128 v[96:99], v232 offset:9216
  v_mfma_f32_16x16x32_bf16 v[36:39], v[120:123], v[104:107], v[36:39]
  v_mfma_f32_16x16x32_bf16 v[20:23], v[124:127], v[100:103], v[20:23]
  v_mfma_f32_16x16x32_bf16 v[40:43], v[124:127], v[104:107], v[40:43]
  s_waitcnt lgkmcnt(7)
  v_mfma_f32_16x16x32_bf16 v[4:7], v[52:55], v[44:47], v[4:7]
  ds_read_b128 v[100:103], v239 offset:2048
  v_mfma_f32_16x16x32_bf16 v[24:27], v[52:55], v[48:51], v[24:27]
  ds_read_b128 v[104:107], v239 offset:6144
  v_mfma_f32_16x16x32_bf16 v[8:11], v[56:59], v[44:47], v[8:11]
  ds_read_b128 v[108:111], v232 offset:10240
  v_mfma_f32_16x16x32_bf16 v[28:31], v[56:59], v[48:51], v[28:31]
  ds_read_b128 v[112:115], v232 offset:11264
  v_mfma_f32_16x16x32_bf16 v[12:15], v[60:63], v[44:47], v[12:15]
  ds_read_b128 v[116:119], v232 offset:12288
  v_mfma_f32_16x16x32_bf16 v[32:35], v[60:63], v[48:51], v[32:35]
  ds_read_b128 v[120:123], v232 offset:13312
  v_mfma_f32_16x16x32_bf16 v[16:19], v[64:67], v[44:47], v[16:19]
  ds_read_b128 v[124:127], v232 offset:14336
  v_mfma_f32_16x16x32_bf16 v[36:39], v[64:67], v[48:51], v[36:39]
  v_mfma_f32_16x16x32_bf16 v[20:23], v[68:71], v[44:47], v[20:23]
  v_mfma_f32_16x16x32_bf16 v[40:43], v[68:71], v[48:51], v[40:43]
  s_waitcnt lgkmcnt(7)
  v_mfma_f32_16x16x32_bf16 v[4:7], v[80:83], v[72:75], v[4:7]
  ds_read_b128 v[44:47], v239 offset:3072
  v_mfma_f32_16x16x32_bf16 v[24:27], v[80:83], v[76:79], v[24:27]
  ds_read_b128 v[48:51], v239 offset:7168
  v_mfma_f32_16x16x32_bf16 v[8:11], v[84:87], v[72:75], v[8:11]
  ds_read_b128 v[52:55], v232 offset:15360
  v_mfma_f32_16x16x32_bf16 v[28:31], v[84:87], v[76:79], v[28:31]
  ds_read_b128 v[56:59], v232 offset:16384
  v_mfma_f32_16x16x32_bf16 v[12:15], v[88:91], v[72:75], v[12:15]
  ds_read_b128 v[60:63], v232 offset:17408
  v_mfma_f32_16x16x32_bf16 v[32:35], v[88:91], v[76:79], v[32:35]
  ds_read_b128 v[64:67], v232 offset:18432
  v_mfma_f32_16x16x32_bf16 v[16:19], v[92:95], v[72:75], v[16:19]
  ds_read_b128 v[68:71], v232 offset:19456
  v_mfma_f32_16x16x32_bf16 v[36:39], v[92:95], v[76:79], v[36:39]
  v_mfma_f32_16x16x32_bf16 v[20:23], v[96:99], v[72:75], v[20:23]
  v_mfma_f32_16x16x32_bf16 v[40:43], v[96:99], v[76:79], v[40:43]
  s_waitcnt lgkmcnt(0)
  s_barrier
  v_mfma_f32_16x16x32_bf16 v[4:7], v[108:111], v[100:103], v[4:7]
  ds_read_b128 v[72:75], v239 offset:32768
  v_mfma_f32_16x16x32_bf16 v[24:27], v[108:111], v[104:107], v[24:27]
  ds_read_b128 v[76:79], v239 offset:36864
  v_mfma_f32_16x16x32_bf16 v[8:11], v[112:115], v[100:103], v[8:11]
  ds_read_b128 v[80:83], v232 offset:20480
  v_mfma_f32_16x16x32_bf16 v[28:31], v[112:115], v[104:107], v[28:31]
  ds_read_b128 v[84:87], v232 offset:21504
  v_mfma_f32_16x16x32_bf16 v[12:15], v[116:119], v[100:103], v[12:15]
  ds_read_b128 v[88:91], v232 offset:22528
  v_mfma_f32_16x16x32_bf16 v[32:35], v[116:119], v[104:107], v[32:35]
  ds_read_b128 v[92:95], v232 offset:23552
  v_mfma_f32_16x16x32_bf16 v[16:19], v[120:123], v[100:103], v[16:19]
  ds_read_b128 v[96:99], v232 offset:24576
  v_mfma_f32_16x16x32_bf16 v[36:39], v[120:123], v[104:107], v[36:39]
  v_mfma_f32_16x16x32_bf16 v[20:23], v[124:127], v[100:103], v[20:23]
  v_mfma_f32_16x16x32_bf16 v[40:43], v[124:127], v[104:107], v[40:43]
  s_waitcnt lgkmcnt(7)
  v_mfma_f32_16x16x32_bf16 v[4:7], v[52:55], v[44:47], v[4:7]
  ds_read_b128 v[100:103], v239 offset:33792
  v_mfma_f32_16x16x32_bf16 v[24:27], v[52:55], v[48:51], v[24:27]
  ds_read_b128 v[104:107], v239 offset:37888
  v_mfma_f32_16x16x32_bf16 v[8:11], v[56:59], v[44:47], v[8:11]
  ds_read_b128 v[108:111], v232 offset:25600
  v_mfma_f32_16x16x32_bf16 v[28:31], v[56:59], v[48:51], v[28:31]
  ds_read_b128 v[112:115], v232 offset:26624
  v_mfma_f32_16x16x32_bf16 v[12:15], v[60:63], v[44:47], v[12:15]
  ds_read_b128 v[116:119], v232 offset:27648
  v_mfma_f32_16x16x32_bf16 v[32:35], v[60:63], v[48:51], v[32:35]
  ds_read_b128 v[120:123], v232 offset:28672
  v_mfma_f32_16x16x32_bf16 v[16:19], v[64:67], v[44:47], v[16:19]
  ds_read_b128 v[124:127], v232 offset:29696
  v_mfma_f32_16x16x32_bf16 v[36:39], v[64:67], v[48:51], v[36:39]
  v_mfma_f32_16x16x32_bf16 v[20:23], v[68:71], v[44:47], v[20:23]
  v_mfma_f32_16x16x32_bf16 v[40:43], v[68:71], v[48:51], v[40:43]
  s_waitcnt lgkmcnt(7)
  v_mfma_f32_16x16x32_bf16 v[4:7], v[80:83], v[72:75], v[4:7]
  ds_read_b128 v[44:47], v239 offset:34816
  v_mfma_f32_16x16x32_bf16 v[24:27], v[80:83], v[76:79], v[24:27]
  ds_read_b128 v[48:51], v239 offset:38912
  v_mfma_f32_16x16x32_bf16 v[8:11], v[84:87], v[72:75], v[8:11]
  ds_read_b128 v[52:55], v232 offset:30720
  v_mfma_f32_16x16x32_bf16 v[28:31], v[84:87], v[76:79], v[28:31]
  ds_read_b128 v[56:59], v232 offset:31744
  v_mfma_f32_16x16x32_bf16 v[12:15], v[88:91], v[72:75], v[12:15]
  ds_read_b128 v[60:63], v232 offset:32768
  v_mfma_f32_16x16x32_bf16 v[32:35], v[88:91], v[76:79], v[32:35]
  ds_read_b128 v[64:67], v232 offset:33792
  v_mfma_f32_16x16x32_bf16 v[16:19], v[92:95], v[72:75], v[16:19]
  ds_read_b128 v[68:71], v232 offset:34816
  v_mfma_f32_16x16x32_bf16 v[36:39], v[92:95], v[76:79], v[36:39]
  v_mfma_f32_16x16x32_bf16 v[20:23], v[96:99], v[72:75], v[20:23]
  v_mfma_f32_16x16x32_bf16 v[40:43], v[96:99], v[76:79], v[40:43]
  s_waitcnt lgkmcnt(7)
  v_mfma_f32_16x16x32_bf16 v[4:7], v[108:111], v[100:103], v[4:7]
  ds_read_b128 v[72:75], v239 offset:35840
  v_mfma_f32_16x16x32_bf16 v[24:27], v[108:111], v[104:107], v[24:27]
  ds_read_b128 v[76:79], v239 offset:39936
  v_mfma_f32_16x16x32_bf16 v[8:11], v[112:115], v[100:103], v[8:11]
  ds_read_b128 v[80:83], v232 offset:35840
  v_mfma_f32_16x16x32_bf16 v[28:31], v[112:115], v[104:107], v[28:31]
  ds_read_b128 v[84:87], v232 offset:36864
  v_mfma_f32_16x16x32_bf16 v[12:15], v[116:119], v[100:103], v[12:15]
  ds_read_b128 v[88:91], v232 offset:37888
  v_mfma_f32_16x16x32_bf16 v[32:35], v[116:119], v[104:107], v[32:35]
  ds_read_b128 v[92:95], v232 offset:38912
  v_mfma_f32_16x16x32_bf16 v[16:19], v[120:123], v[100:103], v[16:19]
  ds_read_b128 v[96:99], v232 offset:39936
  v_mfma_f32_16x16x32_bf16 v[36:39], v[120:123], v[104:107], v[36:39]
  v_mfma_f32_16x16x32_bf16 v[20:23], v[124:127], v[100:103], v[20:23]
  v_mfma_f32_16x16x32_bf16 v[40:43], v[124:127], v[104:107], v[40:43]
  s_waitcnt lgkmcnt(0)
  s_barrier
  v_mfma_f32_16x16x32_bf16 v[4:7], v[52:55], v[44:47], v[4:7]
  ds_read_b128 v[100:103], v240 offset:0
  v_mfma_f32_16x16x32_bf16 v[24:27], v[52:55], v[48:51], v[24:27]
  ds_read_b128 v[104:107], v240 offset:4096
  v_mfma_f32_16x16x32_bf16 v[8:11], v[56:59], v[44:47], v[8:11]
  ds_read_b128 v[108:111], v232 offset:40960
  v_mfma_f32_16x16x32_bf16 v[28:31], v[56:59], v[48:51], v[28:31]
  ds_read_b128 v[112:115], v232 offset:41984
  v_mfma_f32_16x16x32_bf16 v[12:15], v[60:63], v[44:47], v[12:15]
  ds_read_b128 v[116:119], v232 offset:43008
  v_mfma_f32_16x16x32_bf16 v[32:35], v[60:63], v[48:51], v[32:35]
  ds_read_b128 v[120:123], v232 offset:44032
  v_mfma_f32_16x16x32_bf16 v[16:19], v[64:67], v[44:47], v[16:19]
  ds_read_b128 v[124:127], v232 offset:45056
  v_mfma_f32_16x16x32_bf16 v[36:39], v[64:67], v[48:51], v[36:39]
  v_mfma_f32_16x16x32_bf16 v[20:23], v[68:71], v[44:47], v[20:23]
  v_mfma_f32_16x16x32_bf16 v[40:43], v[68:71], v[48:51], v[40:43]
  s_waitcnt lgkmcnt(7)
  v_mfma_f32_16x16x32_bf16 v[4:7], v[80:83], v[72:75], v[4:7]
  ds_read_b128 v[44:47], v240 offset:1024
  v_mfma_f32_16x16x32_bf16 v[24:27], v[80:83], v[76:79], v[24:27]
  ds_read_b128 v[48:51], v240 offset:5120
  v_mfma_f32_16x16x32_bf16 v[8:11], v[84:87], v[72:75], v[8:11]
  ds_read_b128 v[52:55], v232 offset:46080
  v_mfma_f32_16x16x32_bf16 v[28:31], v[84:87], v[76:79], v[28:31]
  ds_read_b128 v[56:59], v232 offset:47104
  v_mfma_f32_16x16x32_bf16 v[12:15], v[88:91], v[72:75], v[12:15]
  ds_read_b128 v[60:63], v232 offset:48128
  v_mfma_f32_16x16x32_bf16 v[32:35], v[88:91], v[76:79], v[32:35]
  ds_read_b128 v[64:67], v232 offset:49152
  v_mfma_f32_16x16x32_bf16 v[16:19], v[92:95], v[72:75], v[16:19]
  ds_read_b128 v[68:71], v232 offset:50176
  v_mfma_f32_16x16x32_bf16 v[36:39], v[92:95], v[76:79], v[36:39]
  v_mfma_f32_16x16x32_bf16 v[20:23], v[96:99], v[72:75], v[20:23]
  v_mfma_f32_16x16x32_bf16 v[40:43], v[96:99], v[76:79], v[40:43]
  s_waitcnt lgkmcnt(7)
  v_mfma_f32_16x16x32_bf16 v[4:7], v[108:111], v[100:103], v[4:7]
  ds_read_b128 v[72:75], v240 offset:2048
  v_mfma_f32_16x16x32_bf16 v[24:27], v[108:111], v[104:107], v[24:27]
  ds_read_b128 v[76:79], v240 offset:6144
  v_mfma_f32_16x16x32_bf16 v[8:11], v[112:115], v[100:103], v[8:11]
  ds_read_b128 v[80:83], v232 offset:51200
  v_mfma_f32_16x16x32_bf16 v[28:31], v[112:115], v[104:107], v[28:31]
  ds_read_b128 v[84:87], v232 offset:52224
  v_mfma_f32_16x16x32_bf16 v[12:15], v[116:119], v[100:103], v[12:15]
  ds_read_b128 v[88:91], v232 offset:53248
  v_mfma_f32_16x16x32_bf16 v[32:35], v[116:119], v[104:107], v[32:35]
  ds_read_b128 v[92:95], v232 offset:54272
  v_mfma_f32_16x16x32_bf16 v[16:19], v[120:123], v[100:103], v[16:19]
  ds_read_b128 v[96:99], v232 offset:55296
  v_mfma_f32_16x16x32_bf16 v[36:39], v[120:123], v[104:107], v[36:39]
  v_mfma_f32_16x16x32_bf16 v[20:23], v[124:127], v[100:103], v[20:23]
  v_mfma_f32_16x16x32_bf16 v[40:43], v[124:127], v[104:107], v[40:43]
  s_waitcnt vmcnt(0)
  v_cmp_ne_u32 vcc, s32, v214
  s_nop 0
  s_and_b32 s22, vcc_lo, 0xff
  s_cselect_b32 s30, 0, 1
  s_cmp_eq_u32 s17, 0
  s_movk_i32 s23, 0xff
  s_cselect_b32 s23, 0xffff, s23
  s_cmp_eq_u32 s17, 3
  s_cselect_b32 s23, 0xff00ff, s23
  s_and_b32 s22, vcc_lo, s23
  s_cselect_b32 s31, 0, 1
  s_bitcmp1_b32 s18, 0
  s_mov_b32 s23, 0xff00ff
  s_cselect_b32 s23, 0xffff, s23
  s_and_b32 s22, vcc_lo, s23
  s_cselect_b32 s33, 0, 1
  s_waitcnt lgkmcnt(7)
  v_mfma_f32_16x16x32_bf16 v[4:7], v[52:55], v[44:47], v[4:7]
  ds_read_b128 v[100:103], v240 offset:3072
  v_mfma_f32_16x16x32_bf16 v[24:27], v[52:55], v[48:51], v[24:27]
  ds_read_b128 v[104:107], v240 offset:7168
  v_mfma_f32_16x16x32_bf16 v[8:11], v[56:59], v[44:47], v[8:11]
  ds_read_b128 v[108:111], v232 offset:56320
  v_mfma_f32_16x16x32_bf16 v[28:31], v[56:59], v[48:51], v[28:31]
  ds_read_b128 v[112:115], v232 offset:57344
  v_mfma_f32_16x16x32_bf16 v[12:15], v[60:63], v[44:47], v[12:15]
  ds_read_b128 v[116:119], v232 offset:58368
  v_mfma_f32_16x16x32_bf16 v[32:35], v[60:63], v[48:51], v[32:35]
  ds_read_b128 v[120:123], v232 offset:59392
  v_mfma_f32_16x16x32_bf16 v[16:19], v[64:67], v[44:47], v[16:19]
  ds_read_b128 v[124:127], v232 offset:60416
  v_mfma_f32_16x16x32_bf16 v[36:39], v[64:67], v[48:51], v[36:39]
  v_mfma_f32_16x16x32_bf16 v[20:23], v[68:71], v[44:47], v[20:23]
  v_mfma_f32_16x16x32_bf16 v[40:43], v[68:71], v[48:51], v[40:43]
  s_waitcnt lgkmcnt(0)
  s_barrier
  v_mfma_f32_16x16x32_bf16 v[4:7], v[80:83], v[72:75], v[4:7]
  ds_read_b128 v[44:47], v239 offset:0
  v_mfma_f32_16x16x32_bf16 v[24:27], v[80:83], v[76:79], v[24:27]
  ds_read_b128 v[48:51], v239 offset:4096
  v_mfma_f32_16x16x32_bf16 v[8:11], v[84:87], v[72:75], v[8:11]
  ds_read_b128 v[52:55], v232 offset:0
  v_mfma_f32_16x16x32_bf16 v[28:31], v[84:87], v[76:79], v[28:31]
  ds_read_b128 v[56:59], v232 offset:1024
  v_mfma_f32_16x16x32_bf16 v[12:15], v[88:91], v[72:75], v[12:15]
  ds_read_b128 v[60:63], v232 offset:2048
  v_mfma_f32_16x16x32_bf16 v[32:35], v[88:91], v[76:79], v[32:35]
  ds_read_b128 v[64:67], v232 offset:3072
  v_mfma_f32_16x16x32_bf16 v[16:19], v[92:95], v[72:75], v[16:19]
  ds_read_b128 v[68:71], v232 offset:4096
  v_mfma_f32_16x16x32_bf16 v[36:39], v[92:95], v[76:79], v[36:39]
  v_mfma_f32_16x16x32_bf16 v[20:23], v[96:99], v[72:75], v[20:23]
  v_mfma_f32_16x16x32_bf16 v[40:43], v[96:99], v[76:79], v[40:43]
  s_waitcnt lgkmcnt(7)
  v_mfma_f32_16x16x32_bf16 v[4:7], v[108:111], v[100:103], v[4:7]
  ds_read_b128 v[72:75], v239 offset:1024
  v_mfma_f32_16x16x32_bf16 v[24:27], v[108:111], v[104:107], v[24:27]
  ds_read_b128 v[76:79], v239 offset:5120
  v_mfma_f32_16x16x32_bf16 v[8:11], v[112:115], v[100:103], v[8:11]
  ds_read_b128 v[80:83], v232 offset:5120
  v_mfma_f32_16x16x32_bf16 v[28:31], v[112:115], v[104:107], v[28:31]
  ds_read_b128 v[84:87], v232 offset:6144
  v_mfma_f32_16x16x32_bf16 v[12:15], v[116:119], v[100:103], v[12:15]
  ds_read_b128 v[88:91], v232 offset:7168
  v_mfma_f32_16x16x32_bf16 v[32:35], v[116:119], v[104:107], v[32:35]
  ds_read_b128 v[92:95], v232 offset:8192
  v_mfma_f32_16x16x32_bf16 v[16:19], v[120:123], v[100:103], v[16:19]
  ds_read_b128 v[96:99], v232 offset:9216
  v_mfma_f32_16x16x32_bf16 v[36:39], v[120:123], v[104:107], v[36:39]
  v_mfma_f32_16x16x32_bf16 v[20:23], v[124:127], v[100:103], v[20:23]
  v_mfma_f32_16x16x32_bf16 v[40:43], v[124:127], v[104:107], v[40:43]
  s_waitcnt lgkmcnt(7)
  v_mfma_f32_16x16x32_bf16 v[4:7], v[52:55], v[44:47], v[4:7]
  ds_read_b128 v[100:103], v239 offset:2048
  v_mfma_f32_16x16x32_bf16 v[24:27], v[52:55], v[48:51], v[24:27]
  ds_read_b128 v[104:107], v239 offset:6144
  v_mfma_f32_16x16x32_bf16 v[8:11], v[56:59], v[44:47], v[8:11]
  ds_read_b128 v[108:111], v232 offset:10240
  v_mfma_f32_16x16x32_bf16 v[28:31], v[56:59], v[48:51], v[28:31]
  ds_read_b128 v[112:115], v232 offset:11264
  v_mfma_f32_16x16x32_bf16 v[12:15], v[60:63], v[44:47], v[12:15]
  ds_read_b128 v[116:119], v232 offset:12288
  v_mfma_f32_16x16x32_bf16 v[32:35], v[60:63], v[48:51], v[32:35]
  ds_read_b128 v[120:123], v232 offset:13312
  v_mfma_f32_16x16x32_bf16 v[16:19], v[64:67], v[44:47], v[16:19]
  ds_read_b128 v[124:127], v232 offset:14336
  v_mfma_f32_16x16x32_bf16 v[36:39], v[64:67], v[48:51], v[36:39]
  v_mfma_f32_16x16x32_bf16 v[20:23], v[68:71], v[44:47], v[20:23]
  v_mfma_f32_16x16x32_bf16 v[40:43], v[68:71], v[48:51], v[40:43]
  s_waitcnt lgkmcnt(7)
  v_mfma_f32_16x16x32_bf16 v[4:7], v[80:83], v[72:75], v[4:7]
  ds_read_b128 v[44:47], v239 offset:3072
  v_mfma_f32_16x16x32_bf16 v[24:27], v[80:83], v[76:79], v[24:27]
  ds_read_b128 v[48:51], v239 offset:7168
  v_mfma_f32_16x16x32_bf16 v[8:11], v[84:87], v[72:75], v[8:11]
  ds_read_b128 v[52:55], v232 offset:15360
  v_mfma_f32_16x16x32_bf16 v[28:31], v[84:87], v[76:79], v[28:31]
  ds_read_b128 v[56:59], v232 offset:16384
  v_mfma_f32_16x16x32_bf16 v[12:15], v[88:91], v[72:75], v[12:15]
  ds_read_b128 v[60:63], v232 offset:17408
  v_mfma_f32_16x16x32_bf16 v[32:35], v[88:91], v[76:79], v[32:35]
  ds_read_b128 v[64:67], v232 offset:18432
  v_mfma_f32_16x16x32_bf16 v[16:19], v[92:95], v[72:75], v[16:19]
  ds_read_b128 v[68:71], v232 offset:19456
  v_mfma_f32_16x16x32_bf16 v[36:39], v[92:95], v[76:79], v[36:39]
  v_mfma_f32_16x16x32_bf16 v[20:23], v[96:99], v[72:75], v[20:23]
  v_mfma_f32_16x16x32_bf16 v[40:43], v[96:99], v[76:79], v[40:43]
  s_waitcnt lgkmcnt(7)
  v_mfma_f32_16x16x32_bf16 v[4:7], v[108:111], v[100:103], v[4:7]
  v_mfma_f32_16x16x32_bf16 v[24:27], v[108:111], v[104:107], v[24:27]
  v_mfma_f32_16x16x32_bf16 v[8:11], v[112:115], v[100:103], v[8:11]
  v_mfma_f32_16x16x32_bf16 v[28:31], v[112:115], v[104:107], v[28:31]
  v_mfma_f32_16x16x32_bf16 v[12:15], v[116:119], v[100:103], v[12:15]
  v_mfma_f32_16x16x32_bf16 v[32:35], v[116:119], v[104:107], v[32:35]
  v_mfma_f32_16x16x32_bf16 v[16:19], v[120:123], v[100:103], v[16:19]
  v_mfma_f32_16x16x32_bf16 v[36:39], v[120:123], v[104:107], v[36:39]
  v_mfma_f32_16x16x32_bf16 v[20:23], v[124:127], v[100:103], v[20:23]
  v_mfma_f32_16x16x32_bf16 v[40:43], v[124:127], v[104:107], v[40:43]
  s_waitcnt lgkmcnt(0)
  s_barrier
  v_mfma_f32_16x16x32_bf16 v[4:7], v[52:55], v[44:47], v[4:7]
  v_mfma_f32_16x16x32_bf16 v[24:27], v[52:55], v[48:51], v[24:27]
  v_mfma_f32_16x16x32_bf16 v[8:11], v[56:59], v[44:47], v[8:11]
  v_mfma_f32_16x16x32_bf16 v[28:31], v[56:59], v[48:51], v[28:31]
  v_mfma_f32_16x16x32_bf16 v[12:15], v[60:63], v[44:47], v[12:15]
  v_mfma_f32_16x16x32_bf16 v[32:35], v[60:63], v[48:51], v[32:35]
  v_mfma_f32_16x16x32_bf16 v[16:19], v[64:67], v[44:47], v[16:19]
  v_mfma_f32_16x16x32_bf16 v[36:39], v[64:67], v[48:51], v[36:39]
  v_mfma_f32_16x16x32_bf16 v[20:23], v[68:71], v[44:47], v[20:23]
  v_mfma_f32_16x16x32_bf16 v[40:43], v[68:71], v[48:51], v[40:43]
kb_cpa:
  s_cmp_eq_u32 s33, 0
  s_cbranch_scc1 kb_kernel_slow_11
  s_lshl_b32 s24, s18, 3
  s_add_u32 s24, s24, s19
  s_xor_b32 s22, s24, 8
  s_mul_i32 s22, s22, 12
  s_add_u32 s22, s22, s17
  s_mul_i32 s22, s22, 5120
  s_add_u32 s22, s22, 0x1400000
  s_add_u32 s23, s22, 4096
  buffer_store_dwordx4 v[24:27], v1, s[8:11], s22 offen offset:0
  buffer_store_dwordx4 v[28:31], v1, s[8:11], s22 offen offset:1024
  buffer_store_dwordx4 v[32:35], v1, s[8:11], s22 offen offset:2048
  buffer_store_dwordx4 v[36:39], v1, s[8:11], s22 offen offset:3072
  buffer_store_dwordx4 v[40:43], v1, s[8:11], s23 offen offset:0
  v_add_u32 v212, 1, v2
  v_and_b32 v213, 1, v212
  v_lshlrev_b32 v213, 9, v213
  v_and_b32 v214, 2, v212
  v_lshl_add_u32 v213, v214, 3, v213
  s_lshl_b32 s22, s27, 7
  s_lshl_b32 s23, s19, 4
  s_add_u32 s22, s22, s23
  v_xor_b32 v213, s22, v213
  v_lshl_add_u32 v213, v212, 2, v213
  v_add_u32 v213, 0xf4000, v213
  v_min_u32 v212, 1, v212
  v_lshlrev_b32 v212, 2, v212
  s_add_u32 s22, s22, 0xf4000
  v_add_u32 v212, s22, v212
  v_mov_b32 v214, 1
  s_waitcnt vmcnt(0)
  s_mov_b64 exec, 1
  buffer_store_dword v214, v213, s[8:11], 0 offen
  s_mov_b64 exec, -1
kb_kernel_fj_12:
  v_lshlrev_b32 v132, 16, v242
  v_and_b32 v133, 0xffff0000, v242
  v_lshlrev_b32 v134, 16, v243
  v_and_b32 v135, 0xffff0000, v243
  v_lshlrev_b32 v136, 16, v244
  v_and_b32 v137, 0xffff0000, v244
  v_lshlrev_b32 v138, 16, v245
  v_and_b32 v139, 0xffff0000, v245
  v_lshlrev_b32 v140, 16, v246
  v_and_b32 v141, 0xffff0000, v246
  v_lshlrev_b32 v142, 16, v247
  v_and_b32 v143, 0xffff0000, v247
  v_lshlrev_b32 v144, 16, v248
  v_and_b32 v145, 0xffff0000, v248
  v_lshlrev_b32 v146, 16, v249
  v_and_b32 v147, 0xffff0000, v249
  v_lshlrev_b32 v148, 16, v250
  v_and_b32 v149, 0xffff0000, v250
  v_lshlrev_b32 v150, 16, v251
  v_and_b32 v151, 0xffff0000, v251
  s_mul_i32 s24, s24, 12
  s_add_u32 s24, s24, s17
  s_mul_i32 s24, s24, 5120
  s_mov_b32 s25, 0x40000
kb_kernel_xpoll_13:
  buffer_load_dword v215, v212, s[8:11], 0 offen sc1
  s_waitcnt vmcnt(0)
  v_cmp_eq_u32 vcc, 0, v215
  s_cbranch_vccz kb_kernel_xok_14
  s_sleep 2
  s_sub_u32 s25, s25, 1
  s_cmp_lg_u32 s25, 0
  s_cbranch_scc1 kb_kernel_xpoll_13
kb_kernel_xok_14:
  s_add_u32 s22, s24, 0x1400000
  s_add_u32 s23, s22, 4096
  buffer_load_dwordx4 v[60:63], v1, s[8:11], s22 offen offset:0 sc1
  buffer_load_dwordx4 v[64:67], v1, s[8:11], s22 offen offset:1024 sc1
  buffer_load_dwordx4 v[68:71], v1, s[8:11], s22 offen offset:2048 sc1
  buffer_load_dwordx4 v[72:75], v1, s[8:11], s22 offen offset:3072 sc1
  buffer_load_dwordx4 v[76:79], v1, s[8:11], s23 offen offset:0 sc1
  s_waitcnt vmcnt(0)
  v_pk_add_f32 v[4:5], v[4:5], v[60:61]
  v_pk_add_f32 v[6:7], v[6:7], v[62:63]
  v_pk_add_f32 v[8:9], v[8:9], v[64:65]
  v_pk_add_f32 v[10:11], v[10:11], v[66:67]
  v_pk_add_f32 v[12:13], v[12:13], v[68:69]
  v_pk_add_f32 v[14:15], v[14:15], v[70:71]
  v_pk_add_f32 v[16:17], v[16:17], v[72:73]
  v_pk_add_f32 v[18:19], v[18:19], v[74:75]
  v_pk_add_f32 v[20:21], v[20:21], v[76:77]
  v_pk_add_f32 v[22:23], v[22:23], v[78:79]
  s_cmp_eq_u32 s30, 0
  s_cbranch_scc1 kb_kernel_slow_15
  v_add_u32 v221, 0x400000, v236
  v_pk_fma_f32 v[148:149], v[20:21], v[188:189], v[148:149]
  v_pk_fma_f32 v[150:151], v[22:23], v[190:191], v[150:151]
  v_pk_mul_f32 v[20:21], v[148:149], v[208:209]
  v_pk_mul_f32 v[22:23], v[150:151], v[210:211]
  v_cvt_pk_bf16_f32 v68, v20, v21
  v_cvt_pk_bf16_f32 v69, v22, v23
  buffer_store_dwordx2 v[68:69], v221, s[8:11], s29 offen
  v_pk_fma_f32 v[132:133], v[4:5], v[172:173], v[132:133]
  v_pk_fma_f32 v[134:135], v[6:7], v[174:175], v[134:135]
  v_pk_mul_f32 v[4:5], v[132:133], v[192:193]
  v_pk_mul_f32 v[6:7], v[134:135], v[194:195]
  v_cvt_pk_bf16_f32 v60, v4, v5
  v_cvt_pk_bf16_f32 v61, v6, v7
  v_pk_fma_f32 v[136:137], v[8:9], v[176:177], v[136:137]
  v_pk_fma_f32 v[138:139], v[10:11], v[178:179], v[138:139]
  v_pk_mul_f32 v[8:9], v[136:137], v[196:197]
  v_pk_mul_f32 v[10:11], v[138:139], v[198:199]
  v_cvt_pk_bf16_f32 v62, v8, v9
  v_cvt_pk_bf16_f32 v63, v10, v11
  buffer_store_dwordx4 v[60:63], v221, s[8:11], s28 offen offset:0
  v_pk_fma_f32 v[140:141], v[12:13], v[180:181], v[140:141]
  v_pk_fma_f32 v[142:143], v[14:15], v[182:183], v[142:143]
  v_pk_mul_f32 v[12:13], v[140:141], v[200:201]
  v_pk_mul_f32 v[14:15], v[142:143], v[202:203]
  v_cvt_pk_bf16_f32 v64, v12, v13
  v_cvt_pk_bf16_f32 v65, v14, v15
  v_pk_fma_f32 v[144:145], v[16:17], v[184:185], v[144:145]
  v_pk_fma_f32 v[146:147], v[18:19], v[186:187], v[146:147]
  v_pk_mul_f32 v[16:17], v[144:145], v[204:205]
  v_pk_mul_f32 v[18:19], v[146:147], v[206:207]
  v_cvt_pk_bf16_f32 v66, v16, v17
  v_cvt_pk_bf16_f32 v67, v18, v19
  buffer_store_dwordx4 v[64:67], v221, s[8:11], s28 offen offset:1024
  v_pk_mul_f32 v[110:111], v[132:133], v[132:133]
  v_pk_mul_f32 v[114:115], v[4:5], v[4:5]
  v_pk_mul_f32 v[116:117], v[4:5], v[192:193]
  v_pk_mul_f32 v[118:119], v[4:5], v[152:153]
  v_pk_add_f32 v[108:109], v[132:133], v[134:135]
  v_pk_fma_f32 v[110:111], v[134:135], v[134:135], v[110:111]
  v_pk_add_f32 v[112:113], v[4:5], v[6:7]
  v_pk_fma_f32 v[114:115], v[6:7], v[6:7], v[114:115]
  v_pk_fma_f32 v[116:117], v[6:7], v[194:195], v[116:117]
  v_pk_fma_f32 v[118:119], v[6:7], v[154:155], v[118:119]
  v_pk_add_f32 v[108:109], v[108:109], v[136:137]
  v_pk_fma_f32 v[110:111], v[136:137], v[136:137], v[110:111]
  v_pk_add_f32 v[112:113], v[112:113], v[8:9]
  v_pk_fma_f32 v[114:115], v[8:9], v[8:9], v[114:115]
  v_pk_fma_f32 v[116:117], v[8:9], v[196:197], v[116:117]
  v_pk_fma_f32 v[118:119], v[8:9], v[156:157], v[118:119]
  v_pk_add_f32 v[108:109], v[108:109], v[138:139]
  v_pk_fma_f32 v[110:111], v[138:139], v[138:139], v[110:111]
  v_pk_add_f32 v[112:113], v[112:113], v[10:11]
  v_pk_fma_f32 v[114:115], v[10:11], v[10:11], v[114:115]
  v_pk_fma_f32 v[116:117], v[10:11], v[198:199], v[116:117]
  v_pk_fma_f32 v[118:119], v[10:11], v[158:159], v[118:119]
  v_pk_add_f32 v[108:109], v[108:109], v[140:141]
  v_pk_fma_f32 v[110:111], v[140:141], v[140:141], v[110:111]
  v_pk_add_f32 v[112:113], v[112:113], v[12:13]
  v_pk_fma_f32 v[114:115], v[12:13], v[12:13], v[114:115]
  v_pk_fma_f32 v[116:117], v[12:13], v[200:201], v[116:117]
  v_pk_fma_f32 v[118:119], v[12:13], v[160:161], v[118:119]
  v_pk_add_f32 v[108:109], v[108:109], v[142:143]
  v_pk_fma_f32 v[110:111], v[142:143], v[142:143], v[110:111]
  v_pk_add_f32 v[112:113], v[112:113], v[14:15]
  v_pk_fma_f32 v[114:115], v[14:15], v[14:15], v[114:115]
  v_pk_fma_f32 v[116:117], v[14:15], v[202:203], v[116:117]
  v_pk_fma_f32 v[118:119], v[14:15], v[162:163], v[118:119]
  v_pk_add_f32 v[108:109], v[108:109], v[144:145]
  v_pk_fma_f32 v[110:111], v[144:145], v[144:145], v[110:111]
  v_pk_add_f32 v[112:113], v[112:113], v[16:17]
  v_pk_fma_f32 v[114:115], v[16:17], v[16:17], v[114:115]
  v_pk_fma_f32 v[116:117], v[16:17], v[204:205], v[116:117]
  v_pk_fma_f32 v[118:119], v[16:17], v[164:165], v[118:119]
  v_pk_add_f32 v[108:109], v[108:109], v[146:147]
  v_pk_fma_f32 v[110:111], v[146:147], v[146:147], v[110:111]
  v_pk_add_f32 v[112:113], v[112:113], v[18:19]
  v_pk_fma_f32 v[114:115], v[18:19], v[18:19], v[114:115]
  v_pk_fma_f32 v[116:117], v[18:19], v[206:207], v[116:117]
  v_pk_fma_f32 v[118:119], v[18:19], v[166:167], v[118:119]
  v_pk_add_f32 v[108:109], v[108:109], v[148:149]
  v_pk_fma_f32 v[110:111], v[148:149], v[148:149], v[110:111]
  v_pk_add_f32 v[112:113], v[112:113], v[20:21]
  v_pk_fma_f32 v[114:115], v[20:21], v[20:21], v[114:115]
  v_pk_fma_f32 v[116:117], v[20:21], v[208:209], v[116:117]
  v_pk_fma_f32 v[118:119], v[20:21], v[168:169], v[118:119]
  v_pk_add_f32 v[108:109], v[108:109], v[150:151]
  v_pk_fma_f32 v[110:111], v[150:151], v[150:151], v[110:111]
  v_pk_add_f32 v[112:113], v[112:113], v[22:23]
  v_pk_fma_f32 v[114:115], v[22:23], v[22:23], v[114:115]
  v_pk_fma_f32 v[116:117], v[22:23], v[210:211], v[116:117]
  v_pk_fma_f32 v[118:119], v[22:23], v[170:171], v[118:119]
  v_add_f32 v100, v108, v109
  v_add_f32 v101, v110, v111
  v_add_f32 v102, v112, v113
  v_add_f32 v103, v114, v115
  v_add_f32 v104, v116, v117
  v_add_f32 v105, v118, v119
  v_mov_b32 v106, 0
  v_mov_b32 v107, 0
  v_and_b32 v222, 15, v2
  s_add_u32 s22, s27, 0
  s_lshl_b32 s22, s22, 4
  v_add_u32 v222, s22, v222
  v_mul_u32_u24 v222, 256, v222
  v_permlane16_swap_b32 v100, v101
  v_permlane16_swap_b32 v102, v103
  v_add_f32 v100, v100, v101
  v_add_f32 v102, v102, v103
  s_nop 1
  v_permlane32_swap_b32 v100, v102
  v_add_f32 v100, v100, v102
  v_permlane16_swap_b32 v104, v105
  v_permlane16_swap_b32 v106, v107
  v_add_f32 v104, v104, v105
  v_add_f32 v106, v106, v107
  s_nop 1
  v_permlane32_swap_b32 v104, v106
  v_add_f32 v104, v104, v106
  v_lshrrev_b32 v212, 4, v2
  v_lshl_add_u32 v222, v212, 2, v222
  s_lshl_b32 s22, s19, 5
  s_add_u32 s22, s22, 0x1240000
  buffer_store_dword v100, v222, s[8:11], s22 offen
  buffer_store_dword v104, v222, s[8:11], s22 offen offset:16
  s_lshl_b32 s22, s27, 7
  s_lshl_b32 s23, s19, 3
  s_add_u32 s22, s22, s23
  s_add_u32 s22, s22, 0xe0000
  v_lshlrev_b32 v212, 7, v2
  v_add_u32 v212, s22, v212
  v_mov_b32 v213, 1
  s_waitcnt vmcnt(0)
  s_mov_b64 exec, 1
  buffer_store_dword v213, v212, s[8:11], 0 offen
  s_mov_b64 exec, -1
kb_kernel_fj_16:
  s_barrier
  s_add_u32 s24, s20, s42
  s_lshl_b32 s28, s24, 9
  s_lshr_b32 s22, s19, 1
  s_mul_i32 s22, s22, 5120
  s_lshl_b32 s23, s42, 3
  s_add_u32 s22, s22, s23
  s_add_u32 s29, s22, 2048
  s_add_u32 s25, s20, 4
  s_cmp_eq_u32 s42, 0
  s_cselect_b32 s25, s25, s20
  v_and_b32 v212, 0x30, v2
  s_lshl_b32 s24, s24, 6
  s_lshl_b32 s25, s25, 6
  v_add_u32 v234, s24, v212
  v_add_u32 v235, s25, v212
  s_mul_i32 s22, s27, 20480
  v_add_u32 v236, s22, v1
  s_lshl_b32 s22, s17, 12
  s_add_u32 s22, s22, 81920
  v_add_u32 v239, s22, v1
  v_add_u32 v240, 65536, v239
  v_mov_b32 v232, v1
  v_add_u32 v233, 65536, v232
  s_mov_b32 s26, 98304
  buffer_load_dwordx4 v[172:175], v234, s[8:11], s26 offen offset:0
  buffer_load_dwordx4 v[176:179], v234, s[8:11], s26 offen offset:64
  buffer_load_dwordx4 v[180:183], v234, s[8:11], s26 offen offset:128
  buffer_load_dwordx4 v[184:187], v234, s[8:11], s26 offen offset:192
  buffer_load_dwordx4 v[188:191], v235, s[8:11], s26 offen offset:0
  s_mov_b32 s26, 100864
  buffer_load_dwordx4 v[192:195], v234, s[8:11], s26 offen offset:0
  buffer_load_dwordx4 v[196:199], v234, s[8:11], s26 offen offset:64
  buffer_load_dwordx4 v[200:203], v234, s[8:11], s26 offen offset:128
  buffer_load_dwordx4 v[204:207], v234, s[8:11], s26 offen offset:192
  buffer_load_dwordx4 v[208:211], v235, s[8:11], s26 offen offset:0
  s_mov_b32 s26, 103424
  buffer_load_dwordx4 v[152:155], v234, s[8:11], s26 offen offset:0
  buffer_load_dwordx4 v[156:159], v234, s[8:11], s26 offen offset:64
  buffer_load_dwordx4 v[160:163], v234, s[8:11], s26 offen offset:128
  buffer_load_dwordx4 v[164:167], v234, s[8:11], s26 offen offset:192
  buffer_load_dwordx4 v[168:171], v235, s[8:11], s26 offen offset:0
  s_barrier
  ds_read_b128 v[60:63], v239 offset:16384
  ds_read_b128 v[64:67], v232 offset:20480
  ds_read_b128 v[68:71], v232 offset:21504
  ds_read_b128 v[72:75], v232 offset:22528
  ds_read_b128 v[76:79], v232 offset:23552
  ds_read_b128 v[80:83], v232 offset:24576
  ds_read_b128 v[84:87], v239 offset:17408
  ds_read_b128 v[88:91], v232 offset:25600
  ds_read_b128 v[92:95], v232 offset:26624
  ds_read_b128 v[96:99], v232 offset:27648
  ds_read_b128 v[100:103], v232 offset:28672
  ds_read_b128 v[104:107], v232 offset:29696
  v_and_b32 v220, 15, v2
  s_add_u32 s22, s27, 0
  s_lshl_b32 s22, s22, 4
  v_add_u32 v220, s22, v220
  v_mul_u32_u24 v220, 256, v220
  v_and_b32 v212, 0x30, v2
  v_lshlrev_b32 v212, 2, v212
  v_add_u32 v220, v220, v212
  s_mov_b32 s26, 0x1240000
  buffer_load_dwordx4 v[28:31], v220, s[8:11], s26 offen offset:0 sc1
  buffer_load_dwordx4 v[32:35], v220, s[8:11], s26 offen offset:16 sc1
  buffer_load_dwordx4 v[36:39], v220, s[8:11], s26 offen offset:32 sc1
  buffer_load_dwordx4 v[40:43], v220, s[8:11], s26 offen offset:48 sc1
  s_waitcnt lgkmcnt(6)
  v_mfma_f32_16x16x32_bf16 v[4:7], v[64:67], v[60:63], 0
  ds_read_b128 v[108:111], v239 offset:18432
  ds_read_b128 v[112:115], v232 offset:30720
  v_mfma_f32_16x16x32_bf16 v[8:11], v[68:71], v[60:63], 0
  ds_read_b128 v[116:119], v232 offset:31744
  ds_read_b128 v[120:123], v232 offset:32768
  v_mfma_f32_16x16x32_bf16 v[12:15], v[72:75], v[60:63], 0
  ds_read_b128 v[124:127], v232 offset:33792
  ds_read_b128 v[128:131], v232 offset:34816
  v_mfma_f32_16x16x32_bf16 v[16:19], v[76:79], v[60:63], 0
  v_mfma_f32_16x16x32_bf16 v[20:23], v[80:83], v[60:63], 0
  s_waitcnt lgkmcnt(6)
  v_mfma_f32_16x16x32_bf16 v[4:7], v[88:91], v[84:87], v[4:7]
  ds_read_b128 v[60:63], v239 offset:19456
  ds_read_b128 v[64:67], v232 offset:35840
  v_mfma_f32_16x16x32_bf16 v[8:11], v[92:95], v[84:87], v[8:11]
  ds_read_b128 v[68:71], v232 offset:36864
  ds_read_b128 v[72:75], v232 offset:37888
  v_mfma_f32_16x16x32_bf16 v[12:15], v[96:99], v[84:87], v[12:15]
  ds_read_b128 v[76:79], v232 offset:38912
  ds_read_b128 v[80:83], v232 offset:39936
  v_mfma_f32_16x16x32_bf16 v[16:19], v[100:103], v[84:87], v[16:19]
  v_mfma_f32_16x16x32_bf16 v[20:23], v[104:107], v[84:87], v[20:23]
  s_waitcnt lgkmcnt(0)
  s_barrier
  v_mfma_f32_16x16x32_bf16 v[4:7], v[112:115], v[108:111], v[4:7]
  ds_read_b128 v[84:87], v239 offset:32768
  ds_read_b128 v[88:91], v232 offset:40960
  v_mfma_f32_16x16x32_bf16 v[8:11], v[116:119], v[108:111], v[8:11]
  ds_read_b128 v[92:95], v232 offset:41984
  ds_read_b128 v[96:99], v232 offset:43008
  v_mfma_f32_16x16x32_bf16 v[12:15], v[120:123], v[108:111], v[12:15]
  ds_read_b128 v[100:103], v232 offset:44032
  ds_read_b128 v[104:107], v232 offset:45056
  v_mfma_f32_16x16x32_bf16 v[16:19], v[124:127], v[108:111], v[16:19]
  v_mfma_f32_16x16x32_bf16 v[20:23], v[128:131], v[108:111], v[20:23]
  s_waitcnt lgkmcnt(6)
  v_mfma_f32_16x16x32_bf16 v[4:7], v[64:67], v[60:63], v[4:7]
  ds_read_b128 v[108:111], v239 offset:33792
  ds_read_b128 v[112:115], v232 offset:46080
  v_mfma_f32_16x16x32_bf16 v[8:11], v[68:71], v[60:63], v[8:11]
  ds_read_b128 v[116:119], v232 offset:47104
  ds_read_b128 v[120:123], v232 offset:48128
  v_mfma_f32_16x16x32_bf16 v[12:15], v[72:75], v[60:63], v[12:15]
  ds_read_b128 v[124:127], v232 offset:49152
  ds_read_b128 v[128:131], v232 offset:50176
  v_mfma_f32_16x16x32_bf16 v[16:19], v[76:79], v[60:63], v[16:19]
  v_mfma_f32_16x16x32_bf16 v[20:23], v[80:83], v[60:63], v[20:23]
  s_waitcnt lgkmcnt(6)
  v_mfma_f32_16x16x32_bf16 v[4:7], v[88:91], v[84:87], v[4:7]
  ds_read_b128 v[60:63], v239 offset:34816
  ds_read_b128 v[64:67], v232 offset:51200
  v_mfma_f32_16x16x32_bf16 v[8:11], v[92:95], v[84:87], v[8:11]
  ds_read_b128 v[68:71], v232 offset:52224
  ds_read_b128 v[72:75], v232 offset:53248
  v_mfma_f32_16x16x32_bf16 v[12:15], v[96:99], v[84:87], v[12:15]
  ds_read_b128 v[76:79], v232 offset:54272
  ds_read_b128 v[80:83], v232 offset:55296
  v_mfma_f32_16x16x32_bf16 v[16:19], v[100:103], v[84:87], v[16:19]
  v_mfma_f32_16x16x32_bf16 v[20:23], v[104:107], v[84:87], v[20:23]
  s_waitcnt lgkmcnt(6)
  v_mfma_f32_16x16x32_bf16 v[4:7], v[112:115], v[108:111], v[4:7]
  ds_read_b128 v[84:87], v239 offset:35840
  ds_read_b128 v[88:91], v232 offset:56320
  v_mfma_f32_16x16x32_bf16 v[8:11], v[116:119], v[108:111], v[8:11]
  ds_read_b128 v[92:95], v232 offset:57344
  ds_read_b128 v[96:99], v232 offset:58368
  v_mfma_f32_16x16x32_bf16 v[12:15], v[120:123], v[108:111], v[12:15]
  ds_read_b128 v[100:103], v232 offset:59392
  ds_read_b128 v[104:107], v232 offset:60416
  v_mfma_f32_16x16x32_bf16 v[16:19], v[124:127], v[108:111], v[16:19]
  v_mfma_f32_16x16x32_bf16 v[20:23], v[128:131], v[108:111], v[20:23]
  s_waitcnt lgkmcnt(0)
  s_barrier
  v_mfma_f32_16x16x32_bf16 v[4:7], v[64:67], v[60:63], v[4:7]
  ds_read_b128 v[108:111], v239 offset:49152
  ds_read_b128 v[112:115], v232 offset:0
  s_waitcnt vmcnt(0)
  v_pk_add_f32 v[28:29], v[28:29], v[36:37]
  v_mfma_f32_16x16x32_bf16 v[8:11], v[68:71], v[60:63], v[8:11]
  ds_read_b128 v[116:119], v232 offset:1024
  ds_read_b128 v[120:123], v232 offset:2048
  v_pk_add_f32 v[30:31], v[30:31], v[38:39]
  v_pk_add_f32 v[32:33], v[32:33], v[40:41]
  v_mfma_f32_16x16x32_bf16 v[12:15], v[72:75], v[60:63], v[12:15]
  ds_read_b128 v[124:127], v232 offset:3072
  ds_read_b128 v[128:131], v232 offset:4096
  v_mov_b32 v36, v28
  v_mov_b32 v37, v29
  v_mfma_f32_16x16x32_bf16 v[16:19], v[76:79], v[60:63], v[16:19]
  v_mov_b32 v38, v30
  v_mov_b32 v39, v31
  v_mfma_f32_16x16x32_bf16 v[20:23], v[80:83], v[60:63], v[20:23]
  v_mov_b32 v40, v32
  v_mov_b32 v41, v33
  s_waitcnt lgkmcnt(6)
  v_mfma_f32_16x16x32_bf16 v[4:7], v[88:91], v[84:87], v[4:7]
  ds_read_b128 v[60:63], v239 offset:50176
  ds_read_b128 v[64:67], v232 offset:5120
  v_permlane16_swap_b32 v28, v36
  v_permlane16_swap_b32 v29, v37
  v_mfma_f32_16x16x32_bf16 v[8:11], v[92:95], v[84:87], v[8:11]
  ds_read_b128 v[68:71], v232 offset:6144
  ds_read_b128 v[72:75], v232 offset:7168
  v_permlane16_swap_b32 v30, v38
  v_permlane16_swap_b32 v31, v39
  v_mfma_f32_16x16x32_bf16 v[12:15], v[96:99], v[84:87], v[12:15]
  ds_read_b128 v[76:79], v232 offset:8192
  ds_read_b128 v[80:83], v232 offset:9216
  v_permlane16_swap_b32 v32, v40
  v_permlane16_swap_b32 v33, v41
  v_mfma_f32_16x16x32_bf16 v[16:19], v[100:103], v[84:87], v[16:19]
  v_pk_add_f32 v[28:29], v[28:29], v[36:37]
  v_pk_add_f32 v[30:31], v[30:31], v[38:39]
  v_mfma_f32_16x16x32_bf16 v[20:23], v[104:107], v[84:87], v[20:23]
  v_pk_add_f32 v[32:33], v[32:33], v[40:41]
  v_mov_b32 v36, v28
  s_waitcnt lgkmcnt(6)
  v_mfma_f32_16x16x32_bf16 v[4:7], v[112:115], v[108:111], v[4:7]
  ds_read_b128 v[84:87], v239 offset:51200
  ds_read_b128 v[88:91], v232 offset:10240
  v_mov_b32 v37, v29
  v_mov_b32 v38, v30
  v_mfma_f32_16x16x32_bf16 v[8:11], v[116:119], v[108:111], v[8:11]
  ds_read_b128 v[92:95], v232 offset:11264
  ds_read_b128 v[96:99], v232 offset:12288
  v_mov_b32 v39, v31
  v_mov_b32 v40, v32
  v_mfma_f32_16x16x32_bf16 v[12:15], v[120:123], v[108:111], v[12:15]
  ds_read_b128 v[100:103], v232 offset:13312
  ds_read_b128 v[104:107], v232 offset:14336
  v_mov_b32 v41, v33
  v_permlane32_swap_b32 v28, v36
  v_mfma_f32_16x16x32_bf16 v[16:19], v[124:127], v[108:111], v[16:19]
  v_permlane32_swap_b32 v29, v37
  v_permlane32_swap_b32 v30, v38
  v_mfma_f32_16x16x32_bf16 v[20:23], v[128:131], v[108:111], v[20:23]
  v_permlane32_swap_b32 v31, v39
  v_permlane32_swap_b32 v32, v40
  s_waitcnt lgkmcnt(6)
  v_mfma_f32_16x16x32_bf16 v[4:7], v[64:67], v[60:63], v[4:7]
  ds_read_b128 v[108:111], v239 offset:52224
  ds_read_b128 v[112:115], v232 offset:15360
  v_permlane32_swap_b32 v33, v41
  v_pk_add_f32 v[28:29], v[28:29], v[36:37]
  v_mfma_f32_16x16x32_bf16 v[8:11], v[68:71], v[60:63], v[8:11]
  ds_read_b128 v[116:119], v232 offset:16384
  ds_read_b128 v[120:123], v232 offset:17408
  v_pk_add_f32 v[30:31], v[30:31], v[38:39]
  v_pk_add_f32 v[32:33], v[32:33], v[40:41]
  v_mfma_f32_16x16x32_bf16 v[12:15], v[72:75], v[60:63], v[12:15]
  ds_read_b128 v[124:127], v232 offset:18432
  ds_read_b128 v[128:131], v232 offset:19456
  v_mul_f32 v28, 0x3acccccd, v28
  v_mul_f32 v29, 0x3acccccd, v29
  v_mfma_f32_16x16x32_bf16 v[16:19], v[76:79], v[60:63], v[16:19]
  v_mul_f32 v30, 0x3acccccd, v30
  v_mul_f32 v31, 0x3acccccd, v31
  v_mfma_f32_16x16x32_bf16 v[20:23], v[80:83], v[60:63], v[20:23]
  v_mul_f32 v32, 0x3acccccd, v32
  v_mul_f32 v33, 0x3acccccd, v33
  s_waitcnt lgkmcnt(0)
  s_barrier
  v_mfma_f32_16x16x32_bf16 v[4:7], v[88:91], v[84:87], v[4:7]
  ds_read_b128 v[60:63], v240 offset:0
  ds_read_b128 v[64:67], v232 offset:61440
  v_mov_b32 v228, v28
  v_fma_f32 v212, -v28, v28, v29
  v_mfma_f32_16x16x32_bf16 v[8:11], v[92:95], v[84:87], v[8:11]
  ds_read_b128 v[68:71], v232 offset:62464
  ds_read_b128 v[72:75], v232 offset:63488
  v_max_f32 v212, 0, v212
  v_add_f32 v212, 0x3727c5ac, v212
  v_mfma_f32_16x16x32_bf16 v[12:15], v[96:99], v[84:87], v[12:15]
  ds_read_b128 v[76:79], v232 offset:64512
  ds_read_b128 v[80:83], v233 offset:0
  v_rsq_f32 v229, v212
  v_fma_f32 v212, -v228, s48, v30
  v_mfma_f32_16x16x32_bf16 v[16:19], v[100:103], v[84:87], v[16:19]
  v_fma_f32 v214, v229, v212, s49
  v_add_f32 v212, v32, v32
  v_mfma_f32_16x16x32_bf16 v[20:23], v[104:107], v[84:87], v[20:23]
  v_fma_f32 v212, -v228, s50, v212
  v_fma_f32 v212, -v228, v212, v31
  s_waitcnt lgkmcnt(6)
  v_mfma_f32_16x16x32_bf16 v[4:7], v[112:115], v[108:111], v[4:7]
  ds_read_b128 v[84:87], v240 offset:1024
  ds_read_b128 v[88:91], v233 offset:1024
  v_fma_f32 v213, -v228, s51, v33
  v_add_f32 v213, v213, v213
  v_mfma_f32_16x16x32_bf16 v[8:11], v[116:119], v[108:111], v[8:11]
  ds_read_b128 v[92:95], v233 offset:2048
  ds_read_b128 v[96:99], v233 offset:3072
  v_fma_f32 v212, v229, v212, v213
  v_fma_f32 v212, v229, v212, s52
  v_mfma_f32_16x16x32_bf16 v[12:15], v[120:123], v[108:111], v[12:15]
  ds_read_b128 v[100:103], v233 offset:4096
  ds_read_b128 v[104:107], v233 offset:5120
  v_fma_f32 v212, -v214, v214, v212
  v_max_f32 v212, 0, v212
  v_mfma_f32_16x16x32_bf16 v[16:19], v[124:127], v[108:111], v[16:19]
  v_add_f32 v212, 0x3727c5ac, v212
  v_rsq_f32 v215, v212
  v_mfma_f32_16x16x32_bf16 v[20:23], v[128:131], v[108:111], v[20:23]
  v_mul_f32 v224, v229, v215
  v_mul_f32 v226, -v224, v228
  s_waitcnt lgkmcnt(6)
  v_mfma_f32_16x16x32_bf16 v[4:7], v[64:67], v[60:63], v[4:7]
  ds_read_b128 v[108:111], v240 offset:2048
  ds_read_b128 v[112:115], v233 offset:6144
  v_mul_f32 v216, -v215, v214
  v_pk_mul_f32 v[172:173], v[172:173], v[226:227] op_sel_hi:[1,0]
  v_mfma_f32_16x16x32_bf16 v[8:11], v[68:71], v[60:63], v[8:11]
  ds_read_b128 v[116:119], v233 offset:7168
  ds_read_b128 v[120:123], v233 offset:8192
  v_pk_fma_f32 v[172:173], v[192:193], v[214:215], v[172:173] op_sel:[0,1,0] op_sel_hi:[1,1,1]
  v_pk_fma_f32 v[172:173], v[152:153], v[216:217], v[172:173] op_sel_hi:[1,0,1]
  v_mfma_f32_16x16x32_bf16 v[12:15], v[72:75], v[60:63], v[12:15]
  ds_read_b128 v[124:127], v233 offset:9216
  ds_read_b128 v[128:131], v233 offset:10240
  v_pk_mul_f32 v[174:175], v[174:175], v[226:227] op_sel_hi:[1,0]
  v_pk_fma_f32 v[174:175], v[194:195], v[214:215], v[174:175] op_sel:[0,1,0] op_sel_hi:[1,1,1]
  v_mfma_f32_16x16x32_bf16 v[16:19], v[76:79], v[60:63], v[16:19]
  v_pk_fma_f32 v[174:175], v[154:155], v[216:217], v[174:175] op_sel_hi:[1,0,1]
  v_pk_mul_f32 v[176:177], v[176:177], v[226:227] op_sel_hi:[1,0]
  v_mfma_f32_16x16x32_bf16 v[20:23], v[80:83], v[60:63], v[20:23]
  v_pk_fma_f32 v[176:177], v[196:197], v[214:215], v[176:177] op_sel:[0,1,0] op_sel_hi:[1,1,1]
  v_pk_fma_f32 v[176:177], v[156:157], v[216:217], v[176:177] op_sel_hi:[1,0,1]
  s_waitcnt lgkmcnt(6)
  v_mfma_f32_16x16x32_bf16 v[4:7], v[88:91], v[84:87], v[4:7]
  ds_read_b128 v[60:63], v240 offset:3072
  ds_read_b128 v[64:67], v233 offset:11264
  v_pk_mul_f32 v[178:179], v[178:179], v[226:227] op_sel_hi:[1,0]
  v_pk_fma_f32 v[178:179], v[198:199], v[214:215], v[178:179] op_sel:[0,1,0] op_sel_hi:[1,1,1]
  v_mfma_f32_16x16x32_bf16 v[8:11], v[92:95], v[84:87], v[8:11]
  ds_read_b128 v[68:71], v233 offset:12288
  ds_read_b128 v[72:75], v233 offset:13312
  v_pk_fma_f32 v[178:179], v[158:159], v[216:217], v[178:179] op_sel_hi:[1,0,1]
  v_pk_mul_f32 v[180:181], v[180:181], v[226:227] op_sel_hi:[1,0]
  v_mfma_f32_16x16x32_bf16 v[12:15], v[96:99], v[84:87], v[12:15]
  ds_read_b128 v[76:79], v233 offset:14336
  ds_read_b128 v[80:83], v233 offset:15360
  v_pk_fma_f32 v[180:181], v[200:201], v[214:215], v[180:181] op_sel:[0,1,0] op_sel_hi:[1,1,1]
  v_pk_fma_f32 v[180:181], v[160:161], v[216:217], v[180:181] op_sel_hi:[1,0,1]
  v_mfma_f32_16x16x32_bf16 v[16:19], v[100:103], v[84:87], v[16:19]
  v_pk_mul_f32 v[182:183], v[182:183], v[226:227] op_sel_hi:[1,0]
  v_pk_fma_f32 v[182:183], v[202:203], v[214:215], v[182:183] op_sel:[0,1,0] op_sel_hi:[1,1,1]
  v_mfma_f32_16x16x32_bf16 v[20:23], v[104:107], v[84:87], v[20:23]
  v_pk_fma_f32 v[182:183], v[162:163], v[216:217], v[182:183] op_sel_hi:[1,0,1]
  v_pk_mul_f32 v[184:185], v[184:185], v[226:227] op_sel_hi:[1,0]
  s_waitcnt lgkmcnt(0)
  s_barrier
  v_mfma_f32_16x16x32_bf16 v[4:7], v[112:115], v[108:111], v[4:7]
  ds_read_b128 v[84:87], v239 offset:0
  ds_read_b128 v[88:91], v232 offset:20480
  v_pk_fma_f32 v[184:185], v[204:205], v[214:215], v[184:185] op_sel:[0,1,0] op_sel_hi:[1,1,1]
  v_pk_fma_f32 v[184:185], v[164:165], v[216:217], v[184:185] op_sel_hi:[1,0,1]
  v_mfma_f32_16x16x32_bf16 v[8:11], v[116:119], v[108:111], v[8:11]
  ds_read_b128 v[92:95], v232 offset:21504
  ds_read_b128 v[96:99], v232 offset:22528
  v_pk_mul_f32 v[186:187], v[186:187], v[226:227] op_sel_hi:[1,0]
  v_pk_fma_f32 v[186:187], v[206:207], v[214:215], v[186:187] op_sel:[0,1,0] op_sel_hi:[1,1,1]
  v_mfma_f32_16x16x32_bf16 v[12:15], v[120:123], v[108:111], v[12:15]
  ds_read_b128 v[100:103], v232 offset:23552
  ds_read_b128 v[104:107], v232 offset:24576
  v_pk_fma_f32 v[186:187], v[166:167], v[216:217], v[186:187] op_sel_hi:[1,0,1]
  v_pk_mul_f32 v[188:189], v[188:189], v[226:227] op_sel_hi:[1,0]
  v_mfma_f32_16x16x32_bf16 v[16:19], v[124:127], v[108:111], v[16:19]
  v_pk_fma_f32 v[188:189], v[208:209], v[214:215], v[188:189] op_sel:[0,1,0] op_sel_hi:[1,1,1]
  v_pk_fma_f32 v[188:189], v[168:169], v[216:217], v[188:189] op_sel_hi:[1,0,1]
  v_mfma_f32_16x16x32_bf16 v[20:23], v[128:131], v[108:111], v[20:23]
  v_pk_mul_f32 v[190:191], v[190:191], v[226:227] op_sel_hi:[1,0]
  v_pk_fma_f32 v[190:191], v[210:211], v[214:215], v[190:191] op_sel:[0,1,0] op_sel_hi:[1,1,1]
  s_waitcnt lgkmcnt(6)
  v_mfma_f32_16x16x32_bf16 v[4:7], v[64:67], v[60:63], v[4:7]
  ds_read_b128 v[108:111], v239 offset:1024
  ds_read_b128 v[112:115], v232 offset:25600
  v_pk_fma_f32 v[190:191], v[170:171], v[216:217], v[190:191] op_sel_hi:[1,0,1]
  v_mfma_f32_16x16x32_bf16 v[8:11], v[68:71], v[60:63], v[8:11]
  ds_read_b128 v[116:119], v232 offset:26624
  ds_read_b128 v[120:123], v232 offset:27648
  v_mfma_f32_16x16x32_bf16 v[12:15], v[72:75], v[60:63], v[12:15]
  ds_read_b128 v[124:127], v232 offset:28672
  ds_read_b128 v[128:131], v232 offset:29696
  v_mfma_f32_16x16x32_bf16 v[16:19], v[76:79], v[60:63], v[16:19]
  v_mfma_f32_16x16x32_bf16 v[20:23], v[80:83], v[60:63], v[20:23]
  s_waitcnt lgkmcnt(6)
  v_mfma_f32_16x16x32_bf16 v[4:7], v[88:91], v[84:87], v[4:7]
  ds_read_b128 v[60:63], v239 offset:2048
  ds_read_b128 v[64:67], v232 offset:30720
  v_mfma_f32_16x16x32_bf16 v[8:11], v[92:95], v[84:87], v[8:11]
  ds_read_b128 v[68:71], v232 offset:31744
  ds_read_b128 v[72:75], v232 offset:32768
  v_mfma_f32_16x16x32_bf16 v[12:15], v[96:99], v[84:87], v[12:15]
  ds_read_b128 v[76:79], v232 offset:33792
  ds_read_b128 v[80:83], v232 offset:34816
  v_mfma_f32_16x16x32_bf16 v[16:19], v[100:103], v[84:87], v[16:19]
  v_mfma_f32_16x16x32_bf16 v[20:23], v[104:107], v[84:87], v[20:23]
  s_waitcnt lgkmcnt(6)
  v_mfma_f32_16x16x32_bf16 v[4:7], v[112:115], v[108:111], v[4:7]
  ds_read_b128 v[84:87], v239 offset:3072
  ds_read_b128 v[88:91], v232 offset:35840
  v_mfma_f32_16x16x32_bf16 v[8:11], v[116:119], v[108:111], v[8:11]
  ds_read_b128 v[92:95], v232 offset:36864
  ds_read_b128 v[96:99], v232 offset:37888
  v_mfma_f32_16x16x32_bf16 v[12:15], v[120:123], v[108:111], v[12:15]
  ds_read_b128 v[100:103], v232 offset:38912
  ds_read_b128 v[104:107], v232 offset:39936
  v_mfma_f32_16x16x32_bf16 v[16:19], v[124:127], v[108:111], v[16:19]
  v_mfma_f32_16x16x32_bf16 v[20:23], v[128:131], v[108:111], v[20:23]
  s_waitcnt lgkmcnt(6)
  v_mfma_f32_16x16x32_bf16 v[4:7], v[64:67], v[60:63], v[4:7]
  v_mfma_f32_16x16x32_bf16 v[8:11], v[68:71], v[60:63], v[8:11]
  v_mfma_f32_16x16x32_bf16 v[12:15], v[72:75], v[60:63], v[12:15]
  v_mfma_f32_16x16x32_bf16 v[16:19], v[76:79], v[60:63], v[16:19]
  v_mfma_f32_16x16x32_bf16 v[20:23], v[80:83], v[60:63], v[20:23]
  s_waitcnt lgkmcnt(0)
  s_barrier
  v_mfma_f32_16x16x32_bf16 v[4:7], v[88:91], v[84:87], v[4:7]
  v_mfma_f32_16x16x32_bf16 v[8:11], v[92:95], v[84:87], v[8:11]
  v_mfma_f32_16x16x32_bf16 v[12:15], v[96:99], v[84:87], v[12:15]
  v_mfma_f32_16x16x32_bf16 v[16:19], v[100:103], v[84:87], v[16:19]
  v_mfma_f32_16x16x32_bf16 v[20:23], v[104:107], v[84:87], v[20:23]
  s_cmp_eq_u32 s31, 0
  s_cbranch_scc1 kb_kernel_slow_17
  v_add_u32 v220, 0x680000, v236
  s_nop 4
  v_pk_fma_f32 v[20:21], v[20:21], v[224:225], v[188:189] op_sel_hi:[1,0,1]
  v_pk_fma_f32 v[22:23], v[22:23], v[224:225], v[190:191] op_sel_hi:[1,0,1]
  v_pk_fma_f32 v[4:5], v[4:5], v[224:225], v[172:173] op_sel_hi:[1,0,1]
  v_pk_fma_f32 v[6:7], v[6:7], v[224:225], v[174:175] op_sel_hi:[1,0,1]
  v_pk_fma_f32 v[8:9], v[8:9], v[224:225], v[176:177] op_sel_hi:[1,0,1]
  v_pk_fma_f32 v[10:11], v[10:11], v[224:225], v[178:179] op_sel_hi:[1,0,1]
  v_pk_mul_f32 v[100:101], v[20:21], v[20:21]
  v_pk_mul_f32 v[102:103], v[22:23], v[22:23]
  v_pk_mul_f32 v[104:105], v[4:5], v[4:5]
  v_pk_mul_f32 v[106:107], v[6:7], v[6:7]
  v_pk_mul_f32 v[108:109], v[8:9], v[8:9]
  v_pk_mul_f32 v[110:111], v[10:11], v[10:11]
  v_pk_fma_f32 v[100:101], v[100:101], s[44:45], v[230:231]
  v_pk_fma_f32 v[102:103], v[102:103], s[44:45], v[230:231]
  v_pk_fma_f32 v[104:105], v[104:105], s[44:45], v[230:231]
  v_pk_fma_f32 v[106:107], v[106:107], s[44:45], v[230:231]
  v_pk_fma_f32 v[108:109], v[108:109], s[44:45], v[230:231]
  v_pk_fma_f32 v[110:111], v[110:111], s[44:45], v[230:231]
  v_pk_mul_f32 v[100:101], v[100:101], v[20:21]
  v_pk_mul_f32 v[102:103], v[102:103], v[22:23]
  v_pk_mul_f32 v[104:105], v[104:105], v[4:5]
  v_pk_mul_f32 v[106:107], v[106:107], v[6:7]
  v_pk_mul_f32 v[108:109], v[108:109], v[8:9]
  v_pk_mul_f32 v[110:111], v[110:111], v[10:11]
  v_exp_f32 v100, v100
  v_exp_f32 v101, v101
  v_exp_f32 v102, v102
  v_exp_f32 v103, v103
  v_exp_f32 v104, v104
  v_exp_f32 v105, v105
  v_exp_f32 v106, v106
  v_exp_f32 v107, v107
  v_exp_f32 v108, v108
  v_exp_f32 v109, v109
  v_exp_f32 v110, v110
  v_exp_f32 v111, v111
  v_pk_add_f32 v[100:101], v[100:101], s[46:47]
  v_pk_add_f32 v[102:103], v[102:103], s[46:47]
  v_pk_add_f32 v[104:105], v[104:105], s[46:47]
  v_pk_add_f32 v[106:107], v[106:107], s[46:47]
  v_pk_add_f32 v[108:109], v[108:109], s[46:47]
  v_pk_add_f32 v[110:111], v[110:111], s[46:47]
  v_rcp_f32 v100, v100
  v_rcp_f32 v101, v101
  v_rcp_f32 v102, v102
  v_rcp_f32 v103, v103
  v_rcp_f32 v104, v104
  v_rcp_f32 v105, v105
  v_rcp_f32 v106, v106
  v_rcp_f32 v107, v107
  v_rcp_f32 v108, v108
  v_rcp_f32 v109, v109
  v_rcp_f32 v110, v110
  v_rcp_f32 v111, v111
  v_pk_mul_f32 v[20:21], v[20:21], v[100:101]
  v_pk_mul_f32 v[22:23], v[22:23], v[102:103]
  v_pk_mul_f32 v[4:5], v[4:5], v[104:105]
  v_pk_mul_f32 v[6:7], v[6:7], v[106:107]
  v_pk_mul_f32 v[8:9], v[8:9], v[108:109]
  v_pk_mul_f32 v[10:11], v[10:11], v[110:111]
  v_cvt_pk_bf16_f32 v68, v20, v21
  v_cvt_pk_bf16_f32 v69, v22, v23
  buffer_store_dwordx2 v[68:69], v220, s[8:11], s29 offen
  v_cvt_pk_bf16_f32 v60, v4, v5
  v_cvt_pk_bf16_f32 v61, v6, v7
  v_cvt_pk_bf16_f32 v62, v8, v9
  v_cvt_pk_bf16_f32 v63, v10, v11
  buffer_store_dwordx4 v[60:63], v220, s[8:11], s28 offen offset:0
  v_pk_fma_f32 v[12:13], v[12:13], v[224:225], v[180:181] op_sel_hi:[1,0,1]
  v_pk_fma_f32 v[14:15], v[14:15], v[224:225], v[182:183] op_sel_hi:[1,0,1]
  v_pk_fma_f32 v[16:17], v[16:17], v[224:225], v[184:185] op_sel_hi:[1,0,1]
  v_pk_fma_f32 v[18:19], v[18:19], v[224:225], v[186:187] op_sel_hi:[1,0,1]
  v_pk_mul_f32 v[100:101], v[12:13], v[12:13]
  v_pk_mul_f32 v[102:103], v[14:15], v[14:15]
  v_pk_mul_f32 v[104:105], v[16:17], v[16:17]
  v_pk_mul_f32 v[106:107], v[18:19], v[18:19]
  v_pk_fma_f32 v[100:101], v[100:101], s[44:45], v[230:231]
  v_pk_fma_f32 v[102:103], v[102:103], s[44:45], v[230:231]
  v_pk_fma_f32 v[104:105], v[104:105], s[44:45], v[230:231]
  v_pk_fma_f32 v[106:107], v[106:107], s[44:45], v[230:231]
  v_pk_mul_f32 v[100:101], v[100:101], v[12:13]
  v_pk_mul_f32 v[102:103], v[102:103], v[14:15]
  v_pk_mul_f32 v[104:105], v[104:105], v[16:17]
  v_pk_mul_f32 v[106:107], v[106:107], v[18:19]
  v_exp_f32 v100, v100
  v_exp_f32 v101, v101
  v_exp_f32 v102, v102
  v_exp_f32 v103, v103
  v_exp_f32 v104, v104
  v_exp_f32 v105, v105
  v_exp_f32 v106, v106
  v_exp_f32 v107, v107
  v_pk_add_f32 v[100:101], v[100:101], s[46:47]
  v_pk_add_f32 v[102:103], v[102:103], s[46:47]
  v_pk_add_f32 v[104:105], v[104:105], s[46:47]
  v_pk_add_f32 v[106:107], v[106:107], s[46:47]
  v_rcp_f32 v100, v100
  v_rcp_f32 v101, v101
  v_rcp_f32 v102, v102
  v_rcp_f32 v103, v103
  v_rcp_f32 v104, v104
  v_rcp_f32 v105, v105
  v_rcp_f32 v106, v106
  v_rcp_f32 v107, v107
  v_pk_mul_f32 v[12:13], v[12:13], v[100:101]
  v_pk_mul_f32 v[14:15], v[14:15], v[102:103]
  v_pk_mul_f32 v[16:17], v[16:17], v[104:105]
  v_pk_mul_f32 v[18:19], v[18:19], v[106:107]
  v_cvt_pk_bf16_f32 v64, v12, v13
  v_cvt_pk_bf16_f32 v65, v14, v15
  v_cvt_pk_bf16_f32 v66, v16, v17
  v_cvt_pk_bf16_f32 v67, v18, v19
  buffer_store_dwordx4 v[64:67], v220, s[8:11], s28 offen offset:1024
  s_lshl_b32 s22, s27, 7
  s_lshl_b32 s23, s19, 3
  s_add_u32 s22, s22, s23
  s_add_u32 s22, s22, 0xe4000
  v_lshlrev_b32 v212, 7, v2
  v_add_u32 v212, s22, v212
  v_mov_b32 v213, 1
  s_waitcnt vmcnt(0)
  s_mov_b64 exec, 1
  buffer_store_dword v213, v212, s[8:11], 0 offen
  s_mov_b64 exec, -1
kb_kernel_fj_18:
  s_barrier
  s_mov_b32 s26, 10240
  buffer_load_dwordx4 v[172:175], v234, s[8:11], s26 offen offset:0
  buffer_load_dwordx4 v[176:179], v234, s[8:11], s26 offen offset:64
  buffer_load_dwordx4 v[180:183], v234, s[8:11], s26 offen offset:128
  buffer_load_dwordx4 v[184:187], v234, s[8:11], s26 offen offset:192
  buffer_load_dwordx4 v[188:191], v235, s[8:11], s26 offen offset:0
  s_mov_b32 s26, 7680
  buffer_load_dwordx4 v[192:195], v234, s[8:11], s26 offen offset:0
  buffer_load_dwordx4 v[196:199], v234, s[8:11], s26 offen offset:64
  buffer_load_dwordx4 v[200:203], v234, s[8:11], s26 offen offset:128
  buffer_load_dwordx4 v[204:207], v234, s[8:11], s26 offen offset:192
  buffer_load_dwordx4 v[208:211], v235, s[8:11], s26 offen offset:0
  s_barrier
  ds_read_b128 v[60:63], v239 offset:16384
  ds_read_b128 v[64:67], v232 offset:40960
  ds_read_b128 v[68:71], v232 offset:41984
  ds_read_b128 v[72:75], v232 offset:43008
  ds_read_b128 v[76:79], v232 offset:44032
  ds_read_b128 v[80:83], v232 offset:45056
  ds_read_b128 v[84:87], v239 offset:17408
  ds_read_b128 v[88:91], v232 offset:46080
  ds_read_b128 v[92:95], v232 offset:47104
  ds_read_b128 v[96:99], v232 offset:48128
  ds_read_b128 v[100:103], v232 offset:49152
  ds_read_b128 v[104:107], v232 offset:50176
  s_waitcnt lgkmcnt(6)
  v_mfma_f32_16x16x32_bf16 v[4:7], v[64:67], v[60:63], 0
  ds_read_b128 v[108:111], v239 offset:18432
  ds_read_b128 v[112:115], v232 offset:51200
  v_mfma_f32_16x16x32_bf16 v[8:11], v[68:71], v[60:63], 0
  ds_read_b128 v[116:119], v232 offset:52224
  ds_read_b128 v[120:123], v232 offset:53248
  v_mfma_f32_16x16x32_bf16 v[12:15], v[72:75], v[60:63], 0
  ds_read_b128 v[124:127], v232 offset:54272
  ds_read_b128 v[128:131], v232 offset:55296
  v_mfma_f32_16x16x32_bf16 v[16:19], v[76:79], v[60:63], 0
  v_mfma_f32_16x16x32_bf16 v[20:23], v[80:83], v[60:63], 0
  s_waitcnt lgkmcnt(6)
  v_mfma_f32_16x16x32_bf16 v[4:7], v[88:91], v[84:87], v[4:7]
  ds_read_b128 v[60:63], v239 offset:19456
  ds_read_b128 v[64:67], v232 offset:56320
  s_waitcnt vmcnt(0)
  v_mfma_f32_16x16x32_bf16 v[8:11], v[92:95], v[84:87], v[8:11]
  ds_read_b128 v[68:71], v232 offset:57344
  ds_read_b128 v[72:75], v232 offset:58368
  v_sub_f32 v152, v132, v228
  v_mfma_f32_16x16x32_bf16 v[12:15], v[96:99], v[84:87], v[12:15]
  ds_read_b128 v[76:79], v232 offset:59392
  ds_read_b128 v[80:83], v232 offset:60416
  v_mul_f32 v152, v152, v229
  v_mfma_f32_16x16x32_bf16 v[16:19], v[100:103], v[84:87], v[16:19]
  v_fma_f32 v152, v152, v172, v192
  v_mfma_f32_16x16x32_bf16 v[20:23], v[104:107], v[84:87], v[20:23]
  v_sub_f32 v153, v133, v228
  s_waitcnt lgkmcnt(0)
  s_barrier
  v_mfma_f32_16x16x32_bf16 v[4:7], v[112:115], v[108:111], v[4:7]
  ds_read_b128 v[84:87], v239 offset:32768
  ds_read_b128 v[88:91], v232 offset:0
  v_mul_f32 v153, v153, v229
  v_mfma_f32_16x16x32_bf16 v[8:11], v[116:119], v[108:111], v[8:11]
  ds_read_b128 v[92:95], v232 offset:1024
  ds_read_b128 v[96:99], v232 offset:2048
  v_fma_f32 v153, v153, v173, v193
  v_mfma_f32_16x16x32_bf16 v[12:15], v[120:123], v[108:111], v[12:15]
  ds_read_b128 v[100:103], v232 offset:3072
  ds_read_b128 v[104:107], v232 offset:4096
  v_sub_f32 v154, v134, v228
  v_mfma_f32_16x16x32_bf16 v[16:19], v[124:127], v[108:111], v[16:19]
  v_mul_f32 v154, v154, v229
  v_mfma_f32_16x16x32_bf16 v[20:23], v[128:131], v[108:111], v[20:23]
  v_fma_f32 v154, v154, v174, v194
  s_waitcnt lgkmcnt(6)
  v_mfma_f32_16x16x32_bf16 v[4:7], v[64:67], v[60:63], v[4:7]
  ds_read_b128 v[108:111], v239 offset:33792
  ds_read_b128 v[112:115], v232 offset:5120
  v_sub_f32 v155, v135, v228
  v_mfma_f32_16x16x32_bf16 v[8:11], v[68:71], v[60:63], v[8:11]
  ds_read_b128 v[116:119], v232 offset:6144
  ds_read_b128 v[120:123], v232 offset:7168
  v_mul_f32 v155, v155, v229
  v_mfma_f32_16x16x32_bf16 v[12:15], v[72:75], v[60:63], v[12:15]
  ds_read_b128 v[124:127], v232 offset:8192
  ds_read_b128 v[128:131], v232 offset:9216
  v_fma_f32 v155, v155, v175, v195
  v_mfma_f32_16x16x32_bf16 v[16:19], v[76:79], v[60:63], v[16:19]
  v_sub_f32 v156, v136, v228
  v_mfma_f32_16x16x32_bf16 v[20:23], v[80:83], v[60:63], v[20:23]
  v_mul_f32 v156, v156, v229
  s_waitcnt lgkmcnt(6)
  v_mfma_f32_16x16x32_bf16 v[4:7], v[88:91], v[84:87], v[4:7]
  ds_read_b128 v[60:63], v239 offset:34816
  ds_read_b128 v[64:67], v232 offset:10240
  v_fma_f32 v156, v156, v176, v196
  v_mfma_f32_16x16x32_bf16 v[8:11], v[92:95], v[84:87], v[8:11]
  ds_read_b128 v[68:71], v232 offset:11264
  ds_read_b128 v[72:75], v232 offset:12288
  v_sub_f32 v157, v137, v228
  v_mfma_f32_16x16x32_bf16 v[12:15], v[96:99], v[84:87], v[12:15]
  ds_read_b128 v[76:79], v232 offset:13312
  ds_read_b128 v[80:83], v232 offset:14336
  v_mul_f32 v157, v157, v229
  v_mfma_f32_16x16x32_bf16 v[16:19], v[100:103], v[84:87], v[16:19]
  v_fma_f32 v157, v157, v177, v197
  v_mfma_f32_16x16x32_bf16 v[20:23], v[104:107], v[84:87], v[20:23]
  v_sub_f32 v158, v138, v228
  s_waitcnt lgkmcnt(6)
  v_mfma_f32_16x16x32_bf16 v[4:7], v[112:115], v[108:111], v[4:7]
  ds_read_b128 v[84:87], v239 offset:35840
  ds_read_b128 v[88:91], v232 offset:15360
  v_mul_f32 v158, v158, v229
  v_mfma_f32_16x16x32_bf16 v[8:11], v[116:119], v[108:111], v[8:11]
  ds_read_b128 v[92:95], v232 offset:16384
  ds_read_b128 v[96:99], v232 offset:17408
  v_fma_f32 v158, v158, v178, v198
  v_mfma_f32_16x16x32_bf16 v[12:15], v[120:123], v[108:111], v[12:15]
  ds_read_b128 v[100:103], v232 offset:18432
  ds_read_b128 v[104:107], v232 offset:19456
  v_sub_f32 v159, v139, v228
  v_mfma_f32_16x16x32_bf16 v[16:19], v[124:127], v[108:111], v[16:19]
  v_mul_f32 v159, v159, v229
  v_mfma_f32_16x16x32_bf16 v[20:23], v[128:131], v[108:111], v[20:23]
  v_fma_f32 v159, v159, v179, v199
  s_waitcnt lgkmcnt(0)
  s_barrier
  v_mfma_f32_16x16x32_bf16 v[4:7], v[64:67], v[60:63], v[4:7]
  ds_read_b128 v[108:111], v239 offset:49152
  ds_read_b128 v[112:115], v232 offset:61440
  v_sub_f32 v160, v140, v228
  v_mfma_f32_16x16x32_bf16 v[8:11], v[68:71], v[60:63], v[8:11]
  ds_read_b128 v[116:119], v232 offset:62464
  ds_read_b128 v[120:123], v232 offset:63488
  v_mul_f32 v160, v160, v229
  v_mfma_f32_16x16x32_bf16 v[12:15], v[72:75], v[60:63], v[12:15]
  ds_read_b128 v[124:127], v232 offset:64512
  ds_read_b128 v[128:131], v233 offset:0
  v_fma_f32 v160, v160, v180, v200
  v_mfma_f32_16x16x32_bf16 v[16:19], v[76:79], v[60:63], v[16:19]
  v_sub_f32 v161, v141, v228
  v_mfma_f32_16x16x32_bf16 v[20:23], v[80:83], v[60:63], v[20:23]
  v_mul_f32 v161, v161, v229
  s_waitcnt lgkmcnt(6)
  v_mfma_f32_16x16x32_bf16 v[4:7], v[88:91], v[84:87], v[4:7]
  ds_read_b128 v[60:63], v239 offset:50176
  ds_read_b128 v[64:67], v233 offset:1024
  v_fma_f32 v161, v161, v181, v201
  v_mfma_f32_16x16x32_bf16 v[8:11], v[92:95], v[84:87], v[8:11]
  ds_read_b128 v[68:71], v233 offset:2048
  ds_read_b128 v[72:75], v233 offset:3072
  v_sub_f32 v162, v142, v228
  v_mfma_f32_16x16x32_bf16 v[12:15], v[96:99], v[84:87], v[12:15]
  ds_read_b128 v[76:79], v233 offset:4096
  ds_read_b128 v[80:83], v233 offset:5120
  v_mul_f32 v162, v162, v229
  v_mfma_f32_16x16x32_bf16 v[16:19], v[100:103], v[84:87], v[16:19]
  v_fma_f32 v162, v162, v182, v202
  v_mfma_f32_16x16x32_bf16 v[20:23], v[104:107], v[84:87], v[20:23]
  v_sub_f32 v163, v143, v228
  s_waitcnt lgkmcnt(6)
  v_mfma_f32_16x16x32_bf16 v[4:7], v[112:115], v[108:111], v[4:7]
  ds_read_b128 v[84:87], v239 offset:51200
  ds_read_b128 v[88:91], v233 offset:6144
  v_mul_f32 v163, v163, v229
  v_mfma_f32_16x16x32_bf16 v[8:11], v[116:119], v[108:111], v[8:11]
  ds_read_b128 v[92:95], v233 offset:7168
  ds_read_b128 v[96:99], v233 offset:8192
  v_fma_f32 v163, v163, v183, v203
  v_mfma_f32_16x16x32_bf16 v[12:15], v[120:123], v[108:111], v[12:15]
  ds_read_b128 v[100:103], v233 offset:9216
  ds_read_b128 v[104:107], v233 offset:10240
  v_sub_f32 v164, v144, v228
  v_mfma_f32_16x16x32_bf16 v[16:19], v[124:127], v[108:111], v[16:19]
  v_mul_f32 v164, v164, v229
  v_mfma_f32_16x16x32_bf16 v[20:23], v[128:131], v[108:111], v[20:23]
  v_fma_f32 v164, v164, v184, v204
  s_waitcnt lgkmcnt(6)
  v_mfma_f32_16x16x32_bf16 v[4:7], v[64:67], v[60:63], v[4:7]
  ds_read_b128 v[108:111], v239 offset:52224
  ds_read_b128 v[112:115], v233 offset:11264
  v_sub_f32 v165, v145, v228
  v_mfma_f32_16x16x32_bf16 v[8:11], v[68:71], v[60:63], v[8:11]
  ds_read_b128 v[116:119], v233 offset:12288
  ds_read_b128 v[120:123], v233 offset:13312
  v_mul_f32 v165, v165, v229
  v_mfma_f32_16x16x32_bf16 v[12:15], v[72:75], v[60:63], v[12:15]
  ds_read_b128 v[124:127], v233 offset:14336
  ds_read_b128 v[128:131], v233 offset:15360
  v_fma_f32 v165, v165, v185, v205
  v_mfma_f32_16x16x32_bf16 v[16:19], v[76:79], v[60:63], v[16:19]
  v_sub_f32 v166, v146, v228
  v_mfma_f32_16x16x32_bf16 v[20:23], v[80:83], v[60:63], v[20:23]
  v_mul_f32 v166, v166, v229
  s_waitcnt lgkmcnt(0)
  s_barrier
  v_mfma_f32_16x16x32_bf16 v[4:7], v[88:91], v[84:87], v[4:7]
  ds_read_b128 v[60:63], v240 offset:0
  ds_read_b128 v[64:67], v232 offset:20480
  v_fma_f32 v166, v166, v186, v206
  v_mfma_f32_16x16x32_bf16 v[8:11], v[92:95], v[84:87], v[8:11]
  ds_read_b128 v[68:71], v232 offset:21504
  ds_read_b128 v[72:75], v232 offset:22528
  v_sub_f32 v167, v147, v228
  v_mfma_f32_16x16x32_bf16 v[12:15], v[96:99], v[84:87], v[12:15]
  ds_read_b128 v[76:79], v232 offset:23552
  ds_read_b128 v[80:83], v232 offset:24576
  v_mul_f32 v167, v167, v229
  v_mfma_f32_16x16x32_bf16 v[16:19], v[100:103], v[84:87], v[16:19]
  v_fma_f32 v167, v167, v187, v207
  v_mfma_f32_16x16x32_bf16 v[20:23], v[104:107], v[84:87], v[20:23]
  v_sub_f32 v168, v148, v228
  s_waitcnt lgkmcnt(6)
  v_mfma_f32_16x16x32_bf16 v[4:7], v[112:115], v[108:111], v[4:7]
  ds_read_b128 v[84:87], v240 offset:1024
  ds_read_b128 v[88:91], v232 offset:25600
  v_mul_f32 v168, v168, v229
  v_mfma_f32_16x16x32_bf16 v[8:11], v[116:119], v[108:111], v[8:11]
  ds_read_b128 v[92:95], v232 offset:26624
  ds_read_b128 v[96:99], v232 offset:27648
  v_fma_f32 v168, v168, v188, v208
  v_mfma_f32_16x16x32_bf16 v[12:15], v[120:123], v[108:111], v[12:15]
  ds_read_b128 v[100:103], v232 offset:28672
  ds_read_b128 v[104:107], v232 offset:29696
  v_sub_f32 v169, v149, v228
  v_mfma_f32_16x16x32_bf16 v[16:19], v[124:127], v[108:111], v[16:19]
  v_mul_f32 v169, v169, v229
  v_mfma_f32_16x16x32_bf16 v[20:23], v[128:131], v[108:111], v[20:23]
  v_fma_f32 v169, v169, v189, v209
  s_waitcnt lgkmcnt(6)
  v_mfma_f32_16x16x32_bf16 v[4:7], v[64:67], v[60:63], v[4:7]
  ds_read_b128 v[108:111], v240 offset:2048
  ds_read_b128 v[112:115], v232 offset:30720
  v_sub_f32 v170, v150, v228
  v_mfma_f32_16x16x32_bf16 v[8:11], v[68:71], v[60:63], v[8:11]
  ds_read_b128 v[116:119], v232 offset:31744
  ds_read_b128 v[120:123], v232 offset:32768
  v_mul_f32 v170, v170, v229
  v_mfma_f32_16x16x32_bf16 v[12:15], v[72:75], v[60:63], v[12:15]
  ds_read_b128 v[124:127], v232 offset:33792
  ds_read_b128 v[128:131], v232 offset:34816
  v_fma_f32 v170, v170, v190, v210
  v_mfma_f32_16x16x32_bf16 v[16:19], v[76:79], v[60:63], v[16:19]
  v_sub_f32 v171, v151, v228
  v_mfma_f32_16x16x32_bf16 v[20:23], v[80:83], v[60:63], v[20:23]
  v_mul_f32 v171, v171, v229
  s_waitcnt lgkmcnt(6)
  v_mfma_f32_16x16x32_bf16 v[4:7], v[88:91], v[84:87], v[4:7]
  ds_read_b128 v[60:63], v240 offset:3072
  ds_read_b128 v[64:67], v232 offset:35840
  v_fma_f32 v171, v171, v191, v211
  v_mfma_f32_16x16x32_bf16 v[8:11], v[92:95], v[84:87], v[8:11]
  ds_read_b128 v[68:71], v232 offset:36864
  ds_read_b128 v[72:75], v232 offset:37888
  v_mfma_f32_16x16x32_bf16 v[12:15], v[96:99], v[84:87], v[12:15]
  ds_read_b128 v[76:79], v232 offset:38912
  ds_read_b128 v[80:83], v232 offset:39936
  v_mfma_f32_16x16x32_bf16 v[16:19], v[100:103], v[84:87], v[16:19]
  v_mfma_f32_16x16x32_bf16 v[20:23], v[104:107], v[84:87], v[20:23]
  s_waitcnt lgkmcnt(0)
  s_barrier
  v_mfma_f32_16x16x32_bf16 v[4:7], v[112:115], v[108:111], v[4:7]
  ds_read_b128 v[84:87], v239 offset:0
  ds_read_b128 v[88:91], v232 offset:40960
  v_mfma_f32_16x16x32_bf16 v[8:11], v[116:119], v[108:111], v[8:11]
  ds_read_b128 v[92:95], v232 offset:41984
  ds_read_b128 v[96:99], v232 offset:43008
  v_mfma_f32_16x16x32_bf16 v[12:15], v[120:123], v[108:111], v[12:15]
  ds_read_b128 v[100:103], v232 offset:44032
  ds_read_b128 v[104:107], v232 offset:45056
  v_mfma_f32_16x16x32_bf16 v[16:19], v[124:127], v[108:111], v[16:19]
  v_mfma_f32_16x16x32_bf16 v[20:23], v[128:131], v[108:111], v[20:23]
  s_waitcnt lgkmcnt(6)
  v_mfma_f32_16x16x32_bf16 v[4:7], v[64:67], v[60:63], v[4:7]
  ds_read_b128 v[108:111], v239 offset:1024
  ds_read_b128 v[112:115], v232 offset:46080
  v_mfma_f32_16x16x32_bf16 v[8:11], v[68:71], v[60:63], v[8:11]
  ds_read_b128 v[116:119], v232 offset:47104
  ds_read_b128 v[120:123], v232 offset:48128
  v_mfma_f32_16x16x32_bf16 v[12:15], v[72:75], v[60:63], v[12:15]
  ds_read_b128 v[124:127], v232 offset:49152
  ds_read_b128 v[128:131], v232 offset:50176
  v_mfma_f32_16x16x32_bf16 v[16:19], v[76:79], v[60:63], v[16:19]
  v_mfma_f32_16x16x32_bf16 v[20:23], v[80:83], v[60:63], v[20:23]
  s_waitcnt lgkmcnt(6)
  v_mfma_f32_16x16x32_bf16 v[4:7], v[88:91], v[84:87], v[4:7]
  ds_read_b128 v[60:63], v239 offset:2048
  ds_read_b128 v[64:67], v232 offset:51200
  v_mfma_f32_16x16x32_bf16 v[8:11], v[92:95], v[84:87], v[8:11]
  ds_read_b128 v[68:71], v232 offset:52224
  ds_read_b128 v[72:75], v232 offset:53248
  v_mfma_f32_16x16x32_bf16 v[12:15], v[96:99], v[84:87], v[12:15]
  ds_read_b128 v[76:79], v232 offset:54272
  ds_read_b128 v[80:83], v232 offset:55296
  v_mfma_f32_16x16x32_bf16 v[16:19], v[100:103], v[84:87], v[16:19]
  v_mfma_f32_16x16x32_bf16 v[20:23], v[104:107], v[84:87], v[20:23]
  s_waitcnt lgkmcnt(6)
  v_mfma_f32_16x16x32_bf16 v[4:7], v[112:115], v[108:111], v[4:7]
  ds_read_b128 v[84:87], v239 offset:3072
  ds_read_b128 v[88:91], v232 offset:56320
  v_mfma_f32_16x16x32_bf16 v[8:11], v[116:119], v[108:111], v[8:11]
  ds_read_b128 v[92:95], v232 offset:57344
  ds_read_b128 v[96:99], v232 offset:58368
  v_mfma_f32_16x16x32_bf16 v[12:15], v[120:123], v[108:111], v[12:15]
  ds_read_b128 v[100:103], v232 offset:59392
  ds_read_b128 v[104:107], v232 offset:60416
  v_mfma_f32_16x16x32_bf16 v[16:19], v[124:127], v[108:111], v[16:19]
  v_mfma_f32_16x16x32_bf16 v[20:23], v[128:131], v[108:111], v[20:23]
  s_waitcnt lgkmcnt(6)
  v_mfma_f32_16x16x32_bf16 v[4:7], v[64:67], v[60:63], v[4:7]
  v_mfma_f32_16x16x32_bf16 v[8:11], v[68:71], v[60:63], v[8:11]
  v_mfma_f32_16x16x32_bf16 v[12:15], v[72:75], v[60:63], v[12:15]
  v_mfma_f32_16x16x32_bf16 v[16:19], v[76:79], v[60:63], v[16:19]
  v_mfma_f32_16x16x32_bf16 v[20:23], v[80:83], v[60:63], v[20:23]
  s_waitcnt lgkmcnt(0)
  s_barrier
  v_mfma_f32_16x16x32_bf16 v[4:7], v[88:91], v[84:87], v[4:7]
  v_mfma_f32_16x16x32_bf16 v[8:11], v[92:95], v[84:87], v[8:11]
  v_mfma_f32_16x16x32_bf16 v[12:15], v[96:99], v[84:87], v[12:15]
  v_mfma_f32_16x16x32_bf16 v[16:19], v[100:103], v[84:87], v[16:19]
  v_mfma_f32_16x16x32_bf16 v[20:23], v[104:107], v[84:87], v[20:23]
  s_cmp_eq_u32 s30, 0
  s_cbranch_scc1 kb_kernel_slow_19
  v_add_u32 v220, 0x900000, v236
  s_nop 4
  v_pk_add_f32 v[168:169], v[168:169], v[20:21]
  v_pk_add_f32 v[170:171], v[170:171], v[22:23]
  v_cvt_pk_bf16_f32 v68, v168, v169
  v_cvt_pk_bf16_f32 v69, v170, v171
  buffer_store_dwordx2 v[68:69], v220, s[8:11], s29 offen
  v_pk_add_f32 v[152:153], v[152:153], v[4:5]
  v_pk_add_f32 v[154:155], v[154:155], v[6:7]
  v_cvt_pk_bf16_f32 v60, v152, v153
  v_cvt_pk_bf16_f32 v61, v154, v155
  v_pk_add_f32 v[156:157], v[156:157], v[8:9]
  v_pk_add_f32 v[158:159], v[158:159], v[10:11]
  v_cvt_pk_bf16_f32 v62, v156, v157
  v_cvt_pk_bf16_f32 v63, v158, v159
  buffer_store_dwordx4 v[60:63], v220, s[8:11], s28 offen offset:0
  v_pk_add_f32 v[160:161], v[160:161], v[12:13]
  v_pk_add_f32 v[162:163], v[162:163], v[14:15]
  v_cvt_pk_bf16_f32 v64, v160, v161
  v_cvt_pk_bf16_f32 v65, v162, v163
  v_pk_add_f32 v[164:165], v[164:165], v[16:17]
  v_pk_add_f32 v[166:167], v[166:167], v[18:19]
  v_cvt_pk_bf16_f32 v66, v164, v165
  v_cvt_pk_bf16_f32 v67, v166, v167
  buffer_store_dwordx4 v[64:67], v220, s[8:11], s28 offen offset:1024
  v_pk_mul_f32 v[110:111], v[152:153], v[152:153]
  v_pk_add_f32 v[108:109], v[152:153], v[154:155]
  v_pk_fma_f32 v[110:111], v[154:155], v[154:155], v[110:111]
  v_pk_add_f32 v[108:109], v[108:109], v[156:157]
  v_pk_fma_f32 v[110:111], v[156:157], v[156:157], v[110:111]
  v_pk_add_f32 v[108:109], v[108:109], v[158:159]
  v_pk_fma_f32 v[110:111], v[158:159], v[158:159], v[110:111]
  v_pk_add_f32 v[108:109], v[108:109], v[160:161]
  v_pk_fma_f32 v[110:111], v[160:161], v[160:161], v[110:111]
  v_pk_add_f32 v[108:109], v[108:109], v[162:163]
  v_pk_fma_f32 v[110:111], v[162:163], v[162:163], v[110:111]
  v_pk_add_f32 v[108:109], v[108:109], v[164:165]
  v_pk_fma_f32 v[110:111], v[164:165], v[164:165], v[110:111]
  v_pk_add_f32 v[108:109], v[108:109], v[166:167]
  v_pk_fma_f32 v[110:111], v[166:167], v[166:167], v[110:111]
  v_pk_add_f32 v[108:109], v[108:109], v[168:169]
  v_pk_fma_f32 v[110:111], v[168:169], v[168:169], v[110:111]
  v_pk_add_f32 v[108:109], v[108:109], v[170:171]
  v_pk_fma_f32 v[110:111], v[170:171], v[170:171], v[110:111]
  v_add_f32 v100, v108, v109
  v_add_f32 v101, v110, v111
  s_nop 1
  v_permlane16_swap_b32 v100, v101
  v_add_f32 v100, v100, v101
  v_mov_b32 v101, v100
  s_nop 1
  v_permlane32_swap_b32 v100, v101
  v_add_f32 v100, v100, v101
  v_and_b32 v222, 15, v2
  s_add_u32 s22, s27, 0
  s_lshl_b32 s22, s22, 4
  v_add_u32 v222, s22, v222
  v_mul_u32_u24 v222, 64, v222
  v_and_b32 v212, 16, v2
  v_lshrrev_b32 v212, 2, v212
  v_add_u32 v222, v222, v212
  s_lshl_b32 s22, s19, 3
  s_add_u32 s22, s22, 0x12d0000
  buffer_store_dword v100, v222, s[8:11], s22 offen
  s_lshl_b32 s22, s27, 7
  s_lshl_b32 s23, s19, 3
  s_add_u32 s22, s22, s23
  s_add_u32 s22, s22, 0xe8000
  v_lshlrev_b32 v212, 7, v2
  v_add_u32 v212, s22, v212
  v_mov_b32 v213, 1
  s_waitcnt vmcnt(0)
  s_mov_b64 exec, 1
  buffer_store_dword v213, v212, s[8:11], 0 offen
  s_mov_b64 exec, -1
kb_kernel_fj_20:
  s_barrier
  s_and_b32 s24, s17, 1
  s_lshl_b32 s24, s24, 1
  s_lshl_b32 s43, s18, 2
  s_add_u32 s43, s43, s24
  s_lshr_b32 s25, s17, 1
  s_lshl_b32 s22, s25, 3
  s_add_u32 s23, s21, s22
  s_lshl_b32 s28, s23, 9
  s_lshl_b32 s29, s21, 9
  s_add_u32 s29, s29, s22
  s_add_u32 s29, s29, 3072
  v_and_b32 v212, 0x30, v2
  s_lshl_b32 s23, s23, 6
  v_add_u32 v234, s23, v212
  s_add_u32 s23, s21, s25
  s_add_u32 s23, s23, 6
  s_lshl_b32 s23, s23, 6
  v_add_u32 v235, s23, v212
  s_mul_i32 s22, s43, 55296
  v_add_u32 v236, s22, v1
  s_lshl_b32 s22, s24, 11
  s_add_u32 s22, s22, 81920
  v_add_u32 v239, s22, v1
  v_add_u32 v240, 65536, v239
  s_mul_i32 s22, s25, 7168
  v_add_u32 v232, s22, v1
  v_add_u32 v233, 65536, v232
  s_mov_b32 s26, 120320
  buffer_load_dwordx4 v[172:175], v234, s[8:11], s26 offen offset:0
  buffer_load_dwordx4 v[176:179], v234, s[8:11], s26 offen offset:64
  buffer_load_dwordx4 v[180:183], v234, s[8:11], s26 offen offset:128
  buffer_load_dwordx4 v[184:187], v234, s[8:11], s26 offen offset:192
  buffer_load_dwordx4 v[188:191], v234, s[8:11], s26 offen offset:256
  buffer_load_dwordx4 v[192:195], v234, s[8:11], s26 offen offset:320
  buffer_load_dwordx4 v[196:199], v235, s[8:11], s26 offen offset:0
  s_barrier
  ds_read_b128 v[60:63], v239 offset:32768
  ds_read_b128 v[64:67], v239 offset:34816
  ds_read_b128 v[68:71], v232 offset:0
  ds_read_b128 v[72:75], v232 offset:1024
  ds_read_b128 v[76:79], v232 offset:2048
  ds_read_b128 v[80:83], v232 offset:3072
  ds_read_b128 v[84:87], v232 offset:4096
  ds_read_b128 v[88:91], v232 offset:5120
  ds_read_b128 v[92:95], v232 offset:6144
  v_and_b32 v220, 15, v2
  s_add_u32 s22, s43, 0
  s_lshl_b32 s22, s22, 4
  v_add_u32 v220, s22, v220
  v_mul_u32_u24 v220, 64, v220
  v_and_b32 v212, 0x30, v2
  v_add_u32 v220, v220, v212
  s_mov_b32 s26, 0x12d0000
  buffer_load_dwordx4 v[204:207], v220, s[8:11], s26 offen sc1
  v_and_b32 v220, 15, v2
  s_add_u32 s22, s43, 1
  s_lshl_b32 s22, s22, 4
  v_add_u32 v220, s22, v220
  v_mul_u32_u24 v220, 64, v220
  v_and_b32 v212, 0x30, v2
  v_add_u32 v220, v220, v212
  s_mov_b32 s26, 0x12d0000
  buffer_load_dwordx4 v[208:211], v220, s[8:11], s26 offen sc1
  s_waitcnt lgkmcnt(0)
  v_mfma_f32_16x16x32_bf16 v[4:7], v[68:71], v[60:63], 0
  ds_read_b128 v[96:99], v239 offset:33792
  v_mfma_f32_16x16x32_bf16 v[32:35], v[68:71], v[64:67], 0
  ds_read_b128 v[100:103], v239 offset:35840
  v_mfma_f32_16x16x32_bf16 v[8:11], v[72:75], v[60:63], 0
  ds_read_b128 v[104:107], v232 offset:14336
  v_mfma_f32_16x16x32_bf16 v[36:39], v[72:75], v[64:67], 0
  ds_read_b128 v[108:111], v232 offset:15360
  v_mfma_f32_16x16x32_bf16 v[12:15], v[76:79], v[60:63], 0
  ds_read_b128 v[112:115], v232 offset:16384
  v_mfma_f32_16x16x32_bf16 v[40:43], v[76:79], v[64:67], 0
  ds_read_b128 v[116:119], v232 offset:17408
  v_mfma_f32_16x16x32_bf16 v[16:19], v[80:83], v[60:63], 0
  ds_read_b128 v[120:123], v232 offset:18432
  v_mfma_f32_16x16x32_bf16 v[44:47], v[80:83], v[64:67], 0
  ds_read_b128 v[124:127], v232 offset:19456
  v_mfma_f32_16x16x32_bf16 v[20:23], v[84:87], v[60:63], 0
  ds_read_b128 v[128:131], v232 offset:20480
  v_mfma_f32_16x16x32_bf16 v[48:51], v[84:87], v[64:67], 0
  v_mfma_f32_16x16x32_bf16 v[24:27], v[88:91], v[60:63], 0
  v_mfma_f32_16x16x32_bf16 v[52:55], v[88:91], v[64:67], 0
  v_mfma_f32_16x16x32_bf16 v[28:31], v[92:95], v[60:63], 0
  v_mfma_f32_16x16x32_bf16 v[56:59], v[92:95], v[64:67], 0
  s_waitcnt lgkmcnt(0)
  s_barrier
  v_mfma_f32_16x16x32_bf16 v[4:7], v[104:107], v[96:99], v[4:7]
  ds_read_b128 v[60:63], v239 offset:40960
  v_mfma_f32_16x16x32_bf16 v[32:35], v[104:107], v[100:103], v[32:35]
  ds_read_b128 v[64:67], v239 offset:43008
  v_mfma_f32_16x16x32_bf16 v[8:11], v[108:111], v[96:99], v[8:11]
  ds_read_b128 v[68:71], v232 offset:28672
  v_mfma_f32_16x16x32_bf16 v[36:39], v[108:111], v[100:103], v[36:39]
  ds_read_b128 v[72:75], v232 offset:29696
  v_mfma_f32_16x16x32_bf16 v[12:15], v[112:115], v[96:99], v[12:15]
  ds_read_b128 v[76:79], v232 offset:30720
  v_mfma_f32_16x16x32_bf16 v[40:43], v[112:115], v[100:103], v[40:43]
  ds_read_b128 v[80:83], v232 offset:31744
  v_mfma_f32_16x16x32_bf16 v[16:19], v[116:119], v[96:99], v[16:19]
  ds_read_b128 v[84:87], v232 offset:32768
  v_mfma_f32_16x16x32_bf16 v[44:47], v[116:119], v[100:103], v[44:47]
  ds_read_b128 v[88:91], v232 offset:33792
  v_mfma_f32_16x16x32_bf16 v[20:23], v[120:123], v[96:99], v[20:23]
  ds_read_b128 v[92:95], v232 offset:34816
  v_mfma_f32_16x16x32_bf16 v[48:51], v[120:123], v[100:103], v[48:51]
  v_mfma_f32_16x16x32_bf16 v[24:27], v[124:127], v[96:99], v[24:27]
  v_mfma_f32_16x16x32_bf16 v[52:55], v[124:127], v[100:103], v[52:55]
  v_mfma_f32_16x16x32_bf16 v[28:31], v[128:131], v[96:99], v[28:31]
  v_mfma_f32_16x16x32_bf16 v[56:59], v[128:131], v[100:103], v[56:59]
  s_waitcnt lgkmcnt(0)
  v_mfma_f32_16x16x32_bf16 v[4:7], v[68:71], v[60:63], v[4:7]
  ds_read_b128 v[96:99], v239 offset:41984
  v_mfma_f32_16x16x32_bf16 v[32:35], v[68:71], v[64:67], v[32:35]
  ds_read_b128 v[100:103], v239 offset:44032
  v_mfma_f32_16x16x32_bf16 v[8:11], v[72:75], v[60:63], v[8:11]
  ds_read_b128 v[104:107], v232 offset:43008
  v_mfma_f32_16x16x32_bf16 v[36:39], v[72:75], v[64:67], v[36:39]
  ds_read_b128 v[108:111], v232 offset:44032
  v_mfma_f32_16x16x32_bf16 v[12:15], v[76:79], v[60:63], v[12:15]
  ds_read_b128 v[112:115], v232 offset:45056
  v_mfma_f32_16x16x32_bf16 v[40:43], v[76:79], v[64:67], v[40:43]
  ds_read_b128 v[116:119], v232 offset:46080
  v_mfma_f32_16x16x32_bf16 v[16:19], v[80:83], v[60:63], v[16:19]
  ds_read_b128 v[120:123], v232 offset:47104
  v_mfma_f32_16x16x32_bf16 v[44:47], v[80:83], v[64:67], v[44:47]
  ds_read_b128 v[124:127], v232 offset:48128
  v_mfma_f32_16x16x32_bf16 v[20:23], v[84:87], v[60:63], v[20:23]
  ds_read_b128 v[128:131], v232 offset:49152
  v_mfma_f32_16x16x32_bf16 v[48:51], v[84:87], v[64:67], v[48:51]
  v_mfma_f32_16x16x32_bf16 v[24:27], v[88:91], v[60:63], v[24:27]
  v_mfma_f32_16x16x32_bf16 v[52:55], v[88:91], v[64:67], v[52:55]
  v_mfma_f32_16x16x32_bf16 v[28:31], v[92:95], v[60:63], v[28:31]
  v_mfma_f32_16x16x32_bf16 v[56:59], v[92:95], v[64:67], v[56:59]
  s_waitcnt lgkmcnt(0)
  s_barrier
  v_mfma_f32_16x16x32_bf16 v[4:7], v[104:107], v[96:99], v[4:7]
  ds_read_b128 v[60:63], v239 offset:49152
  v_mfma_f32_16x16x32_bf16 v[32:35], v[104:107], v[100:103], v[32:35]
  ds_read_b128 v[64:67], v239 offset:51200
  v_mfma_f32_16x16x32_bf16 v[8:11], v[108:111], v[96:99], v[8:11]
  ds_read_b128 v[68:71], v232 offset:57344
  v_mfma_f32_16x16x32_bf16 v[36:39], v[108:111], v[100:103], v[36:39]
  ds_read_b128 v[72:75], v232 offset:58368
  v_mfma_f32_16x16x32_bf16 v[12:15], v[112:115], v[96:99], v[12:15]
  ds_read_b128 v[76:79], v232 offset:59392
  v_mfma_f32_16x16x32_bf16 v[40:43], v[112:115], v[100:103], v[40:43]
  ds_read_b128 v[80:83], v232 offset:60416
  v_mfma_f32_16x16x32_bf16 v[16:19], v[116:119], v[96:99], v[16:19]
  ds_read_b128 v[84:87], v232 offset:61440
  v_mfma_f32_16x16x32_bf16 v[44:47], v[116:119], v[100:103], v[44:47]
  ds_read_b128 v[88:91], v232 offset:62464
  v_mfma_f32_16x16x32_bf16 v[20:23], v[120:123], v[96:99], v[20:23]
  ds_read_b128 v[92:95], v232 offset:63488
  v_mfma_f32_16x16x32_bf16 v[48:51], v[120:123], v[100:103], v[48:51]
  v_mfma_f32_16x16x32_bf16 v[24:27], v[124:127], v[96:99], v[24:27]
  v_mfma_f32_16x16x32_bf16 v[52:55], v[124:127], v[100:103], v[52:55]
  v_mfma_f32_16x16x32_bf16 v[28:31], v[128:131], v[96:99], v[28:31]
  v_mfma_f32_16x16x32_bf16 v[56:59], v[128:131], v[100:103], v[56:59]
  s_waitcnt lgkmcnt(0)
  v_mfma_f32_16x16x32_bf16 v[4:7], v[68:71], v[60:63], v[4:7]
  ds_read_b128 v[96:99], v239 offset:50176
  v_mfma_f32_16x16x32_bf16 v[32:35], v[68:71], v[64:67], v[32:35]
  ds_read_b128 v[100:103], v239 offset:52224
  v_mfma_f32_16x16x32_bf16 v[8:11], v[72:75], v[60:63], v[8:11]
  ds_read_b128 v[104:107], v233 offset:6144
  v_mfma_f32_16x16x32_bf16 v[36:39], v[72:75], v[64:67], v[36:39]
  ds_read_b128 v[108:111], v233 offset:7168
  v_mfma_f32_16x16x32_bf16 v[12:15], v[76:79], v[60:63], v[12:15]
  ds_read_b128 v[112:115], v233 offset:8192
  v_mfma_f32_16x16x32_bf16 v[40:43], v[76:79], v[64:67], v[40:43]
  ds_read_b128 v[116:119], v233 offset:9216
  v_mfma_f32_16x16x32_bf16 v[16:19], v[80:83], v[60:63], v[16:19]
  ds_read_b128 v[120:123], v233 offset:10240
  v_mfma_f32_16x16x32_bf16 v[44:47], v[80:83], v[64:67], v[44:47]
  ds_read_b128 v[124:127], v233 offset:11264
  v_mfma_f32_16x16x32_bf16 v[20:23], v[84:87], v[60:63], v[20:23]
  ds_read_b128 v[128:131], v233 offset:12288
  v_mfma_f32_16x16x32_bf16 v[48:51], v[84:87], v[64:67], v[48:51]
  v_mfma_f32_16x16x32_bf16 v[24:27], v[88:91], v[60:63], v[24:27]
  v_mfma_f32_16x16x32_bf16 v[52:55], v[88:91], v[64:67], v[52:55]
  v_mfma_f32_16x16x32_bf16 v[28:31], v[92:95], v[60:63], v[28:31]
  v_mfma_f32_16x16x32_bf16 v[56:59], v[92:95], v[64:67], v[56:59]
  s_waitcnt lgkmcnt(0)
  s_barrier
  v_mfma_f32_16x16x32_bf16 v[4:7], v[104:107], v[96:99], v[4:7]
  ds_read_b128 v[60:63], v239 offset:57344
  v_mfma_f32_16x16x32_bf16 v[32:35], v[104:107], v[100:103], v[32:35]
  ds_read_b128 v[64:67], v239 offset:59392
  v_mfma_f32_16x16x32_bf16 v[8:11], v[108:111], v[96:99], v[8:11]
  ds_read_b128 v[68:71], v233 offset:20480
  v_mfma_f32_16x16x32_bf16 v[36:39], v[108:111], v[100:103], v[36:39]
  ds_read_b128 v[72:75], v233 offset:21504
  v_mfma_f32_16x16x32_bf16 v[12:15], v[112:115], v[96:99], v[12:15]
  ds_read_b128 v[76:79], v233 offset:22528
  v_mfma_f32_16x16x32_bf16 v[40:43], v[112:115], v[100:103], v[40:43]
  ds_read_b128 v[80:83], v233 offset:23552
  v_mfma_f32_16x16x32_bf16 v[16:19], v[116:119], v[96:99], v[16:19]
  ds_read_b128 v[84:87], v233 offset:24576
  v_mfma_f32_16x16x32_bf16 v[44:47], v[116:119], v[100:103], v[44:47]
  ds_read_b128 v[88:91], v233 offset:25600
  v_mfma_f32_16x16x32_bf16 v[20:23], v[120:123], v[96:99], v[20:23]
  ds_read_b128 v[92:95], v233 offset:26624
  v_mfma_f32_16x16x32_bf16 v[48:51], v[120:123], v[100:103], v[48:51]
  v_mfma_f32_16x16x32_bf16 v[24:27], v[124:127], v[96:99], v[24:27]
  v_mfma_f32_16x16x32_bf16 v[52:55], v[124:127], v[100:103], v[52:55]
  v_mfma_f32_16x16x32_bf16 v[28:31], v[128:131], v[96:99], v[28:31]
  v_mfma_f32_16x16x32_bf16 v[56:59], v[128:131], v[100:103], v[56:59]
  s_waitcnt lgkmcnt(0)
  v_mfma_f32_16x16x32_bf16 v[4:7], v[68:71], v[60:63], v[4:7]
  ds_read_b128 v[96:99], v239 offset:58368
  s_waitcnt vmcnt(0)
  v_mfma_f32_16x16x32_bf16 v[32:35], v[68:71], v[64:67], v[32:35]
  ds_read_b128 v[100:103], v239 offset:60416
  v_add_f32 v204, v204, v206
  v_mfma_f32_16x16x32_bf16 v[8:11], v[72:75], v[60:63], v[8:11]
  ds_read_b128 v[104:107], v233 offset:34816
  v_mul_f32 v204, 0x3acccccd, v204
  v_mfma_f32_16x16x32_bf16 v[36:39], v[72:75], v[64:67], v[36:39]
  ds_read_b128 v[108:111], v233 offset:35840
  v_mov_b32 v212, v204
  v_mfma_f32_16x16x32_bf16 v[12:15], v[76:79], v[60:63], v[12:15]
  ds_read_b128 v[112:115], v233 offset:36864
  v_permlane16_swap_b32 v204, v212
  v_mfma_f32_16x16x32_bf16 v[40:43], v[76:79], v[64:67], v[40:43]
  ds_read_b128 v[116:119], v233 offset:37888
  v_add_f32 v204, v204, v212
  v_mfma_f32_16x16x32_bf16 v[16:19], v[80:83], v[60:63], v[16:19]
  ds_read_b128 v[120:123], v233 offset:38912
  v_mov_b32 v212, v204
  v_mfma_f32_16x16x32_bf16 v[44:47], v[80:83], v[64:67], v[44:47]
  ds_read_b128 v[124:127], v233 offset:39936
  v_permlane32_swap_b32 v204, v212
  v_mfma_f32_16x16x32_bf16 v[20:23], v[84:87], v[60:63], v[20:23]
  ds_read_b128 v[128:131], v233 offset:40960
  v_add_f32 v204, v204, v212
  v_mfma_f32_16x16x32_bf16 v[48:51], v[84:87], v[64:67], v[48:51]
  v_add_f32 v205, v205, v207
  v_mfma_f32_16x16x32_bf16 v[24:27], v[88:91], v[60:63], v[24:27]
  v_mul_f32 v205, 0x3acccccd, v205
  v_mfma_f32_16x16x32_bf16 v[52:55], v[88:91], v[64:67], v[52:55]
  v_mov_b32 v213, v205
  v_mfma_f32_16x16x32_bf16 v[28:31], v[92:95], v[60:63], v[28:31]
  s_nop 0
  v_permlane16_swap_b32 v205, v213
  v_mfma_f32_16x16x32_bf16 v[56:59], v[92:95], v[64:67], v[56:59]
  v_add_f32 v205, v205, v213
  s_waitcnt lgkmcnt(0)
  s_barrier
  v_mfma_f32_16x16x32_bf16 v[4:7], v[104:107], v[96:99], v[4:7]
  ds_read_b128 v[60:63], v240 offset:0
  v_mov_b32 v213, v205
  v_mfma_f32_16x16x32_bf16 v[32:35], v[104:107], v[100:103], v[32:35]
  ds_read_b128 v[64:67], v240 offset:2048
  v_permlane32_swap_b32 v205, v213
  v_mfma_f32_16x16x32_bf16 v[8:11], v[108:111], v[96:99], v[8:11]
  ds_read_b128 v[68:71], v232 offset:0
  v_add_f32 v205, v205, v213
  v_mfma_f32_16x16x32_bf16 v[36:39], v[108:111], v[100:103], v[36:39]
  ds_read_b128 v[72:75], v232 offset:1024
  v_fma_f32 v212, -v204, v204, v205
  v_mfma_f32_16x16x32_bf16 v[12:15], v[112:115], v[96:99], v[12:15]
  ds_read_b128 v[76:79], v232 offset:2048
  v_max_f32 v212, 0, v212
  v_mfma_f32_16x16x32_bf16 v[40:43], v[112:115], v[100:103], v[40:43]
  ds_read_b128 v[80:83], v232 offset:3072
  v_add_f32 v212, 0x3727c5ac, v212
  v_mfma_f32_16x16x32_bf16 v[16:19], v[116:119], v[96:99], v[16:19]
  ds_read_b128 v[84:87], v232 offset:4096
  v_rsq_f32 v224, v212
  v_mfma_f32_16x16x32_bf16 v[44:47], v[116:119], v[100:103], v[44:47]
  ds_read_b128 v[88:91], v232 offset:5120
  v_mul_f32 v225, v224, v204
  v_mfma_f32_16x16x32_bf16 v[20:23], v[120:123], v[96:99], v[20:23]
  ds_read_b128 v[92:95], v232 offset:6144
  v_sub_f32 v225, 0, v225
  v_mfma_f32_16x16x32_bf16 v[48:51], v[120:123], v[100:103], v[48:51]
  v_add_f32 v208, v208, v210
  v_mfma_f32_16x16x32_bf16 v[24:27], v[124:127], v[96:99], v[24:27]
  v_mul_f32 v208, 0x3acccccd, v208
  v_mfma_f32_16x16x32_bf16 v[52:55], v[124:127], v[100:103], v[52:55]
  v_mov_b32 v212, v208
  v_mfma_f32_16x16x32_bf16 v[28:31], v[128:131], v[96:99], v[28:31]
  s_nop 0
  v_permlane16_swap_b32 v208, v212
  v_mfma_f32_16x16x32_bf16 v[56:59], v[128:131], v[100:103], v[56:59]
  v_add_f32 v208, v208, v212
  s_waitcnt lgkmcnt(0)
  v_mfma_f32_16x16x32_bf16 v[4:7], v[68:71], v[60:63], v[4:7]
  ds_read_b128 v[96:99], v240 offset:1024
  v_mov_b32 v212, v208
  v_mfma_f32_16x16x32_bf16 v[32:35], v[68:71], v[64:67], v[32:35]
  ds_read_b128 v[100:103], v240 offset:3072
  v_permlane32_swap_b32 v208, v212
  v_mfma_f32_16x16x32_bf16 v[8:11], v[72:75], v[60:63], v[8:11]
  ds_read_b128 v[104:107], v232 offset:14336
  v_add_f32 v208, v208, v212
  v_mfma_f32_16x16x32_bf16 v[36:39], v[72:75], v[64:67], v[36:39]
  ds_read_b128 v[108:111], v232 offset:15360
  v_add_f32 v209, v209, v211
  v_mfma_f32_16x16x32_bf16 v[12:15], v[76:79], v[60:63], v[12:15]
  ds_read_b128 v[112:115], v232 offset:16384
  v_mul_f32 v209, 0x3acccccd, v209
  v_mfma_f32_16x16x32_bf16 v[40:43], v[76:79], v[64:67], v[40:43]
  ds_read_b128 v[116:119], v232 offset:17408
  v_mov_b32 v213, v209
  v_mfma_f32_16x16x32_bf16 v[16:19], v[80:83], v[60:63], v[16:19]
  ds_read_b128 v[120:123], v232 offset:18432
  v_permlane16_swap_b32 v209, v213
  v_mfma_f32_16x16x32_bf16 v[44:47], v[80:83], v[64:67], v[44:47]
  ds_read_b128 v[124:127], v232 offset:19456
  v_add_f32 v209, v209, v213
  v_mfma_f32_16x16x32_bf16 v[20:23], v[84:87], v[60:63], v[20:23]
  ds_read_b128 v[128:131], v232 offset:20480
  v_mov_b32 v213, v209
  v_mfma_f32_16x16x32_bf16 v[48:51], v[84:87], v[64:67], v[48:51]
  s_nop 0
  v_permlane32_swap_b32 v209, v213
  v_mfma_f32_16x16x32_bf16 v[24:27], v[88:91], v[60:63], v[24:27]
  v_add_f32 v209, v209, v213
  v_mfma_f32_16x16x32_bf16 v[52:55], v[88:91], v[64:67], v[52:55]
  v_fma_f32 v212, -v208, v208, v209
  v_mfma_f32_16x16x32_bf16 v[28:31], v[92:95], v[60:63], v[28:31]
  v_max_f32 v212, 0, v212
  v_mfma_f32_16x16x32_bf16 v[56:59], v[92:95], v[64:67], v[56:59]
  v_add_f32 v212, 0x3727c5ac, v212
  s_waitcnt lgkmcnt(0)
  s_barrier
  v_mfma_f32_16x16x32_bf16 v[4:7], v[104:107], v[96:99], v[4:7]
  ds_read_b128 v[60:63], v240 offset:8192
  v_rsq_f32 v226, v212
  v_mfma_f32_16x16x32_bf16 v[32:35], v[104:107], v[100:103], v[32:35]
  ds_read_b128 v[64:67], v240 offset:10240
  v_mul_f32 v227, v226, v208
  v_mfma_f32_16x16x32_bf16 v[8:11], v[108:111], v[96:99], v[8:11]
  ds_read_b128 v[68:71], v232 offset:28672
  v_sub_f32 v227, 0, v227
  v_mfma_f32_16x16x32_bf16 v[36:39], v[108:111], v[100:103], v[36:39]
  ds_read_b128 v[72:75], v232 offset:29696
  v_mfma_f32_16x16x32_bf16 v[12:15], v[112:115], v[96:99], v[12:15]
  ds_read_b128 v[76:79], v232 offset:30720
  v_mfma_f32_16x16x32_bf16 v[40:43], v[112:115], v[100:103], v[40:43]
  ds_read_b128 v[80:83], v232 offset:31744
  v_mfma_f32_16x16x32_bf16 v[16:19], v[116:119], v[96:99], v[16:19]
  ds_read_b128 v[84:87], v232 offset:32768
  v_mfma_f32_16x16x32_bf16 v[44:47], v[116:119], v[100:103], v[44:47]
  ds_read_b128 v[88:91], v232 offset:33792
  v_mfma_f32_16x16x32_bf16 v[20:23], v[120:123], v[96:99], v[20:23]
  ds_read_b128 v[92:95], v232 offset:34816
  v_mfma_f32_16x16x32_bf16 v[48:51], v[120:123], v[100:103], v[48:51]
  v_mfma_f32_16x16x32_bf16 v[24:27], v[124:127], v[96:99], v[24:27]
  v_mfma_f32_16x16x32_bf16 v[52:55], v[124:127], v[100:103], v[52:55]
  v_mfma_f32_16x16x32_bf16 v[28:31], v[128:131], v[96:99], v[28:31]
  v_mfma_f32_16x16x32_bf16 v[56:59], v[128:131], v[100:103], v[56:59]
  s_waitcnt lgkmcnt(0)
  v_mfma_f32_16x16x32_bf16 v[4:7], v[68:71], v[60:63], v[4:7]
  ds_read_b128 v[96:99], v240 offset:9216
  v_mfma_f32_16x16x32_bf16 v[32:35], v[68:71], v[64:67], v[32:35]
  ds_read_b128 v[100:103], v240 offset:11264
  v_mfma_f32_16x16x32_bf16 v[8:11], v[72:75], v[60:63], v[8:11]
  ds_read_b128 v[104:107], v232 offset:43008
  v_mfma_f32_16x16x32_bf16 v[36:39], v[72:75], v[64:67], v[36:39]
  ds_read_b128 v[108:111], v232 offset:44032
  v_mfma_f32_16x16x32_bf16 v[12:15], v[76:79], v[60:63], v[12:15]
  ds_read_b128 v[112:115], v232 offset:45056
  v_mfma_f32_16x16x32_bf16 v[40:43], v[76:79], v[64:67], v[40:43]
  ds_read_b128 v[116:119], v232 offset:46080
  v_mfma_f32_16x16x32_bf16 v[16:19], v[80:83], v[60:63], v[16:19]
  ds_read_b128 v[120:123], v232 offset:47104
  v_mfma_f32_16x16x32_bf16 v[44:47], v[80:83], v[64:67], v[44:47]
  ds_read_b128 v[124:127], v232 offset:48128
  v_mfma_f32_16x16x32_bf16 v[20:23], v[84:87], v[60:63], v[20:23]
  ds_read_b128 v[128:131], v232 offset:49152
  v_mfma_f32_16x16x32_bf16 v[48:51], v[84:87], v[64:67], v[48:51]
  v_mfma_f32_16x16x32_bf16 v[24:27], v[88:91], v[60:63], v[24:27]
  v_mfma_f32_16x16x32_bf16 v[52:55], v[88:91], v[64:67], v[52:55]
  v_mfma_f32_16x16x32_bf16 v[28:31], v[92:95], v[60:63], v[28:31]
  v_mfma_f32_16x16x32_bf16 v[56:59], v[92:95], v[64:67], v[56:59]
  s_waitcnt lgkmcnt(0)
  s_barrier
  v_mfma_f32_16x16x32_bf16 v[4:7], v[104:107], v[96:99], v[4:7]
  ds_read_b128 v[60:63], v239 offset:32768
  v_mfma_f32_16x16x32_bf16 v[32:35], v[104:107], v[100:103], v[32:35]
  ds_read_b128 v[64:67], v239 offset:34816
  v_mfma_f32_16x16x32_bf16 v[8:11], v[108:111], v[96:99], v[8:11]
  ds_read_b128 v[68:71], v232 offset:57344
  v_mfma_f32_16x16x32_bf16 v[36:39], v[108:111], v[100:103], v[36:39]
  ds_read_b128 v[72:75], v232 offset:58368
  v_mfma_f32_16x16x32_bf16 v[12:15], v[112:115], v[96:99], v[12:15]
  ds_read_b128 v[76:79], v232 offset:59392
  v_mfma_f32_16x16x32_bf16 v[40:43], v[112:115], v[100:103], v[40:43]
  ds_read_b128 v[80:83], v232 offset:60416
  v_mfma_f32_16x16x32_bf16 v[16:19], v[116:119], v[96:99], v[16:19]
  ds_read_b128 v[84:87], v232 offset:61440
  v_mfma_f32_16x16x32_bf16 v[44:47], v[116:119], v[100:103], v[44:47]
  ds_read_b128 v[88:91], v232 offset:62464
  v_mfma_f32_16x16x32_bf16 v[20:23], v[120:123], v[96:99], v[20:23]
  ds_read_b128 v[92:95], v232 offset:63488
  v_mfma_f32_16x16x32_bf16 v[48:51], v[120:123], v[100:103], v[48:51]
  v_mfma_f32_16x16x32_bf16 v[24:27], v[124:127], v[96:99], v[24:27]
  v_mfma_f32_16x16x32_bf16 v[52:55], v[124:127], v[100:103], v[52:55]
  v_mfma_f32_16x16x32_bf16 v[28:31], v[128:131], v[96:99], v[28:31]
  v_mfma_f32_16x16x32_bf16 v[56:59], v[128:131], v[100:103], v[56:59]
  s_waitcnt lgkmcnt(0)
  v_mfma_f32_16x16x32_bf16 v[4:7], v[68:71], v[60:63], v[4:7]
  ds_read_b128 v[96:99], v239 offset:33792
  v_mfma_f32_16x16x32_bf16 v[32:35], v[68:71], v[64:67], v[32:35]
  ds_read_b128 v[100:103], v239 offset:35840
  v_mfma_f32_16x16x32_bf16 v[8:11], v[72:75], v[60:63], v[8:11]
  ds_read_b128 v[104:107], v233 offset:6144
  v_mfma_f32_16x16x32_bf16 v[36:39], v[72:75], v[64:67], v[36:39]
  ds_read_b128 v[108:111], v233 offset:7168
  v_mfma_f32_16x16x32_bf16 v[12:15], v[76:79], v[60:63], v[12:15]
  ds_read_b128 v[112:115], v233 offset:8192
  v_mfma_f32_16x16x32_bf16 v[40:43], v[76:79], v[64:67], v[40:43]
  ds_read_b128 v[116:119], v233 offset:9216
  v_mfma_f32_16x16x32_bf16 v[16:19], v[80:83], v[60:63], v[16:19]
  ds_read_b128 v[120:123], v233 offset:10240
  v_mfma_f32_16x16x32_bf16 v[44:47], v[80:83], v[64:67], v[44:47]
  ds_read_b128 v[124:127], v233 offset:11264
  v_mfma_f32_16x16x32_bf16 v[20:23], v[84:87], v[60:63], v[20:23]
  ds_read_b128 v[128:131], v233 offset:12288
  v_mfma_f32_16x16x32_bf16 v[48:51], v[84:87], v[64:67], v[48:51]
  v_mfma_f32_16x16x32_bf16 v[24:27], v[88:91], v[60:63], v[24:27]
  v_mfma_f32_16x16x32_bf16 v[52:55], v[88:91], v[64:67], v[52:55]
  v_mfma_f32_16x16x32_bf16 v[28:31], v[92:95], v[60:63], v[28:31]
  v_mfma_f32_16x16x32_bf16 v[56:59], v[92:95], v[64:67], v[56:59]
  s_waitcnt lgkmcnt(0)
  s_barrier
  v_mfma_f32_16x16x32_bf16 v[4:7], v[104:107], v[96:99], v[4:7]
  ds_read_b128 v[60:63], v239 offset:40960
  v_mfma_f32_16x16x32_bf16 v[32:35], v[104:107], v[100:103], v[32:35]
  ds_read_b128 v[64:67], v239 offset:43008
  v_mfma_f32_16x16x32_bf16 v[8:11], v[108:111], v[96:99], v[8:11]
  ds_read_b128 v[68:71], v233 offset:20480
  v_mfma_f32_16x16x32_bf16 v[36:39], v[108:111], v[100:103], v[36:39]
  ds_read_b128 v[72:75], v233 offset:21504
  v_mfma_f32_16x16x32_bf16 v[12:15], v[112:115], v[96:99], v[12:15]
  ds_read_b128 v[76:79], v233 offset:22528
  v_mfma_f32_16x16x32_bf16 v[40:43], v[112:115], v[100:103], v[40:43]
  ds_read_b128 v[80:83], v233 offset:23552
  v_mfma_f32_16x16x32_bf16 v[16:19], v[116:119], v[96:99], v[16:19]
  ds_read_b128 v[84:87], v233 offset:24576
  v_mfma_f32_16x16x32_bf16 v[44:47], v[116:119], v[100:103], v[44:47]
  ds_read_b128 v[88:91], v233 offset:25600
  v_mfma_f32_16x16x32_bf16 v[20:23], v[120:123], v[96:99], v[20:23]
  ds_read_b128 v[92:95], v233 offset:26624
  v_mfma_f32_16x16x32_bf16 v[48:51], v[120:123], v[100:103], v[48:51]
  v_mfma_f32_16x16x32_bf16 v[24:27], v[124:127], v[96:99], v[24:27]
  v_mfma_f32_16x16x32_bf16 v[52:55], v[124:127], v[100:103], v[52:55]
  v_mfma_f32_16x16x32_bf16 v[28:31], v[128:131], v[96:99], v[28:31]
  v_mfma_f32_16x16x32_bf16 v[56:59], v[128:131], v[100:103], v[56:59]
  s_waitcnt lgkmcnt(0)
  v_mfma_f32_16x16x32_bf16 v[4:7], v[68:71], v[60:63], v[4:7]
  ds_read_b128 v[96:99], v239 offset:41984
  v_mfma_f32_16x16x32_bf16 v[32:35], v[68:71], v[64:67], v[32:35]
  ds_read_b128 v[100:103], v239 offset:44032
  v_mfma_f32_16x16x32_bf16 v[8:11], v[72:75], v[60:63], v[8:11]
  ds_read_b128 v[104:107], v233 offset:34816
  v_mfma_f32_16x16x32_bf16 v[36:39], v[72:75], v[64:67], v[36:39]
  ds_read_b128 v[108:111], v233 offset:35840
  v_mfma_f32_16x16x32_bf16 v[12:15], v[76:79], v[60:63], v[12:15]
  ds_read_b128 v[112:115], v233 offset:36864
  v_mfma_f32_16x16x32_bf16 v[40:43], v[76:79], v[64:67], v[40:43]
  ds_read_b128 v[116:119], v233 offset:37888
  v_mfma_f32_16x16x32_bf16 v[16:19], v[80:83], v[60:63], v[16:19]
  ds_read_b128 v[120:123], v233 offset:38912
  v_mfma_f32_16x16x32_bf16 v[44:47], v[80:83], v[64:67], v[44:47]
  ds_read_b128 v[124:127], v233 offset:39936
  v_mfma_f32_16x16x32_bf16 v[20:23], v[84:87], v[60:63], v[20:23]
  ds_read_b128 v[128:131], v233 offset:40960
  v_mfma_f32_16x16x32_bf16 v[48:51], v[84:87], v[64:67], v[48:51]
  v_mfma_f32_16x16x32_bf16 v[24:27], v[88:91], v[60:63], v[24:27]
  v_mfma_f32_16x16x32_bf16 v[52:55], v[88:91], v[64:67], v[52:55]
  v_mfma_f32_16x16x32_bf16 v[28:31], v[92:95], v[60:63], v[28:31]
  v_mfma_f32_16x16x32_bf16 v[56:59], v[92:95], v[64:67], v[56:59]
  s_waitcnt lgkmcnt(0)
  s_barrier
  v_mfma_f32_16x16x32_bf16 v[4:7], v[104:107], v[96:99], v[4:7]
  ds_read_b128 v[60:63], v239 offset:49152
  v_mfma_f32_16x16x32_bf16 v[32:35], v[104:107], v[100:103], v[32:35]
  ds_read_b128 v[64:67], v239 offset:51200
  v_mfma_f32_16x16x32_bf16 v[8:11], v[108:111], v[96:99], v[8:11]
  ds_read_b128 v[68:71], v232 offset:0
  v_mfma_f32_16x16x32_bf16 v[36:39], v[108:111], v[100:103], v[36:39]
  ds_read_b128 v[72:75], v232 offset:1024
  v_mfma_f32_16x16x32_bf16 v[12:15], v[112:115], v[96:99], v[12:15]
  ds_read_b128 v[76:79], v232 offset:2048
  v_mfma_f32_16x16x32_bf16 v[40:43], v[112:115], v[100:103], v[40:43]
  ds_read_b128 v[80:83], v232 offset:3072
  v_mfma_f32_16x16x32_bf16 v[16:19], v[116:119], v[96:99], v[16:19]
  ds_read_b128 v[84:87], v232 offset:4096
  v_mfma_f32_16x16x32_bf16 v[44:47], v[116:119], v[100:103], v[44:47]
  ds_read_b128 v[88:91], v232 offset:5120
  v_mfma_f32_16x16x32_bf16 v[20:23], v[120:123], v[96:99], v[20:23]
  ds_read_b128 v[92:95], v232 offset:6144
  v_mfma_f32_16x16x32_bf16 v[48:51], v[120:123], v[100:103], v[48:51]
  v_mfma_f32_16x16x32_bf16 v[24:27], v[124:127], v[96:99], v[24:27]
  v_mfma_f32_16x16x32_bf16 v[52:55], v[124:127], v[100:103], v[52:55]
  v_mfma_f32_16x16x32_bf16 v[28:31], v[128:131], v[96:99], v[28:31]
  v_mfma_f32_16x16x32_bf16 v[56:59], v[128:131], v[100:103], v[56:59]
  s_waitcnt lgkmcnt(0)
  v_mfma_f32_16x16x32_bf16 v[4:7], v[68:71], v[60:63], v[4:7]
  ds_read_b128 v[96:99], v239 offset:50176
  v_mfma_f32_16x16x32_bf16 v[32:35], v[68:71], v[64:67], v[32:35]
  ds_read_b128 v[100:103], v239 offset:52224
  v_mfma_f32_16x16x32_bf16 v[8:11], v[72:75], v[60:63], v[8:11]
  ds_read_b128 v[104:107], v232 offset:14336
  v_mfma_f32_16x16x32_bf16 v[36:39], v[72:75], v[64:67], v[36:39]
  ds_read_b128 v[108:111], v232 offset:15360
  v_mfma_f32_16x16x32_bf16 v[12:15], v[76:79], v[60:63], v[12:15]
  ds_read_b128 v[112:115], v232 offset:16384
  v_mfma_f32_16x16x32_bf16 v[40:43], v[76:79], v[64:67], v[40:43]
  ds_read_b128 v[116:119], v232 offset:17408
  v_mfma_f32_16x16x32_bf16 v[16:19], v[80:83], v[60:63], v[16:19]
  ds_read_b128 v[120:123], v232 offset:18432
  v_mfma_f32_16x16x32_bf16 v[44:47], v[80:83], v[64:67], v[44:47]
  ds_read_b128 v[124:127], v232 offset:19456
  v_mfma_f32_16x16x32_bf16 v[20:23], v[84:87], v[60:63], v[20:23]
  ds_read_b128 v[128:131], v232 offset:20480
  v_mfma_f32_16x16x32_bf16 v[48:51], v[84:87], v[64:67], v[48:51]
  v_mfma_f32_16x16x32_bf16 v[24:27], v[88:91], v[60:63], v[24:27]
  v_mfma_f32_16x16x32_bf16 v[52:55], v[88:91], v[64:67], v[52:55]
  v_mfma_f32_16x16x32_bf16 v[28:31], v[92:95], v[60:63], v[28:31]
  v_mfma_f32_16x16x32_bf16 v[56:59], v[92:95], v[64:67], v[56:59]
  s_waitcnt lgkmcnt(0)
  s_barrier
  v_mfma_f32_16x16x32_bf16 v[4:7], v[104:107], v[96:99], v[4:7]
  ds_read_b128 v[60:63], v239 offset:57344
  v_mfma_f32_16x16x32_bf16 v[32:35], v[104:107], v[100:103], v[32:35]
  ds_read_b128 v[64:67], v239 offset:59392
  v_mfma_f32_16x16x32_bf16 v[8:11], v[108:111], v[96:99], v[8:11]
  ds_read_b128 v[68:71], v232 offset:28672
  v_mfma_f32_16x16x32_bf16 v[36:39], v[108:111], v[100:103], v[36:39]
  ds_read_b128 v[72:75], v232 offset:29696
  v_mfma_f32_16x16x32_bf16 v[12:15], v[112:115], v[96:99], v[12:15]
  ds_read_b128 v[76:79], v232 offset:30720
  v_mfma_f32_16x16x32_bf16 v[40:43], v[112:115], v[100:103], v[40:43]
  ds_read_b128 v[80:83], v232 offset:31744
  v_mfma_f32_16x16x32_bf16 v[16:19], v[116:119], v[96:99], v[16:19]
  ds_read_b128 v[84:87], v232 offset:32768
  v_mfma_f32_16x16x32_bf16 v[44:47], v[116:119], v[100:103], v[44:47]
  ds_read_b128 v[88:91], v232 offset:33792
  v_mfma_f32_16x16x32_bf16 v[20:23], v[120:123], v[96:99], v[20:23]
  ds_read_b128 v[92:95], v232 offset:34816
  v_mfma_f32_16x16x32_bf16 v[48:51], v[120:123], v[100:103], v[48:51]
  v_mfma_f32_16x16x32_bf16 v[24:27], v[124:127], v[96:99], v[24:27]
  v_mfma_f32_16x16x32_bf16 v[52:55], v[124:127], v[100:103], v[52:55]
  v_mfma_f32_16x16x32_bf16 v[28:31], v[128:131], v[96:99], v[28:31]
  v_mfma_f32_16x16x32_bf16 v[56:59], v[128:131], v[100:103], v[56:59]
  s_waitcnt lgkmcnt(0)
  v_mfma_f32_16x16x32_bf16 v[4:7], v[68:71], v[60:63], v[4:7]
  ds_read_b128 v[96:99], v239 offset:58368
  v_mfma_f32_16x16x32_bf16 v[32:35], v[68:71], v[64:67], v[32:35]
  ds_read_b128 v[100:103], v239 offset:60416
  v_mfma_f32_16x16x32_bf16 v[8:11], v[72:75], v[60:63], v[8:11]
  ds_read_b128 v[104:107], v232 offset:43008
  v_mfma_f32_16x16x32_bf16 v[36:39], v[72:75], v[64:67], v[36:39]
  ds_read_b128 v[108:111], v232 offset:44032
  v_mfma_f32_16x16x32_bf16 v[12:15], v[76:79], v[60:63], v[12:15]
  ds_read_b128 v[112:115], v232 offset:45056
  v_mfma_f32_16x16x32_bf16 v[40:43], v[76:79], v[64:67], v[40:43]
  ds_read_b128 v[116:119], v232 offset:46080
  v_mfma_f32_16x16x32_bf16 v[16:19], v[80:83], v[60:63], v[16:19]
  ds_read_b128 v[120:123], v232 offset:47104
  v_mfma_f32_16x16x32_bf16 v[44:47], v[80:83], v[64:67], v[44:47]
  ds_read_b128 v[124:127], v232 offset:48128
  v_mfma_f32_16x16x32_bf16 v[20:23], v[84:87], v[60:63], v[20:23]
  ds_read_b128 v[128:131], v232 offset:49152
  v_mfma_f32_16x16x32_bf16 v[48:51], v[84:87], v[64:67], v[48:51]
  v_mfma_f32_16x16x32_bf16 v[24:27], v[88:91], v[60:63], v[24:27]
  v_mfma_f32_16x16x32_bf16 v[52:55], v[88:91], v[64:67], v[52:55]
  v_mfma_f32_16x16x32_bf16 v[28:31], v[92:95], v[60:63], v[28:31]
  v_mfma_f32_16x16x32_bf16 v[56:59], v[92:95], v[64:67], v[56:59]
  s_waitcnt lgkmcnt(0)
  s_barrier
  v_mfma_f32_16x16x32_bf16 v[4:7], v[104:107], v[96:99], v[4:7]
  v_mfma_f32_16x16x32_bf16 v[32:35], v[104:107], v[100:103], v[32:35]
  v_mfma_f32_16x16x32_bf16 v[8:11], v[108:111], v[96:99], v[8:11]
  v_mfma_f32_16x16x32_bf16 v[36:39], v[108:111], v[100:103], v[36:39]
  v_mfma_f32_16x16x32_bf16 v[12:15], v[112:115], v[96:99], v[12:15]
  v_mfma_f32_16x16x32_bf16 v[40:43], v[112:115], v[100:103], v[40:43]
  v_mfma_f32_16x16x32_bf16 v[16:19], v[116:119], v[96:99], v[16:19]
  v_mfma_f32_16x16x32_bf16 v[44:47], v[116:119], v[100:103], v[44:47]
  v_mfma_f32_16x16x32_bf16 v[20:23], v[120:123], v[96:99], v[20:23]
  v_mfma_f32_16x16x32_bf16 v[48:51], v[120:123], v[100:103], v[48:51]
  v_mfma_f32_16x16x32_bf16 v[24:27], v[124:127], v[96:99], v[24:27]
  v_mfma_f32_16x16x32_bf16 v[52:55], v[124:127], v[100:103], v[52:55]
  v_mfma_f32_16x16x32_bf16 v[28:31], v[128:131], v[96:99], v[28:31]
  v_mfma_f32_16x16x32_bf16 v[56:59], v[128:131], v[100:103], v[56:59]
  s_cmp_eq_u32 s30, 0
  s_cbranch_scc1 kb_kernel_slow_21
  v_add_u32 v220, 0xb80000, v236
  v_add_u32 v221, 0xb8d800, v236
  s_nop 2
  v_pk_mul_f32 v[28:29], v[28:29], v[224:225] op_sel_hi:[1,0]
  v_pk_mul_f32 v[30:31], v[30:31], v[224:225] op_sel_hi:[1,0]
  v_pk_mul_f32 v[4:5], v[4:5], v[224:225] op_sel_hi:[1,0]
  v_pk_mul_f32 v[6:7], v[6:7], v[224:225] op_sel_hi:[1,0]
  v_pk_mul_f32 v[8:9], v[8:9], v[224:225] op_sel_hi:[1,0]
  v_pk_mul_f32 v[10:11], v[10:11], v[224:225] op_sel_hi:[1,0]
  v_pk_fma_f32 v[28:29], v[196:197], v[224:225], v[28:29] op_sel:[0,1,0] op_sel_hi:[1,1,1]
  v_pk_fma_f32 v[30:31], v[198:199], v[224:225], v[30:31] op_sel:[0,1,0] op_sel_hi:[1,1,1]
  v_pk_fma_f32 v[4:5], v[172:173], v[224:225], v[4:5] op_sel:[0,1,0] op_sel_hi:[1,1,1]
  v_pk_fma_f32 v[6:7], v[174:175], v[224:225], v[6:7] op_sel:[0,1,0] op_sel_hi:[1,1,1]
  v_pk_fma_f32 v[8:9], v[176:177], v[224:225], v[8:9] op_sel:[0,1,0] op_sel_hi:[1,1,1]
  v_pk_fma_f32 v[10:11], v[178:179], v[224:225], v[10:11] op_sel:[0,1,0] op_sel_hi:[1,1,1]
  v_pk_mul_f32 v[100:101], v[28:29], v[28:29]
  v_pk_mul_f32 v[102:103], v[30:31], v[30:31]
  v_pk_mul_f32 v[104:105], v[4:5], v[4:5]
  v_pk_mul_f32 v[106:107], v[6:7], v[6:7]
  v_pk_mul_f32 v[108:109], v[8:9], v[8:9]
  v_pk_mul_f32 v[110:111], v[10:11], v[10:11]
  v_pk_fma_f32 v[100:101], v[100:101], s[44:45], v[230:231]
  v_pk_fma_f32 v[102:103], v[102:103], s[44:45], v[230:231]
  v_pk_fma_f32 v[104:105], v[104:105], s[44:45], v[230:231]
  v_pk_fma_f32 v[106:107], v[106:107], s[44:45], v[230:231]
  v_pk_fma_f32 v[108:109], v[108:109], s[44:45], v[230:231]
  v_pk_fma_f32 v[110:111], v[110:111], s[44:45], v[230:231]
  v_pk_mul_f32 v[100:101], v[100:101], v[28:29]
  v_pk_mul_f32 v[102:103], v[102:103], v[30:31]
  v_pk_mul_f32 v[104:105], v[104:105], v[4:5]
  v_pk_mul_f32 v[106:107], v[106:107], v[6:7]
  v_pk_mul_f32 v[108:109], v[108:109], v[8:9]
  v_pk_mul_f32 v[110:111], v[110:111], v[10:11]
  v_exp_f32 v100, v100
  v_exp_f32 v101, v101
  v_exp_f32 v102, v102
  v_exp_f32 v103, v103
  v_exp_f32 v104, v104
  v_exp_f32 v105, v105
  v_exp_f32 v106, v106
  v_exp_f32 v107, v107
  v_exp_f32 v108, v108
  v_exp_f32 v109, v109
  v_exp_f32 v110, v110
  v_exp_f32 v111, v111
  v_pk_add_f32 v[100:101], v[100:101], s[46:47]
  v_pk_add_f32 v[102:103], v[102:103], s[46:47]
  v_pk_add_f32 v[104:105], v[104:105], s[46:47]
  v_pk_add_f32 v[106:107], v[106:107], s[46:47]
  v_pk_add_f32 v[108:109], v[108:109], s[46:47]
  v_pk_add_f32 v[110:111], v[110:111], s[46:47]
  v_rcp_f32 v100, v100
  v_rcp_f32 v101, v101
  v_rcp_f32 v102, v102
  v_rcp_f32 v103, v103
  v_rcp_f32 v104, v104
  v_rcp_f32 v105, v105
  v_rcp_f32 v106, v106
  v_rcp_f32 v107, v107
  v_rcp_f32 v108, v108
  v_rcp_f32 v109, v109
  v_rcp_f32 v110, v110
  v_rcp_f32 v111, v111
  v_pk_mul_f32 v[28:29], v[28:29], v[100:101]
  v_pk_mul_f32 v[30:31], v[30:31], v[102:103]
  v_pk_mul_f32 v[4:5], v[4:5], v[104:105]
  v_pk_mul_f32 v[6:7], v[6:7], v[106:107]
  v_pk_mul_f32 v[8:9], v[8:9], v[108:109]
  v_pk_mul_f32 v[10:11], v[10:11], v[110:111]
  v_cvt_pk_bf16_f32 v72, v28, v29
  v_cvt_pk_bf16_f32 v73, v30, v31
  buffer_store_dwordx2 v[72:73], v220, s[8:11], s29 offen
  v_cvt_pk_bf16_f32 v60, v4, v5
  v_cvt_pk_bf16_f32 v61, v6, v7
  v_cvt_pk_bf16_f32 v62, v8, v9
  v_cvt_pk_bf16_f32 v63, v10, v11
  buffer_store_dwordx4 v[60:63], v220, s[8:11], s28 offen offset:0
  v_pk_mul_f32 v[12:13], v[12:13], v[224:225] op_sel_hi:[1,0]
  v_pk_mul_f32 v[14:15], v[14:15], v[224:225] op_sel_hi:[1,0]
  v_pk_mul_f32 v[16:17], v[16:17], v[224:225] op_sel_hi:[1,0]
  v_pk_mul_f32 v[18:19], v[18:19], v[224:225] op_sel_hi:[1,0]
  v_pk_fma_f32 v[12:13], v[180:181], v[224:225], v[12:13] op_sel:[0,1,0] op_sel_hi:[1,1,1]
  v_pk_fma_f32 v[14:15], v[182:183], v[224:225], v[14:15] op_sel:[0,1,0] op_sel_hi:[1,1,1]
  v_pk_fma_f32 v[16:17], v[184:185], v[224:225], v[16:17] op_sel:[0,1,0] op_sel_hi:[1,1,1]
  v_pk_fma_f32 v[18:19], v[186:187], v[224:225], v[18:19] op_sel:[0,1,0] op_sel_hi:[1,1,1]
  v_pk_mul_f32 v[100:101], v[12:13], v[12:13]
  v_pk_mul_f32 v[102:103], v[14:15], v[14:15]
  v_pk_mul_f32 v[104:105], v[16:17], v[16:17]
  v_pk_mul_f32 v[106:107], v[18:19], v[18:19]
  v_pk_fma_f32 v[100:101], v[100:101], s[44:45], v[230:231]
  v_pk_fma_f32 v[102:103], v[102:103], s[44:45], v[230:231]
  v_pk_fma_f32 v[104:105], v[104:105], s[44:45], v[230:231]
  v_pk_fma_f32 v[106:107], v[106:107], s[44:45], v[230:231]
  v_pk_mul_f32 v[100:101], v[100:101], v[12:13]
  v_pk_mul_f32 v[102:103], v[102:103], v[14:15]
  v_pk_mul_f32 v[104:105], v[104:105], v[16:17]
  v_pk_mul_f32 v[106:107], v[106:107], v[18:19]
  v_exp_f32 v100, v100
  v_exp_f32 v101, v101
  v_exp_f32 v102, v102
  v_exp_f32 v103, v103
  v_exp_f32 v104, v104
  v_exp_f32 v105, v105
  v_exp_f32 v106, v106
  v_exp_f32 v107, v107
  v_pk_add_f32 v[100:101], v[100:101], s[46:47]
  v_pk_add_f32 v[102:103], v[102:103], s[46:47]
  v_pk_add_f32 v[104:105], v[104:105], s[46:47]
  v_pk_add_f32 v[106:107], v[106:107], s[46:47]
  v_rcp_f32 v100, v100
  v_rcp_f32 v101, v101
  v_rcp_f32 v102, v102
  v_rcp_f32 v103, v103
  v_rcp_f32 v104, v104
  v_rcp_f32 v105, v105
  v_rcp_f32 v106, v106
  v_rcp_f32 v107, v107
  v_pk_mul_f32 v[12:13], v[12:13], v[100:101]
  v_pk_mul_f32 v[14:15], v[14:15], v[102:103]
  v_pk_mul_f32 v[16:17], v[16:17], v[104:105]
  v_pk_mul_f32 v[18:19], v[18:19], v[106:107]
  v_cvt_pk_bf16_f32 v64, v12, v13
  v_cvt_pk_bf16_f32 v65, v14, v15
  v_cvt_pk_bf16_f32 v66, v16, v17
  v_cvt_pk_bf16_f32 v67, v18, v19
  buffer_store_dwordx4 v[64:67], v220, s[8:11], s28 offen offset:1024
  v_pk_mul_f32 v[20:21], v[20:21], v[224:225] op_sel_hi:[1,0]
  v_pk_mul_f32 v[22:23], v[22:23], v[224:225] op_sel_hi:[1,0]
  v_pk_mul_f32 v[24:25], v[24:25], v[224:225] op_sel_hi:[1,0]
  v_pk_mul_f32 v[26:27], v[26:27], v[224:225] op_sel_hi:[1,0]
  v_pk_fma_f32 v[20:21], v[188:189], v[224:225], v[20:21] op_sel:[0,1,0] op_sel_hi:[1,1,1]
  v_pk_fma_f32 v[22:23], v[190:191], v[224:225], v[22:23] op_sel:[0,1,0] op_sel_hi:[1,1,1]
  v_pk_fma_f32 v[24:25], v[192:193], v[224:225], v[24:25] op_sel:[0,1,0] op_sel_hi:[1,1,1]
  v_pk_fma_f32 v[26:27], v[194:195], v[224:225], v[26:27] op_sel:[0,1,0] op_sel_hi:[1,1,1]
  v_pk_mul_f32 v[100:101], v[20:21], v[20:21]
  v_pk_mul_f32 v[102:103], v[22:23], v[22:23]
  v_pk_mul_f32 v[104:105], v[24:25], v[24:25]
  v_pk_mul_f32 v[106:107], v[26:27], v[26:27]
  v_pk_fma_f32 v[100:101], v[100:101], s[44:45], v[230:231]
  v_pk_fma_f32 v[102:103], v[102:103], s[44:45], v[230:231]
  v_pk_fma_f32 v[104:105], v[104:105], s[44:45], v[230:231]
  v_pk_fma_f32 v[106:107], v[106:107], s[44:45], v[230:231]
  v_pk_mul_f32 v[100:101], v[100:101], v[20:21]
  v_pk_mul_f32 v[102:103], v[102:103], v[22:23]
  v_pk_mul_f32 v[104:105], v[104:105], v[24:25]
  v_pk_mul_f32 v[106:107], v[106:107], v[26:27]
  v_exp_f32 v100, v100
  v_exp_f32 v101, v101
  v_exp_f32 v102, v102
  v_exp_f32 v103, v103
  v_exp_f32 v104, v104
  v_exp_f32 v105, v105
  v_exp_f32 v106, v106
  v_exp_f32 v107, v107
  v_pk_add_f32 v[100:101], v[100:101], s[46:47]
  v_pk_add_f32 v[102:103], v[102:103], s[46:47]
  v_pk_add_f32 v[104:105], v[104:105], s[46:47]
  v_pk_add_f32 v[106:107], v[106:107], s[46:47]
  v_rcp_f32 v100, v100
  v_rcp_f32 v101, v101
  v_rcp_f32 v102, v102
  v_rcp_f32 v103, v103
  v_rcp_f32 v104, v104
  v_rcp_f32 v105, v105
  v_rcp_f32 v106, v106
  v_rcp_f32 v107, v107
  v_pk_mul_f32 v[20:21], v[20:21], v[100:101]
  v_pk_mul_f32 v[22:23], v[22:23], v[102:103]
  v_pk_mul_f32 v[24:25], v[24:25], v[104:105]
  v_pk_mul_f32 v[26:27], v[26:27], v[106:107]
  v_cvt_pk_bf16_f32 v68, v20, v21
  v_cvt_pk_bf16_f32 v69, v22, v23
  v_cvt_pk_bf16_f32 v70, v24, v25
  v_cvt_pk_bf16_f32 v71, v26, v27
  buffer_store_dwordx4 v[68:71], v220, s[8:11], s28 offen offset:2048
  v_pk_mul_f32 v[56:57], v[56:57], v[226:227] op_sel_hi:[1,0]
  v_pk_mul_f32 v[58:59], v[58:59], v[226:227] op_sel_hi:[1,0]
  v_pk_mul_f32 v[32:33], v[32:33], v[226:227] op_sel_hi:[1,0]
  v_pk_mul_f32 v[34:35], v[34:35], v[226:227] op_sel_hi:[1,0]
  v_pk_mul_f32 v[36:37], v[36:37], v[226:227] op_sel_hi:[1,0]
  v_pk_mul_f32 v[38:39], v[38:39], v[226:227] op_sel_hi:[1,0]
  v_pk_fma_f32 v[56:57], v[196:197], v[226:227], v[56:57] op_sel:[0,1,0] op_sel_hi:[1,1,1]
  v_pk_fma_f32 v[58:59], v[198:199], v[226:227], v[58:59] op_sel:[0,1,0] op_sel_hi:[1,1,1]
  v_pk_fma_f32 v[32:33], v[172:173], v[226:227], v[32:33] op_sel:[0,1,0] op_sel_hi:[1,1,1]
  v_pk_fma_f32 v[34:35], v[174:175], v[226:227], v[34:35] op_sel:[0,1,0] op_sel_hi:[1,1,1]
  v_pk_fma_f32 v[36:37], v[176:177], v[226:227], v[36:37] op_sel:[0,1,0] op_sel_hi:[1,1,1]
  v_pk_fma_f32 v[38:39], v[178:179], v[226:227], v[38:39] op_sel:[0,1,0] op_sel_hi:[1,1,1]
  v_pk_mul_f32 v[100:101], v[56:57], v[56:57]
  v_pk_mul_f32 v[102:103], v[58:59], v[58:59]
  v_pk_mul_f32 v[104:105], v[32:33], v[32:33]
  v_pk_mul_f32 v[106:107], v[34:35], v[34:35]
  v_pk_mul_f32 v[108:109], v[36:37], v[36:37]
  v_pk_mul_f32 v[110:111], v[38:39], v[38:39]
  v_pk_fma_f32 v[100:101], v[100:101], s[44:45], v[230:231]
  v_pk_fma_f32 v[102:103], v[102:103], s[44:45], v[230:231]
  v_pk_fma_f32 v[104:105], v[104:105], s[44:45], v[230:231]
  v_pk_fma_f32 v[106:107], v[106:107], s[44:45], v[230:231]
  v_pk_fma_f32 v[108:109], v[108:109], s[44:45], v[230:231]
  v_pk_fma_f32 v[110:111], v[110:111], s[44:45], v[230:231]
  v_pk_mul_f32 v[100:101], v[100:101], v[56:57]
  v_pk_mul_f32 v[102:103], v[102:103], v[58:59]
  v_pk_mul_f32 v[104:105], v[104:105], v[32:33]
  v_pk_mul_f32 v[106:107], v[106:107], v[34:35]
  v_pk_mul_f32 v[108:109], v[108:109], v[36:37]
  v_pk_mul_f32 v[110:111], v[110:111], v[38:39]
  v_exp_f32 v100, v100
  v_exp_f32 v101, v101
  v_exp_f32 v102, v102
  v_exp_f32 v103, v103
  v_exp_f32 v104, v104
  v_exp_f32 v105, v105
  v_exp_f32 v106, v106
  v_exp_f32 v107, v107
  v_exp_f32 v108, v108
  v_exp_f32 v109, v109
  v_exp_f32 v110, v110
  v_exp_f32 v111, v111
  v_pk_add_f32 v[100:101], v[100:101], s[46:47]
  v_pk_add_f32 v[102:103], v[102:103], s[46:47]
  v_pk_add_f32 v[104:105], v[104:105], s[46:47]
  v_pk_add_f32 v[106:107], v[106:107], s[46:47]
  v_pk_add_f32 v[108:109], v[108:109], s[46:47]
  v_pk_add_f32 v[110:111], v[110:111], s[46:47]
  v_rcp_f32 v100, v100
  v_rcp_f32 v101, v101
  v_rcp_f32 v102, v102
  v_rcp_f32 v103, v103
  v_rcp_f32 v104, v104
  v_rcp_f32 v105, v105
  v_rcp_f32 v106, v106
  v_rcp_f32 v107, v107
  v_rcp_f32 v108, v108
  v_rcp_f32 v109, v109
  v_rcp_f32 v110, v110
  v_rcp_f32 v111, v111
  v_pk_mul_f32 v[56:57], v[56:57], v[100:101]
  v_pk_mul_f32 v[58:59], v[58:59], v[102:103]
  v_pk_mul_f32 v[32:33], v[32:33], v[104:105]
  v_pk_mul_f32 v[34:35], v[34:35], v[106:107]
  v_pk_mul_f32 v[36:37], v[36:37], v[108:109]
  v_pk_mul_f32 v[38:39], v[38:39], v[110:111]
  v_cvt_pk_bf16_f32 v88, v56, v57
  v_cvt_pk_bf16_f32 v89, v58, v59
  buffer_store_dwordx2 v[88:89], v221, s[8:11], s29 offen
  v_cvt_pk_bf16_f32 v76, v32, v33
  v_cvt_pk_bf16_f32 v77, v34, v35
  v_cvt_pk_bf16_f32 v78, v36, v37
  v_cvt_pk_bf16_f32 v79, v38, v39
  buffer_store_dwordx4 v[76:79], v221, s[8:11], s28 offen offset:0
  v_pk_mul_f32 v[40:41], v[40:41], v[226:227] op_sel_hi:[1,0]
  v_pk_mul_f32 v[42:43], v[42:43], v[226:227] op_sel_hi:[1,0]
  v_pk_mul_f32 v[44:45], v[44:45], v[226:227] op_sel_hi:[1,0]
  v_pk_mul_f32 v[46:47], v[46:47], v[226:227] op_sel_hi:[1,0]
  v_pk_fma_f32 v[40:41], v[180:181], v[226:227], v[40:41] op_sel:[0,1,0] op_sel_hi:[1,1,1]
  v_pk_fma_f32 v[42:43], v[182:183], v[226:227], v[42:43] op_sel:[0,1,0] op_sel_hi:[1,1,1]
  v_pk_fma_f32 v[44:45], v[184:185], v[226:227], v[44:45] op_sel:[0,1,0] op_sel_hi:[1,1,1]
  v_pk_fma_f32 v[46:47], v[186:187], v[226:227], v[46:47] op_sel:[0,1,0] op_sel_hi:[1,1,1]
  v_pk_mul_f32 v[100:101], v[40:41], v[40:41]
  v_pk_mul_f32 v[102:103], v[42:43], v[42:43]
  v_pk_mul_f32 v[104:105], v[44:45], v[44:45]
  v_pk_mul_f32 v[106:107], v[46:47], v[46:47]
  v_pk_fma_f32 v[100:101], v[100:101], s[44:45], v[230:231]
  v_pk_fma_f32 v[102:103], v[102:103], s[44:45], v[230:231]
  v_pk_fma_f32 v[104:105], v[104:105], s[44:45], v[230:231]
  v_pk_fma_f32 v[106:107], v[106:107], s[44:45], v[230:231]
  v_pk_mul_f32 v[100:101], v[100:101], v[40:41]
  v_pk_mul_f32 v[102:103], v[102:103], v[42:43]
  v_pk_mul_f32 v[104:105], v[104:105], v[44:45]
  v_pk_mul_f32 v[106:107], v[106:107], v[46:47]
  v_exp_f32 v100, v100
  v_exp_f32 v101, v101
  v_exp_f32 v102, v102
  v_exp_f32 v103, v103
  v_exp_f32 v104, v104
  v_exp_f32 v105, v105
  v_exp_f32 v106, v106
  v_exp_f32 v107, v107
  v_pk_add_f32 v[100:101], v[100:101], s[46:47]
  v_pk_add_f32 v[102:103], v[102:103], s[46:47]
  v_pk_add_f32 v[104:105], v[104:105], s[46:47]
  v_pk_add_f32 v[106:107], v[106:107], s[46:47]
  v_rcp_f32 v100, v100
  v_rcp_f32 v101, v101
  v_rcp_f32 v102, v102
  v_rcp_f32 v103, v103
  v_rcp_f32 v104, v104
  v_rcp_f32 v105, v105
  v_rcp_f32 v106, v106
  v_rcp_f32 v107, v107
  v_pk_mul_f32 v[40:41], v[40:41], v[100:101]
  v_pk_mul_f32 v[42:43], v[42:43], v[102:103]
  v_pk_mul_f32 v[44:45], v[44:45], v[104:105]
  v_pk_mul_f32 v[46:47], v[46:47], v[106:107]
  v_cvt_pk_bf16_f32 v80, v40, v41
  v_cvt_pk_bf16_f32 v81, v42, v43
  v_cvt_pk_bf16_f32 v82, v44, v45
  v_cvt_pk_bf16_f32 v83, v46, v47
  buffer_store_dwordx4 v[80:83], v221, s[8:11], s28 offen offset:1024
  v_pk_mul_f32 v[48:49], v[48:49], v[226:227] op_sel_hi:[1,0]
  v_pk_mul_f32 v[50:51], v[50:51], v[226:227] op_sel_hi:[1,0]
  v_pk_mul_f32 v[52:53], v[52:53], v[226:227] op_sel_hi:[1,0]
  v_pk_mul_f32 v[54:55], v[54:55], v[226:227] op_sel_hi:[1,0]
  v_pk_fma_f32 v[48:49], v[188:189], v[226:227], v[48:49] op_sel:[0,1,0] op_sel_hi:[1,1,1]
  v_pk_fma_f32 v[50:51], v[190:191], v[226:227], v[50:51] op_sel:[0,1,0] op_sel_hi:[1,1,1]
  v_pk_fma_f32 v[52:53], v[192:193], v[226:227], v[52:53] op_sel:[0,1,0] op_sel_hi:[1,1,1]
  v_pk_fma_f32 v[54:55], v[194:195], v[226:227], v[54:55] op_sel:[0,1,0] op_sel_hi:[1,1,1]
  v_pk_mul_f32 v[100:101], v[48:49], v[48:49]
  v_pk_mul_f32 v[102:103], v[50:51], v[50:51]
  v_pk_mul_f32 v[104:105], v[52:53], v[52:53]
  v_pk_mul_f32 v[106:107], v[54:55], v[54:55]
  v_pk_fma_f32 v[100:101], v[100:101], s[44:45], v[230:231]
  v_pk_fma_f32 v[102:103], v[102:103], s[44:45], v[230:231]
  v_pk_fma_f32 v[104:105], v[104:105], s[44:45], v[230:231]
  v_pk_fma_f32 v[106:107], v[106:107], s[44:45], v[230:231]
  v_pk_mul_f32 v[100:101], v[100:101], v[48:49]
  v_pk_mul_f32 v[102:103], v[102:103], v[50:51]
  v_pk_mul_f32 v[104:105], v[104:105], v[52:53]
  v_pk_mul_f32 v[106:107], v[106:107], v[54:55]
  v_exp_f32 v100, v100
  v_exp_f32 v101, v101
  v_exp_f32 v102, v102
  v_exp_f32 v103, v103
  v_exp_f32 v104, v104
  v_exp_f32 v105, v105
  v_exp_f32 v106, v106
  v_exp_f32 v107, v107
  v_pk_add_f32 v[100:101], v[100:101], s[46:47]
  v_pk_add_f32 v[102:103], v[102:103], s[46:47]
  v_pk_add_f32 v[104:105], v[104:105], s[46:47]
  v_pk_add_f32 v[106:107], v[106:107], s[46:47]
  v_rcp_f32 v100, v100
  v_rcp_f32 v101, v101
  v_rcp_f32 v102, v102
  v_rcp_f32 v103, v103
  v_rcp_f32 v104, v104
  v_rcp_f32 v105, v105
  v_rcp_f32 v106, v106
  v_rcp_f32 v107, v107
  v_pk_mul_f32 v[48:49], v[48:49], v[100:101]
  v_pk_mul_f32 v[50:51], v[50:51], v[102:103]
  v_pk_mul_f32 v[52:53], v[52:53], v[104:105]
  v_pk_mul_f32 v[54:55], v[54:55], v[106:107]
  v_cvt_pk_bf16_f32 v84, v48, v49
  v_cvt_pk_bf16_f32 v85, v50, v51
  v_cvt_pk_bf16_f32 v86, v52, v53
  v_cvt_pk_bf16_f32 v87, v54, v55
  buffer_store_dwordx4 v[84:87], v221, s[8:11], s28 offen offset:2048
  s_lshl_b32 s22, s43, 7
  s_lshr_b32 s23, s17, 1
  s_lshl_b32 s23, s23, 2
  s_add_u32 s22, s22, s23
  s_lshl_b32 s23, s19, 3
  s_add_u32 s22, s22, s23
  s_add_u32 s22, s22, 0xec000
  v_lshlrev_b32 v212, 7, v2
  v_add_u32 v212, s22, v212
  v_mov_b32 v213, 1
  s_waitcnt vmcnt(0)
  s_mov_b64 exec, 3
  buffer_store_dword v213, v212, s[8:11], 0 offen
  s_mov_b64 exec, -1
kb_kernel_fj_22:
  s_barrier
  s_add_u32 s24, s20, s42
  s_lshl_b32 s28, s24, 9
  s_lshr_b32 s22, s19, 1
  s_mul_i32 s22, s22, 5120
  s_lshl_b32 s23, s42, 3
  s_add_u32 s22, s22, s23
  s_add_u32 s29, s22, 2048
  s_add_u32 s25, s20, 4
  s_cmp_eq_u32 s42, 0
  s_cselect_b32 s25, s25, s20
  v_and_b32 v212, 0x30, v2
  s_lshl_b32 s24, s24, 6
  s_lshl_b32 s25, s25, 6
  v_add_u32 v234, s24, v212
  v_add_u32 v235, s25, v212
  s_mul_i32 s22, s27, 20480
  v_add_u32 v236, s22, v1
  s_lshl_b32 s22, s17, 12
  s_add_u32 s22, s22, 81920
  v_add_u32 v239, s22, v1
  v_add_u32 v240, 65536, v239
  v_mov_b32 v232, v1
  v_add_u32 v233, 65536, v232
  s_mov_b32 s26, 12800
  buffer_load_dwordx4 v[172:175], v234, s[8:11], s26 offen offset:0
  buffer_load_dwordx4 v[176:179], v234, s[8:11], s26 offen offset:64
  buffer_load_dwordx4 v[180:183], v234, s[8:11], s26 offen offset:128
  buffer_load_dwordx4 v[184:187], v234, s[8:11], s26 offen offset:192
  buffer_load_dwordx4 v[188:191], v235, s[8:11], s26 offen offset:0
  s_barrier
  ds_read_b128 v[60:63], v240 offset:0
  ds_read_b128 v[64:67], v232 offset:61440
  ds_read_b128 v[68:71], v232 offset:62464
  ds_read_b128 v[72:75], v232 offset:63488
  ds_read_b128 v[76:79], v232 offset:64512
  ds_read_b128 v[80:83], v233 offset:0
  ds_read_b128 v[84:87], v240 offset:1024
  ds_read_b128 v[88:91], v233 offset:1024
  ds_read_b128 v[92:95], v233 offset:2048
  ds_read_b128 v[96:99], v233 offset:3072
  ds_read_b128 v[100:103], v233 offset:4096
  ds_read_b128 v[104:107], v233 offset:5120
  s_waitcnt lgkmcnt(6)
  v_mfma_f32_16x16x32_bf16 v[4:7], v[64:67], v[60:63], 0
  ds_read_b128 v[108:111], v240 offset:2048
  ds_read_b128 v[112:115], v233 offset:6144
  v_mfma_f32_16x16x32_bf16 v[8:11], v[68:71], v[60:63], 0
  ds_read_b128 v[116:119], v233 offset:7168
  ds_read_b128 v[120:123], v233 offset:8192
  v_mfma_f32_16x16x32_bf16 v[12:15], v[72:75], v[60:63], 0
  ds_read_b128 v[124:127], v233 offset:9216
  ds_read_b128 v[128:131], v233 offset:10240
  v_mfma_f32_16x16x32_bf16 v[16:19], v[76:79], v[60:63], 0
  v_mfma_f32_16x16x32_bf16 v[20:23], v[80:83], v[60:63], 0
  s_waitcnt lgkmcnt(6)
  v_mfma_f32_16x16x32_bf16 v[4:7], v[88:91], v[84:87], v[4:7]
  ds_read_b128 v[60:63], v240 offset:3072
  ds_read_b128 v[64:67], v233 offset:11264
  s_waitcnt vmcnt(0)
  v_mfma_f32_16x16x32_bf16 v[8:11], v[92:95], v[84:87], v[8:11]
  ds_read_b128 v[68:71], v233 offset:12288
  ds_read_b128 v[72:75], v233 offset:13312
  v_fmac_f32 v132, v152, v172
  v_mfma_f32_16x16x32_bf16 v[12:15], v[96:99], v[84:87], v[12:15]
  ds_read_b128 v[76:79], v233 offset:14336
  ds_read_b128 v[80:83], v233 offset:15360
  v_fmac_f32 v133, v153, v173
  v_mfma_f32_16x16x32_bf16 v[16:19], v[100:103], v[84:87], v[16:19]
  v_fmac_f32 v134, v154, v174
  v_mfma_f32_16x16x32_bf16 v[20:23], v[104:107], v[84:87], v[20:23]
  v_fmac_f32 v135, v155, v175
  s_waitcnt lgkmcnt(0)
  s_barrier
  v_mfma_f32_16x16x32_bf16 v[4:7], v[112:115], v[108:111], v[4:7]
  ds_read_b128 v[84:87], v239 offset:0
  ds_read_b128 v[88:91], v232 offset:0
  v_fmac_f32 v136, v156, v176
  v_mfma_f32_16x16x32_bf16 v[8:11], v[116:119], v[108:111], v[8:11]
  ds_read_b128 v[92:95], v232 offset:1024
  ds_read_b128 v[96:99], v232 offset:2048
  v_fmac_f32 v137, v157, v177
  v_mfma_f32_16x16x32_bf16 v[12:15], v[120:123], v[108:111], v[12:15]
  ds_read_b128 v[100:103], v232 offset:3072
  ds_read_b128 v[104:107], v232 offset:4096
  v_fmac_f32 v138, v158, v178
  v_mfma_f32_16x16x32_bf16 v[16:19], v[124:127], v[108:111], v[16:19]
  v_fmac_f32 v139, v159, v179
  v_mfma_f32_16x16x32_bf16 v[20:23], v[128:131], v[108:111], v[20:23]
  v_fmac_f32 v140, v160, v180
  s_waitcnt lgkmcnt(6)
  v_mfma_f32_16x16x32_bf16 v[4:7], v[64:67], v[60:63], v[4:7]
  ds_read_b128 v[108:111], v239 offset:1024
  ds_read_b128 v[112:115], v232 offset:5120
  v_fmac_f32 v141, v161, v181
  v_mfma_f32_16x16x32_bf16 v[8:11], v[68:71], v[60:63], v[8:11]
  ds_read_b128 v[116:119], v232 offset:6144
  ds_read_b128 v[120:123], v232 offset:7168
  v_fmac_f32 v142, v162, v182
  v_mfma_f32_16x16x32_bf16 v[12:15], v[72:75], v[60:63], v[12:15]
  ds_read_b128 v[124:127], v232 offset:8192
  ds_read_b128 v[128:131], v232 offset:9216
  v_fmac_f32 v143, v163, v183
  v_mfma_f32_16x16x32_bf16 v[16:19], v[76:79], v[60:63], v[16:19]
  v_fmac_f32 v144, v164, v184
  v_mfma_f32_16x16x32_bf16 v[20:23], v[80:83], v[60:63], v[20:23]
  v_fmac_f32 v145, v165, v185
  s_waitcnt lgkmcnt(6)
  v_mfma_f32_16x16x32_bf16 v[4:7], v[88:91], v[84:87], v[4:7]
  ds_read_b128 v[60:63], v239 offset:2048
  ds_read_b128 v[64:67], v232 offset:10240
  v_fmac_f32 v146, v166, v186
  v_mfma_f32_16x16x32_bf16 v[8:11], v[92:95], v[84:87], v[8:11]
  ds_read_b128 v[68:71], v232 offset:11264
  ds_read_b128 v[72:75], v232 offset:12288
  v_fmac_f32 v147, v167, v187
  v_mfma_f32_16x16x32_bf16 v[12:15], v[96:99], v[84:87], v[12:15]
  ds_read_b128 v[76:79], v232 offset:13312
  ds_read_b128 v[80:83], v232 offset:14336
  v_fmac_f32 v148, v168, v188
  v_mfma_f32_16x16x32_bf16 v[16:19], v[100:103], v[84:87], v[16:19]
  v_fmac_f32 v149, v169, v189
  v_mfma_f32_16x16x32_bf16 v[20:23], v[104:107], v[84:87], v[20:23]
  v_fmac_f32 v150, v170, v190
  s_waitcnt lgkmcnt(6)
  v_mfma_f32_16x16x32_bf16 v[4:7], v[112:115], v[108:111], v[4:7]
  ds_read_b128 v[84:87], v239 offset:3072
  ds_read_b128 v[88:91], v232 offset:15360
  v_fmac_f32 v151, v171, v191
  v_mfma_f32_16x16x32_bf16 v[8:11], v[116:119], v[108:111], v[8:11]
  ds_read_b128 v[92:95], v232 offset:16384
  ds_read_b128 v[96:99], v232 offset:17408
  v_mfma_f32_16x16x32_bf16 v[12:15], v[120:123], v[108:111], v[12:15]
  ds_read_b128 v[100:103], v232 offset:18432
  ds_read_b128 v[104:107], v232 offset:19456
  v_mfma_f32_16x16x32_bf16 v[16:19], v[124:127], v[108:111], v[16:19]
  v_mfma_f32_16x16x32_bf16 v[20:23], v[128:131], v[108:111], v[20:23]
  s_waitcnt lgkmcnt(0)
  s_barrier
  v_mfma_f32_16x16x32_bf16 v[4:7], v[64:67], v[60:63], v[4:7]
  ds_read_b128 v[108:111], v239 offset:16384
  ds_read_b128 v[112:115], v232 offset:20480
  v_mfma_f32_16x16x32_bf16 v[8:11], v[68:71], v[60:63], v[8:11]
  ds_read_b128 v[116:119], v232 offset:21504
  ds_read_b128 v[120:123], v232 offset:22528
  v_mfma_f32_16x16x32_bf16 v[12:15], v[72:75], v[60:63], v[12:15]
  ds_read_b128 v[124:127], v232 offset:23552
  ds_read_b128 v[128:131], v232 offset:24576
  v_mfma_f32_16x16x32_bf16 v[16:19], v[76:79], v[60:63], v[16:19]
  v_mfma_f32_16x16x32_bf16 v[20:23], v[80:83], v[60:63], v[20:23]
  s_waitcnt lgkmcnt(6)
  v_mfma_f32_16x16x32_bf16 v[4:7], v[88:91], v[84:87], v[4:7]
  ds_read_b128 v[60:63], v239 offset:17408
  ds_read_b128 v[64:67], v232 offset:25600
  v_mfma_f32_16x16x32_bf16 v[8:11], v[92:95], v[84:87], v[8:11]
  ds_read_b128 v[68:71], v232 offset:26624
  ds_read_b128 v[72:75], v232 offset:27648
  v_mfma_f32_16x16x32_bf16 v[12:15], v[96:99], v[84:87], v[12:15]
  ds_read_b128 v[76:79], v232 offset:28672
  ds_read_b128 v[80:83], v232 offset:29696
  v_mfma_f32_16x16x32_bf16 v[16:19], v[100:103], v[84:87], v[16:19]
  v_mfma_f32_16x16x32_bf16 v[20:23], v[104:107], v[84:87], v[20:23]
  s_waitcnt lgkmcnt(6)
  v_mfma_f32_16x16x32_bf16 v[4:7], v[112:115], v[108:111], v[4:7]
  ds_read_b128 v[84:87], v239 offset:18432
  ds_read_b128 v[88:91], v232 offset:30720
  v_mfma_f32_16x16x32_bf16 v[8:11], v[116:119], v[108:111], v[8:11]
  ds_read_b128 v[92:95], v232 offset:31744
  ds_read_b128 v[96:99], v232 offset:32768
  v_mfma_f32_16x16x32_bf16 v[12:15], v[120:123], v[108:111], v[12:15]
  ds_read_b128 v[100:103], v232 offset:33792
  ds_read_b128 v[104:107], v232 offset:34816
  v_mfma_f32_16x16x32_bf16 v[16:19], v[124:127], v[108:111], v[16:19]
  v_mfma_f32_16x16x32_bf16 v[20:23], v[128:131], v[108:111], v[20:23]
  s_waitcnt lgkmcnt(6)
  v_mfma_f32_16x16x32_bf16 v[4:7], v[64:67], v[60:63], v[4:7]
  ds_read_b128 v[108:111], v239 offset:19456
  ds_read_b128 v[112:115], v232 offset:35840
  v_mfma_f32_16x16x32_bf16 v[8:11], v[68:71], v[60:63], v[8:11]
  ds_read_b128 v[116:119], v232 offset:36864
  ds_read_b128 v[120:123], v232 offset:37888
  v_mfma_f32_16x16x32_bf16 v[12:15], v[72:75], v[60:63], v[12:15]
  ds_read_b128 v[124:127], v232 offset:38912
  ds_read_b128 v[128:131], v232 offset:39936
  v_mfma_f32_16x16x32_bf16 v[16:19], v[76:79], v[60:63], v[16:19]
  v_mfma_f32_16x16x32_bf16 v[20:23], v[80:83], v[60:63], v[20:23]
  s_waitcnt lgkmcnt(0)
  s_barrier
  v_mfma_f32_16x16x32_bf16 v[4:7], v[88:91], v[84:87], v[4:7]
  ds_read_b128 v[60:63], v239 offset:32768
  ds_read_b128 v[64:67], v232 offset:40960
  v_mfma_f32_16x16x32_bf16 v[8:11], v[92:95], v[84:87], v[8:11]
  ds_read_b128 v[68:71], v232 offset:41984
  ds_read_b128 v[72:75], v232 offset:43008
  v_mfma_f32_16x16x32_bf16 v[12:15], v[96:99], v[84:87], v[12:15]
  ds_read_b128 v[76:79], v232 offset:44032
  ds_read_b128 v[80:83], v232 offset:45056
  v_mfma_f32_16x16x32_bf16 v[16:19], v[100:103], v[84:87], v[16:19]
  v_mfma_f32_16x16x32_bf16 v[20:23], v[104:107], v[84:87], v[20:23]
  s_waitcnt lgkmcnt(6)
  v_mfma_f32_16x16x32_bf16 v[4:7], v[112:115], v[108:111], v[4:7]
  ds_read_b128 v[84:87], v239 offset:33792
  ds_read_b128 v[88:91], v232 offset:46080
  v_mfma_f32_16x16x32_bf16 v[8:11], v[116:119], v[108:111], v[8:11]
  ds_read_b128 v[92:95], v232 offset:47104
  ds_read_b128 v[96:99], v232 offset:48128
  v_mfma_f32_16x16x32_bf16 v[12:15], v[120:123], v[108:111], v[12:15]
  ds_read_b128 v[100:103], v232 offset:49152
  ds_read_b128 v[104:107], v232 offset:50176
  v_mfma_f32_16x16x32_bf16 v[16:19], v[124:127], v[108:111], v[16:19]
  v_mfma_f32_16x16x32_bf16 v[20:23], v[128:131], v[108:111], v[20:23]
  s_waitcnt lgkmcnt(6)
  v_mfma_f32_16x16x32_bf16 v[4:7], v[64:67], v[60:63], v[4:7]
  ds_read_b128 v[108:111], v239 offset:34816
  ds_read_b128 v[112:115], v232 offset:51200
  v_mfma_f32_16x16x32_bf16 v[8:11], v[68:71], v[60:63], v[8:11]
  ds_read_b128 v[116:119], v232 offset:52224
  ds_read_b128 v[120:123], v232 offset:53248
  v_mfma_f32_16x16x32_bf16 v[12:15], v[72:75], v[60:63], v[12:15]
  ds_read_b128 v[124:127], v232 offset:54272
  ds_read_b128 v[128:131], v232 offset:55296
  v_mfma_f32_16x16x32_bf16 v[16:19], v[76:79], v[60:63], v[16:19]
  v_mfma_f32_16x16x32_bf16 v[20:23], v[80:83], v[60:63], v[20:23]
  s_waitcnt lgkmcnt(6)
  v_mfma_f32_16x16x32_bf16 v[4:7], v[88:91], v[84:87], v[4:7]
  ds_read_b128 v[60:63], v239 offset:35840
  ds_read_b128 v[64:67], v232 offset:56320
  v_mfma_f32_16x16x32_bf16 v[8:11], v[92:95], v[84:87], v[8:11]
  ds_read_b128 v[68:71], v232 offset:57344
  ds_read_b128 v[72:75], v232 offset:58368
  v_mfma_f32_16x16x32_bf16 v[12:15], v[96:99], v[84:87], v[12:15]
  ds_read_b128 v[76:79], v232 offset:59392
  ds_read_b128 v[80:83], v232 offset:60416
  v_mfma_f32_16x16x32_bf16 v[16:19], v[100:103], v[84:87], v[16:19]
  v_mfma_f32_16x16x32_bf16 v[20:23], v[104:107], v[84:87], v[20:23]
  s_waitcnt lgkmcnt(0)
  s_barrier
  v_mfma_f32_16x16x32_bf16 v[4:7], v[112:115], v[108:111], v[4:7]
  ds_read_b128 v[84:87], v239 offset:49152
  ds_read_b128 v[88:91], v232 offset:61440
  v_mfma_f32_16x16x32_bf16 v[8:11], v[116:119], v[108:111], v[8:11]
  ds_read_b128 v[92:95], v232 offset:62464
  ds_read_b128 v[96:99], v232 offset:63488
  v_mfma_f32_16x16x32_bf16 v[12:15], v[120:123], v[108:111], v[12:15]
  ds_read_b128 v[100:103], v232 offset:64512
  ds_read_b128 v[104:107], v233 offset:0
  v_mfma_f32_16x16x32_bf16 v[16:19], v[124:127], v[108:111], v[16:19]
  v_mfma_f32_16x16x32_bf16 v[20:23], v[128:131], v[108:111], v[20:23]
  s_waitcnt lgkmcnt(6)
  v_mfma_f32_16x16x32_bf16 v[4:7], v[64:67], v[60:63], v[4:7]
  ds_read_b128 v[108:111], v239 offset:50176
  ds_read_b128 v[112:115], v233 offset:1024
  v_mfma_f32_16x16x32_bf16 v[8:11], v[68:71], v[60:63], v[8:11]
  ds_read_b128 v[116:119], v233 offset:2048
  ds_read_b128 v[120:123], v233 offset:3072
  v_mfma_f32_16x16x32_bf16 v[12:15], v[72:75], v[60:63], v[12:15]
  ds_read_b128 v[124:127], v233 offset:4096
  ds_read_b128 v[128:131], v233 offset:5120
  v_mfma_f32_16x16x32_bf16 v[16:19], v[76:79], v[60:63], v[16:19]
  v_mfma_f32_16x16x32_bf16 v[20:23], v[80:83], v[60:63], v[20:23]
  s_waitcnt lgkmcnt(6)
  v_mfma_f32_16x16x32_bf16 v[4:7], v[88:91], v[84:87], v[4:7]
  ds_read_b128 v[60:63], v239 offset:51200
  ds_read_b128 v[64:67], v233 offset:6144
  v_mfma_f32_16x16x32_bf16 v[8:11], v[92:95], v[84:87], v[8:11]
  ds_read_b128 v[68:71], v233 offset:7168
  ds_read_b128 v[72:75], v233 offset:8192
  v_mfma_f32_16x16x32_bf16 v[12:15], v[96:99], v[84:87], v[12:15]
  ds_read_b128 v[76:79], v233 offset:9216
  ds_read_b128 v[80:83], v233 offset:10240
  v_mfma_f32_16x16x32_bf16 v[16:19], v[100:103], v[84:87], v[16:19]
  v_mfma_f32_16x16x32_bf16 v[20:23], v[104:107], v[84:87], v[20:23]
  s_waitcnt lgkmcnt(6)
  v_mfma_f32_16x16x32_bf16 v[4:7], v[112:115], v[108:111], v[4:7]
  ds_read_b128 v[84:87], v239 offset:52224
  ds_read_b128 v[88:91], v233 offset:11264
  v_mfma_f32_16x16x32_bf16 v[8:11], v[116:119], v[108:111], v[8:11]
  ds_read_b128 v[92:95], v233 offset:12288
  ds_read_b128 v[96:99], v233 offset:13312
  v_mfma_f32_16x16x32_bf16 v[12:15], v[120:123], v[108:111], v[12:15]
  ds_read_b128 v[100:103], v233 offset:14336
  ds_read_b128 v[104:107], v233 offset:15360
  v_mfma_f32_16x16x32_bf16 v[16:19], v[124:127], v[108:111], v[16:19]
  v_mfma_f32_16x16x32_bf16 v[20:23], v[128:131], v[108:111], v[20:23]
  s_waitcnt lgkmcnt(0)
  s_barrier
  v_mfma_f32_16x16x32_bf16 v[4:7], v[64:67], v[60:63], v[4:7]
  ds_read_b128 v[108:111], v240 offset:0
  ds_read_b128 v[112:115], v232 offset:0
  v_mfma_f32_16x16x32_bf16 v[8:11], v[68:71], v[60:63], v[8:11]
  ds_read_b128 v[116:119], v232 offset:1024
  ds_read_b128 v[120:123], v232 offset:2048
  v_mfma_f32_16x16x32_bf16 v[12:15], v[72:75], v[60:63], v[12:15]
  ds_read_b128 v[124:127], v232 offset:3072
  ds_read_b128 v[128:131], v232 offset:4096
  v_mfma_f32_16x16x32_bf16 v[16:19], v[76:79], v[60:63], v[16:19]
  v_mfma_f32_16x16x32_bf16 v[20:23], v[80:83], v[60:63], v[20:23]
  s_waitcnt lgkmcnt(6)
  v_mfma_f32_16x16x32_bf16 v[4:7], v[88:91], v[84:87], v[4:7]
  ds_read_b128 v[60:63], v240 offset:1024
  ds_read_b128 v[64:67], v232 offset:5120
  v_mfma_f32_16x16x32_bf16 v[8:11], v[92:95], v[84:87], v[8:11]
  ds_read_b128 v[68:71], v232 offset:6144
  ds_read_b128 v[72:75], v232 offset:7168
  v_mfma_f32_16x16x32_bf16 v[12:15], v[96:99], v[84:87], v[12:15]
  ds_read_b128 v[76:79], v232 offset:8192
  ds_read_b128 v[80:83], v232 offset:9216
  v_mfma_f32_16x16x32_bf16 v[16:19], v[100:103], v[84:87], v[16:19]
  v_mfma_f32_16x16x32_bf16 v[20:23], v[104:107], v[84:87], v[20:23]
  s_waitcnt lgkmcnt(6)
  v_mfma_f32_16x16x32_bf16 v[4:7], v[112:115], v[108:111], v[4:7]
  ds_read_b128 v[84:87], v240 offset:2048
  ds_read_b128 v[88:91], v232 offset:10240
  v_mfma_f32_16x16x32_bf16 v[8:11], v[116:119], v[108:111], v[8:11]
  ds_read_b128 v[92:95], v232 offset:11264
  ds_read_b128 v[96:99], v232 offset:12288
  v_mfma_f32_16x16x32_bf16 v[12:15], v[120:123], v[108:111], v[12:15]
  ds_read_b128 v[100:103], v232 offset:13312
  ds_read_b128 v[104:107], v232 offset:14336
  v_mfma_f32_16x16x32_bf16 v[16:19], v[124:127], v[108:111], v[16:19]
  v_mfma_f32_16x16x32_bf16 v[20:23], v[128:131], v[108:111], v[20:23]
  s_waitcnt lgkmcnt(6)
  v_mfma_f32_16x16x32_bf16 v[4:7], v[64:67], v[60:63], v[4:7]
  ds_read_b128 v[108:111], v240 offset:3072
  ds_read_b128 v[112:115], v232 offset:15360
  v_mfma_f32_16x16x32_bf16 v[8:11], v[68:71], v[60:63], v[8:11]
  ds_read_b128 v[116:119], v232 offset:16384
  ds_read_b128 v[120:123], v232 offset:17408
  v_mfma_f32_16x16x32_bf16 v[12:15], v[72:75], v[60:63], v[12:15]
  ds_read_b128 v[124:127], v232 offset:18432
  ds_read_b128 v[128:131], v232 offset:19456
  v_mfma_f32_16x16x32_bf16 v[16:19], v[76:79], v[60:63], v[16:19]
  v_mfma_f32_16x16x32_bf16 v[20:23], v[80:83], v[60:63], v[20:23]
  s_waitcnt lgkmcnt(0)
  s_barrier
  v_mfma_f32_16x16x32_bf16 v[4:7], v[88:91], v[84:87], v[4:7]
  ds_read_b128 v[60:63], v239 offset:0
  ds_read_b128 v[64:67], v232 offset:20480
  v_mfma_f32_16x16x32_bf16 v[8:11], v[92:95], v[84:87], v[8:11]
  ds_read_b128 v[68:71], v232 offset:21504
  ds_read_b128 v[72:75], v232 offset:22528
  v_mfma_f32_16x16x32_bf16 v[12:15], v[96:99], v[84:87], v[12:15]
  ds_read_b128 v[76:79], v232 offset:23552
  ds_read_b128 v[80:83], v232 offset:24576
  v_mfma_f32_16x16x32_bf16 v[16:19], v[100:103], v[84:87], v[16:19]
  v_mfma_f32_16x16x32_bf16 v[20:23], v[104:107], v[84:87], v[20:23]
  s_waitcnt lgkmcnt(6)
  v_mfma_f32_16x16x32_bf16 v[4:7], v[112:115], v[108:111], v[4:7]
  ds_read_b128 v[84:87], v239 offset:1024
  ds_read_b128 v[88:91], v232 offset:25600
  v_mfma_f32_16x16x32_bf16 v[8:11], v[116:119], v[108:111], v[8:11]
  ds_read_b128 v[92:95], v232 offset:26624
  ds_read_b128 v[96:99], v232 offset:27648
  v_mfma_f32_16x16x32_bf16 v[12:15], v[120:123], v[108:111], v[12:15]
  ds_read_b128 v[100:103], v232 offset:28672
  ds_read_b128 v[104:107], v232 offset:29696
  v_mfma_f32_16x16x32_bf16 v[16:19], v[124:127], v[108:111], v[16:19]
  v_mfma_f32_16x16x32_bf16 v[20:23], v[128:131], v[108:111], v[20:23]
  s_waitcnt lgkmcnt(6)
  v_mfma_f32_16x16x32_bf16 v[4:7], v[64:67], v[60:63], v[4:7]
  ds_read_b128 v[108:111], v239 offset:2048
  ds_read_b128 v[112:115], v232 offset:30720
  v_mfma_f32_16x16x32_bf16 v[8:11], v[68:71], v[60:63], v[8:11]
  ds_read_b128 v[116:119], v232 offset:31744
  ds_read_b128 v[120:123], v232 offset:32768
  v_mfma_f32_16x16x32_bf16 v[12:15], v[72:75], v[60:63], v[12:15]
  ds_read_b128 v[124:127], v232 offset:33792
  ds_read_b128 v[128:131], v232 offset:34816
  v_mfma_f32_16x16x32_bf16 v[16:19], v[76:79], v[60:63], v[16:19]
  v_mfma_f32_16x16x32_bf16 v[20:23], v[80:83], v[60:63], v[20:23]
  s_waitcnt lgkmcnt(6)
  v_mfma_f32_16x16x32_bf16 v[4:7], v[88:91], v[84:87], v[4:7]
  ds_read_b128 v[60:63], v239 offset:3072
  ds_read_b128 v[64:67], v232 offset:35840
  v_mfma_f32_16x16x32_bf16 v[8:11], v[92:95], v[84:87], v[8:11]
  ds_read_b128 v[68:71], v232 offset:36864
  ds_read_b128 v[72:75], v232 offset:37888
  v_mfma_f32_16x16x32_bf16 v[12:15], v[96:99], v[84:87], v[12:15]
  ds_read_b128 v[76:79], v232 offset:38912
  ds_read_b128 v[80:83], v232 offset:39936
  v_mfma_f32_16x16x32_bf16 v[16:19], v[100:103], v[84:87], v[16:19]
  v_mfma_f32_16x16x32_bf16 v[20:23], v[104:107], v[84:87], v[20:23]
  s_waitcnt lgkmcnt(0)
  s_barrier
  v_mfma_f32_16x16x32_bf16 v[4:7], v[112:115], v[108:111], v[4:7]
  ds_read_b128 v[84:87], v239 offset:16384
  ds_read_b128 v[88:91], v232 offset:40960
  v_mfma_f32_16x16x32_bf16 v[8:11], v[116:119], v[108:111], v[8:11]
  ds_read_b128 v[92:95], v232 offset:41984
  ds_read_b128 v[96:99], v232 offset:43008
  v_mfma_f32_16x16x32_bf16 v[12:15], v[120:123], v[108:111], v[12:15]
  ds_read_b128 v[100:103], v232 offset:44032
  ds_read_b128 v[104:107], v232 offset:45056
  v_mfma_f32_16x16x32_bf16 v[16:19], v[124:127], v[108:111], v[16:19]
  v_mfma_f32_16x16x32_bf16 v[20:23], v[128:131], v[108:111], v[20:23]
  s_waitcnt lgkmcnt(6)
  v_mfma_f32_16x16x32_bf16 v[4:7], v[64:67], v[60:63], v[4:7]
  ds_read_b128 v[108:111], v239 offset:17408
  ds_read_b128 v[112:115], v232 offset:46080
  v_mfma_f32_16x16x32_bf16 v[8:11], v[68:71], v[60:63], v[8:11]
  ds_read_b128 v[116:119], v232 offset:47104
  ds_read_b128 v[120:123], v232 offset:48128
  v_mfma_f32_16x16x32_bf16 v[12:15], v[72:75], v[60:63], v[12:15]
  ds_read_b128 v[124:127], v232 offset:49152
  ds_read_b128 v[128:131], v232 offset:50176
  v_mfma_f32_16x16x32_bf16 v[16:19], v[76:79], v[60:63], v[16:19]
  v_mfma_f32_16x16x32_bf16 v[20:23], v[80:83], v[60:63], v[20:23]
  s_waitcnt lgkmcnt(6)
  v_mfma_f32_16x16x32_bf16 v[4:7], v[88:91], v[84:87], v[4:7]
  ds_read_b128 v[60:63], v239 offset:18432
  ds_read_b128 v[64:67], v232 offset:51200
  v_mfma_f32_16x16x32_bf16 v[8:11], v[92:95], v[84:87], v[8:11]
  ds_read_b128 v[68:71], v232 offset:52224
  ds_read_b128 v[72:75], v232 offset:53248
  v_mfma_f32_16x16x32_bf16 v[12:15], v[96:99], v[84:87], v[12:15]
  ds_read_b128 v[76:79], v232 offset:54272
  ds_read_b128 v[80:83], v232 offset:55296
  v_mfma_f32_16x16x32_bf16 v[16:19], v[100:103], v[84:87], v[16:19]
  v_mfma_f32_16x16x32_bf16 v[20:23], v[104:107], v[84:87], v[20:23]
  s_waitcnt lgkmcnt(6)
  v_mfma_f32_16x16x32_bf16 v[4:7], v[112:115], v[108:111], v[4:7]
  ds_read_b128 v[84:87], v239 offset:19456
  ds_read_b128 v[88:91], v232 offset:56320
  v_mfma_f32_16x16x32_bf16 v[8:11], v[116:119], v[108:111], v[8:11]
  ds_read_b128 v[92:95], v232 offset:57344
  ds_read_b128 v[96:99], v232 offset:58368
  v_mfma_f32_16x16x32_bf16 v[12:15], v[120:123], v[108:111], v[12:15]
  ds_read_b128 v[100:103], v232 offset:59392
  ds_read_b128 v[104:107], v232 offset:60416
  v_mfma_f32_16x16x32_bf16 v[16:19], v[124:127], v[108:111], v[16:19]
  v_mfma_f32_16x16x32_bf16 v[20:23], v[128:131], v[108:111], v[20:23]
  s_waitcnt lgkmcnt(0)
  s_barrier
  v_mfma_f32_16x16x32_bf16 v[4:7], v[64:67], v[60:63], v[4:7]
  ds_read_b128 v[108:111], v239 offset:32768
  ds_read_b128 v[112:115], v232 offset:61440
  v_mfma_f32_16x16x32_bf16 v[8:11], v[68:71], v[60:63], v[8:11]
  ds_read_b128 v[116:119], v232 offset:62464
  ds_read_b128 v[120:123], v232 offset:63488
  v_mfma_f32_16x16x32_bf16 v[12:15], v[72:75], v[60:63], v[12:15]
  ds_read_b128 v[124:127], v232 offset:64512
  ds_read_b128 v[128:131], v233 offset:0
  v_mfma_f32_16x16x32_bf16 v[16:19], v[76:79], v[60:63], v[16:19]
  v_mfma_f32_16x16x32_bf16 v[20:23], v[80:83], v[60:63], v[20:23]
  s_waitcnt lgkmcnt(6)
  v_mfma_f32_16x16x32_bf16 v[4:7], v[88:91], v[84:87], v[4:7]
  ds_read_b128 v[60:63], v239 offset:33792
  ds_read_b128 v[64:67], v233 offset:1024
  v_mfma_f32_16x16x32_bf16 v[8:11], v[92:95], v[84:87], v[8:11]
  ds_read_b128 v[68:71], v233 offset:2048
  ds_read_b128 v[72:75], v233 offset:3072
  v_mfma_f32_16x16x32_bf16 v[12:15], v[96:99], v[84:87], v[12:15]
  ds_read_b128 v[76:79], v233 offset:4096
  ds_read_b128 v[80:83], v233 offset:5120
  v_mfma_f32_16x16x32_bf16 v[16:19], v[100:103], v[84:87], v[16:19]
  v_mfma_f32_16x16x32_bf16 v[20:23], v[104:107], v[84:87], v[20:23]
  s_waitcnt lgkmcnt(6)
  v_mfma_f32_16x16x32_bf16 v[4:7], v[112:115], v[108:111], v[4:7]
  ds_read_b128 v[84:87], v239 offset:34816
  ds_read_b128 v[88:91], v233 offset:6144
  v_mfma_f32_16x16x32_bf16 v[8:11], v[116:119], v[108:111], v[8:11]
  ds_read_b128 v[92:95], v233 offset:7168
  ds_read_b128 v[96:99], v233 offset:8192
  v_mfma_f32_16x16x32_bf16 v[12:15], v[120:123], v[108:111], v[12:15]
  ds_read_b128 v[100:103], v233 offset:9216
  ds_read_b128 v[104:107], v233 offset:10240
  v_mfma_f32_16x16x32_bf16 v[16:19], v[124:127], v[108:111], v[16:19]
  v_mfma_f32_16x16x32_bf16 v[20:23], v[128:131], v[108:111], v[20:23]
  s_waitcnt lgkmcnt(6)
  v_mfma_f32_16x16x32_bf16 v[4:7], v[64:67], v[60:63], v[4:7]
  ds_read_b128 v[108:111], v239 offset:35840
  ds_read_b128 v[112:115], v233 offset:11264
  v_mfma_f32_16x16x32_bf16 v[8:11], v[68:71], v[60:63], v[8:11]
  ds_read_b128 v[116:119], v233 offset:12288
  ds_read_b128 v[120:123], v233 offset:13312
  v_mfma_f32_16x16x32_bf16 v[12:15], v[72:75], v[60:63], v[12:15]
  ds_read_b128 v[124:127], v233 offset:14336
  ds_read_b128 v[128:131], v233 offset:15360
  v_mfma_f32_16x16x32_bf16 v[16:19], v[76:79], v[60:63], v[16:19]
  v_mfma_f32_16x16x32_bf16 v[20:23], v[80:83], v[60:63], v[20:23]
  s_waitcnt lgkmcnt(0)
  s_barrier
  v_mfma_f32_16x16x32_bf16 v[4:7], v[88:91], v[84:87], v[4:7]
  ds_read_b128 v[60:63], v239 offset:49152
  ds_read_b128 v[64:67], v232 offset:0
  v_mfma_f32_16x16x32_bf16 v[8:11], v[92:95], v[84:87], v[8:11]
  ds_read_b128 v[68:71], v232 offset:1024
  ds_read_b128 v[72:75], v232 offset:2048
  v_mfma_f32_16x16x32_bf16 v[12:15], v[96:99], v[84:87], v[12:15]
  ds_read_b128 v[76:79], v232 offset:3072
  ds_read_b128 v[80:83], v232 offset:4096
  v_mfma_f32_16x16x32_bf16 v[16:19], v[100:103], v[84:87], v[16:19]
  v_mfma_f32_16x16x32_bf16 v[20:23], v[104:107], v[84:87], v[20:23]
  s_waitcnt lgkmcnt(6)
  v_mfma_f32_16x16x32_bf16 v[4:7], v[112:115], v[108:111], v[4:7]
  ds_read_b128 v[84:87], v239 offset:50176
  ds_read_b128 v[88:91], v232 offset:5120
  v_mfma_f32_16x16x32_bf16 v[8:11], v[116:119], v[108:111], v[8:11]
  ds_read_b128 v[92:95], v232 offset:6144
  ds_read_b128 v[96:99], v232 offset:7168
  v_mfma_f32_16x16x32_bf16 v[12:15], v[120:123], v[108:111], v[12:15]
  ds_read_b128 v[100:103], v232 offset:8192
  ds_read_b128 v[104:107], v232 offset:9216
  v_mfma_f32_16x16x32_bf16 v[16:19], v[124:127], v[108:111], v[16:19]
  v_mfma_f32_16x16x32_bf16 v[20:23], v[128:131], v[108:111], v[20:23]
  s_waitcnt lgkmcnt(6)
  v_mfma_f32_16x16x32_bf16 v[4:7], v[64:67], v[60:63], v[4:7]
  ds_read_b128 v[108:111], v239 offset:51200
  ds_read_b128 v[112:115], v232 offset:10240
  v_mfma_f32_16x16x32_bf16 v[8:11], v[68:71], v[60:63], v[8:11]
  ds_read_b128 v[116:119], v232 offset:11264
  ds_read_b128 v[120:123], v232 offset:12288
  v_mfma_f32_16x16x32_bf16 v[12:15], v[72:75], v[60:63], v[12:15]
  ds_read_b128 v[124:127], v232 offset:13312
  ds_read_b128 v[128:131], v232 offset:14336
  v_mfma_f32_16x16x32_bf16 v[16:19], v[76:79], v[60:63], v[16:19]
  v_mfma_f32_16x16x32_bf16 v[20:23], v[80:83], v[60:63], v[20:23]
  s_waitcnt lgkmcnt(6)
  v_mfma_f32_16x16x32_bf16 v[4:7], v[88:91], v[84:87], v[4:7]
  ds_read_b128 v[60:63], v239 offset:52224
  ds_read_b128 v[64:67], v232 offset:15360
  v_mfma_f32_16x16x32_bf16 v[8:11], v[92:95], v[84:87], v[8:11]
  ds_read_b128 v[68:71], v232 offset:16384
  ds_read_b128 v[72:75], v232 offset:17408
  v_mfma_f32_16x16x32_bf16 v[12:15], v[96:99], v[84:87], v[12:15]
  ds_read_b128 v[76:79], v232 offset:18432
  ds_read_b128 v[80:83], v232 offset:19456
  v_mfma_f32_16x16x32_bf16 v[16:19], v[100:103], v[84:87], v[16:19]
  v_mfma_f32_16x16x32_bf16 v[20:23], v[104:107], v[84:87], v[20:23]
  s_waitcnt lgkmcnt(0)
  s_barrier
  v_mfma_f32_16x16x32_bf16 v[4:7], v[112:115], v[108:111], v[4:7]
  ds_read_b128 v[84:87], v240 offset:0
  ds_read_b128 v[88:91], v232 offset:20480
  v_mfma_f32_16x16x32_bf16 v[8:11], v[116:119], v[108:111], v[8:11]
  ds_read_b128 v[92:95], v232 offset:21504
  ds_read_b128 v[96:99], v232 offset:22528
  v_mfma_f32_16x16x32_bf16 v[12:15], v[120:123], v[108:111], v[12:15]
  ds_read_b128 v[100:103], v232 offset:23552
  ds_read_b128 v[104:107], v232 offset:24576
  v_mfma_f32_16x16x32_bf16 v[16:19], v[124:127], v[108:111], v[16:19]
  v_mfma_f32_16x16x32_bf16 v[20:23], v[128:131], v[108:111], v[20:23]
  s_waitcnt lgkmcnt(6)
  v_mfma_f32_16x16x32_bf16 v[4:7], v[64:67], v[60:63], v[4:7]
  ds_read_b128 v[108:111], v240 offset:1024
  ds_read_b128 v[112:115], v232 offset:25600
  v_mfma_f32_16x16x32_bf16 v[8:11], v[68:71], v[60:63], v[8:11]
  ds_read_b128 v[116:119], v232 offset:26624
  ds_read_b128 v[120:123], v232 offset:27648
  v_mfma_f32_16x16x32_bf16 v[12:15], v[72:75], v[60:63], v[12:15]
  ds_read_b128 v[124:127], v232 offset:28672
  ds_read_b128 v[128:131], v232 offset:29696
  v_mfma_f32_16x16x32_bf16 v[16:19], v[76:79], v[60:63], v[16:19]
  v_mfma_f32_16x16x32_bf16 v[20:23], v[80:83], v[60:63], v[20:23]
  s_waitcnt lgkmcnt(6)
  v_mfma_f32_16x16x32_bf16 v[4:7], v[88:91], v[84:87], v[4:7]
  ds_read_b128 v[60:63], v240 offset:2048
  ds_read_b128 v[64:67], v232 offset:30720
  v_mfma_f32_16x16x32_bf16 v[8:11], v[92:95], v[84:87], v[8:11]
  ds_read_b128 v[68:71], v232 offset:31744
  ds_read_b128 v[72:75], v232 offset:32768
  v_mfma_f32_16x16x32_bf16 v[12:15], v[96:99], v[84:87], v[12:15]
  ds_read_b128 v[76:79], v232 offset:33792
  ds_read_b128 v[80:83], v232 offset:34816
  v_mfma_f32_16x16x32_bf16 v[16:19], v[100:103], v[84:87], v[16:19]
  v_mfma_f32_16x16x32_bf16 v[20:23], v[104:107], v[84:87], v[20:23]
  s_waitcnt lgkmcnt(6)
  v_mfma_f32_16x16x32_bf16 v[4:7], v[112:115], v[108:111], v[4:7]
  ds_read_b128 v[84:87], v240 offset:3072
  ds_read_b128 v[88:91], v232 offset:35840
  v_mfma_f32_16x16x32_bf16 v[8:11], v[116:119], v[108:111], v[8:11]
  ds_read_b128 v[92:95], v232 offset:36864
  ds_read_b128 v[96:99], v232 offset:37888
  v_mfma_f32_16x16x32_bf16 v[12:15], v[120:123], v[108:111], v[12:15]
  ds_read_b128 v[100:103], v232 offset:38912
  ds_read_b128 v[104:107], v232 offset:39936
  v_mfma_f32_16x16x32_bf16 v[16:19], v[124:127], v[108:111], v[16:19]
  v_mfma_f32_16x16x32_bf16 v[20:23], v[128:131], v[108:111], v[20:23]
  s_waitcnt lgkmcnt(0)
  s_barrier
  v_mfma_f32_16x16x32_bf16 v[4:7], v[64:67], v[60:63], v[4:7]
  ds_read_b128 v[108:111], v239 offset:0
  ds_read_b128 v[112:115], v232 offset:40960
  v_mfma_f32_16x16x32_bf16 v[8:11], v[68:71], v[60:63], v[8:11]
  ds_read_b128 v[116:119], v232 offset:41984
  ds_read_b128 v[120:123], v232 offset:43008
  v_mfma_f32_16x16x32_bf16 v[12:15], v[72:75], v[60:63], v[12:15]
  ds_read_b128 v[124:127], v232 offset:44032
  ds_read_b128 v[128:131], v232 offset:45056
  v_mfma_f32_16x16x32_bf16 v[16:19], v[76:79], v[60:63], v[16:19]
  v_mfma_f32_16x16x32_bf16 v[20:23], v[80:83], v[60:63], v[20:23]
  s_waitcnt lgkmcnt(6)
  v_mfma_f32_16x16x32_bf16 v[4:7], v[88:91], v[84:87], v[4:7]
  ds_read_b128 v[60:63], v239 offset:1024
  ds_read_b128 v[64:67], v232 offset:46080
  v_mfma_f32_16x16x32_bf16 v[8:11], v[92:95], v[84:87], v[8:11]
  ds_read_b128 v[68:71], v232 offset:47104
  ds_read_b128 v[72:75], v232 offset:48128
  v_mfma_f32_16x16x32_bf16 v[12:15], v[96:99], v[84:87], v[12:15]
  ds_read_b128 v[76:79], v232 offset:49152
  ds_read_b128 v[80:83], v232 offset:50176
  v_mfma_f32_16x16x32_bf16 v[16:19], v[100:103], v[84:87], v[16:19]
  v_mfma_f32_16x16x32_bf16 v[20:23], v[104:107], v[84:87], v[20:23]
  s_waitcnt lgkmcnt(6)
  v_mfma_f32_16x16x32_bf16 v[4:7], v[112:115], v[108:111], v[4:7]
  ds_read_b128 v[84:87], v239 offset:2048
  ds_read_b128 v[88:91], v232 offset:51200
  v_mfma_f32_16x16x32_bf16 v[8:11], v[116:119], v[108:111], v[8:11]
  ds_read_b128 v[92:95], v232 offset:52224
  ds_read_b128 v[96:99], v232 offset:53248
  v_mfma_f32_16x16x32_bf16 v[12:15], v[120:123], v[108:111], v[12:15]
  ds_read_b128 v[100:103], v232 offset:54272
  ds_read_b128 v[104:107], v232 offset:55296
  v_mfma_f32_16x16x32_bf16 v[16:19], v[124:127], v[108:111], v[16:19]
  v_mfma_f32_16x16x32_bf16 v[20:23], v[128:131], v[108:111], v[20:23]
  s_waitcnt lgkmcnt(6)
  v_mfma_f32_16x16x32_bf16 v[4:7], v[64:67], v[60:63], v[4:7]
  ds_read_b128 v[108:111], v239 offset:3072
  ds_read_b128 v[112:115], v232 offset:56320
  v_mfma_f32_16x16x32_bf16 v[8:11], v[68:71], v[60:63], v[8:11]
  ds_read_b128 v[116:119], v232 offset:57344
  ds_read_b128 v[120:123], v232 offset:58368
  v_mfma_f32_16x16x32_bf16 v[12:15], v[72:75], v[60:63], v[12:15]
  ds_read_b128 v[124:127], v232 offset:59392
  ds_read_b128 v[128:131], v232 offset:60416
  v_mfma_f32_16x16x32_bf16 v[16:19], v[76:79], v[60:63], v[16:19]
  v_mfma_f32_16x16x32_bf16 v[20:23], v[80:83], v[60:63], v[20:23]
  s_waitcnt lgkmcnt(0)
  s_barrier
  v_mfma_f32_16x16x32_bf16 v[4:7], v[88:91], v[84:87], v[4:7]
  ds_read_b128 v[60:63], v239 offset:16384
  ds_read_b128 v[64:67], v232 offset:61440
  v_mfma_f32_16x16x32_bf16 v[8:11], v[92:95], v[84:87], v[8:11]
  ds_read_b128 v[68:71], v232 offset:62464
  ds_read_b128 v[72:75], v232 offset:63488
  v_mfma_f32_16x16x32_bf16 v[12:15], v[96:99], v[84:87], v[12:15]
  ds_read_b128 v[76:79], v232 offset:64512
  ds_read_b128 v[80:83], v233 offset:0
  v_mfma_f32_16x16x32_bf16 v[16:19], v[100:103], v[84:87], v[16:19]
  v_mfma_f32_16x16x32_bf16 v[20:23], v[104:107], v[84:87], v[20:23]
  s_waitcnt lgkmcnt(6)
  v_mfma_f32_16x16x32_bf16 v[4:7], v[112:115], v[108:111], v[4:7]
  ds_read_b128 v[84:87], v239 offset:17408
  ds_read_b128 v[88:91], v233 offset:1024
  v_mfma_f32_16x16x32_bf16 v[8:11], v[116:119], v[108:111], v[8:11]
  ds_read_b128 v[92:95], v233 offset:2048
  ds_read_b128 v[96:99], v233 offset:3072
  v_mfma_f32_16x16x32_bf16 v[12:15], v[120:123], v[108:111], v[12:15]
  ds_read_b128 v[100:103], v233 offset:4096
  ds_read_b128 v[104:107], v233 offset:5120
  v_mfma_f32_16x16x32_bf16 v[16:19], v[124:127], v[108:111], v[16:19]
  v_mfma_f32_16x16x32_bf16 v[20:23], v[128:131], v[108:111], v[20:23]
  s_waitcnt lgkmcnt(6)
  v_mfma_f32_16x16x32_bf16 v[4:7], v[64:67], v[60:63], v[4:7]
  ds_read_b128 v[108:111], v239 offset:18432
  ds_read_b128 v[112:115], v233 offset:6144
  v_mfma_f32_16x16x32_bf16 v[8:11], v[68:71], v[60:63], v[8:11]
  ds_read_b128 v[116:119], v233 offset:7168
  ds_read_b128 v[120:123], v233 offset:8192
  v_mfma_f32_16x16x32_bf16 v[12:15], v[72:75], v[60:63], v[12:15]
  ds_read_b128 v[124:127], v233 offset:9216
  ds_read_b128 v[128:131], v233 offset:10240
  v_mfma_f32_16x16x32_bf16 v[16:19], v[76:79], v[60:63], v[16:19]
  v_mfma_f32_16x16x32_bf16 v[20:23], v[80:83], v[60:63], v[20:23]
  s_waitcnt lgkmcnt(6)
  v_mfma_f32_16x16x32_bf16 v[4:7], v[88:91], v[84:87], v[4:7]
  ds_read_b128 v[60:63], v239 offset:19456
  ds_read_b128 v[64:67], v233 offset:11264
  v_mfma_f32_16x16x32_bf16 v[8:11], v[92:95], v[84:87], v[8:11]
  ds_read_b128 v[68:71], v233 offset:12288
  ds_read_b128 v[72:75], v233 offset:13312
  v_mfma_f32_16x16x32_bf16 v[12:15], v[96:99], v[84:87], v[12:15]
  ds_read_b128 v[76:79], v233 offset:14336
  ds_read_b128 v[80:83], v233 offset:15360
  v_mfma_f32_16x16x32_bf16 v[16:19], v[100:103], v[84:87], v[16:19]
  v_mfma_f32_16x16x32_bf16 v[20:23], v[104:107], v[84:87], v[20:23]
  s_waitcnt lgkmcnt(0)
  s_barrier
  v_mfma_f32_16x16x32_bf16 v[4:7], v[112:115], v[108:111], v[4:7]
  ds_read_b128 v[84:87], v239 offset:32768
  ds_read_b128 v[88:91], v232 offset:0
  v_mfma_f32_16x16x32_bf16 v[8:11], v[116:119], v[108:111], v[8:11]
  ds_read_b128 v[92:95], v232 offset:1024
  ds_read_b128 v[96:99], v232 offset:2048
  v_mfma_f32_16x16x32_bf16 v[12:15], v[120:123], v[108:111], v[12:15]
  ds_read_b128 v[100:103], v232 offset:3072
  ds_read_b128 v[104:107], v232 offset:4096
  v_mfma_f32_16x16x32_bf16 v[16:19], v[124:127], v[108:111], v[16:19]
  v_mfma_f32_16x16x32_bf16 v[20:23], v[128:131], v[108:111], v[20:23]
  s_waitcnt lgkmcnt(6)
  v_mfma_f32_16x16x32_bf16 v[4:7], v[64:67], v[60:63], v[4:7]
  ds_read_b128 v[108:111], v239 offset:33792
  ds_read_b128 v[112:115], v232 offset:5120
  v_mfma_f32_16x16x32_bf16 v[8:11], v[68:71], v[60:63], v[8:11]
  ds_read_b128 v[116:119], v232 offset:6144
  ds_read_b128 v[120:123], v232 offset:7168
  v_mfma_f32_16x16x32_bf16 v[12:15], v[72:75], v[60:63], v[12:15]
  ds_read_b128 v[124:127], v232 offset:8192
  ds_read_b128 v[128:131], v232 offset:9216
  v_mfma_f32_16x16x32_bf16 v[16:19], v[76:79], v[60:63], v[16:19]
  v_mfma_f32_16x16x32_bf16 v[20:23], v[80:83], v[60:63], v[20:23]
  s_waitcnt lgkmcnt(6)
  v_mfma_f32_16x16x32_bf16 v[4:7], v[88:91], v[84:87], v[4:7]
  v_mfma_f32_16x16x32_bf16 v[8:11], v[92:95], v[84:87], v[8:11]
  v_mfma_f32_16x16x32_bf16 v[12:15], v[96:99], v[84:87], v[12:15]
  v_mfma_f32_16x16x32_bf16 v[16:19], v[100:103], v[84:87], v[16:19]
  v_mfma_f32_16x16x32_bf16 v[20:23], v[104:107], v[84:87], v[20:23]
  s_waitcnt lgkmcnt(0)
  v_mfma_f32_16x16x32_bf16 v[4:7], v[112:115], v[108:111], v[4:7]
  v_mfma_f32_16x16x32_bf16 v[8:11], v[116:119], v[108:111], v[8:11]
  v_mfma_f32_16x16x32_bf16 v[12:15], v[120:123], v[108:111], v[12:15]
  v_mfma_f32_16x16x32_bf16 v[16:19], v[124:127], v[108:111], v[16:19]
  v_mfma_f32_16x16x32_bf16 v[20:23], v[128:131], v[108:111], v[20:23]
  s_mov_b32 s12, s40
  s_and_b32 s13, s41, 0xffff
  s_mov_b32 s14, 0x280000
  s_mov_b32 s15, 0x20000
  v_fma_f32 v4, v4, v172, v132
  v_fma_f32 v5, v5, v173, v133
  v_fma_f32 v6, v6, v174, v134
  v_fma_f32 v7, v7, v175, v135
  v_cvt_pk_bf16_f32 v60, v4, v5
  v_cvt_pk_bf16_f32 v61, v6, v7
  buffer_store_dwordx2 v[60:61], v237, s[12:15], 0 offen offset:0
  v_fma_f32 v8, v8, v176, v136
  v_fma_f32 v9, v9, v177, v137
  v_fma_f32 v10, v10, v178, v138
  v_fma_f32 v11, v11, v179, v139
  v_cvt_pk_bf16_f32 v62, v8, v9
  v_cvt_pk_bf16_f32 v63, v10, v11
  buffer_store_dwordx2 v[62:63], v237, s[12:15], 0 offen offset:32
  v_fma_f32 v12, v12, v180, v140
  v_fma_f32 v13, v13, v181, v141
  v_fma_f32 v14, v14, v182, v142
  v_fma_f32 v15, v15, v183, v143
  v_cvt_pk_bf16_f32 v64, v12, v13
  v_cvt_pk_bf16_f32 v65, v14, v15
  buffer_store_dwordx2 v[64:65], v237, s[12:15], 0 offen offset:64
  v_fma_f32 v16, v16, v184, v144
  v_fma_f32 v17, v17, v185, v145
  v_fma_f32 v18, v18, v186, v146
  v_fma_f32 v19, v19, v187, v147
  v_cvt_pk_bf16_f32 v66, v16, v17
  v_cvt_pk_bf16_f32 v67, v18, v19
  buffer_store_dwordx2 v[66:67], v237, s[12:15], 0 offen offset:96
  v_fma_f32 v20, v20, v188, v148
  v_fma_f32 v21, v21, v189, v149
  v_fma_f32 v22, v22, v190, v150
  v_fma_f32 v23, v23, v191, v151
  v_cvt_pk_bf16_f32 v68, v20, v21
  v_cvt_pk_bf16_f32 v69, v22, v23
  buffer_store_dwordx2 v[68:69], v238, s[12:15], 0 offen offset:0
kb_end:
  s_endpgm
kb_kernel_slow_17:
  v_add_u32 v220, 0x680000, v236
  s_nop 4
  v_pk_fma_f32 v[20:21], v[20:21], v[224:225], v[188:189] op_sel_hi:[1,0,1]
  v_pk_fma_f32 v[22:23], v[22:23], v[224:225], v[190:191] op_sel_hi:[1,0,1]
  v_pk_fma_f32 v[4:5], v[4:5], v[224:225], v[172:173] op_sel_hi:[1,0,1]
  v_pk_fma_f32 v[6:7], v[6:7], v[224:225], v[174:175] op_sel_hi:[1,0,1]
  v_pk_fma_f32 v[8:9], v[8:9], v[224:225], v[176:177] op_sel_hi:[1,0,1]
  v_pk_fma_f32 v[10:11], v[10:11], v[224:225], v[178:179] op_sel_hi:[1,0,1]
  v_pk_mul_f32 v[100:101], v[20:21], v[20:21]
  v_pk_mul_f32 v[102:103], v[22:23], v[22:23]
  v_pk_mul_f32 v[104:105], v[4:5], v[4:5]
  v_pk_mul_f32 v[106:107], v[6:7], v[6:7]
  v_pk_mul_f32 v[108:109], v[8:9], v[8:9]
  v_pk_mul_f32 v[110:111], v[10:11], v[10:11]
  v_pk_fma_f32 v[100:101], v[100:101], s[44:45], v[230:231]
  v_pk_fma_f32 v[102:103], v[102:103], s[44:45], v[230:231]
  v_pk_fma_f32 v[104:105], v[104:105], s[44:45], v[230:231]
  v_pk_fma_f32 v[106:107], v[106:107], s[44:45], v[230:231]
  v_pk_fma_f32 v[108:109], v[108:109], s[44:45], v[230:231]
  v_pk_fma_f32 v[110:111], v[110:111], s[44:45], v[230:231]
  v_pk_mul_f32 v[100:101], v[100:101], v[20:21]
  v_pk_mul_f32 v[102:103], v[102:103], v[22:23]
  v_pk_mul_f32 v[104:105], v[104:105], v[4:5]
  v_pk_mul_f32 v[106:107], v[106:107], v[6:7]
  v_pk_mul_f32 v[108:109], v[108:109], v[8:9]
  v_pk_mul_f32 v[110:111], v[110:111], v[10:11]
  v_exp_f32 v100, v100
  v_exp_f32 v101, v101
  v_exp_f32 v102, v102
  v_exp_f32 v103, v103
  v_exp_f32 v104, v104
  v_exp_f32 v105, v105
  v_exp_f32 v106, v106
  v_exp_f32 v107, v107
  v_exp_f32 v108, v108
  v_exp_f32 v109, v109
  v_exp_f32 v110, v110
  v_exp_f32 v111, v111
  v_pk_add_f32 v[100:101], v[100:101], s[46:47]
  v_pk_add_f32 v[102:103], v[102:103], s[46:47]
  v_pk_add_f32 v[104:105], v[104:105], s[46:47]
  v_pk_add_f32 v[106:107], v[106:107], s[46:47]
  v_pk_add_f32 v[108:109], v[108:109], s[46:47]
  v_pk_add_f32 v[110:111], v[110:111], s[46:47]
  v_rcp_f32 v100, v100
  v_rcp_f32 v101, v101
  v_rcp_f32 v102, v102
  v_rcp_f32 v103, v103
  v_rcp_f32 v104, v104
  v_rcp_f32 v105, v105
  v_rcp_f32 v106, v106
  v_rcp_f32 v107, v107
  v_rcp_f32 v108, v108
  v_rcp_f32 v109, v109
  v_rcp_f32 v110, v110
  v_rcp_f32 v111, v111
  v_pk_mul_f32 v[20:21], v[20:21], v[100:101]
  v_pk_mul_f32 v[22:23], v[22:23], v[102:103]
  v_pk_mul_f32 v[4:5], v[4:5], v[104:105]
  v_pk_mul_f32 v[6:7], v[6:7], v[106:107]
  v_pk_mul_f32 v[8:9], v[8:9], v[108:109]
  v_pk_mul_f32 v[10:11], v[10:11], v[110:111]
  v_cvt_pk_bf16_f32 v68, v20, v21
  v_cvt_pk_bf16_f32 v69, v22, v23
  buffer_store_dwordx2 v[68:69], v220, s[8:11], s29 offen sc1
  v_cvt_pk_bf16_f32 v60, v4, v5
  v_cvt_pk_bf16_f32 v61, v6, v7
  v_cvt_pk_bf16_f32 v62, v8, v9
  v_cvt_pk_bf16_f32 v63, v10, v11
  buffer_store_dwordx4 v[60:63], v220, s[8:11], s28 offen offset:0 sc1
  v_pk_fma_f32 v[12:13], v[12:13], v[224:225], v[180:181] op_sel_hi:[1,0,1]
  v_pk_fma_f32 v[14:15], v[14:15], v[224:225], v[182:183] op_sel_hi:[1,0,1]
  v_pk_fma_f32 v[16:17], v[16:17], v[224:225], v[184:185] op_sel_hi:[1,0,1]
  v_pk_fma_f32 v[18:19], v[18:19], v[224:225], v[186:187] op_sel_hi:[1,0,1]
  v_pk_mul_f32 v[100:101], v[12:13], v[12:13]
  v_pk_mul_f32 v[102:103], v[14:15], v[14:15]
  v_pk_mul_f32 v[104:105], v[16:17], v[16:17]
  v_pk_mul_f32 v[106:107], v[18:19], v[18:19]
  v_pk_fma_f32 v[100:101], v[100:101], s[44:45], v[230:231]
  v_pk_fma_f32 v[102:103], v[102:103], s[44:45], v[230:231]
  v_pk_fma_f32 v[104:105], v[104:105], s[44:45], v[230:231]
  v_pk_fma_f32 v[106:107], v[106:107], s[44:45], v[230:231]
  v_pk_mul_f32 v[100:101], v[100:101], v[12:13]
  v_pk_mul_f32 v[102:103], v[102:103], v[14:15]
  v_pk_mul_f32 v[104:105], v[104:105], v[16:17]
  v_pk_mul_f32 v[106:107], v[106:107], v[18:19]
  v_exp_f32 v100, v100
  v_exp_f32 v101, v101
  v_exp_f32 v102, v102
  v_exp_f32 v103, v103
  v_exp_f32 v104, v104
  v_exp_f32 v105, v105
  v_exp_f32 v106, v106
  v_exp_f32 v107, v107
  v_pk_add_f32 v[100:101], v[100:101], s[46:47]
  v_pk_add_f32 v[102:103], v[102:103], s[46:47]
  v_pk_add_f32 v[104:105], v[104:105], s[46:47]
  v_pk_add_f32 v[106:107], v[106:107], s[46:47]
  v_rcp_f32 v100, v100
  v_rcp_f32 v101, v101
  v_rcp_f32 v102, v102
  v_rcp_f32 v103, v103
  v_rcp_f32 v104, v104
  v_rcp_f32 v105, v105
  v_rcp_f32 v106, v106
  v_rcp_f32 v107, v107
  v_pk_mul_f32 v[12:13], v[12:13], v[100:101]
  v_pk_mul_f32 v[14:15], v[14:15], v[102:103]
  v_pk_mul_f32 v[16:17], v[16:17], v[104:105]
  v_pk_mul_f32 v[18:19], v[18:19], v[106:107]
  v_cvt_pk_bf16_f32 v64, v12, v13
  v_cvt_pk_bf16_f32 v65, v14, v15
  v_cvt_pk_bf16_f32 v66, v16, v17
  v_cvt_pk_bf16_f32 v67, v18, v19
  buffer_store_dwordx4 v[64:67], v220, s[8:11], s28 offen offset:1024 sc1
  s_lshl_b32 s22, s27, 7
  s_lshl_b32 s23, s19, 3
  s_add_u32 s22, s22, s23
  s_add_u32 s22, s22, 0xe4000
  v_lshlrev_b32 v212, 7, v2
  v_add_u32 v212, s22, v212
  v_mov_b32 v213, 1
  s_waitcnt vmcnt(0)
  s_mov_b64 exec, 1
  buffer_store_dword v213, v212, s[8:11], 0 offen sc1
  s_mov_b64 exec, -1
  s_branch kb_kernel_fj_18
kb_end2:
kb_kernel_slow_11:
  s_lshl_b32 s24, s18, 3
  s_add_u32 s24, s24, s19
  s_xor_b32 s22, s24, 8
  s_mul_i32 s22, s22, 12
  s_add_u32 s22, s22, s17
  s_mul_i32 s22, s22, 5120
  s_add_u32 s22, s22, 0x1400000
  s_add_u32 s23, s22, 4096
  buffer_store_dwordx4 v[24:27], v1, s[8:11], s22 offen offset:0 sc1
  buffer_store_dwordx4 v[28:31], v1, s[8:11], s22 offen offset:1024 sc1
  buffer_store_dwordx4 v[32:35], v1, s[8:11], s22 offen offset:2048 sc1
  buffer_store_dwordx4 v[36:39], v1, s[8:11], s22 offen offset:3072 sc1
  buffer_store_dwordx4 v[40:43], v1, s[8:11], s23 offen offset:0 sc1
  v_add_u32 v212, 1, v2
  v_and_b32 v213, 1, v212
  v_lshlrev_b32 v213, 9, v213
  v_and_b32 v214, 2, v212
  v_lshl_add_u32 v213, v214, 3, v213
  s_lshl_b32 s22, s27, 7
  s_lshl_b32 s23, s19, 4
  s_add_u32 s22, s22, s23
  v_xor_b32 v213, s22, v213
  v_lshl_add_u32 v213, v212, 2, v213
  v_add_u32 v213, 0xf4000, v213
  v_min_u32 v212, 1, v212
  v_lshlrev_b32 v212, 2, v212
  s_add_u32 s22, s22, 0xf4000
  v_add_u32 v212, s22, v212
  v_mov_b32 v214, 1
  s_waitcnt vmcnt(0)
  s_mov_b64 exec, 1
  buffer_store_dword v214, v213, s[8:11], 0 offen sc1
  s_mov_b64 exec, -1
  s_branch kb_kernel_fj_12
kb_kernel_slow_15:
  v_add_u32 v221, 0x400000, v236
  v_pk_fma_f32 v[148:149], v[20:21], v[188:189], v[148:149]
  v_pk_fma_f32 v[150:151], v[22:23], v[190:191], v[150:151]
  v_pk_mul_f32 v[20:21], v[148:149], v[208:209]
  v_pk_mul_f32 v[22:23], v[150:151], v[210:211]
  v_cvt_pk_bf16_f32 v68, v20, v21
  v_cvt_pk_bf16_f32 v69, v22, v23
  buffer_store_dwordx2 v[68:69], v221, s[8:11], s29 offen sc1
  v_pk_fma_f32 v[132:133], v[4:5], v[172:173], v[132:133]
  v_pk_fma_f32 v[134:135], v[6:7], v[174:175], v[134:135]
  v_pk_mul_f32 v[4:5], v[132:133], v[192:193]
  v_pk_mul_f32 v[6:7], v[134:135], v[194:195]
  v_cvt_pk_bf16_f32 v60, v4, v5
  v_cvt_pk_bf16_f32 v61, v6, v7
  v_pk_fma_f32 v[136:137], v[8:9], v[176:177], v[136:137]
  v_pk_fma_f32 v[138:139], v[10:11], v[178:179], v[138:139]
  v_pk_mul_f32 v[8:9], v[136:137], v[196:197]
  v_pk_mul_f32 v[10:11], v[138:139], v[198:199]
  v_cvt_pk_bf16_f32 v62, v8, v9
  v_cvt_pk_bf16_f32 v63, v10, v11
  buffer_store_dwordx4 v[60:63], v221, s[8:11], s28 offen offset:0 sc1
  v_pk_fma_f32 v[140:141], v[12:13], v[180:181], v[140:141]
  v_pk_fma_f32 v[142:143], v[14:15], v[182:183], v[142:143]
  v_pk_mul_f32 v[12:13], v[140:141], v[200:201]
  v_pk_mul_f32 v[14:15], v[142:143], v[202:203]
  v_cvt_pk_bf16_f32 v64, v12, v13
  v_cvt_pk_bf16_f32 v65, v14, v15
  v_pk_fma_f32 v[144:145], v[16:17], v[184:185], v[144:145]
  v_pk_fma_f32 v[146:147], v[18:19], v[186:187], v[146:147]
  v_pk_mul_f32 v[16:17], v[144:145], v[204:205]
  v_pk_mul_f32 v[18:19], v[146:147], v[206:207]
  v_cvt_pk_bf16_f32 v66, v16, v17
  v_cvt_pk_bf16_f32 v67, v18, v19
  buffer_store_dwordx4 v[64:67], v221, s[8:11], s28 offen offset:1024 sc1
  v_pk_mul_f32 v[110:111], v[132:133], v[132:133]
  v_pk_mul_f32 v[114:115], v[4:5], v[4:5]
  v_pk_mul_f32 v[116:117], v[4:5], v[192:193]
  v_pk_mul_f32 v[118:119], v[4:5], v[152:153]
  v_pk_add_f32 v[108:109], v[132:133], v[134:135]
  v_pk_fma_f32 v[110:111], v[134:135], v[134:135], v[110:111]
  v_pk_add_f32 v[112:113], v[4:5], v[6:7]
  v_pk_fma_f32 v[114:115], v[6:7], v[6:7], v[114:115]
  v_pk_fma_f32 v[116:117], v[6:7], v[194:195], v[116:117]
  v_pk_fma_f32 v[118:119], v[6:7], v[154:155], v[118:119]
  v_pk_add_f32 v[108:109], v[108:109], v[136:137]
  v_pk_fma_f32 v[110:111], v[136:137], v[136:137], v[110:111]
  v_pk_add_f32 v[112:113], v[112:113], v[8:9]
  v_pk_fma_f32 v[114:115], v[8:9], v[8:9], v[114:115]
  v_pk_fma_f32 v[116:117], v[8:9], v[196:197], v[116:117]
  v_pk_fma_f32 v[118:119], v[8:9], v[156:157], v[118:119]
  v_pk_add_f32 v[108:109], v[108:109], v[138:139]
  v_pk_fma_f32 v[110:111], v[138:139], v[138:139], v[110:111]
  v_pk_add_f32 v[112:113], v[112:113], v[10:11]
  v_pk_fma_f32 v[114:115], v[10:11], v[10:11], v[114:115]
  v_pk_fma_f32 v[116:117], v[10:11], v[198:199], v[116:117]
  v_pk_fma_f32 v[118:119], v[10:11], v[158:159], v[118:119]
  v_pk_add_f32 v[108:109], v[108:109], v[140:141]
  v_pk_fma_f32 v[110:111], v[140:141], v[140:141], v[110:111]
  v_pk_add_f32 v[112:113], v[112:113], v[12:13]
  v_pk_fma_f32 v[114:115], v[12:13], v[12:13], v[114:115]
  v_pk_fma_f32 v[116:117], v[12:13], v[200:201], v[116:117]
  v_pk_fma_f32 v[118:119], v[12:13], v[160:161], v[118:119]
  v_pk_add_f32 v[108:109], v[108:109], v[142:143]
  v_pk_fma_f32 v[110:111], v[142:143], v[142:143], v[110:111]
  v_pk_add_f32 v[112:113], v[112:113], v[14:15]
  v_pk_fma_f32 v[114:115], v[14:15], v[14:15], v[114:115]
  v_pk_fma_f32 v[116:117], v[14:15], v[202:203], v[116:117]
  v_pk_fma_f32 v[118:119], v[14:15], v[162:163], v[118:119]
  v_pk_add_f32 v[108:109], v[108:109], v[144:145]
  v_pk_fma_f32 v[110:111], v[144:145], v[144:145], v[110:111]
  v_pk_add_f32 v[112:113], v[112:113], v[16:17]
  v_pk_fma_f32 v[114:115], v[16:17], v[16:17], v[114:115]
  v_pk_fma_f32 v[116:117], v[16:17], v[204:205], v[116:117]
  v_pk_fma_f32 v[118:119], v[16:17], v[164:165], v[118:119]
  v_pk_add_f32 v[108:109], v[108:109], v[146:147]
  v_pk_fma_f32 v[110:111], v[146:147], v[146:147], v[110:111]
  v_pk_add_f32 v[112:113], v[112:113], v[18:19]
  v_pk_fma_f32 v[114:115], v[18:19], v[18:19], v[114:115]
  v_pk_fma_f32 v[116:117], v[18:19], v[206:207], v[116:117]
  v_pk_fma_f32 v[118:119], v[18:19], v[166:167], v[118:119]
  v_pk_add_f32 v[108:109], v[108:109], v[148:149]
  v_pk_fma_f32 v[110:111], v[148:149], v[148:149], v[110:111]
  v_pk_add_f32 v[112:113], v[112:113], v[20:21]
  v_pk_fma_f32 v[114:115], v[20:21], v[20:21], v[114:115]
  v_pk_fma_f32 v[116:117], v[20:21], v[208:209], v[116:117]
  v_pk_fma_f32 v[118:119], v[20:21], v[168:169], v[118:119]
  v_pk_add_f32 v[108:109], v[108:109], v[150:151]
  v_pk_fma_f32 v[110:111], v[150:151], v[150:151], v[110:111]
  v_pk_add_f32 v[112:113], v[112:113], v[22:23]
  v_pk_fma_f32 v[114:115], v[22:23], v[22:23], v[114:115]
  v_pk_fma_f32 v[116:117], v[22:23], v[210:211], v[116:117]
  v_pk_fma_f32 v[118:119], v[22:23], v[170:171], v[118:119]
  v_add_f32 v100, v108, v109
  v_add_f32 v101, v110, v111
  v_add_f32 v102, v112, v113
  v_add_f32 v103, v114, v115
  v_add_f32 v104, v116, v117
  v_add_f32 v105, v118, v119
  v_mov_b32 v106, 0
  v_mov_b32 v107, 0
  v_and_b32 v222, 15, v2
  s_add_u32 s22, s27, 0
  s_lshl_b32 s22, s22, 4
  v_add_u32 v222, s22, v222
  v_mul_u32_u24 v222, 256, v222
  v_permlane16_swap_b32 v100, v101
  v_permlane16_swap_b32 v102, v103
  v_add_f32 v100, v100, v101
  v_add_f32 v102, v102, v103
  s_nop 1
  v_permlane32_swap_b32 v100, v102
  v_add_f32 v100, v100, v102
  v_permlane16_swap_b32 v104, v105
  v_permlane16_swap_b32 v106, v107
  v_add_f32 v104, v104, v105
  v_add_f32 v106, v106, v107
  s_nop 1
  v_permlane32_swap_b32 v104, v106
  v_add_f32 v104, v104, v106
  v_lshrrev_b32 v212, 4, v2
  v_lshl_add_u32 v222, v212, 2, v222
  s_lshl_b32 s22, s19, 5
  s_add_u32 s22, s22, 0x1240000
  buffer_store_dword v100, v222, s[8:11], s22 offen sc1
  buffer_store_dword v104, v222, s[8:11], s22 offen offset:16 sc1
  s_lshl_b32 s22, s27, 7
  s_lshl_b32 s23, s19, 3
  s_add_u32 s22, s22, s23
  s_add_u32 s22, s22, 0xe0000
  v_lshlrev_b32 v212, 7, v2
  v_add_u32 v212, s22, v212
  v_mov_b32 v213, 1
  s_waitcnt vmcnt(0)
  s_mov_b64 exec, 1
  buffer_store_dword v213, v212, s[8:11], 0 offen sc1
  s_mov_b64 exec, -1
  s_branch kb_kernel_fj_16
kb_kernel_slow_19:
  v_add_u32 v220, 0x900000, v236
  s_nop 4
  v_pk_add_f32 v[168:169], v[168:169], v[20:21]
  v_pk_add_f32 v[170:171], v[170:171], v[22:23]
  v_cvt_pk_bf16_f32 v68, v168, v169
  v_cvt_pk_bf16_f32 v69, v170, v171
  buffer_store_dwordx2 v[68:69], v220, s[8:11], s29 offen sc1
  v_pk_add_f32 v[152:153], v[152:153], v[4:5]
  v_pk_add_f32 v[154:155], v[154:155], v[6:7]
  v_cvt_pk_bf16_f32 v60, v152, v153
  v_cvt_pk_bf16_f32 v61, v154, v155
  v_pk_add_f32 v[156:157], v[156:157], v[8:9]
  v_pk_add_f32 v[158:159], v[158:159], v[10:11]
  v_cvt_pk_bf16_f32 v62, v156, v157
  v_cvt_pk_bf16_f32 v63, v158, v159
  buffer_store_dwordx4 v[60:63], v220, s[8:11], s28 offen offset:0 sc1
  v_pk_add_f32 v[160:161], v[160:161], v[12:13]
  v_pk_add_f32 v[162:163], v[162:163], v[14:15]
  v_cvt_pk_bf16_f32 v64, v160, v161
  v_cvt_pk_bf16_f32 v65, v162, v163
  v_pk_add_f32 v[164:165], v[164:165], v[16:17]
  v_pk_add_f32 v[166:167], v[166:167], v[18:19]
  v_cvt_pk_bf16_f32 v66, v164, v165
  v_cvt_pk_bf16_f32 v67, v166, v167
  buffer_store_dwordx4 v[64:67], v220, s[8:11], s28 offen offset:1024 sc1
  v_pk_mul_f32 v[110:111], v[152:153], v[152:153]
  v_pk_add_f32 v[108:109], v[152:153], v[154:155]
  v_pk_fma_f32 v[110:111], v[154:155], v[154:155], v[110:111]
  v_pk_add_f32 v[108:109], v[108:109], v[156:157]
  v_pk_fma_f32 v[110:111], v[156:157], v[156:157], v[110:111]
  v_pk_add_f32 v[108:109], v[108:109], v[158:159]
  v_pk_fma_f32 v[110:111], v[158:159], v[158:159], v[110:111]
  v_pk_add_f32 v[108:109], v[108:109], v[160:161]
  v_pk_fma_f32 v[110:111], v[160:161], v[160:161], v[110:111]
  v_pk_add_f32 v[108:109], v[108:109], v[162:163]
  v_pk_fma_f32 v[110:111], v[162:163], v[162:163], v[110:111]
  v_pk_add_f32 v[108:109], v[108:109], v[164:165]
  v_pk_fma_f32 v[110:111], v[164:165], v[164:165], v[110:111]
  v_pk_add_f32 v[108:109], v[108:109], v[166:167]
  v_pk_fma_f32 v[110:111], v[166:167], v[166:167], v[110:111]
  v_pk_add_f32 v[108:109], v[108:109], v[168:169]
  v_pk_fma_f32 v[110:111], v[168:169], v[168:169], v[110:111]
  v_pk_add_f32 v[108:109], v[108:109], v[170:171]
  v_pk_fma_f32 v[110:111], v[170:171], v[170:171], v[110:111]
  v_add_f32 v100, v108, v109
  v_add_f32 v101, v110, v111
  s_nop 1
  v_permlane16_swap_b32 v100, v101
  v_add_f32 v100, v100, v101
  v_mov_b32 v101, v100
  s_nop 1
  v_permlane32_swap_b32 v100, v101
  v_add_f32 v100, v100, v101
  v_and_b32 v222, 15, v2
  s_add_u32 s22, s27, 0
  s_lshl_b32 s22, s22, 4
  v_add_u32 v222, s22, v222
  v_mul_u32_u24 v222, 64, v222
  v_and_b32 v212, 16, v2
  v_lshrrev_b32 v212, 2, v212
  v_add_u32 v222, v222, v212
  s_lshl_b32 s22, s19, 3
  s_add_u32 s22, s22, 0x12d0000
  buffer_store_dword v100, v222, s[8:11], s22 offen sc1
  s_lshl_b32 s22, s27, 7
  s_lshl_b32 s23, s19, 3
  s_add_u32 s22, s22, s23
  s_add_u32 s22, s22, 0xe8000
  v_lshlrev_b32 v212, 7, v2
  v_add_u32 v212, s22, v212
  v_mov_b32 v213, 1
  s_waitcnt vmcnt(0)
  s_mov_b64 exec, 1
  buffer_store_dword v213, v212, s[8:11], 0 offen sc1
  s_mov_b64 exec, -1
  s_branch kb_kernel_fj_20
kb_kernel_slow_21:
  v_add_u32 v220, 0xb80000, v236
  v_add_u32 v221, 0xb8d800, v236
  s_nop 2
  v_pk_mul_f32 v[28:29], v[28:29], v[224:225] op_sel_hi:[1,0]
  v_pk_mul_f32 v[30:31], v[30:31], v[224:225] op_sel_hi:[1,0]
  v_pk_mul_f32 v[4:5], v[4:5], v[224:225] op_sel_hi:[1,0]
  v_pk_mul_f32 v[6:7], v[6:7], v[224:225] op_sel_hi:[1,0]
  v_pk_mul_f32 v[8:9], v[8:9], v[224:225] op_sel_hi:[1,0]
  v_pk_mul_f32 v[10:11], v[10:11], v[224:225] op_sel_hi:[1,0]
  v_pk_fma_f32 v[28:29], v[196:197], v[224:225], v[28:29] op_sel:[0,1,0] op_sel_hi:[1,1,1]
  v_pk_fma_f32 v[30:31], v[198:199], v[224:225], v[30:31] op_sel:[0,1,0] op_sel_hi:[1,1,1]
  v_pk_fma_f32 v[4:5], v[172:173], v[224:225], v[4:5] op_sel:[0,1,0] op_sel_hi:[1,1,1]
  v_pk_fma_f32 v[6:7], v[174:175], v[224:225], v[6:7] op_sel:[0,1,0] op_sel_hi:[1,1,1]
  v_pk_fma_f32 v[8:9], v[176:177], v[224:225], v[8:9] op_sel:[0,1,0] op_sel_hi:[1,1,1]
  v_pk_fma_f32 v[10:11], v[178:179], v[224:225], v[10:11] op_sel:[0,1,0] op_sel_hi:[1,1,1]
  v_pk_mul_f32 v[100:101], v[28:29], v[28:29]
  v_pk_mul_f32 v[102:103], v[30:31], v[30:31]
  v_pk_mul_f32 v[104:105], v[4:5], v[4:5]
  v_pk_mul_f32 v[106:107], v[6:7], v[6:7]
  v_pk_mul_f32 v[108:109], v[8:9], v[8:9]
  v_pk_mul_f32 v[110:111], v[10:11], v[10:11]
  v_pk_fma_f32 v[100:101], v[100:101], s[44:45], v[230:231]
  v_pk_fma_f32 v[102:103], v[102:103], s[44:45], v[230:231]
  v_pk_fma_f32 v[104:105], v[104:105], s[44:45], v[230:231]
  v_pk_fma_f32 v[106:107], v[106:107], s[44:45], v[230:231]
  v_pk_fma_f32 v[108:109], v[108:109], s[44:45], v[230:231]
  v_pk_fma_f32 v[110:111], v[110:111], s[44:45], v[230:231]
  v_pk_mul_f32 v[100:101], v[100:101], v[28:29]
  v_pk_mul_f32 v[102:103], v[102:103], v[30:31]
  v_pk_mul_f32 v[104:105], v[104:105], v[4:5]
  v_pk_mul_f32 v[106:107], v[106:107], v[6:7]
  v_pk_mul_f32 v[108:109], v[108:109], v[8:9]
  v_pk_mul_f32 v[110:111], v[110:111], v[10:11]
  v_exp_f32 v100, v100
  v_exp_f32 v101, v101
  v_exp_f32 v102, v102
  v_exp_f32 v103, v103
  v_exp_f32 v104, v104
  v_exp_f32 v105, v105
  v_exp_f32 v106, v106
  v_exp_f32 v107, v107
  v_exp_f32 v108, v108
  v_exp_f32 v109, v109
  v_exp_f32 v110, v110
  v_exp_f32 v111, v111
  v_pk_add_f32 v[100:101], v[100:101], s[46:47]
  v_pk_add_f32 v[102:103], v[102:103], s[46:47]
  v_pk_add_f32 v[104:105], v[104:105], s[46:47]
  v_pk_add_f32 v[106:107], v[106:107], s[46:47]
  v_pk_add_f32 v[108:109], v[108:109], s[46:47]
  v_pk_add_f32 v[110:111], v[110:111], s[46:47]
  v_rcp_f32 v100, v100
  v_rcp_f32 v101, v101
  v_rcp_f32 v102, v102
  v_rcp_f32 v103, v103
  v_rcp_f32 v104, v104
  v_rcp_f32 v105, v105
  v_rcp_f32 v106, v106
  v_rcp_f32 v107, v107
  v_rcp_f32 v108, v108
  v_rcp_f32 v109, v109
  v_rcp_f32 v110, v110
  v_rcp_f32 v111, v111
  v_pk_mul_f32 v[28:29], v[28:29], v[100:101]
  v_pk_mul_f32 v[30:31], v[30:31], v[102:103]
  v_pk_mul_f32 v[4:5], v[4:5], v[104:105]
  v_pk_mul_f32 v[6:7], v[6:7], v[106:107]
  v_pk_mul_f32 v[8:9], v[8:9], v[108:109]
  v_pk_mul_f32 v[10:11], v[10:11], v[110:111]
  v_cvt_pk_bf16_f32 v72, v28, v29
  v_cvt_pk_bf16_f32 v73, v30, v31
  buffer_store_dwordx2 v[72:73], v220, s[8:11], s29 offen sc1
  v_cvt_pk_bf16_f32 v60, v4, v5
  v_cvt_pk_bf16_f32 v61, v6, v7
  v_cvt_pk_bf16_f32 v62, v8, v9
  v_cvt_pk_bf16_f32 v63, v10, v11
  buffer_store_dwordx4 v[60:63], v220, s[8:11], s28 offen offset:0 sc1
  v_pk_mul_f32 v[12:13], v[12:13], v[224:225] op_sel_hi:[1,0]
  v_pk_mul_f32 v[14:15], v[14:15], v[224:225] op_sel_hi:[1,0]
  v_pk_mul_f32 v[16:17], v[16:17], v[224:225] op_sel_hi:[1,0]
  v_pk_mul_f32 v[18:19], v[18:19], v[224:225] op_sel_hi:[1,0]
  v_pk_fma_f32 v[12:13], v[180:181], v[224:225], v[12:13] op_sel:[0,1,0] op_sel_hi:[1,1,1]
  v_pk_fma_f32 v[14:15], v[182:183], v[224:225], v[14:15] op_sel:[0,1,0] op_sel_hi:[1,1,1]
  v_pk_fma_f32 v[16:17], v[184:185], v[224:225], v[16:17] op_sel:[0,1,0] op_sel_hi:[1,1,1]
  v_pk_fma_f32 v[18:19], v[186:187], v[224:225], v[18:19] op_sel:[0,1,0] op_sel_hi:[1,1,1]
  v_pk_mul_f32 v[100:101], v[12:13], v[12:13]
  v_pk_mul_f32 v[102:103], v[14:15], v[14:15]
  v_pk_mul_f32 v[104:105], v[16:17], v[16:17]
  v_pk_mul_f32 v[106:107], v[18:19], v[18:19]
  v_pk_fma_f32 v[100:101], v[100:101], s[44:45], v[230:231]
  v_pk_fma_f32 v[102:103], v[102:103], s[44:45], v[230:231]
  v_pk_fma_f32 v[104:105], v[104:105], s[44:45], v[230:231]
  v_pk_fma_f32 v[106:107], v[106:107], s[44:45], v[230:231]
  v_pk_mul_f32 v[100:101], v[100:101], v[12:13]
  v_pk_mul_f32 v[102:103], v[102:103], v[14:15]
  v_pk_mul_f32 v[104:105], v[104:105], v[16:17]
  v_pk_mul_f32 v[106:107], v[106:107], v[18:19]
  v_exp_f32 v100, v100
  v_exp_f32 v101, v101
  v_exp_f32 v102, v102
  v_exp_f32 v103, v103
  v_exp_f32 v104, v104
  v_exp_f32 v105, v105
  v_exp_f32 v106, v106
  v_exp_f32 v107, v107
  v_pk_add_f32 v[100:101], v[100:101], s[46:47]
  v_pk_add_f32 v[102:103], v[102:103], s[46:47]
  v_pk_add_f32 v[104:105], v[104:105], s[46:47]
  v_pk_add_f32 v[106:107], v[106:107], s[46:47]
  v_rcp_f32 v100, v100
  v_rcp_f32 v101, v101
  v_rcp_f32 v102, v102
  v_rcp_f32 v103, v103
  v_rcp_f32 v104, v104
  v_rcp_f32 v105, v105
  v_rcp_f32 v106, v106
  v_rcp_f32 v107, v107
  v_pk_mul_f32 v[12:13], v[12:13], v[100:101]
  v_pk_mul_f32 v[14:15], v[14:15], v[102:103]
  v_pk_mul_f32 v[16:17], v[16:17], v[104:105]
  v_pk_mul_f32 v[18:19], v[18:19], v[106:107]
  v_cvt_pk_bf16_f32 v64, v12, v13
  v_cvt_pk_bf16_f32 v65, v14, v15
  v_cvt_pk_bf16_f32 v66, v16, v17
  v_cvt_pk_bf16_f32 v67, v18, v19
  buffer_store_dwordx4 v[64:67], v220, s[8:11], s28 offen offset:1024 sc1
  v_pk_mul_f32 v[20:21], v[20:21], v[224:225] op_sel_hi:[1,0]
  v_pk_mul_f32 v[22:23], v[22:23], v[224:225] op_sel_hi:[1,0]
  v_pk_mul_f32 v[24:25], v[24:25], v[224:225] op_sel_hi:[1,0]
  v_pk_mul_f32 v[26:27], v[26:27], v[224:225] op_sel_hi:[1,0]
  v_pk_fma_f32 v[20:21], v[188:189], v[224:225], v[20:21] op_sel:[0,1,0] op_sel_hi:[1,1,1]
  v_pk_fma_f32 v[22:23], v[190:191], v[224:225], v[22:23] op_sel:[0,1,0] op_sel_hi:[1,1,1]
  v_pk_fma_f32 v[24:25], v[192:193], v[224:225], v[24:25] op_sel:[0,1,0] op_sel_hi:[1,1,1]
  v_pk_fma_f32 v[26:27], v[194:195], v[224:225], v[26:27] op_sel:[0,1,0] op_sel_hi:[1,1,1]
  v_pk_mul_f32 v[100:101], v[20:21], v[20:21]
  v_pk_mul_f32 v[102:103], v[22:23], v[22:23]
  v_pk_mul_f32 v[104:105], v[24:25], v[24:25]
  v_pk_mul_f32 v[106:107], v[26:27], v[26:27]
  v_pk_fma_f32 v[100:101], v[100:101], s[44:45], v[230:231]
  v_pk_fma_f32 v[102:103], v[102:103], s[44:45], v[230:231]
  v_pk_fma_f32 v[104:105], v[104:105], s[44:45], v[230:231]
  v_pk_fma_f32 v[106:107], v[106:107], s[44:45], v[230:231]
  v_pk_mul_f32 v[100:101], v[100:101], v[20:21]
  v_pk_mul_f32 v[102:103], v[102:103], v[22:23]
  v_pk_mul_f32 v[104:105], v[104:105], v[24:25]
  v_pk_mul_f32 v[106:107], v[106:107], v[26:27]
  v_exp_f32 v100, v100
  v_exp_f32 v101, v101
  v_exp_f32 v102, v102
  v_exp_f32 v103, v103
  v_exp_f32 v104, v104
  v_exp_f32 v105, v105
  v_exp_f32 v106, v106
  v_exp_f32 v107, v107
  v_pk_add_f32 v[100:101], v[100:101], s[46:47]
  v_pk_add_f32 v[102:103], v[102:103], s[46:47]
  v_pk_add_f32 v[104:105], v[104:105], s[46:47]
  v_pk_add_f32 v[106:107], v[106:107], s[46:47]
  v_rcp_f32 v100, v100
  v_rcp_f32 v101, v101
  v_rcp_f32 v102, v102
  v_rcp_f32 v103, v103
  v_rcp_f32 v104, v104
  v_rcp_f32 v105, v105
  v_rcp_f32 v106, v106
  v_rcp_f32 v107, v107
  v_pk_mul_f32 v[20:21], v[20:21], v[100:101]
  v_pk_mul_f32 v[22:23], v[22:23], v[102:103]
  v_pk_mul_f32 v[24:25], v[24:25], v[104:105]
  v_pk_mul_f32 v[26:27], v[26:27], v[106:107]
  v_cvt_pk_bf16_f32 v68, v20, v21
  v_cvt_pk_bf16_f32 v69, v22, v23
  v_cvt_pk_bf16_f32 v70, v24, v25
  v_cvt_pk_bf16_f32 v71, v26, v27
  buffer_store_dwordx4 v[68:71], v220, s[8:11], s28 offen offset:2048 sc1
  v_pk_mul_f32 v[56:57], v[56:57], v[226:227] op_sel_hi:[1,0]
  v_pk_mul_f32 v[58:59], v[58:59], v[226:227] op_sel_hi:[1,0]
  v_pk_mul_f32 v[32:33], v[32:33], v[226:227] op_sel_hi:[1,0]
  v_pk_mul_f32 v[34:35], v[34:35], v[226:227] op_sel_hi:[1,0]
  v_pk_mul_f32 v[36:37], v[36:37], v[226:227] op_sel_hi:[1,0]
  v_pk_mul_f32 v[38:39], v[38:39], v[226:227] op_sel_hi:[1,0]
  v_pk_fma_f32 v[56:57], v[196:197], v[226:227], v[56:57] op_sel:[0,1,0] op_sel_hi:[1,1,1]
  v_pk_fma_f32 v[58:59], v[198:199], v[226:227], v[58:59] op_sel:[0,1,0] op_sel_hi:[1,1,1]
  v_pk_fma_f32 v[32:33], v[172:173], v[226:227], v[32:33] op_sel:[0,1,0] op_sel_hi:[1,1,1]
  v_pk_fma_f32 v[34:35], v[174:175], v[226:227], v[34:35] op_sel:[0,1,0] op_sel_hi:[1,1,1]
  v_pk_fma_f32 v[36:37], v[176:177], v[226:227], v[36:37] op_sel:[0,1,0] op_sel_hi:[1,1,1]
  v_pk_fma_f32 v[38:39], v[178:179], v[226:227], v[38:39] op_sel:[0,1,0] op_sel_hi:[1,1,1]
  v_pk_mul_f32 v[100:101], v[56:57], v[56:57]
  v_pk_mul_f32 v[102:103], v[58:59], v[58:59]
  v_pk_mul_f32 v[104:105], v[32:33], v[32:33]
  v_pk_mul_f32 v[106:107], v[34:35], v[34:35]
  v_pk_mul_f32 v[108:109], v[36:37], v[36:37]
  v_pk_mul_f32 v[110:111], v[38:39], v[38:39]
  v_pk_fma_f32 v[100:101], v[100:101], s[44:45], v[230:231]
  v_pk_fma_f32 v[102:103], v[102:103], s[44:45], v[230:231]
  v_pk_fma_f32 v[104:105], v[104:105], s[44:45], v[230:231]
  v_pk_fma_f32 v[106:107], v[106:107], s[44:45], v[230:231]
  v_pk_fma_f32 v[108:109], v[108:109], s[44:45], v[230:231]
  v_pk_fma_f32 v[110:111], v[110:111], s[44:45], v[230:231]
  v_pk_mul_f32 v[100:101], v[100:101], v[56:57]
  v_pk_mul_f32 v[102:103], v[102:103], v[58:59]
  v_pk_mul_f32 v[104:105], v[104:105], v[32:33]
  v_pk_mul_f32 v[106:107], v[106:107], v[34:35]
  v_pk_mul_f32 v[108:109], v[108:109], v[36:37]
  v_pk_mul_f32 v[110:111], v[110:111], v[38:39]
  v_exp_f32 v100, v100
  v_exp_f32 v101, v101
  v_exp_f32 v102, v102
  v_exp_f32 v103, v103
  v_exp_f32 v104, v104
  v_exp_f32 v105, v105
  v_exp_f32 v106, v106
  v_exp_f32 v107, v107
  v_exp_f32 v108, v108
  v_exp_f32 v109, v109
  v_exp_f32 v110, v110
  v_exp_f32 v111, v111
  v_pk_add_f32 v[100:101], v[100:101], s[46:47]
  v_pk_add_f32 v[102:103], v[102:103], s[46:47]
  v_pk_add_f32 v[104:105], v[104:105], s[46:47]
  v_pk_add_f32 v[106:107], v[106:107], s[46:47]
  v_pk_add_f32 v[108:109], v[108:109], s[46:47]
  v_pk_add_f32 v[110:111], v[110:111], s[46:47]
  v_rcp_f32 v100, v100
  v_rcp_f32 v101, v101
  v_rcp_f32 v102, v102
  v_rcp_f32 v103, v103
  v_rcp_f32 v104, v104
  v_rcp_f32 v105, v105
  v_rcp_f32 v106, v106
  v_rcp_f32 v107, v107
  v_rcp_f32 v108, v108
  v_rcp_f32 v109, v109
  v_rcp_f32 v110, v110
  v_rcp_f32 v111, v111
  v_pk_mul_f32 v[56:57], v[56:57], v[100:101]
  v_pk_mul_f32 v[58:59], v[58:59], v[102:103]
  v_pk_mul_f32 v[32:33], v[32:33], v[104:105]
  v_pk_mul_f32 v[34:35], v[34:35], v[106:107]
  v_pk_mul_f32 v[36:37], v[36:37], v[108:109]
  v_pk_mul_f32 v[38:39], v[38:39], v[110:111]
  v_cvt_pk_bf16_f32 v88, v56, v57
  v_cvt_pk_bf16_f32 v89, v58, v59
  buffer_store_dwordx2 v[88:89], v221, s[8:11], s29 offen sc1
  v_cvt_pk_bf16_f32 v76, v32, v33
  v_cvt_pk_bf16_f32 v77, v34, v35
  v_cvt_pk_bf16_f32 v78, v36, v37
  v_cvt_pk_bf16_f32 v79, v38, v39
  buffer_store_dwordx4 v[76:79], v221, s[8:11], s28 offen offset:0 sc1
  v_pk_mul_f32 v[40:41], v[40:41], v[226:227] op_sel_hi:[1,0]
  v_pk_mul_f32 v[42:43], v[42:43], v[226:227] op_sel_hi:[1,0]
  v_pk_mul_f32 v[44:45], v[44:45], v[226:227] op_sel_hi:[1,0]
  v_pk_mul_f32 v[46:47], v[46:47], v[226:227] op_sel_hi:[1,0]
  v_pk_fma_f32 v[40:41], v[180:181], v[226:227], v[40:41] op_sel:[0,1,0] op_sel_hi:[1,1,1]
  v_pk_fma_f32 v[42:43], v[182:183], v[226:227], v[42:43] op_sel:[0,1,0] op_sel_hi:[1,1,1]
  v_pk_fma_f32 v[44:45], v[184:185], v[226:227], v[44:45] op_sel:[0,1,0] op_sel_hi:[1,1,1]
  v_pk_fma_f32 v[46:47], v[186:187], v[226:227], v[46:47] op_sel:[0,1,0] op_sel_hi:[1,1,1]
  v_pk_mul_f32 v[100:101], v[40:41], v[40:41]
  v_pk_mul_f32 v[102:103], v[42:43], v[42:43]
  v_pk_mul_f32 v[104:105], v[44:45], v[44:45]
  v_pk_mul_f32 v[106:107], v[46:47], v[46:47]
  v_pk_fma_f32 v[100:101], v[100:101], s[44:45], v[230:231]
  v_pk_fma_f32 v[102:103], v[102:103], s[44:45], v[230:231]
  v_pk_fma_f32 v[104:105], v[104:105], s[44:45], v[230:231]
  v_pk_fma_f32 v[106:107], v[106:107], s[44:45], v[230:231]
  v_pk_mul_f32 v[100:101], v[100:101], v[40:41]
  v_pk_mul_f32 v[102:103], v[102:103], v[42:43]
  v_pk_mul_f32 v[104:105], v[104:105], v[44:45]
  v_pk_mul_f32 v[106:107], v[106:107], v[46:47]
  v_exp_f32 v100, v100
  v_exp_f32 v101, v101
  v_exp_f32 v102, v102
  v_exp_f32 v103, v103
  v_exp_f32 v104, v104
  v_exp_f32 v105, v105
  v_exp_f32 v106, v106
  v_exp_f32 v107, v107
  v_pk_add_f32 v[100:101], v[100:101], s[46:47]
  v_pk_add_f32 v[102:103], v[102:103], s[46:47]
  v_pk_add_f32 v[104:105], v[104:105], s[46:47]
  v_pk_add_f32 v[106:107], v[106:107], s[46:47]
  v_rcp_f32 v100, v100
  v_rcp_f32 v101, v101
  v_rcp_f32 v102, v102
  v_rcp_f32 v103, v103
  v_rcp_f32 v104, v104
  v_rcp_f32 v105, v105
  v_rcp_f32 v106, v106
  v_rcp_f32 v107, v107
  v_pk_mul_f32 v[40:41], v[40:41], v[100:101]
  v_pk_mul_f32 v[42:43], v[42:43], v[102:103]
  v_pk_mul_f32 v[44:45], v[44:45], v[104:105]
  v_pk_mul_f32 v[46:47], v[46:47], v[106:107]
  v_cvt_pk_bf16_f32 v80, v40, v41
  v_cvt_pk_bf16_f32 v81, v42, v43
  v_cvt_pk_bf16_f32 v82, v44, v45
  v_cvt_pk_bf16_f32 v83, v46, v47
  buffer_store_dwordx4 v[80:83], v221, s[8:11], s28 offen offset:1024 sc1
  v_pk_mul_f32 v[48:49], v[48:49], v[226:227] op_sel_hi:[1,0]
  v_pk_mul_f32 v[50:51], v[50:51], v[226:227] op_sel_hi:[1,0]
  v_pk_mul_f32 v[52:53], v[52:53], v[226:227] op_sel_hi:[1,0]
  v_pk_mul_f32 v[54:55], v[54:55], v[226:227] op_sel_hi:[1,0]
  v_pk_fma_f32 v[48:49], v[188:189], v[226:227], v[48:49] op_sel:[0,1,0] op_sel_hi:[1,1,1]
  v_pk_fma_f32 v[50:51], v[190:191], v[226:227], v[50:51] op_sel:[0,1,0] op_sel_hi:[1,1,1]
  v_pk_fma_f32 v[52:53], v[192:193], v[226:227], v[52:53] op_sel:[0,1,0] op_sel_hi:[1,1,1]
  v_pk_fma_f32 v[54:55], v[194:195], v[226:227], v[54:55] op_sel:[0,1,0] op_sel_hi:[1,1,1]
  v_pk_mul_f32 v[100:101], v[48:49], v[48:49]
  v_pk_mul_f32 v[102:103], v[50:51], v[50:51]
  v_pk_mul_f32 v[104:105], v[52:53], v[52:53]
  v_pk_mul_f32 v[106:107], v[54:55], v[54:55]
  v_pk_fma_f32 v[100:101], v[100:101], s[44:45], v[230:231]
  v_pk_fma_f32 v[102:103], v[102:103], s[44:45], v[230:231]
  v_pk_fma_f32 v[104:105], v[104:105], s[44:45], v[230:231]
  v_pk_fma_f32 v[106:107], v[106:107], s[44:45], v[230:231]
  v_pk_mul_f32 v[100:101], v[100:101], v[48:49]
  v_pk_mul_f32 v[102:103], v[102:103], v[50:51]
  v_pk_mul_f32 v[104:105], v[104:105], v[52:53]
  v_pk_mul_f32 v[106:107], v[106:107], v[54:55]
  v_exp_f32 v100, v100
  v_exp_f32 v101, v101
  v_exp_f32 v102, v102
  v_exp_f32 v103, v103
  v_exp_f32 v104, v104
  v_exp_f32 v105, v105
  v_exp_f32 v106, v106
  v_exp_f32 v107, v107
  v_pk_add_f32 v[100:101], v[100:101], s[46:47]
  v_pk_add_f32 v[102:103], v[102:103], s[46:47]
  v_pk_add_f32 v[104:105], v[104:105], s[46:47]
  v_pk_add_f32 v[106:107], v[106:107], s[46:47]
  v_rcp_f32 v100, v100
  v_rcp_f32 v101, v101
  v_rcp_f32 v102, v102
  v_rcp_f32 v103, v103
  v_rcp_f32 v104, v104
  v_rcp_f32 v105, v105
  v_rcp_f32 v106, v106
  v_rcp_f32 v107, v107
  v_pk_mul_f32 v[48:49], v[48:49], v[100:101]
  v_pk_mul_f32 v[50:51], v[50:51], v[102:103]
  v_pk_mul_f32 v[52:53], v[52:53], v[104:105]
  v_pk_mul_f32 v[54:55], v[54:55], v[106:107]
  v_cvt_pk_bf16_f32 v84, v48, v49
  v_cvt_pk_bf16_f32 v85, v50, v51
  v_cvt_pk_bf16_f32 v86, v52, v53
  v_cvt_pk_bf16_f32 v87, v54, v55
  buffer_store_dwordx4 v[84:87], v221, s[8:11], s28 offen offset:2048 sc1
  s_lshl_b32 s22, s43, 7
  s_lshr_b32 s23, s17, 1
  s_lshl_b32 s23, s23, 2
  s_add_u32 s22, s22, s23
  s_lshl_b32 s23, s19, 3
  s_add_u32 s22, s22, s23
  s_add_u32 s22, s22, 0xec000
  v_lshlrev_b32 v212, 7, v2
  v_add_u32 v212, s22, v212
  v_mov_b32 v213, 1
  s_waitcnt vmcnt(0)
  s_mov_b64 exec, 3
  buffer_store_dword v213, v212, s[8:11], 0 offen sc1
  s_mov_b64 exec, -1
  s_branch kb_kernel_fj_22
.section .rodata,"a"
.p2align 6
.amdhsa_kernel ka_kernel
  .amdhsa_next_free_vgpr 256
  .amdhsa_next_free_sgpr 102
  .amdhsa_accum_offset 256
  .amdhsa_group_segment_fixed_size 0
  .amdhsa_kernarg_size 128
  .amdhsa_user_sgpr_count 2
  .amdhsa_user_sgpr_kernarg_segment_ptr 1
  .amdhsa_system_sgpr_workgroup_id_x 1
  .amdhsa_float_denorm_mode_32 3
.end_amdhsa_kernel
.section .rodata,"a"
.p2align 6
.amdhsa_kernel kb_kernel
  .amdhsa_next_free_vgpr 252
  .amdhsa_next_free_sgpr 53
  .amdhsa_accum_offset 252
  .amdhsa_group_segment_fixed_size 0
  .amdhsa_kernarg_size 128
  .amdhsa_user_sgpr_count 2
  .amdhsa_user_sgpr_kernarg_segment_ptr 1
  .amdhsa_system_sgpr_workgroup_id_x 1
  .amdhsa_float_denorm_mode_32 3
.end_amdhsa_kernel
```
